```python
import torch

def _softmax(x, axis=-1):
    return torch.softmax(x, dim=axis)
def _gelu(x):
    return torch.nn.functional.gelu(x, approximate="tanh")
def _silu(x):
    return torch.nn.functional.silu(x)
def _sigmoid(x):
    return torch.sigmoid(x)
def _layernorm(x, axis=-1, eps=1e-5):
    m = x.mean(dim=axis, keepdim=True)
    v = x.var(dim=axis, keepdim=True, unbiased=False)
    return (x - m) / torch.sqrt(v + eps)
def _scatter_add(tgt, idx, src, axis=0):
    return tgt.clone().index_add_(axis, idx, src)
def _segment_sum(src, seg, n):
    out = torch.zeros((n,) + src.shape[1:], dtype=src.dtype)
    return out.index_add_(0, seg, src)
def _pad(x, pw):
    flat = tuple(v for pair in reversed(pw) for v in pair)
    return torch.nn.functional.pad(x, flat)

kernel_name = 'recurrent_scan__mha_block_cached__dense_activation_squared_relu__prompt'

def setup_inputs():

    _w = (lambda a: (lambda t: t.to(torch.bfloat16) if t.is_floating_point() else t)(torch.as_tensor(a)))
    def _A_setup():
        B, Sq, D = 1, 2048, 640
        H, Sk, Dh = 32, 2048, 192
        return {
            "x": _w((lambda *s: torch.randn(*s, dtype=torch.bfloat16) * 0.05)(B, Sq, D)),
            "k_cache": _w((lambda *s: torch.randn(*s, dtype=torch.bfloat16) * 0.8)(B, H, Sk, Dh)),
            "v_cache": _w((lambda *s: torch.randn(*s, dtype=torch.bfloat16) * 0.2)(B, H, Sk, Dh)),
            "wq": _w((lambda *s: torch.randn(*s, dtype=torch.bfloat16) * 0.8)(D, H * Dh) * (D ** -0.5)),
            "wo": _w((lambda *s: torch.randn(*s, dtype=torch.bfloat16) * 0.2)(H * Dh, D) * ((H * Dh) ** -0.5)),
        }
    _A_in = _A_setup()

    def _B_setup():
        B, S, D, F = 1, 2048, 640, 1536
        return {
            "x": _w((lambda *s: torch.randn(*s, dtype=torch.bfloat16) * 0.05)(B, S, D)),
            "w1": _w((lambda *s: torch.randn(*s, dtype=torch.bfloat16) * 0.1)(D, F)),
            "b1": _w((lambda *s: torch.randn(*s, dtype=torch.bfloat16) * 0.8)(F)),
            "w2": _w((lambda *s: torch.randn(*s, dtype=torch.bfloat16) * 0.1)(F, D)),
            "b2": _w((lambda *s: torch.randn(*s, dtype=torch.bfloat16) * 12.8)(D)),
        }
    _B_in = _B_setup()

    return {
        "A_x": _A_in["x"],
        "A_k_cache": _A_in["k_cache"],
        "A_v_cache": _A_in["v_cache"],
        "A_wq": _A_in["wq"],
        "A_wo": _A_in["wo"],
        "B_x": _B_in["x"],
        "B_w1": _B_in["w1"],
        "B_b1": _B_in["b1"],
        "B_w2": _B_in["w2"],
        "B_b2": _B_in["b2"],
    }

def reference(A_x, A_k_cache, A_v_cache, A_wq, A_wo, B_x, B_w1, B_b1, B_w2, B_b2):
    def _A_ref(x, k_cache, v_cache, wq, wo):
        B, Sq, D = x.shape
        H, Dh = 32, 192
        q = (lambda x, *d: x.permute(*d))((x @ wq).reshape(B, Sq, H, Dh), 0, 2, 1, 3)
        scores = torch.einsum("bhqd,bhkd->bhqk", q, k_cache) * (Dh ** -0.5)
        p = _softmax(scores, axis=-1)
        o = torch.einsum("bhqk,bhkd->bhqd", p, v_cache)
        return (lambda x, *d: x.permute(*d))(o, 0, 2, 1, 3).reshape(B, Sq, H * Dh) @ wo

    def _B_ref(x, w1, b1, w2, b2):
        h = torch.einsum("bsd,df->bsf", x, w1) + b1
        zero = torch.zeros_like(h)
        r = torch.where(h > zero, h, zero)
        h = r * r
        out = torch.einsum("bsf,fd->bsd", h, w2) + b2
        return out

    x = A_x
    xn = _layernorm(x, axis=-1)
    s = _A_ref(xn, A_k_cache, A_v_cache, A_wq, A_wo)
    g = _silu(_B_ref(xn, B_w1, B_b1, B_w2, B_b2))
    return x + s * g
```

```asm
; @launch kernel=ln_kernel grid=(256,1,1) block=(256,1,1) lds=0
; @launch kernel=attn_kernel grid=(256,1,1) block=(256,1,1) lds=163840
; @launch kernel=oproj_kernel grid=(256,1,1) block=(256,1,1) lds=163840
; @launch kernel=recurrent_scan__mha_block_cached__dense_activation_squared_relu__prompt_kernel grid=(640,1,1) block=(256,1,1) lds=0
.amdgcn_target "amdgcn-amd-amdhsa--gfx950"
.text
.globl ln_kernel
.p2align 8
.type ln_kernel,@function
ln_kernel:
    s_cmp_ge_u32 s2, 128
    s_cbranch_scc1 K0_PF
    s_load_dwordx2 s[4:5], s[0:1], 0
    s_load_dwordx2 s[6:7], s[0:1], 96
    v_and_b32 v1, 15, v0
    v_lshrrev_b32 v2, 4, v0
    s_lshl_b32 s3, s2, 4
    v_add_u32 v3, s3, v2
    s_movk_i32 s30, 1280
    v_mul_lo_u32 v3, v3, s30
    v_lshl_add_u32 v3, v1, 4, v3
    s_mul_i32 s17, s2, 20480
    v_lshrrev_b32 v72, 2, v1
    v_lshlrev_b32 v72, 10, v72
    v_lshl_add_u32 v72, v2, 4, v72
    v_and_b32 v73, 1, v1
    v_lshl_add_u32 v72, v73, 9, v72
    v_bfe_u32 v73, v1, 1, 1
    v_lshl_add_u32 v72, v73, 3, v72
    v_add_u32 v72, s17, v72
    s_waitcnt lgkmcnt(0)
    s_mov_b32 s8, s4
    s_mov_b32 s9, s5
    s_mov_b32 s10, 2621440
    s_mov_b32 s11, 0x00020000
    s_mov_b32 s12, s6
    s_mov_b32 s13, s7
    s_mov_b32 s14, 2621440
    s_mov_b32 s15, 0x00020000
    buffer_load_dwordx4 v[4:7], v3, s[8:11], 0 offen offset:0
    buffer_load_dwordx4 v[8:11], v3, s[8:11], 0 offen offset:256
    buffer_load_dwordx4 v[12:15], v3, s[8:11], 0 offen offset:512
    buffer_load_dwordx4 v[16:19], v3, s[8:11], 0 offen offset:768
    buffer_load_dwordx4 v[20:23], v3, s[8:11], 0 offen offset:1024
    s_waitcnt vmcnt(0)
    v_lshlrev_b32 v32, 16, v4
    v_and_b32 v33, 0xffff0000, v4
    v_lshlrev_b32 v34, 16, v5
    v_and_b32 v35, 0xffff0000, v5
    v_lshlrev_b32 v36, 16, v6
    v_and_b32 v37, 0xffff0000, v6
    v_lshlrev_b32 v38, 16, v7
    v_and_b32 v39, 0xffff0000, v7
    v_lshlrev_b32 v40, 16, v8
    v_and_b32 v41, 0xffff0000, v8
    v_lshlrev_b32 v42, 16, v9
    v_and_b32 v43, 0xffff0000, v9
    v_lshlrev_b32 v44, 16, v10
    v_and_b32 v45, 0xffff0000, v10
    v_lshlrev_b32 v46, 16, v11
    v_and_b32 v47, 0xffff0000, v11
    v_lshlrev_b32 v48, 16, v12
    v_and_b32 v49, 0xffff0000, v12
    v_lshlrev_b32 v50, 16, v13
    v_and_b32 v51, 0xffff0000, v13
    v_lshlrev_b32 v52, 16, v14
    v_and_b32 v53, 0xffff0000, v14
    v_lshlrev_b32 v54, 16, v15
    v_and_b32 v55, 0xffff0000, v15
    v_lshlrev_b32 v56, 16, v16
    v_and_b32 v57, 0xffff0000, v16
    v_lshlrev_b32 v58, 16, v17
    v_and_b32 v59, 0xffff0000, v17
    v_lshlrev_b32 v60, 16, v18
    v_and_b32 v61, 0xffff0000, v18
    v_lshlrev_b32 v62, 16, v19
    v_and_b32 v63, 0xffff0000, v19
    v_lshlrev_b32 v64, 16, v20
    v_and_b32 v65, 0xffff0000, v20
    v_lshlrev_b32 v66, 16, v21
    v_and_b32 v67, 0xffff0000, v21
    v_lshlrev_b32 v68, 16, v22
    v_and_b32 v69, 0xffff0000, v22
    v_lshlrev_b32 v70, 16, v23
    v_and_b32 v71, 0xffff0000, v23
    v_add_f32 v3, v32, v33
    v_add_f32 v3, v3, v34
    v_add_f32 v3, v3, v35
    v_add_f32 v3, v3, v36
    v_add_f32 v3, v3, v37
    v_add_f32 v3, v3, v38
    v_add_f32 v3, v3, v39
    v_add_f32 v3, v3, v40
    v_add_f32 v3, v3, v41
    v_add_f32 v3, v3, v42
    v_add_f32 v3, v3, v43
    v_add_f32 v3, v3, v44
    v_add_f32 v3, v3, v45
    v_add_f32 v3, v3, v46
    v_add_f32 v3, v3, v47
    v_add_f32 v3, v3, v48
    v_add_f32 v3, v3, v49
    v_add_f32 v3, v3, v50
    v_add_f32 v3, v3, v51
    v_add_f32 v3, v3, v52
    v_add_f32 v3, v3, v53
    v_add_f32 v3, v3, v54
    v_add_f32 v3, v3, v55
    v_add_f32 v3, v3, v56
    v_add_f32 v3, v3, v57
    v_add_f32 v3, v3, v58
    v_add_f32 v3, v3, v59
    v_add_f32 v3, v3, v60
    v_add_f32 v3, v3, v61
    v_add_f32 v3, v3, v62
    v_add_f32 v3, v3, v63
    v_add_f32 v3, v3, v64
    v_add_f32 v3, v3, v65
    v_add_f32 v3, v3, v66
    v_add_f32 v3, v3, v67
    v_add_f32 v3, v3, v68
    v_add_f32 v3, v3, v69
    v_add_f32 v3, v3, v70
    v_add_f32 v3, v3, v71
    ds_swizzle_b32 v1, v3 offset:1055
    s_waitcnt lgkmcnt(0)
    v_add_f32 v3, v3, v1
    ds_swizzle_b32 v1, v3 offset:2079
    s_waitcnt lgkmcnt(0)
    v_add_f32 v3, v3, v1
    ds_swizzle_b32 v1, v3 offset:4127
    s_waitcnt lgkmcnt(0)
    v_add_f32 v3, v3, v1
    ds_swizzle_b32 v1, v3 offset:8223
    s_waitcnt lgkmcnt(0)
    v_add_f32 v3, v3, v1
    v_mul_f32 v3, 0x3acccccd, v3
    v_sub_f32 v32, v32, v3
    v_sub_f32 v33, v33, v3
    v_sub_f32 v34, v34, v3
    v_sub_f32 v35, v35, v3
    v_sub_f32 v36, v36, v3
    v_sub_f32 v37, v37, v3
    v_sub_f32 v38, v38, v3
    v_sub_f32 v39, v39, v3
    v_sub_f32 v40, v40, v3
    v_sub_f32 v41, v41, v3
    v_sub_f32 v42, v42, v3
    v_sub_f32 v43, v43, v3
    v_sub_f32 v44, v44, v3
    v_sub_f32 v45, v45, v3
    v_sub_f32 v46, v46, v3
    v_sub_f32 v47, v47, v3
    v_sub_f32 v48, v48, v3
    v_sub_f32 v49, v49, v3
    v_sub_f32 v50, v50, v3
    v_sub_f32 v51, v51, v3
    v_sub_f32 v52, v52, v3
    v_sub_f32 v53, v53, v3
    v_sub_f32 v54, v54, v3
    v_sub_f32 v55, v55, v3
    v_sub_f32 v56, v56, v3
    v_sub_f32 v57, v57, v3
    v_sub_f32 v58, v58, v3
    v_sub_f32 v59, v59, v3
    v_sub_f32 v60, v60, v3
    v_sub_f32 v61, v61, v3
    v_sub_f32 v62, v62, v3
    v_sub_f32 v63, v63, v3
    v_sub_f32 v64, v64, v3
    v_sub_f32 v65, v65, v3
    v_sub_f32 v66, v66, v3
    v_sub_f32 v67, v67, v3
    v_sub_f32 v68, v68, v3
    v_sub_f32 v69, v69, v3
    v_sub_f32 v70, v70, v3
    v_sub_f32 v71, v71, v3
    v_mul_f32 v3, v32, v32
    v_fmac_f32 v3, v33, v33
    v_fmac_f32 v3, v34, v34
    v_fmac_f32 v3, v35, v35
    v_fmac_f32 v3, v36, v36
    v_fmac_f32 v3, v37, v37
    v_fmac_f32 v3, v38, v38
    v_fmac_f32 v3, v39, v39
    v_fmac_f32 v3, v40, v40
    v_fmac_f32 v3, v41, v41
    v_fmac_f32 v3, v42, v42
    v_fmac_f32 v3, v43, v43
    v_fmac_f32 v3, v44, v44
    v_fmac_f32 v3, v45, v45
    v_fmac_f32 v3, v46, v46
    v_fmac_f32 v3, v47, v47
    v_fmac_f32 v3, v48, v48
    v_fmac_f32 v3, v49, v49
    v_fmac_f32 v3, v50, v50
    v_fmac_f32 v3, v51, v51
    v_fmac_f32 v3, v52, v52
    v_fmac_f32 v3, v53, v53
    v_fmac_f32 v3, v54, v54
    v_fmac_f32 v3, v55, v55
    v_fmac_f32 v3, v56, v56
    v_fmac_f32 v3, v57, v57
    v_fmac_f32 v3, v58, v58
    v_fmac_f32 v3, v59, v59
    v_fmac_f32 v3, v60, v60
    v_fmac_f32 v3, v61, v61
    v_fmac_f32 v3, v62, v62
    v_fmac_f32 v3, v63, v63
    v_fmac_f32 v3, v64, v64
    v_fmac_f32 v3, v65, v65
    v_fmac_f32 v3, v66, v66
    v_fmac_f32 v3, v67, v67
    v_fmac_f32 v3, v68, v68
    v_fmac_f32 v3, v69, v69
    v_fmac_f32 v3, v70, v70
    v_fmac_f32 v3, v71, v71
    ds_swizzle_b32 v1, v3 offset:1055
    s_waitcnt lgkmcnt(0)
    v_add_f32 v3, v3, v1
    ds_swizzle_b32 v1, v3 offset:2079
    s_waitcnt lgkmcnt(0)
    v_add_f32 v3, v3, v1
    ds_swizzle_b32 v1, v3 offset:4127
    s_waitcnt lgkmcnt(0)
    v_add_f32 v3, v3, v1
    ds_swizzle_b32 v1, v3 offset:8223
    s_waitcnt lgkmcnt(0)
    v_add_f32 v3, v3, v1
    v_mov_b32 v1, 0x3727c5ac
    v_fmac_f32 v1, 0x3acccccd, v3
    v_rsq_f32 v1, v1
    s_nop 1
    v_mul_f32 v32, v32, v1
    v_mul_f32 v33, v33, v1
    v_mul_f32 v34, v34, v1
    v_mul_f32 v35, v35, v1
    v_mul_f32 v36, v36, v1
    v_mul_f32 v37, v37, v1
    v_mul_f32 v38, v38, v1
    v_mul_f32 v39, v39, v1
    v_mul_f32 v40, v40, v1
    v_mul_f32 v41, v41, v1
    v_mul_f32 v42, v42, v1
    v_mul_f32 v43, v43, v1
    v_mul_f32 v44, v44, v1
    v_mul_f32 v45, v45, v1
    v_mul_f32 v46, v46, v1
    v_mul_f32 v47, v47, v1
    v_mul_f32 v48, v48, v1
    v_mul_f32 v49, v49, v1
    v_mul_f32 v50, v50, v1
    v_mul_f32 v51, v51, v1
    v_mul_f32 v52, v52, v1
    v_mul_f32 v53, v53, v1
    v_mul_f32 v54, v54, v1
    v_mul_f32 v55, v55, v1
    v_mul_f32 v56, v56, v1
    v_mul_f32 v57, v57, v1
    v_mul_f32 v58, v58, v1
    v_mul_f32 v59, v59, v1
    v_mul_f32 v60, v60, v1
    v_mul_f32 v61, v61, v1
    v_mul_f32 v62, v62, v1
    v_mul_f32 v63, v63, v1
    v_mul_f32 v64, v64, v1
    v_mul_f32 v65, v65, v1
    v_mul_f32 v66, v66, v1
    v_mul_f32 v67, v67, v1
    v_mul_f32 v68, v68, v1
    v_mul_f32 v69, v69, v1
    v_mul_f32 v70, v70, v1
    v_mul_f32 v71, v71, v1
    v_cvt_pk_bf16_f32 v4, v32, v33
    v_cvt_pk_bf16_f32 v5, v34, v35
    v_cvt_pk_bf16_f32 v6, v36, v37
    v_cvt_pk_bf16_f32 v7, v38, v39
    v_cvt_pk_bf16_f32 v8, v40, v41
    v_cvt_pk_bf16_f32 v9, v42, v43
    v_cvt_pk_bf16_f32 v10, v44, v45
    v_cvt_pk_bf16_f32 v11, v46, v47
    v_cvt_pk_bf16_f32 v12, v48, v49
    v_cvt_pk_bf16_f32 v13, v50, v51
    v_cvt_pk_bf16_f32 v14, v52, v53
    v_cvt_pk_bf16_f32 v15, v54, v55
    v_cvt_pk_bf16_f32 v16, v56, v57
    v_cvt_pk_bf16_f32 v17, v58, v59
    v_cvt_pk_bf16_f32 v18, v60, v61
    v_cvt_pk_bf16_f32 v19, v62, v63
    v_cvt_pk_bf16_f32 v20, v64, v65
    v_cvt_pk_bf16_f32 v21, v66, v67
    v_cvt_pk_bf16_f32 v22, v68, v69
    v_cvt_pk_bf16_f32 v23, v70, v71
    buffer_store_dwordx2 v[4:5], v72, s[12:15], 0 offen
    buffer_store_dwordx2 v[6:7], v72, s[12:15], 0 offen offset:256
    v_add_u32 v72, 4096, v72
    buffer_store_dwordx2 v[8:9], v72, s[12:15], 0 offen
    buffer_store_dwordx2 v[10:11], v72, s[12:15], 0 offen offset:256
    v_add_u32 v72, 4096, v72
    buffer_store_dwordx2 v[12:13], v72, s[12:15], 0 offen
    buffer_store_dwordx2 v[14:15], v72, s[12:15], 0 offen offset:256
    v_add_u32 v72, 4096, v72
    buffer_store_dwordx2 v[16:17], v72, s[12:15], 0 offen
    buffer_store_dwordx2 v[18:19], v72, s[12:15], 0 offen offset:256
    v_add_u32 v72, 4096, v72
    buffer_store_dwordx2 v[20:21], v72, s[12:15], 0 offen
    buffer_store_dwordx2 v[22:23], v72, s[12:15], 0 offen offset:256
    s_endpgm
K0_PF:
    s_cmp_ge_u32 s2, 256
    s_cbranch_scc1 K0_DONE
    s_load_dwordx2 s[20:21], s[0:1], 24
    s_load_dwordx2 s[22:23], s[0:1], 48
    s_sub_u32 s3, s2, 128
    v_lshlrev_b32 v74, 4, v0
    s_mul_i32 s28, s3, 61440
    v_add_u32 v75, s28, v74
    s_waitcnt lgkmcnt(0)
    s_mov_b32 s16, s20
    s_mov_b32 s17, s21
    s_mov_b32 s18, 7864320
    s_mov_b32 s19, 0x00020000
    s_mov_b32 s24, s22
    s_mov_b32 s25, s23
    s_mov_b32 s26, 1966080
    s_mov_b32 s27, 0x00020000
    buffer_load_dwordx4 v[76:79], v75, s[16:19], 0 offen
    v_add_u32 v75, 4096, v75
    buffer_load_dwordx4 v[80:83], v75, s[16:19], 0 offen
    v_add_u32 v75, 4096, v75
    buffer_load_dwordx4 v[84:87], v75, s[16:19], 0 offen
    v_add_u32 v75, 4096, v75
    buffer_load_dwordx4 v[88:91], v75, s[16:19], 0 offen
    v_add_u32 v75, 4096, v75
    buffer_load_dwordx4 v[76:79], v75, s[16:19], 0 offen
    v_add_u32 v75, 4096, v75
    buffer_load_dwordx4 v[80:83], v75, s[16:19], 0 offen
    v_add_u32 v75, 4096, v75
    buffer_load_dwordx4 v[84:87], v75, s[16:19], 0 offen
    v_add_u32 v75, 4096, v75
    buffer_load_dwordx4 v[88:91], v75, s[16:19], 0 offen
    v_add_u32 v75, 4096, v75
    buffer_load_dwordx4 v[76:79], v75, s[16:19], 0 offen
    v_add_u32 v75, 4096, v75
    buffer_load_dwordx4 v[80:83], v75, s[16:19], 0 offen
    v_add_u32 v75, 4096, v75
    buffer_load_dwordx4 v[84:87], v75, s[16:19], 0 offen
    v_add_u32 v75, 4096, v75
    buffer_load_dwordx4 v[88:91], v75, s[16:19], 0 offen
    v_add_u32 v75, 4096, v75
    buffer_load_dwordx4 v[76:79], v75, s[16:19], 0 offen
    v_add_u32 v75, 4096, v75
    buffer_load_dwordx4 v[80:83], v75, s[16:19], 0 offen
    v_add_u32 v75, 4096, v75
    buffer_load_dwordx4 v[84:87], v75, s[16:19], 0 offen
    v_add_u32 v75, 4096, v75
    s_mul_i32 s28, s3, 15360
    v_add_u32 v75, s28, v74
    buffer_load_dwordx4 v[76:79], v75, s[24:27], 0 offen
    v_add_u32 v75, 4096, v75
    buffer_load_dwordx4 v[80:83], v75, s[24:27], 0 offen
    v_add_u32 v75, 4096, v75
    buffer_load_dwordx4 v[84:87], v75, s[24:27], 0 offen
    v_add_u32 v75, 4096, v75
    buffer_load_dwordx4 v[88:91], v75, s[24:27], 0 offen
    v_add_u32 v75, 4096, v75
K0_DONE:
    s_endpgm
.section .rodata,"a"
.p2align 6
.amdhsa_kernel ln_kernel
  .amdhsa_next_free_vgpr 96
  .amdhsa_next_free_sgpr 100
  .amdhsa_accum_offset 96
  .amdhsa_group_segment_fixed_size 0
  .amdhsa_kernarg_size 104
  .amdhsa_user_sgpr_count 2
  .amdhsa_user_sgpr_kernarg_segment_ptr 1
  .amdhsa_system_sgpr_workgroup_id_x 1
.end_amdhsa_kernel
.text
.globl attn_kernel
.p2align 8
.type attn_kernel,@function
attn_kernel:
s_cmp_ge_u32 s2, 256
s_cbranch_scc1 K1_DONE
s_load_dwordx4 s[52:55], s[0:1], 8
s_load_dwordx2 s[56:57], s[0:1], 24
s_load_dwordx4 s[60:63], s[0:1], 48
s_load_dwordx2 s[58:59], s[0:1], 96
s_and_b32 s3, s2, 7
s_lshr_b32 s4, s2, 3
s_lshl_b32 s3, s3, 2
s_lshr_b32 s5, s4, 3
s_add_u32 s3, s3, s5
s_and_b32 s4, s4, 7
v_lshrrev_b32 v2, 6, v0
v_and_b32 v1, 63, v0
s_nop 0
v_readfirstlane_b32 s5, v2
s_waitcnt lgkmcnt(0)
s_mov_b32 s8, s58
s_mov_b32 s9, s59
s_mov_b32 s10, 2621440
s_mov_b32 s11, 0x00020000
s_mov_b32 s12, s56
s_mov_b32 s13, s57
s_mov_b32 s14, 7864320
s_mov_b32 s15, 0x00020000
s_mov_b32 s16, s60
s_mov_b32 s17, s61
s_mov_b32 s18, 1966080
s_mov_b32 s19, 0x00020000
s_mov_b32 s20, s52
s_mov_b32 s21, s53
s_mov_b32 s22, 25165824
s_mov_b32 s23, 0x00020000
s_sub_u32 s24, s54, 12288
s_subb_u32 s25, s55, 0
s_mov_b32 s26, 25178112
s_mov_b32 s27, 0x00020000
s_add_u32 s28, s58, 4194304
s_addc_u32 s29, s59, 0
s_mov_b32 s30, 25165824
s_mov_b32 s31, 0x00020000
s_add_u32 s32, s58, 33554432
s_addc_u32 s33, s59, 0
s_mov_b32 s34, 6291456
s_mov_b32 s35, 0x00020000
s_mov_b32 s36, s62
s_mov_b32 s37, s63
s_mov_b32 s38, 3072
s_mov_b32 s39, 0x00020000
s_lshl_b32 s6, s4, 4
s_lshl_b32 s7, s5, 2
s_add_u32 s74, s6, s7
s_mul_i32 s7, s74, 20480
v_lshlrev_b32 v35, 4, v1
v_add_u32 v2, s7, v35
s_mov_b32 s75, 0
s_mul_i32 s6, s5, 192
v_add_u32 v36, s6, v1
v_mul_u32_u24 v37, 2731, v36
v_lshrrev_b32 v37, 16, v37
v_mul_u32_u24 v38, 24, v37
v_sub_u32 v38, v36, v38
v_bfe_u32 v39, v37, 1, 2
v_lshlrev_b32 v39, 1, v39
v_xor_b32 v39, v39, v38
v_lshlrev_b32 v39, 4, v39
v_mul_u32_u24 v40, 12288, v37
v_add_u32 v40, v40, v39
v_subrev_u32 v4, 0, v40
v_mul_u32_u24 v40, 384, v37
v_add_u32 v40, v40, v39
v_subrev_u32 v25, 0, v40
v_bfe_u32 v39, v37, 1, 3
v_xor_b32 v39, v39, v38
v_lshlrev_b32 v39, 4, v39
v_mul_u32_u24 v40, 384, v37
v_add_u32 v40, v40, v39
v_subrev_u32 v22, 0, v40
v_add_u32 v36, s6, v1
v_add_u32 v36, 64, v36
v_mul_u32_u24 v37, 2731, v36
v_lshrrev_b32 v37, 16, v37
v_mul_u32_u24 v38, 24, v37
v_sub_u32 v38, v36, v38
v_bfe_u32 v39, v37, 1, 2
v_lshlrev_b32 v39, 1, v39
v_xor_b32 v39, v39, v38
v_lshlrev_b32 v39, 4, v39
v_mul_u32_u24 v40, 12288, v37
v_add_u32 v40, v40, v39
v_subrev_u32 v5, 1024, v40
v_mul_u32_u24 v40, 384, v37
v_add_u32 v40, v40, v39
v_subrev_u32 v26, 1024, v40
v_bfe_u32 v39, v37, 1, 3
v_xor_b32 v39, v39, v38
v_lshlrev_b32 v39, 4, v39
v_mul_u32_u24 v40, 384, v37
v_add_u32 v40, v40, v39
v_subrev_u32 v23, 1024, v40
v_add_u32 v36, s6, v1
v_add_u32 v36, 128, v36
v_mul_u32_u24 v37, 2731, v36
v_lshrrev_b32 v37, 16, v37
v_mul_u32_u24 v38, 24, v37
v_sub_u32 v38, v36, v38
v_bfe_u32 v39, v37, 1, 2
v_lshlrev_b32 v39, 1, v39
v_xor_b32 v39, v39, v38
v_lshlrev_b32 v39, 4, v39
v_mul_u32_u24 v40, 12288, v37
v_add_u32 v40, v40, v39
v_subrev_u32 v6, 2048, v40
v_mul_u32_u24 v40, 384, v37
v_add_u32 v40, v40, v39
v_subrev_u32 v27, 2048, v40
v_bfe_u32 v39, v37, 1, 3
v_xor_b32 v39, v39, v38
v_lshlrev_b32 v39, 4, v39
v_mul_u32_u24 v40, 384, v37
v_add_u32 v40, v40, v39
v_subrev_u32 v24, 2048, v40
s_lshl_b32 s6, s5, 6
v_add_u32 v36, s6, v1
v_lshrrev_b32 v37, 3, v36
v_and_b32 v38, 7, v36
v_bfe_u32 v39, v37, 1, 2
v_lshlrev_b32 v39, 1, v39
v_xor_b32 v39, v39, v38
v_lshlrev_b32 v39, 4, v39
v_mul_u32_u24 v40, 3072, v37
v_add_u32 v7, v40, v39
v_lshrrev_b32 v36, 4, v1
v_bfe_u32 v37, v1, 2, 2
v_bfe_u32 v38, v1, 1, 1
v_and_b32 v39, 1, v1
v_and_b32 v40, 1, v36
v_lshlrev_b32 v40, 1, v40
v_lshrrev_b32 v41, 1, v37
v_add_u32 v40, v40, v41
v_lshlrev_b32 v41, 4, v38
v_lshl_add_u32 v41, v39, 3, v41
v_lshl_add_u32 v42, v36, 2, v37
v_mul_u32_u24 v43, 384, v42
v_add_u32 v43, v43, v41
v_lshlrev_b32 v44, 7, v42
v_add_u32 v44, v44, v41
v_add_u32 v44, 110592, v44
v_xor_b32 v45, 0, v40
v_lshl_add_u32 v8, v45, 5, v43
v_add_u32 v18, 73728, v8
v_add_u32 v8, 98304, v8
v_lshl_add_u32 v12, v45, 5, v44
v_xor_b32 v45, 1, v40
v_lshl_add_u32 v9, v45, 5, v43
v_add_u32 v19, 73728, v9
v_add_u32 v9, 98304, v9
v_lshl_add_u32 v13, v45, 5, v44
v_xor_b32 v45, 2, v40
v_lshl_add_u32 v10, v45, 5, v43
v_add_u32 v20, 73728, v10
v_add_u32 v10, 98304, v10
v_lshl_add_u32 v14, v45, 5, v44
v_xor_b32 v45, 3, v40
v_lshl_add_u32 v11, v45, 5, v43
v_add_u32 v21, 73728, v11
v_add_u32 v11, 98304, v11
v_and_b32 v37, 15, v1
v_bfe_u32 v38, v1, 1, 3
v_xor_b32 v38, v38, v36
v_mul_u32_u24 v39, 384, v37
v_add_u32 v39, 0, v39
v_xor_b32 v40, 0, v38
v_lshl_add_u32 v16, v40, 4, v39
v_xor_b32 v40, 4, v38
v_lshl_add_u32 v17, v40, 4, v39
s_mul_i32 s40, s3, 384
s_mul_i32 s41, s3, 96
s_mul_i32 s42, s3, 786432
s_mov_b32 s43, s42
s_mul_i32 s44, s5, 3072
s_lshl_b32 s45, s5, 10
s_add_u32 s45, s45, 12288
s_add_u32 s46, s44, 0
s_add_u32 s47, s44, 73728
s_mov_b32 s49, 0
s_mov_b32 s64, 0xff800000
s_mov_b32 s66, 0xff800000
s_add_u32 m0, s44, 98304
s_nop 0
buffer_load_dwordx4 v4, s[12:15], s40 offen offset:0 lds
buffer_load_dwordx4 v5, s[12:15], s40 offen offset:1024 lds
buffer_load_dwordx4 v6, s[12:15], s40 offen offset:2048 lds
s_add_u32 m0, s45, 98304
s_add_u32 s40, s40, 393216
buffer_load_dwordx4 v7, s[16:19], s41 offen lds
s_add_u32 s41, s41, 98304
s_add_u32 s6, s75, 0
buffer_load_dwordx4 v[192:195], v2, s[8:11], s6 offen
s_add_u32 s6, s75, 20480
buffer_load_dwordx4 v[196:199], v2, s[8:11], s6 offen
s_add_u32 s6, s75, 40960
buffer_load_dwordx4 v[200:203], v2, s[8:11], s6 offen
s_add_u32 s6, s75, 61440
buffer_load_dwordx4 v[204:207], v2, s[8:11], s6 offen
s_add_u32 s75, s75, 1024
s_add_u32 m0, s44, 114688
s_nop 0
buffer_load_dwordx4 v4, s[12:15], s40 offen offset:0 lds
buffer_load_dwordx4 v5, s[12:15], s40 offen offset:1024 lds
buffer_load_dwordx4 v6, s[12:15], s40 offen offset:2048 lds
s_add_u32 m0, s45, 114688
s_add_u32 s40, s40, 393216
buffer_load_dwordx4 v7, s[16:19], s41 offen lds
s_add_u32 s41, s41, 98304
s_add_u32 s6, s75, 0
buffer_load_dwordx4 v[208:211], v2, s[8:11], s6 offen
s_add_u32 s6, s75, 20480
buffer_load_dwordx4 v[212:215], v2, s[8:11], s6 offen
s_add_u32 s6, s75, 40960
buffer_load_dwordx4 v[216:219], v2, s[8:11], s6 offen
s_add_u32 s6, s75, 61440
buffer_load_dwordx4 v[220:223], v2, s[8:11], s6 offen
s_add_u32 s75, s75, 1024
s_add_u32 m0, s44, 131072
s_nop 0
buffer_load_dwordx4 v4, s[12:15], s40 offen offset:0 lds
buffer_load_dwordx4 v5, s[12:15], s40 offen offset:1024 lds
buffer_load_dwordx4 v6, s[12:15], s40 offen offset:2048 lds
s_add_u32 m0, s45, 131072
s_add_u32 s40, s40, 393216
buffer_load_dwordx4 v7, s[16:19], s41 offen lds
s_add_u32 s41, s41, 98304
v_lshrrev_b32 v116, 4, v1
v_lshlrev_b32 v116, 3, v116
s_mul_i32 s6, s3, 96
buffer_load_dwordx2 v[240:241], v116, s[36:39], s6 offen offset:0
buffer_load_dwordx2 v[242:243], v116, s[36:39], s6 offen offset:32
buffer_load_dwordx2 v[244:245], v116, s[36:39], s6 offen offset:64
s_waitcnt vmcnt(19)
s_barrier
ds_read_b64_tr_b16 v[160:161], v8 offset:0
ds_read_b64_tr_b16 v[162:163], v8 offset:6144
ds_read_b64_tr_b16 v[164:165], v9 offset:0
ds_read_b64_tr_b16 v[166:167], v9 offset:6144
s_waitcnt vmcnt(11)
s_barrier
s_waitcnt lgkmcnt(2)
v_mfma_f32_16x16x32_bf16 a[0:3], v[160:163], v[192:195], 0
ds_read_b64_tr_b16 v[168:169], v10 offset:0
v_mfma_f32_16x16x32_bf16 a[4:7], v[160:163], v[196:199], 0
ds_read_b64_tr_b16 v[170:171], v10 offset:6144
v_mfma_f32_16x16x32_bf16 a[8:11], v[160:163], v[200:203], 0
s_add_u32 m0, s44, 147456
v_mfma_f32_16x16x32_bf16 a[12:15], v[160:163], v[204:207], 0
s_waitcnt lgkmcnt(2)
buffer_load_dwordx4 v4, s[12:15], s40 offen offset:0 lds
v_mfma_f32_16x16x32_bf16 a[16:19], v[164:167], v[192:195], 0
ds_read_b64_tr_b16 v[172:173], v11 offset:0
v_mfma_f32_16x16x32_bf16 a[20:23], v[164:167], v[196:199], 0
ds_read_b64_tr_b16 v[174:175], v11 offset:6144
v_mfma_f32_16x16x32_bf16 a[24:27], v[164:167], v[200:203], 0
buffer_load_dwordx4 v5, s[12:15], s40 offen offset:1024 lds
v_mfma_f32_16x16x32_bf16 a[28:31], v[164:167], v[204:207], 0
s_waitcnt lgkmcnt(2)
buffer_load_dwordx4 v6, s[12:15], s40 offen offset:2048 lds
v_mfma_f32_16x16x32_bf16 a[32:35], v[168:171], v[192:195], 0
ds_read_b64_tr_b16 v[176:177], v8 offset:128
v_mfma_f32_16x16x32_bf16 a[36:39], v[168:171], v[196:199], 0
ds_read_b64_tr_b16 v[178:179], v8 offset:6272
v_mfma_f32_16x16x32_bf16 a[40:43], v[168:171], v[200:203], 0
s_add_u32 m0, s45, 147456
s_add_u32 s40, s40, 393216
v_mfma_f32_16x16x32_bf16 a[44:47], v[168:171], v[204:207], 0
s_waitcnt lgkmcnt(2)
buffer_load_dwordx4 v7, s[16:19], s41 offen lds
s_add_u32 s41, s41, 98304
v_mfma_f32_16x16x32_bf16 a[48:51], v[172:175], v[192:195], 0
ds_read_b64_tr_b16 v[180:181], v9 offset:128
v_mfma_f32_16x16x32_bf16 a[52:55], v[172:175], v[196:199], 0
ds_read_b64_tr_b16 v[182:183], v9 offset:6272
v_mfma_f32_16x16x32_bf16 a[56:59], v[172:175], v[200:203], 0
s_add_u32 s6, s75, 0
buffer_load_dwordx4 v[224:227], v2, s[8:11], s6 offen
v_mfma_f32_16x16x32_bf16 a[60:63], v[172:175], v[204:207], 0
s_waitcnt lgkmcnt(2)
v_mfma_f32_16x16x32_bf16 a[64:67], v[176:179], v[192:195], 0
ds_read_b64_tr_b16 v[184:185], v10 offset:128
v_mfma_f32_16x16x32_bf16 a[68:71], v[176:179], v[196:199], 0
ds_read_b64_tr_b16 v[186:187], v10 offset:6272
v_mfma_f32_16x16x32_bf16 a[72:75], v[176:179], v[200:203], 0
s_add_u32 s6, s75, 20480
buffer_load_dwordx4 v[228:231], v2, s[8:11], s6 offen
v_mfma_f32_16x16x32_bf16 a[76:79], v[176:179], v[204:207], 0
s_waitcnt lgkmcnt(2)
v_mfma_f32_16x16x32_bf16 a[80:83], v[180:183], v[192:195], 0
ds_read_b64_tr_b16 v[188:189], v11 offset:128
v_mfma_f32_16x16x32_bf16 a[84:87], v[180:183], v[196:199], 0
ds_read_b64_tr_b16 v[190:191], v11 offset:6272
v_mfma_f32_16x16x32_bf16 a[88:91], v[180:183], v[200:203], 0
s_add_u32 s6, s75, 40960
buffer_load_dwordx4 v[232:235], v2, s[8:11], s6 offen
v_mfma_f32_16x16x32_bf16 a[92:95], v[180:183], v[204:207], 0
s_waitcnt lgkmcnt(2)
v_mfma_f32_16x16x32_bf16 a[96:99], v[184:187], v[192:195], 0
ds_read_b64_tr_b16 v[160:161], v8 offset:256
v_mfma_f32_16x16x32_bf16 a[100:103], v[184:187], v[196:199], 0
ds_read_b64_tr_b16 v[162:163], v8 offset:6400
v_mfma_f32_16x16x32_bf16 a[104:107], v[184:187], v[200:203], 0
s_add_u32 s6, s75, 61440
buffer_load_dwordx4 v[236:239], v2, s[8:11], s6 offen
v_mfma_f32_16x16x32_bf16 a[108:111], v[184:187], v[204:207], 0
s_waitcnt lgkmcnt(2)
v_mfma_f32_16x16x32_bf16 a[112:115], v[188:191], v[192:195], 0
ds_read_b64_tr_b16 v[164:165], v9 offset:256
v_mfma_f32_16x16x32_bf16 a[116:119], v[188:191], v[196:199], 0
ds_read_b64_tr_b16 v[166:167], v9 offset:6400
v_mfma_f32_16x16x32_bf16 a[120:123], v[188:191], v[200:203], 0
s_add_u32 s75, s75, 1024
v_mfma_f32_16x16x32_bf16 a[124:127], v[188:191], v[204:207], 0
s_waitcnt lgkmcnt(2)
v_mfma_f32_16x16x32_bf16 a[128:131], v[160:163], v[192:195], 0
ds_read_b64_tr_b16 v[168:169], v10 offset:256
v_mfma_f32_16x16x32_bf16 a[132:135], v[160:163], v[196:199], 0
ds_read_b64_tr_b16 v[170:171], v10 offset:6400
v_mfma_f32_16x16x32_bf16 a[136:139], v[160:163], v[200:203], 0
v_mfma_f32_16x16x32_bf16 a[140:143], v[160:163], v[204:207], 0
s_waitcnt lgkmcnt(2)
v_mfma_f32_16x16x32_bf16 a[144:147], v[164:167], v[192:195], 0
ds_read_b64_tr_b16 v[172:173], v11 offset:256
v_mfma_f32_16x16x32_bf16 a[148:151], v[164:167], v[196:199], 0
ds_read_b64_tr_b16 v[174:175], v11 offset:6400
v_mfma_f32_16x16x32_bf16 a[152:155], v[164:167], v[200:203], 0
v_mfma_f32_16x16x32_bf16 a[156:159], v[164:167], v[204:207], 0
s_waitcnt lgkmcnt(2)
v_mfma_f32_16x16x32_bf16 a[160:163], v[168:171], v[192:195], 0
ds_read_b64_tr_b16 v[176:177], v12 offset:0
v_mfma_f32_16x16x32_bf16 a[164:167], v[168:171], v[196:199], 0
ds_read_b64_tr_b16 v[178:179], v12 offset:2048
v_mfma_f32_16x16x32_bf16 a[168:171], v[168:171], v[200:203], 0
v_mfma_f32_16x16x32_bf16 a[172:175], v[168:171], v[204:207], 0
s_waitcnt lgkmcnt(2)
v_mfma_f32_16x16x32_bf16 a[176:179], v[172:175], v[192:195], 0
ds_read_b64_tr_b16 v[180:181], v13 offset:0
v_mfma_f32_16x16x32_bf16 a[180:183], v[172:175], v[196:199], 0
ds_read_b64_tr_b16 v[182:183], v13 offset:2048
v_mfma_f32_16x16x32_bf16 a[184:187], v[172:175], v[200:203], 0
v_mfma_f32_16x16x32_bf16 a[188:191], v[172:175], v[204:207], 0
s_waitcnt lgkmcnt(2)
v_mfma_f32_16x16x32_bf16 a[192:195], v[176:179], v[192:195], 0
ds_read_b64_tr_b16 v[184:185], v14 offset:0
v_mfma_f32_16x16x32_bf16 a[196:199], v[176:179], v[196:199], 0
ds_read_b64_tr_b16 v[186:187], v14 offset:2048
v_mfma_f32_16x16x32_bf16 a[200:203], v[176:179], v[200:203], 0
v_mfma_f32_16x16x32_bf16 a[204:207], v[176:179], v[204:207], 0
s_waitcnt lgkmcnt(2)
v_mfma_f32_16x16x32_bf16 a[208:211], v[180:183], v[192:195], 0
ds_read_b64_tr_b16 v[188:189], v8 offset:16384
v_mfma_f32_16x16x32_bf16 a[212:215], v[180:183], v[196:199], 0
ds_read_b64_tr_b16 v[190:191], v8 offset:22528
v_mfma_f32_16x16x32_bf16 a[216:219], v[180:183], v[200:203], 0
v_mfma_f32_16x16x32_bf16 a[220:223], v[180:183], v[204:207], 0
s_waitcnt lgkmcnt(2)
v_mfma_f32_16x16x32_bf16 a[224:227], v[184:187], v[192:195], 0
ds_read_b64_tr_b16 v[160:161], v9 offset:16384
v_mfma_f32_16x16x32_bf16 a[228:231], v[184:187], v[196:199], 0
ds_read_b64_tr_b16 v[162:163], v9 offset:22528
v_mfma_f32_16x16x32_bf16 a[232:235], v[184:187], v[200:203], 0
v_mfma_f32_16x16x32_bf16 a[236:239], v[184:187], v[204:207], 0
s_waitcnt vmcnt(15) lgkmcnt(2)
v_mfma_f32_16x16x32_bf16 a[0:3], v[188:191], v[208:211], a[0:3]
s_waitcnt vmcnt(11)
s_barrier
ds_read_b64_tr_b16 v[164:165], v10 offset:16384
v_mfma_f32_16x16x32_bf16 a[4:7], v[188:191], v[212:215], a[4:7]
ds_read_b64_tr_b16 v[166:167], v10 offset:22528
v_mfma_f32_16x16x32_bf16 a[8:11], v[188:191], v[216:219], a[8:11]
s_add_u32 m0, s44, 98304
v_mfma_f32_16x16x32_bf16 a[12:15], v[188:191], v[220:223], a[12:15]
s_waitcnt lgkmcnt(2)
buffer_load_dwordx4 v4, s[12:15], s40 offen offset:0 lds
v_mfma_f32_16x16x32_bf16 a[16:19], v[160:163], v[208:211], a[16:19]
ds_read_b64_tr_b16 v[168:169], v11 offset:16384
v_mfma_f32_16x16x32_bf16 a[20:23], v[160:163], v[212:215], a[20:23]
ds_read_b64_tr_b16 v[170:171], v11 offset:22528
v_mfma_f32_16x16x32_bf16 a[24:27], v[160:163], v[216:219], a[24:27]
buffer_load_dwordx4 v5, s[12:15], s40 offen offset:1024 lds
v_mfma_f32_16x16x32_bf16 a[28:31], v[160:163], v[220:223], a[28:31]
s_waitcnt lgkmcnt(2)
buffer_load_dwordx4 v6, s[12:15], s40 offen offset:2048 lds
v_mfma_f32_16x16x32_bf16 a[32:35], v[164:167], v[208:211], a[32:35]
ds_read_b64_tr_b16 v[172:173], v8 offset:16512
v_mfma_f32_16x16x32_bf16 a[36:39], v[164:167], v[212:215], a[36:39]
ds_read_b64_tr_b16 v[174:175], v8 offset:22656
v_mfma_f32_16x16x32_bf16 a[40:43], v[164:167], v[216:219], a[40:43]
s_add_u32 m0, s45, 98304
s_add_u32 s40, s40, 393216
v_mfma_f32_16x16x32_bf16 a[44:47], v[164:167], v[220:223], a[44:47]
s_waitcnt lgkmcnt(2)
buffer_load_dwordx4 v7, s[16:19], s41 offen lds
s_add_u32 s41, s41, 98304
v_mfma_f32_16x16x32_bf16 a[48:51], v[168:171], v[208:211], a[48:51]
ds_read_b64_tr_b16 v[176:177], v9 offset:16512
v_mfma_f32_16x16x32_bf16 a[52:55], v[168:171], v[212:215], a[52:55]
ds_read_b64_tr_b16 v[178:179], v9 offset:22656
v_mfma_f32_16x16x32_bf16 a[56:59], v[168:171], v[216:219], a[56:59]
s_add_u32 s6, s75, 0
buffer_load_dwordx4 v[192:195], v2, s[8:11], s6 offen
v_mfma_f32_16x16x32_bf16 a[60:63], v[168:171], v[220:223], a[60:63]
s_waitcnt lgkmcnt(2)
v_mfma_f32_16x16x32_bf16 a[64:67], v[172:175], v[208:211], a[64:67]
ds_read_b64_tr_b16 v[180:181], v10 offset:16512
v_mfma_f32_16x16x32_bf16 a[68:71], v[172:175], v[212:215], a[68:71]
ds_read_b64_tr_b16 v[182:183], v10 offset:22656
v_mfma_f32_16x16x32_bf16 a[72:75], v[172:175], v[216:219], a[72:75]
s_add_u32 s6, s75, 20480
buffer_load_dwordx4 v[196:199], v2, s[8:11], s6 offen
v_mfma_f32_16x16x32_bf16 a[76:79], v[172:175], v[220:223], a[76:79]
s_waitcnt lgkmcnt(2)
v_mfma_f32_16x16x32_bf16 a[80:83], v[176:179], v[208:211], a[80:83]
ds_read_b64_tr_b16 v[184:185], v11 offset:16512
v_mfma_f32_16x16x32_bf16 a[84:87], v[176:179], v[212:215], a[84:87]
ds_read_b64_tr_b16 v[186:187], v11 offset:22656
v_mfma_f32_16x16x32_bf16 a[88:91], v[176:179], v[216:219], a[88:91]
s_add_u32 s6, s75, 40960
buffer_load_dwordx4 v[200:203], v2, s[8:11], s6 offen
v_mfma_f32_16x16x32_bf16 a[92:95], v[176:179], v[220:223], a[92:95]
s_waitcnt lgkmcnt(2)
v_mfma_f32_16x16x32_bf16 a[96:99], v[180:183], v[208:211], a[96:99]
ds_read_b64_tr_b16 v[188:189], v8 offset:16640
v_mfma_f32_16x16x32_bf16 a[100:103], v[180:183], v[212:215], a[100:103]
ds_read_b64_tr_b16 v[190:191], v8 offset:22784
v_mfma_f32_16x16x32_bf16 a[104:107], v[180:183], v[216:219], a[104:107]
s_add_u32 s6, s75, 61440
buffer_load_dwordx4 v[204:207], v2, s[8:11], s6 offen
v_mfma_f32_16x16x32_bf16 a[108:111], v[180:183], v[220:223], a[108:111]
s_waitcnt lgkmcnt(2)
v_mfma_f32_16x16x32_bf16 a[112:115], v[184:187], v[208:211], a[112:115]
ds_read_b64_tr_b16 v[160:161], v9 offset:16640
v_mfma_f32_16x16x32_bf16 a[116:119], v[184:187], v[212:215], a[116:119]
ds_read_b64_tr_b16 v[162:163], v9 offset:22784
v_mfma_f32_16x16x32_bf16 a[120:123], v[184:187], v[216:219], a[120:123]
s_add_u32 s75, s75, 1024
v_mfma_f32_16x16x32_bf16 a[124:127], v[184:187], v[220:223], a[124:127]
s_waitcnt lgkmcnt(2)
v_mfma_f32_16x16x32_bf16 a[128:131], v[188:191], v[208:211], a[128:131]
ds_read_b64_tr_b16 v[164:165], v10 offset:16640
v_mfma_f32_16x16x32_bf16 a[132:135], v[188:191], v[212:215], a[132:135]
ds_read_b64_tr_b16 v[166:167], v10 offset:22784
v_mfma_f32_16x16x32_bf16 a[136:139], v[188:191], v[216:219], a[136:139]
v_mfma_f32_16x16x32_bf16 a[140:143], v[188:191], v[220:223], a[140:143]
s_waitcnt lgkmcnt(2)
v_mfma_f32_16x16x32_bf16 a[144:147], v[160:163], v[208:211], a[144:147]
ds_read_b64_tr_b16 v[168:169], v11 offset:16640
v_mfma_f32_16x16x32_bf16 a[148:151], v[160:163], v[212:215], a[148:151]
ds_read_b64_tr_b16 v[170:171], v11 offset:22784
v_mfma_f32_16x16x32_bf16 a[152:155], v[160:163], v[216:219], a[152:155]
v_mfma_f32_16x16x32_bf16 a[156:159], v[160:163], v[220:223], a[156:159]
s_waitcnt lgkmcnt(2)
v_mfma_f32_16x16x32_bf16 a[160:163], v[164:167], v[208:211], a[160:163]
ds_read_b64_tr_b16 v[172:173], v12 offset:16384
v_mfma_f32_16x16x32_bf16 a[164:167], v[164:167], v[212:215], a[164:167]
ds_read_b64_tr_b16 v[174:175], v12 offset:18432
v_mfma_f32_16x16x32_bf16 a[168:171], v[164:167], v[216:219], a[168:171]
v_mfma_f32_16x16x32_bf16 a[172:175], v[164:167], v[220:223], a[172:175]
s_waitcnt lgkmcnt(2)
v_mfma_f32_16x16x32_bf16 a[176:179], v[168:171], v[208:211], a[176:179]
ds_read_b64_tr_b16 v[176:177], v13 offset:16384
v_mfma_f32_16x16x32_bf16 a[180:183], v[168:171], v[212:215], a[180:183]
ds_read_b64_tr_b16 v[178:179], v13 offset:18432
v_mfma_f32_16x16x32_bf16 a[184:187], v[168:171], v[216:219], a[184:187]
v_mfma_f32_16x16x32_bf16 a[188:191], v[168:171], v[220:223], a[188:191]
s_waitcnt lgkmcnt(2)
v_mfma_f32_16x16x32_bf16 a[192:195], v[172:175], v[208:211], a[192:195]
ds_read_b64_tr_b16 v[180:181], v14 offset:16384
v_mfma_f32_16x16x32_bf16 a[196:199], v[172:175], v[212:215], a[196:199]
ds_read_b64_tr_b16 v[182:183], v14 offset:18432
v_mfma_f32_16x16x32_bf16 a[200:203], v[172:175], v[216:219], a[200:203]
v_mfma_f32_16x16x32_bf16 a[204:207], v[172:175], v[220:223], a[204:207]
s_waitcnt lgkmcnt(2)
v_mfma_f32_16x16x32_bf16 a[208:211], v[176:179], v[208:211], a[208:211]
ds_read_b64_tr_b16 v[184:185], v8 offset:32768
v_mfma_f32_16x16x32_bf16 a[212:215], v[176:179], v[212:215], a[212:215]
ds_read_b64_tr_b16 v[186:187], v8 offset:38912
v_mfma_f32_16x16x32_bf16 a[216:219], v[176:179], v[216:219], a[216:219]
v_mfma_f32_16x16x32_bf16 a[220:223], v[176:179], v[220:223], a[220:223]
s_waitcnt lgkmcnt(2)
v_mfma_f32_16x16x32_bf16 a[224:227], v[180:183], v[208:211], a[224:227]
ds_read_b64_tr_b16 v[188:189], v9 offset:32768
v_mfma_f32_16x16x32_bf16 a[228:231], v[180:183], v[212:215], a[228:231]
ds_read_b64_tr_b16 v[190:191], v9 offset:38912
v_mfma_f32_16x16x32_bf16 a[232:235], v[180:183], v[216:219], a[232:235]
v_mfma_f32_16x16x32_bf16 a[236:239], v[180:183], v[220:223], a[236:239]
s_waitcnt vmcnt(8) lgkmcnt(2)
v_mfma_f32_16x16x32_bf16 a[0:3], v[184:187], v[224:227], a[0:3]
s_barrier
ds_read_b64_tr_b16 v[160:161], v10 offset:32768
v_mfma_f32_16x16x32_bf16 a[4:7], v[184:187], v[228:231], a[4:7]
ds_read_b64_tr_b16 v[162:163], v10 offset:38912
v_mfma_f32_16x16x32_bf16 a[8:11], v[184:187], v[232:235], a[8:11]
s_add_u32 m0, s44, 114688
v_mfma_f32_16x16x32_bf16 a[12:15], v[184:187], v[236:239], a[12:15]
s_waitcnt lgkmcnt(2)
buffer_load_dwordx4 v4, s[12:15], s40 offen offset:0 lds
v_mfma_f32_16x16x32_bf16 a[16:19], v[188:191], v[224:227], a[16:19]
ds_read_b64_tr_b16 v[164:165], v11 offset:32768
v_mfma_f32_16x16x32_bf16 a[20:23], v[188:191], v[228:231], a[20:23]
ds_read_b64_tr_b16 v[166:167], v11 offset:38912
v_mfma_f32_16x16x32_bf16 a[24:27], v[188:191], v[232:235], a[24:27]
buffer_load_dwordx4 v5, s[12:15], s40 offen offset:1024 lds
v_mfma_f32_16x16x32_bf16 a[28:31], v[188:191], v[236:239], a[28:31]
s_waitcnt lgkmcnt(2)
buffer_load_dwordx4 v6, s[12:15], s40 offen offset:2048 lds
v_mfma_f32_16x16x32_bf16 a[32:35], v[160:163], v[224:227], a[32:35]
ds_read_b64_tr_b16 v[168:169], v8 offset:32896
v_mfma_f32_16x16x32_bf16 a[36:39], v[160:163], v[228:231], a[36:39]
ds_read_b64_tr_b16 v[170:171], v8 offset:39040
v_mfma_f32_16x16x32_bf16 a[40:43], v[160:163], v[232:235], a[40:43]
s_add_u32 m0, s45, 114688
s_add_u32 s40, s40, 393216
v_mfma_f32_16x16x32_bf16 a[44:47], v[160:163], v[236:239], a[44:47]
s_waitcnt lgkmcnt(2)
buffer_load_dwordx4 v7, s[16:19], s41 offen lds
s_add_u32 s41, s41, 98304
v_mfma_f32_16x16x32_bf16 a[48:51], v[164:167], v[224:227], a[48:51]
ds_read_b64_tr_b16 v[172:173], v9 offset:32896
v_mfma_f32_16x16x32_bf16 a[52:55], v[164:167], v[228:231], a[52:55]
ds_read_b64_tr_b16 v[174:175], v9 offset:39040
v_mfma_f32_16x16x32_bf16 a[56:59], v[164:167], v[232:235], a[56:59]
s_add_u32 s6, s75, 0
buffer_load_dwordx4 v[208:211], v2, s[8:11], s6 offen
v_mfma_f32_16x16x32_bf16 a[60:63], v[164:167], v[236:239], a[60:63]
s_waitcnt lgkmcnt(2)
v_mfma_f32_16x16x32_bf16 a[64:67], v[168:171], v[224:227], a[64:67]
ds_read_b64_tr_b16 v[176:177], v10 offset:32896
v_mfma_f32_16x16x32_bf16 a[68:71], v[168:171], v[228:231], a[68:71]
ds_read_b64_tr_b16 v[178:179], v10 offset:39040
v_mfma_f32_16x16x32_bf16 a[72:75], v[168:171], v[232:235], a[72:75]
s_add_u32 s6, s75, 20480
buffer_load_dwordx4 v[212:215], v2, s[8:11], s6 offen
v_mfma_f32_16x16x32_bf16 a[76:79], v[168:171], v[236:239], a[76:79]
s_waitcnt lgkmcnt(2)
v_mfma_f32_16x16x32_bf16 a[80:83], v[172:175], v[224:227], a[80:83]
ds_read_b64_tr_b16 v[180:181], v11 offset:32896
v_mfma_f32_16x16x32_bf16 a[84:87], v[172:175], v[228:231], a[84:87]
ds_read_b64_tr_b16 v[182:183], v11 offset:39040
v_mfma_f32_16x16x32_bf16 a[88:91], v[172:175], v[232:235], a[88:91]
s_add_u32 s6, s75, 40960
buffer_load_dwordx4 v[216:219], v2, s[8:11], s6 offen
v_mfma_f32_16x16x32_bf16 a[92:95], v[172:175], v[236:239], a[92:95]
s_waitcnt lgkmcnt(2)
v_mfma_f32_16x16x32_bf16 a[96:99], v[176:179], v[224:227], a[96:99]
ds_read_b64_tr_b16 v[184:185], v8 offset:33024
v_mfma_f32_16x16x32_bf16 a[100:103], v[176:179], v[228:231], a[100:103]
ds_read_b64_tr_b16 v[186:187], v8 offset:39168
v_mfma_f32_16x16x32_bf16 a[104:107], v[176:179], v[232:235], a[104:107]
s_add_u32 s6, s75, 61440
buffer_load_dwordx4 v[220:223], v2, s[8:11], s6 offen
v_mfma_f32_16x16x32_bf16 a[108:111], v[176:179], v[236:239], a[108:111]
s_waitcnt lgkmcnt(2)
v_mfma_f32_16x16x32_bf16 a[112:115], v[180:183], v[224:227], a[112:115]
ds_read_b64_tr_b16 v[188:189], v9 offset:33024
v_mfma_f32_16x16x32_bf16 a[116:119], v[180:183], v[228:231], a[116:119]
ds_read_b64_tr_b16 v[190:191], v9 offset:39168
v_mfma_f32_16x16x32_bf16 a[120:123], v[180:183], v[232:235], a[120:123]
s_add_u32 s75, s75, 1024
v_mfma_f32_16x16x32_bf16 a[124:127], v[180:183], v[236:239], a[124:127]
s_waitcnt lgkmcnt(2)
v_mfma_f32_16x16x32_bf16 a[128:131], v[184:187], v[224:227], a[128:131]
ds_read_b64_tr_b16 v[160:161], v10 offset:33024
v_mfma_f32_16x16x32_bf16 a[132:135], v[184:187], v[228:231], a[132:135]
ds_read_b64_tr_b16 v[162:163], v10 offset:39168
v_mfma_f32_16x16x32_bf16 a[136:139], v[184:187], v[232:235], a[136:139]
v_mfma_f32_16x16x32_bf16 a[140:143], v[184:187], v[236:239], a[140:143]
s_waitcnt lgkmcnt(2)
v_mfma_f32_16x16x32_bf16 a[144:147], v[188:191], v[224:227], a[144:147]
ds_read_b64_tr_b16 v[164:165], v11 offset:33024
v_mfma_f32_16x16x32_bf16 a[148:151], v[188:191], v[228:231], a[148:151]
ds_read_b64_tr_b16 v[166:167], v11 offset:39168
v_mfma_f32_16x16x32_bf16 a[152:155], v[188:191], v[232:235], a[152:155]
v_mfma_f32_16x16x32_bf16 a[156:159], v[188:191], v[236:239], a[156:159]
s_waitcnt lgkmcnt(2)
v_mfma_f32_16x16x32_bf16 a[160:163], v[160:163], v[224:227], a[160:163]
ds_read_b64_tr_b16 v[168:169], v12 offset:32768
v_mfma_f32_16x16x32_bf16 a[164:167], v[160:163], v[228:231], a[164:167]
ds_read_b64_tr_b16 v[170:171], v12 offset:34816
v_mfma_f32_16x16x32_bf16 a[168:171], v[160:163], v[232:235], a[168:171]
v_mfma_f32_16x16x32_bf16 a[172:175], v[160:163], v[236:239], a[172:175]
s_waitcnt lgkmcnt(2)
v_mfma_f32_16x16x32_bf16 a[176:179], v[164:167], v[224:227], a[176:179]
ds_read_b64_tr_b16 v[172:173], v13 offset:32768
v_mfma_f32_16x16x32_bf16 a[180:183], v[164:167], v[228:231], a[180:183]
ds_read_b64_tr_b16 v[174:175], v13 offset:34816
v_mfma_f32_16x16x32_bf16 a[184:187], v[164:167], v[232:235], a[184:187]
v_mfma_f32_16x16x32_bf16 a[188:191], v[164:167], v[236:239], a[188:191]
s_waitcnt lgkmcnt(2)
v_mfma_f32_16x16x32_bf16 a[192:195], v[168:171], v[224:227], a[192:195]
ds_read_b64_tr_b16 v[176:177], v14 offset:32768
v_mfma_f32_16x16x32_bf16 a[196:199], v[168:171], v[228:231], a[196:199]
ds_read_b64_tr_b16 v[178:179], v14 offset:34816
v_mfma_f32_16x16x32_bf16 a[200:203], v[168:171], v[232:235], a[200:203]
v_mfma_f32_16x16x32_bf16 a[204:207], v[168:171], v[236:239], a[204:207]
s_waitcnt lgkmcnt(2)
v_mfma_f32_16x16x32_bf16 a[208:211], v[172:175], v[224:227], a[208:211]
ds_read_b64_tr_b16 v[180:181], v8 offset:49152
v_mfma_f32_16x16x32_bf16 a[212:215], v[172:175], v[228:231], a[212:215]
ds_read_b64_tr_b16 v[182:183], v8 offset:55296
v_mfma_f32_16x16x32_bf16 a[216:219], v[172:175], v[232:235], a[216:219]
v_mfma_f32_16x16x32_bf16 a[220:223], v[172:175], v[236:239], a[220:223]
s_waitcnt lgkmcnt(2)
v_mfma_f32_16x16x32_bf16 a[224:227], v[176:179], v[224:227], a[224:227]
ds_read_b64_tr_b16 v[184:185], v9 offset:49152
v_mfma_f32_16x16x32_bf16 a[228:231], v[176:179], v[228:231], a[228:231]
ds_read_b64_tr_b16 v[186:187], v9 offset:55296
v_mfma_f32_16x16x32_bf16 a[232:235], v[176:179], v[232:235], a[232:235]
v_mfma_f32_16x16x32_bf16 a[236:239], v[176:179], v[236:239], a[236:239]
s_waitcnt vmcnt(8) lgkmcnt(2)
v_mfma_f32_16x16x32_bf16 a[0:3], v[180:183], v[192:195], a[0:3]
s_barrier
ds_read_b64_tr_b16 v[188:189], v10 offset:49152
v_mfma_f32_16x16x32_bf16 a[4:7], v[180:183], v[196:199], a[4:7]
ds_read_b64_tr_b16 v[190:191], v10 offset:55296
v_mfma_f32_16x16x32_bf16 a[8:11], v[180:183], v[200:203], a[8:11]
s_add_u32 m0, s44, 131072
v_mfma_f32_16x16x32_bf16 a[12:15], v[180:183], v[204:207], a[12:15]
s_waitcnt lgkmcnt(2)
buffer_load_dwordx4 v4, s[12:15], s40 offen offset:0 lds
v_mfma_f32_16x16x32_bf16 a[16:19], v[184:187], v[192:195], a[16:19]
ds_read_b64_tr_b16 v[160:161], v11 offset:49152
v_mfma_f32_16x16x32_bf16 a[20:23], v[184:187], v[196:199], a[20:23]
ds_read_b64_tr_b16 v[162:163], v11 offset:55296
v_mfma_f32_16x16x32_bf16 a[24:27], v[184:187], v[200:203], a[24:27]
buffer_load_dwordx4 v5, s[12:15], s40 offen offset:1024 lds
v_mfma_f32_16x16x32_bf16 a[28:31], v[184:187], v[204:207], a[28:31]
s_waitcnt lgkmcnt(2)
buffer_load_dwordx4 v6, s[12:15], s40 offen offset:2048 lds
v_mfma_f32_16x16x32_bf16 a[32:35], v[188:191], v[192:195], a[32:35]
ds_read_b64_tr_b16 v[164:165], v8 offset:49280
v_mfma_f32_16x16x32_bf16 a[36:39], v[188:191], v[196:199], a[36:39]
ds_read_b64_tr_b16 v[166:167], v8 offset:55424
v_mfma_f32_16x16x32_bf16 a[40:43], v[188:191], v[200:203], a[40:43]
s_add_u32 m0, s45, 131072
s_add_u32 s40, s40, 393216
v_mfma_f32_16x16x32_bf16 a[44:47], v[188:191], v[204:207], a[44:47]
s_waitcnt lgkmcnt(2)
buffer_load_dwordx4 v7, s[16:19], s41 offen lds
s_add_u32 s41, s41, 98304
v_mfma_f32_16x16x32_bf16 a[48:51], v[160:163], v[192:195], a[48:51]
ds_read_b64_tr_b16 v[168:169], v9 offset:49280
v_mfma_f32_16x16x32_bf16 a[52:55], v[160:163], v[196:199], a[52:55]
ds_read_b64_tr_b16 v[170:171], v9 offset:55424
v_mfma_f32_16x16x32_bf16 a[56:59], v[160:163], v[200:203], a[56:59]
s_add_u32 s6, s75, 0
buffer_load_dwordx4 v[224:227], v2, s[8:11], s6 offen
v_mfma_f32_16x16x32_bf16 a[60:63], v[160:163], v[204:207], a[60:63]
s_waitcnt lgkmcnt(2)
v_mfma_f32_16x16x32_bf16 a[64:67], v[164:167], v[192:195], a[64:67]
ds_read_b64_tr_b16 v[172:173], v10 offset:49280
v_mfma_f32_16x16x32_bf16 a[68:71], v[164:167], v[196:199], a[68:71]
ds_read_b64_tr_b16 v[174:175], v10 offset:55424
v_mfma_f32_16x16x32_bf16 a[72:75], v[164:167], v[200:203], a[72:75]
s_add_u32 s6, s75, 20480
buffer_load_dwordx4 v[228:231], v2, s[8:11], s6 offen
v_mfma_f32_16x16x32_bf16 a[76:79], v[164:167], v[204:207], a[76:79]
s_waitcnt lgkmcnt(2)
v_mfma_f32_16x16x32_bf16 a[80:83], v[168:171], v[192:195], a[80:83]
ds_read_b64_tr_b16 v[176:177], v11 offset:49280
v_mfma_f32_16x16x32_bf16 a[84:87], v[168:171], v[196:199], a[84:87]
ds_read_b64_tr_b16 v[178:179], v11 offset:55424
v_mfma_f32_16x16x32_bf16 a[88:91], v[168:171], v[200:203], a[88:91]
s_add_u32 s6, s75, 40960
buffer_load_dwordx4 v[232:235], v2, s[8:11], s6 offen
v_mfma_f32_16x16x32_bf16 a[92:95], v[168:171], v[204:207], a[92:95]
s_waitcnt lgkmcnt(2)
v_mfma_f32_16x16x32_bf16 a[96:99], v[172:175], v[192:195], a[96:99]
ds_read_b64_tr_b16 v[180:181], v8 offset:49408
v_mfma_f32_16x16x32_bf16 a[100:103], v[172:175], v[196:199], a[100:103]
ds_read_b64_tr_b16 v[182:183], v8 offset:55552
v_mfma_f32_16x16x32_bf16 a[104:107], v[172:175], v[200:203], a[104:107]
s_add_u32 s6, s75, 61440
buffer_load_dwordx4 v[236:239], v2, s[8:11], s6 offen
v_mfma_f32_16x16x32_bf16 a[108:111], v[172:175], v[204:207], a[108:111]
s_waitcnt lgkmcnt(2)
v_mfma_f32_16x16x32_bf16 a[112:115], v[176:179], v[192:195], a[112:115]
ds_read_b64_tr_b16 v[184:185], v9 offset:49408
v_mfma_f32_16x16x32_bf16 a[116:119], v[176:179], v[196:199], a[116:119]
ds_read_b64_tr_b16 v[186:187], v9 offset:55552
v_mfma_f32_16x16x32_bf16 a[120:123], v[176:179], v[200:203], a[120:123]
s_add_u32 s75, s75, 1024
v_mfma_f32_16x16x32_bf16 a[124:127], v[176:179], v[204:207], a[124:127]
s_waitcnt lgkmcnt(2)
v_mfma_f32_16x16x32_bf16 a[128:131], v[180:183], v[192:195], a[128:131]
ds_read_b64_tr_b16 v[188:189], v10 offset:49408
v_mfma_f32_16x16x32_bf16 a[132:135], v[180:183], v[196:199], a[132:135]
ds_read_b64_tr_b16 v[190:191], v10 offset:55552
v_mfma_f32_16x16x32_bf16 a[136:139], v[180:183], v[200:203], a[136:139]
v_mfma_f32_16x16x32_bf16 a[140:143], v[180:183], v[204:207], a[140:143]
s_waitcnt lgkmcnt(2)
v_mfma_f32_16x16x32_bf16 a[144:147], v[184:187], v[192:195], a[144:147]
ds_read_b64_tr_b16 v[160:161], v11 offset:49408
v_mfma_f32_16x16x32_bf16 a[148:151], v[184:187], v[196:199], a[148:151]
ds_read_b64_tr_b16 v[162:163], v11 offset:55552
v_mfma_f32_16x16x32_bf16 a[152:155], v[184:187], v[200:203], a[152:155]
v_mfma_f32_16x16x32_bf16 a[156:159], v[184:187], v[204:207], a[156:159]
s_waitcnt lgkmcnt(2)
v_mfma_f32_16x16x32_bf16 a[160:163], v[188:191], v[192:195], a[160:163]
ds_read_b64_tr_b16 v[164:165], v12 offset:49152
v_mfma_f32_16x16x32_bf16 a[164:167], v[188:191], v[196:199], a[164:167]
ds_read_b64_tr_b16 v[166:167], v12 offset:51200
v_mfma_f32_16x16x32_bf16 a[168:171], v[188:191], v[200:203], a[168:171]
v_mfma_f32_16x16x32_bf16 a[172:175], v[188:191], v[204:207], a[172:175]
s_waitcnt lgkmcnt(2)
v_mfma_f32_16x16x32_bf16 a[176:179], v[160:163], v[192:195], a[176:179]
ds_read_b64_tr_b16 v[168:169], v13 offset:49152
v_mfma_f32_16x16x32_bf16 a[180:183], v[160:163], v[196:199], a[180:183]
ds_read_b64_tr_b16 v[170:171], v13 offset:51200
v_mfma_f32_16x16x32_bf16 a[184:187], v[160:163], v[200:203], a[184:187]
v_mfma_f32_16x16x32_bf16 a[188:191], v[160:163], v[204:207], a[188:191]
s_waitcnt lgkmcnt(2)
v_mfma_f32_16x16x32_bf16 a[192:195], v[164:167], v[192:195], a[192:195]
ds_read_b64_tr_b16 v[172:173], v14 offset:49152
v_mfma_f32_16x16x32_bf16 a[196:199], v[164:167], v[196:199], a[196:199]
ds_read_b64_tr_b16 v[174:175], v14 offset:51200
v_mfma_f32_16x16x32_bf16 a[200:203], v[164:167], v[200:203], a[200:203]
v_mfma_f32_16x16x32_bf16 a[204:207], v[164:167], v[204:207], a[204:207]
s_waitcnt lgkmcnt(2)
v_mfma_f32_16x16x32_bf16 a[208:211], v[168:171], v[192:195], a[208:211]
ds_read_b64_tr_b16 v[176:177], v8 offset:0
v_mfma_f32_16x16x32_bf16 a[212:215], v[168:171], v[196:199], a[212:215]
ds_read_b64_tr_b16 v[178:179], v8 offset:6144
v_mfma_f32_16x16x32_bf16 a[216:219], v[168:171], v[200:203], a[216:219]
v_mfma_f32_16x16x32_bf16 a[220:223], v[168:171], v[204:207], a[220:223]
s_waitcnt lgkmcnt(2)
v_mfma_f32_16x16x32_bf16 a[224:227], v[172:175], v[192:195], a[224:227]
ds_read_b64_tr_b16 v[180:181], v9 offset:0
v_mfma_f32_16x16x32_bf16 a[228:231], v[172:175], v[196:199], a[228:231]
ds_read_b64_tr_b16 v[182:183], v9 offset:6144
v_mfma_f32_16x16x32_bf16 a[232:235], v[172:175], v[200:203], a[232:235]
v_mfma_f32_16x16x32_bf16 a[236:239], v[172:175], v[204:207], a[236:239]
s_waitcnt vmcnt(8) lgkmcnt(2)
v_mfma_f32_16x16x32_bf16 a[0:3], v[176:179], v[208:211], a[0:3]
s_barrier
ds_read_b64_tr_b16 v[184:185], v10 offset:0
v_mfma_f32_16x16x32_bf16 a[4:7], v[176:179], v[212:215], a[4:7]
ds_read_b64_tr_b16 v[186:187], v10 offset:6144
v_mfma_f32_16x16x32_bf16 a[8:11], v[176:179], v[216:219], a[8:11]
s_add_u32 m0, s44, 147456
v_mfma_f32_16x16x32_bf16 a[12:15], v[176:179], v[220:223], a[12:15]
s_waitcnt lgkmcnt(2)
buffer_load_dwordx4 v4, s[12:15], s40 offen offset:0 lds
v_mfma_f32_16x16x32_bf16 a[16:19], v[180:183], v[208:211], a[16:19]
ds_read_b64_tr_b16 v[188:189], v11 offset:0
v_mfma_f32_16x16x32_bf16 a[20:23], v[180:183], v[212:215], a[20:23]
ds_read_b64_tr_b16 v[190:191], v11 offset:6144
v_mfma_f32_16x16x32_bf16 a[24:27], v[180:183], v[216:219], a[24:27]
buffer_load_dwordx4 v5, s[12:15], s40 offen offset:1024 lds
v_mfma_f32_16x16x32_bf16 a[28:31], v[180:183], v[220:223], a[28:31]
s_waitcnt lgkmcnt(2)
buffer_load_dwordx4 v6, s[12:15], s40 offen offset:2048 lds
v_mfma_f32_16x16x32_bf16 a[32:35], v[184:187], v[208:211], a[32:35]
ds_read_b64_tr_b16 v[160:161], v8 offset:128
v_mfma_f32_16x16x32_bf16 a[36:39], v[184:187], v[212:215], a[36:39]
ds_read_b64_tr_b16 v[162:163], v8 offset:6272
v_mfma_f32_16x16x32_bf16 a[40:43], v[184:187], v[216:219], a[40:43]
s_add_u32 m0, s45, 147456
s_add_u32 s40, s40, 393216
v_mfma_f32_16x16x32_bf16 a[44:47], v[184:187], v[220:223], a[44:47]
s_waitcnt lgkmcnt(2)
buffer_load_dwordx4 v7, s[16:19], s41 offen lds
s_add_u32 s41, s41, 98304
v_mfma_f32_16x16x32_bf16 a[48:51], v[188:191], v[208:211], a[48:51]
ds_read_b64_tr_b16 v[164:165], v9 offset:128
v_mfma_f32_16x16x32_bf16 a[52:55], v[188:191], v[212:215], a[52:55]
ds_read_b64_tr_b16 v[166:167], v9 offset:6272
v_mfma_f32_16x16x32_bf16 a[56:59], v[188:191], v[216:219], a[56:59]
s_add_u32 s6, s75, 0
buffer_load_dwordx4 v[192:195], v2, s[8:11], s6 offen
v_mfma_f32_16x16x32_bf16 a[60:63], v[188:191], v[220:223], a[60:63]
s_waitcnt lgkmcnt(2)
v_mfma_f32_16x16x32_bf16 a[64:67], v[160:163], v[208:211], a[64:67]
ds_read_b64_tr_b16 v[168:169], v10 offset:128
v_mfma_f32_16x16x32_bf16 a[68:71], v[160:163], v[212:215], a[68:71]
ds_read_b64_tr_b16 v[170:171], v10 offset:6272
v_mfma_f32_16x16x32_bf16 a[72:75], v[160:163], v[216:219], a[72:75]
s_add_u32 s6, s75, 20480
buffer_load_dwordx4 v[196:199], v2, s[8:11], s6 offen
v_mfma_f32_16x16x32_bf16 a[76:79], v[160:163], v[220:223], a[76:79]
s_waitcnt lgkmcnt(2)
v_mfma_f32_16x16x32_bf16 a[80:83], v[164:167], v[208:211], a[80:83]
ds_read_b64_tr_b16 v[172:173], v11 offset:128
v_mfma_f32_16x16x32_bf16 a[84:87], v[164:167], v[212:215], a[84:87]
ds_read_b64_tr_b16 v[174:175], v11 offset:6272
v_mfma_f32_16x16x32_bf16 a[88:91], v[164:167], v[216:219], a[88:91]
s_add_u32 s6, s75, 40960
buffer_load_dwordx4 v[200:203], v2, s[8:11], s6 offen
v_mfma_f32_16x16x32_bf16 a[92:95], v[164:167], v[220:223], a[92:95]
s_waitcnt lgkmcnt(2)
v_mfma_f32_16x16x32_bf16 a[96:99], v[168:171], v[208:211], a[96:99]
ds_read_b64_tr_b16 v[176:177], v8 offset:256
v_mfma_f32_16x16x32_bf16 a[100:103], v[168:171], v[212:215], a[100:103]
ds_read_b64_tr_b16 v[178:179], v8 offset:6400
v_mfma_f32_16x16x32_bf16 a[104:107], v[168:171], v[216:219], a[104:107]
s_add_u32 s6, s75, 61440
buffer_load_dwordx4 v[204:207], v2, s[8:11], s6 offen
v_mfma_f32_16x16x32_bf16 a[108:111], v[168:171], v[220:223], a[108:111]
s_waitcnt lgkmcnt(2)
v_mfma_f32_16x16x32_bf16 a[112:115], v[172:175], v[208:211], a[112:115]
ds_read_b64_tr_b16 v[180:181], v9 offset:256
v_mfma_f32_16x16x32_bf16 a[116:119], v[172:175], v[212:215], a[116:119]
ds_read_b64_tr_b16 v[182:183], v9 offset:6400
v_mfma_f32_16x16x32_bf16 a[120:123], v[172:175], v[216:219], a[120:123]
s_add_u32 s75, s75, 1024
v_mfma_f32_16x16x32_bf16 a[124:127], v[172:175], v[220:223], a[124:127]
s_waitcnt lgkmcnt(2)
v_mfma_f32_16x16x32_bf16 a[128:131], v[176:179], v[208:211], a[128:131]
ds_read_b64_tr_b16 v[184:185], v10 offset:256
v_mfma_f32_16x16x32_bf16 a[132:135], v[176:179], v[212:215], a[132:135]
ds_read_b64_tr_b16 v[186:187], v10 offset:6400
v_mfma_f32_16x16x32_bf16 a[136:139], v[176:179], v[216:219], a[136:139]
v_mfma_f32_16x16x32_bf16 a[140:143], v[176:179], v[220:223], a[140:143]
s_waitcnt lgkmcnt(2)
v_mfma_f32_16x16x32_bf16 a[144:147], v[180:183], v[208:211], a[144:147]
ds_read_b64_tr_b16 v[188:189], v11 offset:256
v_mfma_f32_16x16x32_bf16 a[148:151], v[180:183], v[212:215], a[148:151]
ds_read_b64_tr_b16 v[190:191], v11 offset:6400
v_mfma_f32_16x16x32_bf16 a[152:155], v[180:183], v[216:219], a[152:155]
v_mfma_f32_16x16x32_bf16 a[156:159], v[180:183], v[220:223], a[156:159]
s_waitcnt lgkmcnt(2)
v_mfma_f32_16x16x32_bf16 a[160:163], v[184:187], v[208:211], a[160:163]
ds_read_b64_tr_b16 v[160:161], v12 offset:0
v_mfma_f32_16x16x32_bf16 a[164:167], v[184:187], v[212:215], a[164:167]
ds_read_b64_tr_b16 v[162:163], v12 offset:2048
v_mfma_f32_16x16x32_bf16 a[168:171], v[184:187], v[216:219], a[168:171]
v_mfma_f32_16x16x32_bf16 a[172:175], v[184:187], v[220:223], a[172:175]
s_waitcnt lgkmcnt(2)
v_mfma_f32_16x16x32_bf16 a[176:179], v[188:191], v[208:211], a[176:179]
ds_read_b64_tr_b16 v[164:165], v13 offset:0
v_mfma_f32_16x16x32_bf16 a[180:183], v[188:191], v[212:215], a[180:183]
ds_read_b64_tr_b16 v[166:167], v13 offset:2048
v_mfma_f32_16x16x32_bf16 a[184:187], v[188:191], v[216:219], a[184:187]
v_mfma_f32_16x16x32_bf16 a[188:191], v[188:191], v[220:223], a[188:191]
s_waitcnt lgkmcnt(2)
v_mfma_f32_16x16x32_bf16 a[192:195], v[160:163], v[208:211], a[192:195]
ds_read_b64_tr_b16 v[168:169], v14 offset:0
v_mfma_f32_16x16x32_bf16 a[196:199], v[160:163], v[212:215], a[196:199]
ds_read_b64_tr_b16 v[170:171], v14 offset:2048
v_mfma_f32_16x16x32_bf16 a[200:203], v[160:163], v[216:219], a[200:203]
v_mfma_f32_16x16x32_bf16 a[204:207], v[160:163], v[220:223], a[204:207]
s_waitcnt lgkmcnt(2)
v_mfma_f32_16x16x32_bf16 a[208:211], v[164:167], v[208:211], a[208:211]
ds_read_b64_tr_b16 v[172:173], v8 offset:16384
v_mfma_f32_16x16x32_bf16 a[212:215], v[164:167], v[212:215], a[212:215]
ds_read_b64_tr_b16 v[174:175], v8 offset:22528
v_mfma_f32_16x16x32_bf16 a[216:219], v[164:167], v[216:219], a[216:219]
v_mfma_f32_16x16x32_bf16 a[220:223], v[164:167], v[220:223], a[220:223]
s_waitcnt lgkmcnt(2)
v_mfma_f32_16x16x32_bf16 a[224:227], v[168:171], v[208:211], a[224:227]
ds_read_b64_tr_b16 v[176:177], v9 offset:16384
v_mfma_f32_16x16x32_bf16 a[228:231], v[168:171], v[212:215], a[228:231]
ds_read_b64_tr_b16 v[178:179], v9 offset:22528
v_mfma_f32_16x16x32_bf16 a[232:235], v[168:171], v[216:219], a[232:235]
v_mfma_f32_16x16x32_bf16 a[236:239], v[168:171], v[220:223], a[236:239]
s_waitcnt vmcnt(8) lgkmcnt(2)
v_mfma_f32_16x16x32_bf16 a[0:3], v[172:175], v[224:227], a[0:3]
s_barrier
ds_read_b64_tr_b16 v[180:181], v10 offset:16384
v_mfma_f32_16x16x32_bf16 a[4:7], v[172:175], v[228:231], a[4:7]
ds_read_b64_tr_b16 v[182:183], v10 offset:22528
v_mfma_f32_16x16x32_bf16 a[8:11], v[172:175], v[232:235], a[8:11]
s_add_u32 m0, s44, 98304
v_mfma_f32_16x16x32_bf16 a[12:15], v[172:175], v[236:239], a[12:15]
s_waitcnt lgkmcnt(2)
buffer_load_dwordx4 v4, s[12:15], s40 offen offset:0 lds
v_mfma_f32_16x16x32_bf16 a[16:19], v[176:179], v[224:227], a[16:19]
ds_read_b64_tr_b16 v[184:185], v11 offset:16384
v_mfma_f32_16x16x32_bf16 a[20:23], v[176:179], v[228:231], a[20:23]
ds_read_b64_tr_b16 v[186:187], v11 offset:22528
v_mfma_f32_16x16x32_bf16 a[24:27], v[176:179], v[232:235], a[24:27]
buffer_load_dwordx4 v5, s[12:15], s40 offen offset:1024 lds
v_mfma_f32_16x16x32_bf16 a[28:31], v[176:179], v[236:239], a[28:31]
s_waitcnt lgkmcnt(2)
buffer_load_dwordx4 v6, s[12:15], s40 offen offset:2048 lds
v_mfma_f32_16x16x32_bf16 a[32:35], v[180:183], v[224:227], a[32:35]
ds_read_b64_tr_b16 v[188:189], v8 offset:16512
v_mfma_f32_16x16x32_bf16 a[36:39], v[180:183], v[228:231], a[36:39]
ds_read_b64_tr_b16 v[190:191], v8 offset:22656
v_mfma_f32_16x16x32_bf16 a[40:43], v[180:183], v[232:235], a[40:43]
s_add_u32 m0, s45, 98304
s_add_u32 s40, s40, 393216
v_mfma_f32_16x16x32_bf16 a[44:47], v[180:183], v[236:239], a[44:47]
s_waitcnt lgkmcnt(2)
buffer_load_dwordx4 v7, s[16:19], s41 offen lds
s_add_u32 s41, s41, 98304
v_mfma_f32_16x16x32_bf16 a[48:51], v[184:187], v[224:227], a[48:51]
ds_read_b64_tr_b16 v[160:161], v9 offset:16512
v_mfma_f32_16x16x32_bf16 a[52:55], v[184:187], v[228:231], a[52:55]
ds_read_b64_tr_b16 v[162:163], v9 offset:22656
v_mfma_f32_16x16x32_bf16 a[56:59], v[184:187], v[232:235], a[56:59]
s_add_u32 s6, s75, 0
buffer_load_dwordx4 v[208:211], v2, s[8:11], s6 offen
v_mfma_f32_16x16x32_bf16 a[60:63], v[184:187], v[236:239], a[60:63]
s_waitcnt lgkmcnt(2)
v_mfma_f32_16x16x32_bf16 a[64:67], v[188:191], v[224:227], a[64:67]
ds_read_b64_tr_b16 v[164:165], v10 offset:16512
v_mfma_f32_16x16x32_bf16 a[68:71], v[188:191], v[228:231], a[68:71]
ds_read_b64_tr_b16 v[166:167], v10 offset:22656
v_mfma_f32_16x16x32_bf16 a[72:75], v[188:191], v[232:235], a[72:75]
s_add_u32 s6, s75, 20480
buffer_load_dwordx4 v[212:215], v2, s[8:11], s6 offen
v_mfma_f32_16x16x32_bf16 a[76:79], v[188:191], v[236:239], a[76:79]
s_waitcnt lgkmcnt(2)
v_mfma_f32_16x16x32_bf16 a[80:83], v[160:163], v[224:227], a[80:83]
ds_read_b64_tr_b16 v[168:169], v11 offset:16512
v_mfma_f32_16x16x32_bf16 a[84:87], v[160:163], v[228:231], a[84:87]
ds_read_b64_tr_b16 v[170:171], v11 offset:22656
v_mfma_f32_16x16x32_bf16 a[88:91], v[160:163], v[232:235], a[88:91]
s_add_u32 s6, s75, 40960
buffer_load_dwordx4 v[216:219], v2, s[8:11], s6 offen
v_mfma_f32_16x16x32_bf16 a[92:95], v[160:163], v[236:239], a[92:95]
s_waitcnt lgkmcnt(2)
v_mfma_f32_16x16x32_bf16 a[96:99], v[164:167], v[224:227], a[96:99]
ds_read_b64_tr_b16 v[172:173], v8 offset:16640
v_mfma_f32_16x16x32_bf16 a[100:103], v[164:167], v[228:231], a[100:103]
ds_read_b64_tr_b16 v[174:175], v8 offset:22784
v_mfma_f32_16x16x32_bf16 a[104:107], v[164:167], v[232:235], a[104:107]
s_add_u32 s6, s75, 61440
buffer_load_dwordx4 v[220:223], v2, s[8:11], s6 offen
v_mfma_f32_16x16x32_bf16 a[108:111], v[164:167], v[236:239], a[108:111]
s_waitcnt lgkmcnt(2)
v_mfma_f32_16x16x32_bf16 a[112:115], v[168:171], v[224:227], a[112:115]
ds_read_b64_tr_b16 v[176:177], v9 offset:16640
v_mfma_f32_16x16x32_bf16 a[116:119], v[168:171], v[228:231], a[116:119]
ds_read_b64_tr_b16 v[178:179], v9 offset:22784
v_mfma_f32_16x16x32_bf16 a[120:123], v[168:171], v[232:235], a[120:123]
s_add_u32 s75, s75, 1024
v_mfma_f32_16x16x32_bf16 a[124:127], v[168:171], v[236:239], a[124:127]
s_waitcnt lgkmcnt(2)
v_mfma_f32_16x16x32_bf16 a[128:131], v[172:175], v[224:227], a[128:131]
ds_read_b64_tr_b16 v[180:181], v10 offset:16640
v_mfma_f32_16x16x32_bf16 a[132:135], v[172:175], v[228:231], a[132:135]
ds_read_b64_tr_b16 v[182:183], v10 offset:22784
v_mfma_f32_16x16x32_bf16 a[136:139], v[172:175], v[232:235], a[136:139]
v_mfma_f32_16x16x32_bf16 a[140:143], v[172:175], v[236:239], a[140:143]
s_waitcnt lgkmcnt(2)
v_mfma_f32_16x16x32_bf16 a[144:147], v[176:179], v[224:227], a[144:147]
ds_read_b64_tr_b16 v[184:185], v11 offset:16640
v_mfma_f32_16x16x32_bf16 a[148:151], v[176:179], v[228:231], a[148:151]
ds_read_b64_tr_b16 v[186:187], v11 offset:22784
v_mfma_f32_16x16x32_bf16 a[152:155], v[176:179], v[232:235], a[152:155]
v_mfma_f32_16x16x32_bf16 a[156:159], v[176:179], v[236:239], a[156:159]
s_waitcnt lgkmcnt(2)
v_mfma_f32_16x16x32_bf16 a[160:163], v[180:183], v[224:227], a[160:163]
ds_read_b64_tr_b16 v[188:189], v12 offset:16384
v_mfma_f32_16x16x32_bf16 a[164:167], v[180:183], v[228:231], a[164:167]
ds_read_b64_tr_b16 v[190:191], v12 offset:18432
v_mfma_f32_16x16x32_bf16 a[168:171], v[180:183], v[232:235], a[168:171]
v_mfma_f32_16x16x32_bf16 a[172:175], v[180:183], v[236:239], a[172:175]
s_waitcnt lgkmcnt(2)
v_mfma_f32_16x16x32_bf16 a[176:179], v[184:187], v[224:227], a[176:179]
ds_read_b64_tr_b16 v[160:161], v13 offset:16384
v_mfma_f32_16x16x32_bf16 a[180:183], v[184:187], v[228:231], a[180:183]
ds_read_b64_tr_b16 v[162:163], v13 offset:18432
v_mfma_f32_16x16x32_bf16 a[184:187], v[184:187], v[232:235], a[184:187]
v_mfma_f32_16x16x32_bf16 a[188:191], v[184:187], v[236:239], a[188:191]
s_waitcnt lgkmcnt(2)
v_mfma_f32_16x16x32_bf16 a[192:195], v[188:191], v[224:227], a[192:195]
ds_read_b64_tr_b16 v[164:165], v14 offset:16384
v_mfma_f32_16x16x32_bf16 a[196:199], v[188:191], v[228:231], a[196:199]
ds_read_b64_tr_b16 v[166:167], v14 offset:18432
v_mfma_f32_16x16x32_bf16 a[200:203], v[188:191], v[232:235], a[200:203]
v_mfma_f32_16x16x32_bf16 a[204:207], v[188:191], v[236:239], a[204:207]
s_waitcnt lgkmcnt(2)
v_mfma_f32_16x16x32_bf16 a[208:211], v[160:163], v[224:227], a[208:211]
ds_read_b64_tr_b16 v[168:169], v8 offset:32768
v_mfma_f32_16x16x32_bf16 a[212:215], v[160:163], v[228:231], a[212:215]
ds_read_b64_tr_b16 v[170:171], v8 offset:38912
v_mfma_f32_16x16x32_bf16 a[216:219], v[160:163], v[232:235], a[216:219]
v_mfma_f32_16x16x32_bf16 a[220:223], v[160:163], v[236:239], a[220:223]
s_waitcnt lgkmcnt(2)
v_mfma_f32_16x16x32_bf16 a[224:227], v[164:167], v[224:227], a[224:227]
ds_read_b64_tr_b16 v[172:173], v9 offset:32768
v_mfma_f32_16x16x32_bf16 a[228:231], v[164:167], v[228:231], a[228:231]
ds_read_b64_tr_b16 v[174:175], v9 offset:38912
v_mfma_f32_16x16x32_bf16 a[232:235], v[164:167], v[232:235], a[232:235]
v_mfma_f32_16x16x32_bf16 a[236:239], v[164:167], v[236:239], a[236:239]
s_waitcnt vmcnt(8) lgkmcnt(2)
v_mfma_f32_16x16x32_bf16 a[0:3], v[168:171], v[192:195], a[0:3]
s_barrier
ds_read_b64_tr_b16 v[176:177], v10 offset:32768
v_mfma_f32_16x16x32_bf16 a[4:7], v[168:171], v[196:199], a[4:7]
ds_read_b64_tr_b16 v[178:179], v10 offset:38912
v_mfma_f32_16x16x32_bf16 a[8:11], v[168:171], v[200:203], a[8:11]
s_add_u32 m0, s44, 114688
v_mfma_f32_16x16x32_bf16 a[12:15], v[168:171], v[204:207], a[12:15]
s_waitcnt lgkmcnt(2)
buffer_load_dwordx4 v4, s[12:15], s40 offen offset:0 lds
v_mfma_f32_16x16x32_bf16 a[16:19], v[172:175], v[192:195], a[16:19]
ds_read_b64_tr_b16 v[180:181], v11 offset:32768
v_mfma_f32_16x16x32_bf16 a[20:23], v[172:175], v[196:199], a[20:23]
ds_read_b64_tr_b16 v[182:183], v11 offset:38912
v_mfma_f32_16x16x32_bf16 a[24:27], v[172:175], v[200:203], a[24:27]
buffer_load_dwordx4 v5, s[12:15], s40 offen offset:1024 lds
v_mfma_f32_16x16x32_bf16 a[28:31], v[172:175], v[204:207], a[28:31]
s_waitcnt lgkmcnt(2)
buffer_load_dwordx4 v6, s[12:15], s40 offen offset:2048 lds
v_mfma_f32_16x16x32_bf16 a[32:35], v[176:179], v[192:195], a[32:35]
ds_read_b64_tr_b16 v[184:185], v8 offset:32896
v_mfma_f32_16x16x32_bf16 a[36:39], v[176:179], v[196:199], a[36:39]
ds_read_b64_tr_b16 v[186:187], v8 offset:39040
v_mfma_f32_16x16x32_bf16 a[40:43], v[176:179], v[200:203], a[40:43]
s_add_u32 m0, s45, 114688
s_add_u32 s40, s40, 393216
v_mfma_f32_16x16x32_bf16 a[44:47], v[176:179], v[204:207], a[44:47]
s_waitcnt lgkmcnt(2)
buffer_load_dwordx4 v7, s[16:19], s41 offen lds
s_add_u32 s41, s41, 98304
v_mfma_f32_16x16x32_bf16 a[48:51], v[180:183], v[192:195], a[48:51]
ds_read_b64_tr_b16 v[188:189], v9 offset:32896
v_mfma_f32_16x16x32_bf16 a[52:55], v[180:183], v[196:199], a[52:55]
ds_read_b64_tr_b16 v[190:191], v9 offset:39040
v_mfma_f32_16x16x32_bf16 a[56:59], v[180:183], v[200:203], a[56:59]
s_add_u32 s6, s75, 0
buffer_load_dwordx4 v[224:227], v2, s[8:11], s6 offen
v_mfma_f32_16x16x32_bf16 a[60:63], v[180:183], v[204:207], a[60:63]
s_waitcnt lgkmcnt(2)
v_mfma_f32_16x16x32_bf16 a[64:67], v[184:187], v[192:195], a[64:67]
ds_read_b64_tr_b16 v[160:161], v10 offset:32896
v_mfma_f32_16x16x32_bf16 a[68:71], v[184:187], v[196:199], a[68:71]
ds_read_b64_tr_b16 v[162:163], v10 offset:39040
v_mfma_f32_16x16x32_bf16 a[72:75], v[184:187], v[200:203], a[72:75]
s_add_u32 s6, s75, 20480
buffer_load_dwordx4 v[228:231], v2, s[8:11], s6 offen
v_mfma_f32_16x16x32_bf16 a[76:79], v[184:187], v[204:207], a[76:79]
s_waitcnt lgkmcnt(2)
v_mfma_f32_16x16x32_bf16 a[80:83], v[188:191], v[192:195], a[80:83]
ds_read_b64_tr_b16 v[164:165], v11 offset:32896
v_mfma_f32_16x16x32_bf16 a[84:87], v[188:191], v[196:199], a[84:87]
ds_read_b64_tr_b16 v[166:167], v11 offset:39040
v_mfma_f32_16x16x32_bf16 a[88:91], v[188:191], v[200:203], a[88:91]
s_add_u32 s6, s75, 40960
buffer_load_dwordx4 v[232:235], v2, s[8:11], s6 offen
v_mfma_f32_16x16x32_bf16 a[92:95], v[188:191], v[204:207], a[92:95]
s_waitcnt lgkmcnt(2)
v_mfma_f32_16x16x32_bf16 a[96:99], v[160:163], v[192:195], a[96:99]
ds_read_b64_tr_b16 v[168:169], v8 offset:33024
v_mfma_f32_16x16x32_bf16 a[100:103], v[160:163], v[196:199], a[100:103]
ds_read_b64_tr_b16 v[170:171], v8 offset:39168
v_mfma_f32_16x16x32_bf16 a[104:107], v[160:163], v[200:203], a[104:107]
s_add_u32 s6, s75, 61440
buffer_load_dwordx4 v[236:239], v2, s[8:11], s6 offen
v_mfma_f32_16x16x32_bf16 a[108:111], v[160:163], v[204:207], a[108:111]
s_waitcnt lgkmcnt(2)
v_mfma_f32_16x16x32_bf16 a[112:115], v[164:167], v[192:195], a[112:115]
ds_read_b64_tr_b16 v[172:173], v9 offset:33024
v_mfma_f32_16x16x32_bf16 a[116:119], v[164:167], v[196:199], a[116:119]
ds_read_b64_tr_b16 v[174:175], v9 offset:39168
v_mfma_f32_16x16x32_bf16 a[120:123], v[164:167], v[200:203], a[120:123]
s_add_u32 s75, s75, 1024
v_mfma_f32_16x16x32_bf16 a[124:127], v[164:167], v[204:207], a[124:127]
s_waitcnt lgkmcnt(2)
v_mfma_f32_16x16x32_bf16 a[128:131], v[168:171], v[192:195], a[128:131]
ds_read_b64_tr_b16 v[176:177], v10 offset:33024
v_mfma_f32_16x16x32_bf16 a[132:135], v[168:171], v[196:199], a[132:135]
ds_read_b64_tr_b16 v[178:179], v10 offset:39168
v_mfma_f32_16x16x32_bf16 a[136:139], v[168:171], v[200:203], a[136:139]
v_mfma_f32_16x16x32_bf16 a[140:143], v[168:171], v[204:207], a[140:143]
s_waitcnt lgkmcnt(2)
v_mfma_f32_16x16x32_bf16 a[144:147], v[172:175], v[192:195], a[144:147]
ds_read_b64_tr_b16 v[180:181], v11 offset:33024
v_mfma_f32_16x16x32_bf16 a[148:151], v[172:175], v[196:199], a[148:151]
ds_read_b64_tr_b16 v[182:183], v11 offset:39168
v_mfma_f32_16x16x32_bf16 a[152:155], v[172:175], v[200:203], a[152:155]
v_mfma_f32_16x16x32_bf16 a[156:159], v[172:175], v[204:207], a[156:159]
s_waitcnt lgkmcnt(2)
v_mfma_f32_16x16x32_bf16 a[160:163], v[176:179], v[192:195], a[160:163]
ds_read_b64_tr_b16 v[184:185], v12 offset:32768
v_mfma_f32_16x16x32_bf16 a[164:167], v[176:179], v[196:199], a[164:167]
ds_read_b64_tr_b16 v[186:187], v12 offset:34816
v_mfma_f32_16x16x32_bf16 a[168:171], v[176:179], v[200:203], a[168:171]
v_mfma_f32_16x16x32_bf16 a[172:175], v[176:179], v[204:207], a[172:175]
s_waitcnt lgkmcnt(2)
v_mfma_f32_16x16x32_bf16 a[176:179], v[180:183], v[192:195], a[176:179]
ds_read_b64_tr_b16 v[188:189], v13 offset:32768
v_mfma_f32_16x16x32_bf16 a[180:183], v[180:183], v[196:199], a[180:183]
ds_read_b64_tr_b16 v[190:191], v13 offset:34816
v_mfma_f32_16x16x32_bf16 a[184:187], v[180:183], v[200:203], a[184:187]
v_mfma_f32_16x16x32_bf16 a[188:191], v[180:183], v[204:207], a[188:191]
s_waitcnt lgkmcnt(2)
v_mfma_f32_16x16x32_bf16 a[192:195], v[184:187], v[192:195], a[192:195]
ds_read_b64_tr_b16 v[160:161], v14 offset:32768
v_mfma_f32_16x16x32_bf16 a[196:199], v[184:187], v[196:199], a[196:199]
ds_read_b64_tr_b16 v[162:163], v14 offset:34816
v_mfma_f32_16x16x32_bf16 a[200:203], v[184:187], v[200:203], a[200:203]
v_mfma_f32_16x16x32_bf16 a[204:207], v[184:187], v[204:207], a[204:207]
s_waitcnt lgkmcnt(2)
v_mfma_f32_16x16x32_bf16 a[208:211], v[188:191], v[192:195], a[208:211]
ds_read_b64_tr_b16 v[164:165], v8 offset:49152
v_mfma_f32_16x16x32_bf16 a[212:215], v[188:191], v[196:199], a[212:215]
ds_read_b64_tr_b16 v[166:167], v8 offset:55296
v_mfma_f32_16x16x32_bf16 a[216:219], v[188:191], v[200:203], a[216:219]
v_mfma_f32_16x16x32_bf16 a[220:223], v[188:191], v[204:207], a[220:223]
s_waitcnt lgkmcnt(2)
v_mfma_f32_16x16x32_bf16 a[224:227], v[160:163], v[192:195], a[224:227]
ds_read_b64_tr_b16 v[168:169], v9 offset:49152
v_mfma_f32_16x16x32_bf16 a[228:231], v[160:163], v[196:199], a[228:231]
ds_read_b64_tr_b16 v[170:171], v9 offset:55296
v_mfma_f32_16x16x32_bf16 a[232:235], v[160:163], v[200:203], a[232:235]
v_mfma_f32_16x16x32_bf16 a[236:239], v[160:163], v[204:207], a[236:239]
s_waitcnt vmcnt(8) lgkmcnt(2)
v_mfma_f32_16x16x32_bf16 a[0:3], v[164:167], v[208:211], a[0:3]
s_barrier
ds_read_b64_tr_b16 v[172:173], v10 offset:49152
v_mfma_f32_16x16x32_bf16 a[4:7], v[164:167], v[212:215], a[4:7]
ds_read_b64_tr_b16 v[174:175], v10 offset:55296
v_mfma_f32_16x16x32_bf16 a[8:11], v[164:167], v[216:219], a[8:11]
s_add_u32 m0, s44, 131072
v_mfma_f32_16x16x32_bf16 a[12:15], v[164:167], v[220:223], a[12:15]
s_waitcnt lgkmcnt(2)
buffer_load_dwordx4 v4, s[12:15], s40 offen offset:0 lds
v_mfma_f32_16x16x32_bf16 a[16:19], v[168:171], v[208:211], a[16:19]
ds_read_b64_tr_b16 v[176:177], v11 offset:49152
v_mfma_f32_16x16x32_bf16 a[20:23], v[168:171], v[212:215], a[20:23]
ds_read_b64_tr_b16 v[178:179], v11 offset:55296
v_mfma_f32_16x16x32_bf16 a[24:27], v[168:171], v[216:219], a[24:27]
buffer_load_dwordx4 v5, s[12:15], s40 offen offset:1024 lds
v_mfma_f32_16x16x32_bf16 a[28:31], v[168:171], v[220:223], a[28:31]
s_waitcnt lgkmcnt(2)
buffer_load_dwordx4 v6, s[12:15], s40 offen offset:2048 lds
v_mfma_f32_16x16x32_bf16 a[32:35], v[172:175], v[208:211], a[32:35]
ds_read_b64_tr_b16 v[180:181], v8 offset:49280
v_mfma_f32_16x16x32_bf16 a[36:39], v[172:175], v[212:215], a[36:39]
ds_read_b64_tr_b16 v[182:183], v8 offset:55424
v_mfma_f32_16x16x32_bf16 a[40:43], v[172:175], v[216:219], a[40:43]
s_add_u32 m0, s45, 131072
s_add_u32 s40, s40, 393216
v_mfma_f32_16x16x32_bf16 a[44:47], v[172:175], v[220:223], a[44:47]
s_waitcnt lgkmcnt(2)
buffer_load_dwordx4 v7, s[16:19], s41 offen lds
s_add_u32 s41, s41, 98304
v_mfma_f32_16x16x32_bf16 a[48:51], v[176:179], v[208:211], a[48:51]
ds_read_b64_tr_b16 v[184:185], v9 offset:49280
v_mfma_f32_16x16x32_bf16 a[52:55], v[176:179], v[212:215], a[52:55]
ds_read_b64_tr_b16 v[186:187], v9 offset:55424
v_mfma_f32_16x16x32_bf16 a[56:59], v[176:179], v[216:219], a[56:59]
s_add_u32 s6, s75, 0
buffer_load_dwordx4 v[192:195], v2, s[8:11], s6 offen
v_mfma_f32_16x16x32_bf16 a[60:63], v[176:179], v[220:223], a[60:63]
s_waitcnt lgkmcnt(2)
v_mfma_f32_16x16x32_bf16 a[64:67], v[180:183], v[208:211], a[64:67]
ds_read_b64_tr_b16 v[188:189], v10 offset:49280
v_mfma_f32_16x16x32_bf16 a[68:71], v[180:183], v[212:215], a[68:71]
ds_read_b64_tr_b16 v[190:191], v10 offset:55424
v_mfma_f32_16x16x32_bf16 a[72:75], v[180:183], v[216:219], a[72:75]
s_add_u32 s6, s75, 20480
buffer_load_dwordx4 v[196:199], v2, s[8:11], s6 offen
v_mfma_f32_16x16x32_bf16 a[76:79], v[180:183], v[220:223], a[76:79]
s_waitcnt lgkmcnt(2)
v_mfma_f32_16x16x32_bf16 a[80:83], v[184:187], v[208:211], a[80:83]
ds_read_b64_tr_b16 v[160:161], v11 offset:49280
v_mfma_f32_16x16x32_bf16 a[84:87], v[184:187], v[212:215], a[84:87]
ds_read_b64_tr_b16 v[162:163], v11 offset:55424
v_mfma_f32_16x16x32_bf16 a[88:91], v[184:187], v[216:219], a[88:91]
s_add_u32 s6, s75, 40960
buffer_load_dwordx4 v[200:203], v2, s[8:11], s6 offen
v_mfma_f32_16x16x32_bf16 a[92:95], v[184:187], v[220:223], a[92:95]
s_waitcnt lgkmcnt(2)
v_mfma_f32_16x16x32_bf16 a[96:99], v[188:191], v[208:211], a[96:99]
ds_read_b64_tr_b16 v[164:165], v8 offset:49408
v_mfma_f32_16x16x32_bf16 a[100:103], v[188:191], v[212:215], a[100:103]
ds_read_b64_tr_b16 v[166:167], v8 offset:55552
v_mfma_f32_16x16x32_bf16 a[104:107], v[188:191], v[216:219], a[104:107]
s_add_u32 s6, s75, 61440
buffer_load_dwordx4 v[204:207], v2, s[8:11], s6 offen
v_mfma_f32_16x16x32_bf16 a[108:111], v[188:191], v[220:223], a[108:111]
s_waitcnt lgkmcnt(2)
v_mfma_f32_16x16x32_bf16 a[112:115], v[160:163], v[208:211], a[112:115]
ds_read_b64_tr_b16 v[168:169], v9 offset:49408
v_mfma_f32_16x16x32_bf16 a[116:119], v[160:163], v[212:215], a[116:119]
ds_read_b64_tr_b16 v[170:171], v9 offset:55552
v_mfma_f32_16x16x32_bf16 a[120:123], v[160:163], v[216:219], a[120:123]
s_add_u32 s75, s75, 1024
v_mfma_f32_16x16x32_bf16 a[124:127], v[160:163], v[220:223], a[124:127]
s_waitcnt lgkmcnt(2)
v_mfma_f32_16x16x32_bf16 a[128:131], v[164:167], v[208:211], a[128:131]
ds_read_b64_tr_b16 v[172:173], v10 offset:49408
v_mfma_f32_16x16x32_bf16 a[132:135], v[164:167], v[212:215], a[132:135]
ds_read_b64_tr_b16 v[174:175], v10 offset:55552
v_mfma_f32_16x16x32_bf16 a[136:139], v[164:167], v[216:219], a[136:139]
v_mfma_f32_16x16x32_bf16 a[140:143], v[164:167], v[220:223], a[140:143]
s_waitcnt lgkmcnt(2)
v_mfma_f32_16x16x32_bf16 a[144:147], v[168:171], v[208:211], a[144:147]
ds_read_b64_tr_b16 v[176:177], v11 offset:49408
v_mfma_f32_16x16x32_bf16 a[148:151], v[168:171], v[212:215], a[148:151]
ds_read_b64_tr_b16 v[178:179], v11 offset:55552
v_mfma_f32_16x16x32_bf16 a[152:155], v[168:171], v[216:219], a[152:155]
v_mfma_f32_16x16x32_bf16 a[156:159], v[168:171], v[220:223], a[156:159]
s_waitcnt lgkmcnt(2)
v_mfma_f32_16x16x32_bf16 a[160:163], v[172:175], v[208:211], a[160:163]
ds_read_b64_tr_b16 v[180:181], v12 offset:49152
v_mfma_f32_16x16x32_bf16 a[164:167], v[172:175], v[212:215], a[164:167]
ds_read_b64_tr_b16 v[182:183], v12 offset:51200
v_mfma_f32_16x16x32_bf16 a[168:171], v[172:175], v[216:219], a[168:171]
v_mfma_f32_16x16x32_bf16 a[172:175], v[172:175], v[220:223], a[172:175]
s_waitcnt lgkmcnt(2)
v_mfma_f32_16x16x32_bf16 a[176:179], v[176:179], v[208:211], a[176:179]
ds_read_b64_tr_b16 v[184:185], v13 offset:49152
v_mfma_f32_16x16x32_bf16 a[180:183], v[176:179], v[212:215], a[180:183]
ds_read_b64_tr_b16 v[186:187], v13 offset:51200
v_mfma_f32_16x16x32_bf16 a[184:187], v[176:179], v[216:219], a[184:187]
v_mfma_f32_16x16x32_bf16 a[188:191], v[176:179], v[220:223], a[188:191]
s_waitcnt lgkmcnt(2)
v_mfma_f32_16x16x32_bf16 a[192:195], v[180:183], v[208:211], a[192:195]
ds_read_b64_tr_b16 v[188:189], v14 offset:49152
v_mfma_f32_16x16x32_bf16 a[196:199], v[180:183], v[212:215], a[196:199]
ds_read_b64_tr_b16 v[190:191], v14 offset:51200
v_mfma_f32_16x16x32_bf16 a[200:203], v[180:183], v[216:219], a[200:203]
v_mfma_f32_16x16x32_bf16 a[204:207], v[180:183], v[220:223], a[204:207]
s_waitcnt lgkmcnt(2)
v_mfma_f32_16x16x32_bf16 a[208:211], v[184:187], v[208:211], a[208:211]
ds_read_b64_tr_b16 v[160:161], v8 offset:0
v_mfma_f32_16x16x32_bf16 a[212:215], v[184:187], v[212:215], a[212:215]
ds_read_b64_tr_b16 v[162:163], v8 offset:6144
v_mfma_f32_16x16x32_bf16 a[216:219], v[184:187], v[216:219], a[216:219]
v_mfma_f32_16x16x32_bf16 a[220:223], v[184:187], v[220:223], a[220:223]
s_waitcnt lgkmcnt(2)
v_mfma_f32_16x16x32_bf16 a[224:227], v[188:191], v[208:211], a[224:227]
ds_read_b64_tr_b16 v[164:165], v9 offset:0
v_mfma_f32_16x16x32_bf16 a[228:231], v[188:191], v[212:215], a[228:231]
ds_read_b64_tr_b16 v[166:167], v9 offset:6144
v_mfma_f32_16x16x32_bf16 a[232:235], v[188:191], v[216:219], a[232:235]
v_mfma_f32_16x16x32_bf16 a[236:239], v[188:191], v[220:223], a[236:239]
s_waitcnt vmcnt(8) lgkmcnt(2)
v_mfma_f32_16x16x32_bf16 a[0:3], v[160:163], v[224:227], a[0:3]
s_barrier
ds_read_b64_tr_b16 v[168:169], v10 offset:0
v_mfma_f32_16x16x32_bf16 a[4:7], v[160:163], v[228:231], a[4:7]
ds_read_b64_tr_b16 v[170:171], v10 offset:6144
v_mfma_f32_16x16x32_bf16 a[8:11], v[160:163], v[232:235], a[8:11]
s_add_u32 m0, s44, 147456
v_mfma_f32_16x16x32_bf16 a[12:15], v[160:163], v[236:239], a[12:15]
s_waitcnt lgkmcnt(2)
buffer_load_dwordx4 v4, s[12:15], s40 offen offset:0 lds
v_mfma_f32_16x16x32_bf16 a[16:19], v[164:167], v[224:227], a[16:19]
ds_read_b64_tr_b16 v[172:173], v11 offset:0
v_mfma_f32_16x16x32_bf16 a[20:23], v[164:167], v[228:231], a[20:23]
ds_read_b64_tr_b16 v[174:175], v11 offset:6144
v_mfma_f32_16x16x32_bf16 a[24:27], v[164:167], v[232:235], a[24:27]
buffer_load_dwordx4 v5, s[12:15], s40 offen offset:1024 lds
v_mfma_f32_16x16x32_bf16 a[28:31], v[164:167], v[236:239], a[28:31]
s_waitcnt lgkmcnt(2)
buffer_load_dwordx4 v6, s[12:15], s40 offen offset:2048 lds
v_mfma_f32_16x16x32_bf16 a[32:35], v[168:171], v[224:227], a[32:35]
ds_read_b64_tr_b16 v[176:177], v8 offset:128
v_mfma_f32_16x16x32_bf16 a[36:39], v[168:171], v[228:231], a[36:39]
ds_read_b64_tr_b16 v[178:179], v8 offset:6272
v_mfma_f32_16x16x32_bf16 a[40:43], v[168:171], v[232:235], a[40:43]
s_add_u32 m0, s45, 147456
s_add_u32 s40, s40, 393216
v_mfma_f32_16x16x32_bf16 a[44:47], v[168:171], v[236:239], a[44:47]
s_waitcnt lgkmcnt(2)
buffer_load_dwordx4 v7, s[16:19], s41 offen lds
s_add_u32 s41, s41, 98304
v_mfma_f32_16x16x32_bf16 a[48:51], v[172:175], v[224:227], a[48:51]
ds_read_b64_tr_b16 v[180:181], v9 offset:128
v_mfma_f32_16x16x32_bf16 a[52:55], v[172:175], v[228:231], a[52:55]
ds_read_b64_tr_b16 v[182:183], v9 offset:6272
v_mfma_f32_16x16x32_bf16 a[56:59], v[172:175], v[232:235], a[56:59]
s_add_u32 s6, s75, 0
buffer_load_dwordx4 v[208:211], v2, s[8:11], s6 offen
v_mfma_f32_16x16x32_bf16 a[60:63], v[172:175], v[236:239], a[60:63]
s_waitcnt lgkmcnt(2)
v_mfma_f32_16x16x32_bf16 a[64:67], v[176:179], v[224:227], a[64:67]
ds_read_b64_tr_b16 v[184:185], v10 offset:128
v_mfma_f32_16x16x32_bf16 a[68:71], v[176:179], v[228:231], a[68:71]
ds_read_b64_tr_b16 v[186:187], v10 offset:6272
v_mfma_f32_16x16x32_bf16 a[72:75], v[176:179], v[232:235], a[72:75]
s_add_u32 s6, s75, 20480
buffer_load_dwordx4 v[212:215], v2, s[8:11], s6 offen
v_mfma_f32_16x16x32_bf16 a[76:79], v[176:179], v[236:239], a[76:79]
s_waitcnt lgkmcnt(2)
v_mfma_f32_16x16x32_bf16 a[80:83], v[180:183], v[224:227], a[80:83]
ds_read_b64_tr_b16 v[188:189], v11 offset:128
v_mfma_f32_16x16x32_bf16 a[84:87], v[180:183], v[228:231], a[84:87]
ds_read_b64_tr_b16 v[190:191], v11 offset:6272
v_mfma_f32_16x16x32_bf16 a[88:91], v[180:183], v[232:235], a[88:91]
s_add_u32 s6, s75, 40960
buffer_load_dwordx4 v[216:219], v2, s[8:11], s6 offen
v_mfma_f32_16x16x32_bf16 a[92:95], v[180:183], v[236:239], a[92:95]
s_waitcnt lgkmcnt(2)
v_mfma_f32_16x16x32_bf16 a[96:99], v[184:187], v[224:227], a[96:99]
ds_read_b64_tr_b16 v[160:161], v8 offset:256
v_mfma_f32_16x16x32_bf16 a[100:103], v[184:187], v[228:231], a[100:103]
ds_read_b64_tr_b16 v[162:163], v8 offset:6400
v_mfma_f32_16x16x32_bf16 a[104:107], v[184:187], v[232:235], a[104:107]
s_add_u32 s6, s75, 61440
buffer_load_dwordx4 v[220:223], v2, s[8:11], s6 offen
v_mfma_f32_16x16x32_bf16 a[108:111], v[184:187], v[236:239], a[108:111]
s_waitcnt lgkmcnt(2)
v_mfma_f32_16x16x32_bf16 a[112:115], v[188:191], v[224:227], a[112:115]
ds_read_b64_tr_b16 v[164:165], v9 offset:256
v_mfma_f32_16x16x32_bf16 a[116:119], v[188:191], v[228:231], a[116:119]
ds_read_b64_tr_b16 v[166:167], v9 offset:6400
v_mfma_f32_16x16x32_bf16 a[120:123], v[188:191], v[232:235], a[120:123]
s_add_u32 s75, s75, 1024
v_mfma_f32_16x16x32_bf16 a[124:127], v[188:191], v[236:239], a[124:127]
s_waitcnt lgkmcnt(2)
v_mfma_f32_16x16x32_bf16 a[128:131], v[160:163], v[224:227], a[128:131]
ds_read_b64_tr_b16 v[168:169], v10 offset:256
v_mfma_f32_16x16x32_bf16 a[132:135], v[160:163], v[228:231], a[132:135]
ds_read_b64_tr_b16 v[170:171], v10 offset:6400
v_mfma_f32_16x16x32_bf16 a[136:139], v[160:163], v[232:235], a[136:139]
s_add_u32 m0, s46, 0
v_mfma_f32_16x16x32_bf16 a[140:143], v[160:163], v[236:239], a[140:143]
s_waitcnt lgkmcnt(2)
buffer_load_dwordx4 v22, s[20:23], s42 offen offset:0 lds
v_mfma_f32_16x16x32_bf16 a[144:147], v[164:167], v[224:227], a[144:147]
ds_read_b64_tr_b16 v[172:173], v11 offset:256
v_mfma_f32_16x16x32_bf16 a[148:151], v[164:167], v[228:231], a[148:151]
ds_read_b64_tr_b16 v[174:175], v11 offset:6400
v_mfma_f32_16x16x32_bf16 a[152:155], v[164:167], v[232:235], a[152:155]
buffer_load_dwordx4 v23, s[20:23], s42 offen offset:1024 lds
v_mfma_f32_16x16x32_bf16 a[156:159], v[164:167], v[236:239], a[156:159]
s_waitcnt lgkmcnt(2)
buffer_load_dwordx4 v24, s[20:23], s42 offen offset:2048 lds
v_mfma_f32_16x16x32_bf16 a[160:163], v[168:171], v[224:227], a[160:163]
ds_read_b64_tr_b16 v[176:177], v12 offset:0
v_mfma_f32_16x16x32_bf16 a[164:167], v[168:171], v[228:231], a[164:167]
ds_read_b64_tr_b16 v[178:179], v12 offset:2048
v_mfma_f32_16x16x32_bf16 a[168:171], v[168:171], v[232:235], a[168:171]
s_add_u32 s42, s42, 12288
v_mfma_f32_16x16x32_bf16 a[172:175], v[168:171], v[236:239], a[172:175]
s_waitcnt lgkmcnt(2)
v_mfma_f32_16x16x32_bf16 a[176:179], v[172:175], v[224:227], a[176:179]
ds_read_b64_tr_b16 v[180:181], v13 offset:0
v_mfma_f32_16x16x32_bf16 a[180:183], v[172:175], v[228:231], a[180:183]
ds_read_b64_tr_b16 v[182:183], v13 offset:2048
v_mfma_f32_16x16x32_bf16 a[184:187], v[172:175], v[232:235], a[184:187]
v_mfma_f32_16x16x32_bf16 a[188:191], v[172:175], v[236:239], a[188:191]
s_waitcnt lgkmcnt(2)
v_mfma_f32_16x16x32_bf16 a[192:195], v[176:179], v[224:227], a[192:195]
ds_read_b64_tr_b16 v[184:185], v14 offset:0
v_mfma_f32_16x16x32_bf16 a[196:199], v[176:179], v[228:231], a[196:199]
ds_read_b64_tr_b16 v[186:187], v14 offset:2048
v_mfma_f32_16x16x32_bf16 a[200:203], v[176:179], v[232:235], a[200:203]
v_mfma_f32_16x16x32_bf16 a[204:207], v[176:179], v[236:239], a[204:207]
s_waitcnt lgkmcnt(2)
v_mfma_f32_16x16x32_bf16 a[208:211], v[180:183], v[224:227], a[208:211]
ds_read_b64_tr_b16 v[188:189], v8 offset:16384
v_mfma_f32_16x16x32_bf16 a[212:215], v[180:183], v[228:231], a[212:215]
ds_read_b64_tr_b16 v[190:191], v8 offset:22528
v_mfma_f32_16x16x32_bf16 a[216:219], v[180:183], v[232:235], a[216:219]
v_mfma_f32_16x16x32_bf16 a[220:223], v[180:183], v[236:239], a[220:223]
s_waitcnt lgkmcnt(2)
v_mfma_f32_16x16x32_bf16 a[224:227], v[184:187], v[224:227], a[224:227]
ds_read_b64_tr_b16 v[160:161], v9 offset:16384
v_mfma_f32_16x16x32_bf16 a[228:231], v[184:187], v[228:231], a[228:231]
ds_read_b64_tr_b16 v[162:163], v9 offset:22528
v_mfma_f32_16x16x32_bf16 a[232:235], v[184:187], v[232:235], a[232:235]
v_mfma_f32_16x16x32_bf16 a[236:239], v[184:187], v[236:239], a[236:239]
s_waitcnt vmcnt(11) lgkmcnt(2)
v_mfma_f32_16x16x32_bf16 a[0:3], v[188:191], v[192:195], a[0:3]
s_barrier
ds_read_b64_tr_b16 v[164:165], v10 offset:16384
v_mfma_f32_16x16x32_bf16 a[4:7], v[188:191], v[196:199], a[4:7]
ds_read_b64_tr_b16 v[166:167], v10 offset:22528
v_mfma_f32_16x16x32_bf16 a[8:11], v[188:191], v[200:203], a[8:11]
s_add_u32 m0, s44, 98304
v_mfma_f32_16x16x32_bf16 a[12:15], v[188:191], v[204:207], a[12:15]
s_waitcnt lgkmcnt(2)
buffer_load_dwordx4 v4, s[12:15], s40 offen offset:0 lds
v_mfma_f32_16x16x32_bf16 a[16:19], v[160:163], v[192:195], a[16:19]
ds_read_b64_tr_b16 v[168:169], v11 offset:16384
v_mfma_f32_16x16x32_bf16 a[20:23], v[160:163], v[196:199], a[20:23]
ds_read_b64_tr_b16 v[170:171], v11 offset:22528
v_mfma_f32_16x16x32_bf16 a[24:27], v[160:163], v[200:203], a[24:27]
buffer_load_dwordx4 v5, s[12:15], s40 offen offset:1024 lds
v_mfma_f32_16x16x32_bf16 a[28:31], v[160:163], v[204:207], a[28:31]
s_waitcnt lgkmcnt(2)
buffer_load_dwordx4 v6, s[12:15], s40 offen offset:2048 lds
v_mfma_f32_16x16x32_bf16 a[32:35], v[164:167], v[192:195], a[32:35]
ds_read_b64_tr_b16 v[172:173], v8 offset:16512
v_mfma_f32_16x16x32_bf16 a[36:39], v[164:167], v[196:199], a[36:39]
ds_read_b64_tr_b16 v[174:175], v8 offset:22656
v_mfma_f32_16x16x32_bf16 a[40:43], v[164:167], v[200:203], a[40:43]
s_add_u32 m0, s45, 98304
s_add_u32 s40, s40, 393216
v_mfma_f32_16x16x32_bf16 a[44:47], v[164:167], v[204:207], a[44:47]
s_waitcnt lgkmcnt(2)
buffer_load_dwordx4 v7, s[16:19], s41 offen lds
s_add_u32 s41, s41, 98304
v_mfma_f32_16x16x32_bf16 a[48:51], v[168:171], v[192:195], a[48:51]
ds_read_b64_tr_b16 v[176:177], v9 offset:16512
v_mfma_f32_16x16x32_bf16 a[52:55], v[168:171], v[196:199], a[52:55]
ds_read_b64_tr_b16 v[178:179], v9 offset:22656
v_mfma_f32_16x16x32_bf16 a[56:59], v[168:171], v[200:203], a[56:59]
s_add_u32 s6, s75, 0
buffer_load_dwordx4 v[224:227], v2, s[8:11], s6 offen
v_mfma_f32_16x16x32_bf16 a[60:63], v[168:171], v[204:207], a[60:63]
s_waitcnt lgkmcnt(2)
v_mfma_f32_16x16x32_bf16 a[64:67], v[172:175], v[192:195], a[64:67]
ds_read_b64_tr_b16 v[180:181], v10 offset:16512
v_mfma_f32_16x16x32_bf16 a[68:71], v[172:175], v[196:199], a[68:71]
ds_read_b64_tr_b16 v[182:183], v10 offset:22656
v_mfma_f32_16x16x32_bf16 a[72:75], v[172:175], v[200:203], a[72:75]
s_add_u32 s6, s75, 20480
buffer_load_dwordx4 v[228:231], v2, s[8:11], s6 offen
v_mfma_f32_16x16x32_bf16 a[76:79], v[172:175], v[204:207], a[76:79]
s_waitcnt lgkmcnt(2)
v_mfma_f32_16x16x32_bf16 a[80:83], v[176:179], v[192:195], a[80:83]
ds_read_b64_tr_b16 v[184:185], v11 offset:16512
v_mfma_f32_16x16x32_bf16 a[84:87], v[176:179], v[196:199], a[84:87]
ds_read_b64_tr_b16 v[186:187], v11 offset:22656
v_mfma_f32_16x16x32_bf16 a[88:91], v[176:179], v[200:203], a[88:91]
s_add_u32 s6, s75, 40960
buffer_load_dwordx4 v[232:235], v2, s[8:11], s6 offen
v_mfma_f32_16x16x32_bf16 a[92:95], v[176:179], v[204:207], a[92:95]
s_waitcnt lgkmcnt(2)
v_mfma_f32_16x16x32_bf16 a[96:99], v[180:183], v[192:195], a[96:99]
ds_read_b64_tr_b16 v[188:189], v8 offset:16640
v_mfma_f32_16x16x32_bf16 a[100:103], v[180:183], v[196:199], a[100:103]
ds_read_b64_tr_b16 v[190:191], v8 offset:22784
v_mfma_f32_16x16x32_bf16 a[104:107], v[180:183], v[200:203], a[104:107]
s_add_u32 s6, s75, 61440
buffer_load_dwordx4 v[236:239], v2, s[8:11], s6 offen
v_mfma_f32_16x16x32_bf16 a[108:111], v[180:183], v[204:207], a[108:111]
s_waitcnt lgkmcnt(2)
v_mfma_f32_16x16x32_bf16 a[112:115], v[184:187], v[192:195], a[112:115]
ds_read_b64_tr_b16 v[160:161], v9 offset:16640
v_mfma_f32_16x16x32_bf16 a[116:119], v[184:187], v[196:199], a[116:119]
ds_read_b64_tr_b16 v[162:163], v9 offset:22784
v_mfma_f32_16x16x32_bf16 a[120:123], v[184:187], v[200:203], a[120:123]
s_add_u32 s75, s75, 1024
v_mfma_f32_16x16x32_bf16 a[124:127], v[184:187], v[204:207], a[124:127]
s_waitcnt lgkmcnt(2)
v_mfma_f32_16x16x32_bf16 a[128:131], v[188:191], v[192:195], a[128:131]
ds_read_b64_tr_b16 v[164:165], v10 offset:16640
v_mfma_f32_16x16x32_bf16 a[132:135], v[188:191], v[196:199], a[132:135]
ds_read_b64_tr_b16 v[166:167], v10 offset:22784
v_mfma_f32_16x16x32_bf16 a[136:139], v[188:191], v[200:203], a[136:139]
s_add_u32 m0, s46, 12288
v_mfma_f32_16x16x32_bf16 a[140:143], v[188:191], v[204:207], a[140:143]
s_waitcnt lgkmcnt(2)
buffer_load_dwordx4 v22, s[20:23], s42 offen offset:0 lds
v_mfma_f32_16x16x32_bf16 a[144:147], v[160:163], v[192:195], a[144:147]
ds_read_b64_tr_b16 v[168:169], v11 offset:16640
v_mfma_f32_16x16x32_bf16 a[148:151], v[160:163], v[196:199], a[148:151]
ds_read_b64_tr_b16 v[170:171], v11 offset:22784
v_mfma_f32_16x16x32_bf16 a[152:155], v[160:163], v[200:203], a[152:155]
buffer_load_dwordx4 v23, s[20:23], s42 offen offset:1024 lds
v_mfma_f32_16x16x32_bf16 a[156:159], v[160:163], v[204:207], a[156:159]
s_waitcnt lgkmcnt(2)
buffer_load_dwordx4 v24, s[20:23], s42 offen offset:2048 lds
v_mfma_f32_16x16x32_bf16 a[160:163], v[164:167], v[192:195], a[160:163]
ds_read_b64_tr_b16 v[172:173], v12 offset:16384
v_mfma_f32_16x16x32_bf16 a[164:167], v[164:167], v[196:199], a[164:167]
ds_read_b64_tr_b16 v[174:175], v12 offset:18432
v_mfma_f32_16x16x32_bf16 a[168:171], v[164:167], v[200:203], a[168:171]
v_mfma_f32_16x16x32_bf16 a[172:175], v[164:167], v[204:207], a[172:175]
s_waitcnt lgkmcnt(2)
v_mfma_f32_16x16x32_bf16 a[176:179], v[168:171], v[192:195], a[176:179]
ds_read_b64_tr_b16 v[176:177], v13 offset:16384
v_mfma_f32_16x16x32_bf16 a[180:183], v[168:171], v[196:199], a[180:183]
ds_read_b64_tr_b16 v[178:179], v13 offset:18432
v_mfma_f32_16x16x32_bf16 a[184:187], v[168:171], v[200:203], a[184:187]
v_mfma_f32_16x16x32_bf16 a[188:191], v[168:171], v[204:207], a[188:191]
s_waitcnt lgkmcnt(2)
v_mfma_f32_16x16x32_bf16 a[192:195], v[172:175], v[192:195], a[192:195]
ds_read_b64_tr_b16 v[180:181], v14 offset:16384
v_mfma_f32_16x16x32_bf16 a[196:199], v[172:175], v[196:199], a[196:199]
ds_read_b64_tr_b16 v[182:183], v14 offset:18432
v_mfma_f32_16x16x32_bf16 a[200:203], v[172:175], v[200:203], a[200:203]
v_mfma_f32_16x16x32_bf16 a[204:207], v[172:175], v[204:207], a[204:207]
s_waitcnt lgkmcnt(2)
v_mfma_f32_16x16x32_bf16 a[208:211], v[176:179], v[192:195], a[208:211]
ds_read_b64_tr_b16 v[184:185], v8 offset:32768
v_mfma_f32_16x16x32_bf16 a[212:215], v[176:179], v[196:199], a[212:215]
ds_read_b64_tr_b16 v[186:187], v8 offset:38912
v_mfma_f32_16x16x32_bf16 a[216:219], v[176:179], v[200:203], a[216:219]
v_mfma_f32_16x16x32_bf16 a[220:223], v[176:179], v[204:207], a[220:223]
s_waitcnt lgkmcnt(2)
v_mfma_f32_16x16x32_bf16 a[224:227], v[180:183], v[192:195], a[224:227]
ds_read_b64_tr_b16 v[188:189], v9 offset:32768
v_mfma_f32_16x16x32_bf16 a[228:231], v[180:183], v[196:199], a[228:231]
ds_read_b64_tr_b16 v[190:191], v9 offset:38912
v_mfma_f32_16x16x32_bf16 a[232:235], v[180:183], v[200:203], a[232:235]
v_mfma_f32_16x16x32_bf16 a[236:239], v[180:183], v[204:207], a[236:239]
s_waitcnt vmcnt(14) lgkmcnt(2)
v_mfma_f32_16x16x32_bf16 a[0:3], v[184:187], v[208:211], a[0:3]
s_barrier
ds_read_b64_tr_b16 v[160:161], v10 offset:32768
v_mfma_f32_16x16x32_bf16 a[4:7], v[184:187], v[212:215], a[4:7]
ds_read_b64_tr_b16 v[162:163], v10 offset:38912
v_mfma_f32_16x16x32_bf16 a[8:11], v[184:187], v[216:219], a[8:11]
s_add_u32 m0, s44, 114688
v_mfma_f32_16x16x32_bf16 a[12:15], v[184:187], v[220:223], a[12:15]
s_waitcnt lgkmcnt(2)
buffer_load_dwordx4 v4, s[12:15], s40 offen offset:0 lds
v_mfma_f32_16x16x32_bf16 a[16:19], v[188:191], v[208:211], a[16:19]
ds_read_b64_tr_b16 v[164:165], v11 offset:32768
v_mfma_f32_16x16x32_bf16 a[20:23], v[188:191], v[212:215], a[20:23]
ds_read_b64_tr_b16 v[166:167], v11 offset:38912
v_mfma_f32_16x16x32_bf16 a[24:27], v[188:191], v[216:219], a[24:27]
buffer_load_dwordx4 v5, s[12:15], s40 offen offset:1024 lds
v_mfma_f32_16x16x32_bf16 a[28:31], v[188:191], v[220:223], a[28:31]
s_waitcnt lgkmcnt(2)
buffer_load_dwordx4 v6, s[12:15], s40 offen offset:2048 lds
v_mfma_f32_16x16x32_bf16 a[32:35], v[160:163], v[208:211], a[32:35]
ds_read_b64_tr_b16 v[168:169], v8 offset:32896
v_mfma_f32_16x16x32_bf16 a[36:39], v[160:163], v[212:215], a[36:39]
ds_read_b64_tr_b16 v[170:171], v8 offset:39040
v_mfma_f32_16x16x32_bf16 a[40:43], v[160:163], v[216:219], a[40:43]
s_add_u32 m0, s45, 114688
s_add_u32 s40, s40, 393216
v_mfma_f32_16x16x32_bf16 a[44:47], v[160:163], v[220:223], a[44:47]
s_waitcnt lgkmcnt(2)
buffer_load_dwordx4 v7, s[16:19], s41 offen lds
s_add_u32 s41, s41, 98304
v_mfma_f32_16x16x32_bf16 a[48:51], v[164:167], v[208:211], a[48:51]
ds_read_b64_tr_b16 v[172:173], v9 offset:32896
v_mfma_f32_16x16x32_bf16 a[52:55], v[164:167], v[212:215], a[52:55]
ds_read_b64_tr_b16 v[174:175], v9 offset:39040
v_mfma_f32_16x16x32_bf16 a[56:59], v[164:167], v[216:219], a[56:59]
s_add_u32 s6, s75, 0
buffer_load_dwordx4 v[192:195], v2, s[8:11], s6 offen
v_mfma_f32_16x16x32_bf16 a[60:63], v[164:167], v[220:223], a[60:63]
s_waitcnt lgkmcnt(2)
v_mfma_f32_16x16x32_bf16 a[64:67], v[168:171], v[208:211], a[64:67]
ds_read_b64_tr_b16 v[176:177], v10 offset:32896
v_mfma_f32_16x16x32_bf16 a[68:71], v[168:171], v[212:215], a[68:71]
ds_read_b64_tr_b16 v[178:179], v10 offset:39040
v_mfma_f32_16x16x32_bf16 a[72:75], v[168:171], v[216:219], a[72:75]
s_add_u32 s6, s75, 20480
buffer_load_dwordx4 v[196:199], v2, s[8:11], s6 offen
v_mfma_f32_16x16x32_bf16 a[76:79], v[168:171], v[220:223], a[76:79]
s_waitcnt lgkmcnt(2)
v_mfma_f32_16x16x32_bf16 a[80:83], v[172:175], v[208:211], a[80:83]
ds_read_b64_tr_b16 v[180:181], v11 offset:32896
v_mfma_f32_16x16x32_bf16 a[84:87], v[172:175], v[212:215], a[84:87]
ds_read_b64_tr_b16 v[182:183], v11 offset:39040
v_mfma_f32_16x16x32_bf16 a[88:91], v[172:175], v[216:219], a[88:91]
s_add_u32 s6, s75, 40960
buffer_load_dwordx4 v[200:203], v2, s[8:11], s6 offen
v_mfma_f32_16x16x32_bf16 a[92:95], v[172:175], v[220:223], a[92:95]
s_waitcnt lgkmcnt(2)
v_mfma_f32_16x16x32_bf16 a[96:99], v[176:179], v[208:211], a[96:99]
ds_read_b64_tr_b16 v[184:185], v8 offset:33024
v_mfma_f32_16x16x32_bf16 a[100:103], v[176:179], v[212:215], a[100:103]
ds_read_b64_tr_b16 v[186:187], v8 offset:39168
v_mfma_f32_16x16x32_bf16 a[104:107], v[176:179], v[216:219], a[104:107]
s_add_u32 s6, s75, 61440
buffer_load_dwordx4 v[204:207], v2, s[8:11], s6 offen
v_mfma_f32_16x16x32_bf16 a[108:111], v[176:179], v[220:223], a[108:111]
s_waitcnt lgkmcnt(2)
v_mfma_f32_16x16x32_bf16 a[112:115], v[180:183], v[208:211], a[112:115]
ds_read_b64_tr_b16 v[188:189], v9 offset:33024
v_mfma_f32_16x16x32_bf16 a[116:119], v[180:183], v[212:215], a[116:119]
ds_read_b64_tr_b16 v[190:191], v9 offset:39168
v_mfma_f32_16x16x32_bf16 a[120:123], v[180:183], v[216:219], a[120:123]
s_add_u32 s75, s75, 1024
v_mfma_f32_16x16x32_bf16 a[124:127], v[180:183], v[220:223], a[124:127]
s_waitcnt lgkmcnt(2)
v_mfma_f32_16x16x32_bf16 a[128:131], v[184:187], v[208:211], a[128:131]
ds_read_b64_tr_b16 v[160:161], v10 offset:33024
v_mfma_f32_16x16x32_bf16 a[132:135], v[184:187], v[212:215], a[132:135]
ds_read_b64_tr_b16 v[162:163], v10 offset:39168
v_mfma_f32_16x16x32_bf16 a[136:139], v[184:187], v[216:219], a[136:139]
s_add_u32 m0, s47, 0
v_mfma_f32_16x16x32_bf16 a[140:143], v[184:187], v[220:223], a[140:143]
s_waitcnt lgkmcnt(2)
buffer_load_dwordx4 v25, s[24:27], s42 offen offset:0 lds
v_mfma_f32_16x16x32_bf16 a[144:147], v[188:191], v[208:211], a[144:147]
ds_read_b64_tr_b16 v[164:165], v11 offset:33024
v_mfma_f32_16x16x32_bf16 a[148:151], v[188:191], v[212:215], a[148:151]
ds_read_b64_tr_b16 v[166:167], v11 offset:39168
v_mfma_f32_16x16x32_bf16 a[152:155], v[188:191], v[216:219], a[152:155]
buffer_load_dwordx4 v26, s[24:27], s42 offen offset:1024 lds
v_mfma_f32_16x16x32_bf16 a[156:159], v[188:191], v[220:223], a[156:159]
s_waitcnt lgkmcnt(2)
buffer_load_dwordx4 v27, s[24:27], s42 offen offset:2048 lds
v_mfma_f32_16x16x32_bf16 a[160:163], v[160:163], v[208:211], a[160:163]
ds_read_b64_tr_b16 v[168:169], v12 offset:32768
v_mfma_f32_16x16x32_bf16 a[164:167], v[160:163], v[212:215], a[164:167]
ds_read_b64_tr_b16 v[170:171], v12 offset:34816
v_mfma_f32_16x16x32_bf16 a[168:171], v[160:163], v[216:219], a[168:171]
s_add_u32 s42, s42, 12288
v_mfma_f32_16x16x32_bf16 a[172:175], v[160:163], v[220:223], a[172:175]
s_waitcnt lgkmcnt(2)
v_mfma_f32_16x16x32_bf16 a[176:179], v[164:167], v[208:211], a[176:179]
ds_read_b64_tr_b16 v[172:173], v13 offset:32768
v_mfma_f32_16x16x32_bf16 a[180:183], v[164:167], v[212:215], a[180:183]
ds_read_b64_tr_b16 v[174:175], v13 offset:34816
v_mfma_f32_16x16x32_bf16 a[184:187], v[164:167], v[216:219], a[184:187]
v_mfma_f32_16x16x32_bf16 a[188:191], v[164:167], v[220:223], a[188:191]
s_waitcnt lgkmcnt(2)
v_mfma_f32_16x16x32_bf16 a[192:195], v[168:171], v[208:211], a[192:195]
ds_read_b64_tr_b16 v[176:177], v14 offset:32768
v_mfma_f32_16x16x32_bf16 a[196:199], v[168:171], v[212:215], a[196:199]
ds_read_b64_tr_b16 v[178:179], v14 offset:34816
v_mfma_f32_16x16x32_bf16 a[200:203], v[168:171], v[216:219], a[200:203]
v_mfma_f32_16x16x32_bf16 a[204:207], v[168:171], v[220:223], a[204:207]
s_waitcnt lgkmcnt(2)
v_mfma_f32_16x16x32_bf16 a[208:211], v[172:175], v[208:211], a[208:211]
ds_read_b64_tr_b16 v[180:181], v8 offset:49152
v_mfma_f32_16x16x32_bf16 a[212:215], v[172:175], v[212:215], a[212:215]
ds_read_b64_tr_b16 v[182:183], v8 offset:55296
v_mfma_f32_16x16x32_bf16 a[216:219], v[172:175], v[216:219], a[216:219]
v_mfma_f32_16x16x32_bf16 a[220:223], v[172:175], v[220:223], a[220:223]
s_waitcnt lgkmcnt(2)
v_mfma_f32_16x16x32_bf16 a[224:227], v[176:179], v[208:211], a[224:227]
ds_read_b64_tr_b16 v[184:185], v9 offset:49152
v_mfma_f32_16x16x32_bf16 a[228:231], v[176:179], v[212:215], a[228:231]
ds_read_b64_tr_b16 v[186:187], v9 offset:55296
v_mfma_f32_16x16x32_bf16 a[232:235], v[176:179], v[216:219], a[232:235]
v_mfma_f32_16x16x32_bf16 a[236:239], v[176:179], v[220:223], a[236:239]
s_waitcnt vmcnt(14) lgkmcnt(2)
v_mfma_f32_16x16x32_bf16 a[0:3], v[180:183], v[224:227], a[0:3]
s_barrier
ds_read_b64_tr_b16 v[188:189], v10 offset:49152
v_mfma_f32_16x16x32_bf16 a[4:7], v[180:183], v[228:231], a[4:7]
ds_read_b64_tr_b16 v[190:191], v10 offset:55296
v_mfma_f32_16x16x32_bf16 a[8:11], v[180:183], v[232:235], a[8:11]
s_add_u32 m0, s44, 131072
v_mfma_f32_16x16x32_bf16 a[12:15], v[180:183], v[236:239], a[12:15]
s_waitcnt lgkmcnt(2)
buffer_load_dwordx4 v4, s[12:15], s40 offen offset:0 lds
v_mfma_f32_16x16x32_bf16 a[16:19], v[184:187], v[224:227], a[16:19]
ds_read_b64_tr_b16 v[160:161], v11 offset:49152
v_mfma_f32_16x16x32_bf16 a[20:23], v[184:187], v[228:231], a[20:23]
ds_read_b64_tr_b16 v[162:163], v11 offset:55296
v_mfma_f32_16x16x32_bf16 a[24:27], v[184:187], v[232:235], a[24:27]
buffer_load_dwordx4 v5, s[12:15], s40 offen offset:1024 lds
v_mfma_f32_16x16x32_bf16 a[28:31], v[184:187], v[236:239], a[28:31]
s_waitcnt lgkmcnt(2)
buffer_load_dwordx4 v6, s[12:15], s40 offen offset:2048 lds
v_mfma_f32_16x16x32_bf16 a[32:35], v[188:191], v[224:227], a[32:35]
ds_read_b64_tr_b16 v[164:165], v8 offset:49280
v_mfma_f32_16x16x32_bf16 a[36:39], v[188:191], v[228:231], a[36:39]
ds_read_b64_tr_b16 v[166:167], v8 offset:55424
v_mfma_f32_16x16x32_bf16 a[40:43], v[188:191], v[232:235], a[40:43]
s_add_u32 m0, s45, 131072
s_add_u32 s40, s40, 393216
v_mfma_f32_16x16x32_bf16 a[44:47], v[188:191], v[236:239], a[44:47]
s_waitcnt lgkmcnt(2)
buffer_load_dwordx4 v7, s[16:19], s41 offen lds
s_add_u32 s41, s41, 98304
v_mfma_f32_16x16x32_bf16 a[48:51], v[160:163], v[224:227], a[48:51]
ds_read_b64_tr_b16 v[168:169], v9 offset:49280
v_mfma_f32_16x16x32_bf16 a[52:55], v[160:163], v[228:231], a[52:55]
ds_read_b64_tr_b16 v[170:171], v9 offset:55424
v_mfma_f32_16x16x32_bf16 a[56:59], v[160:163], v[232:235], a[56:59]
s_add_u32 s6, s75, 0
buffer_load_dwordx4 v[208:211], v2, s[8:11], s6 offen
v_mfma_f32_16x16x32_bf16 a[60:63], v[160:163], v[236:239], a[60:63]
s_waitcnt lgkmcnt(2)
v_mfma_f32_16x16x32_bf16 a[64:67], v[164:167], v[224:227], a[64:67]
ds_read_b64_tr_b16 v[172:173], v10 offset:49280
v_mfma_f32_16x16x32_bf16 a[68:71], v[164:167], v[228:231], a[68:71]
ds_read_b64_tr_b16 v[174:175], v10 offset:55424
v_mfma_f32_16x16x32_bf16 a[72:75], v[164:167], v[232:235], a[72:75]
s_add_u32 s6, s75, 20480
buffer_load_dwordx4 v[212:215], v2, s[8:11], s6 offen
v_mfma_f32_16x16x32_bf16 a[76:79], v[164:167], v[236:239], a[76:79]
s_waitcnt lgkmcnt(2)
v_mfma_f32_16x16x32_bf16 a[80:83], v[168:171], v[224:227], a[80:83]
ds_read_b64_tr_b16 v[176:177], v11 offset:49280
v_mfma_f32_16x16x32_bf16 a[84:87], v[168:171], v[228:231], a[84:87]
ds_read_b64_tr_b16 v[178:179], v11 offset:55424
v_mfma_f32_16x16x32_bf16 a[88:91], v[168:171], v[232:235], a[88:91]
s_add_u32 s6, s75, 40960
buffer_load_dwordx4 v[216:219], v2, s[8:11], s6 offen
v_mfma_f32_16x16x32_bf16 a[92:95], v[168:171], v[236:239], a[92:95]
s_waitcnt lgkmcnt(2)
v_mfma_f32_16x16x32_bf16 a[96:99], v[172:175], v[224:227], a[96:99]
ds_read_b64_tr_b16 v[180:181], v8 offset:49408
v_mfma_f32_16x16x32_bf16 a[100:103], v[172:175], v[228:231], a[100:103]
ds_read_b64_tr_b16 v[182:183], v8 offset:55552
v_mfma_f32_16x16x32_bf16 a[104:107], v[172:175], v[232:235], a[104:107]
s_add_u32 s6, s75, 61440
buffer_load_dwordx4 v[220:223], v2, s[8:11], s6 offen
v_mfma_f32_16x16x32_bf16 a[108:111], v[172:175], v[236:239], a[108:111]
s_waitcnt lgkmcnt(2)
v_mfma_f32_16x16x32_bf16 a[112:115], v[176:179], v[224:227], a[112:115]
ds_read_b64_tr_b16 v[184:185], v9 offset:49408
v_mfma_f32_16x16x32_bf16 a[116:119], v[176:179], v[228:231], a[116:119]
ds_read_b64_tr_b16 v[186:187], v9 offset:55552
v_mfma_f32_16x16x32_bf16 a[120:123], v[176:179], v[232:235], a[120:123]
s_add_u32 s75, s75, 1024
v_mfma_f32_16x16x32_bf16 a[124:127], v[176:179], v[236:239], a[124:127]
s_waitcnt lgkmcnt(2)
v_mfma_f32_16x16x32_bf16 a[128:131], v[180:183], v[224:227], a[128:131]
ds_read_b64_tr_b16 v[188:189], v10 offset:49408
v_mfma_f32_16x16x32_bf16 a[132:135], v[180:183], v[228:231], a[132:135]
ds_read_b64_tr_b16 v[190:191], v10 offset:55552
v_mfma_f32_16x16x32_bf16 a[136:139], v[180:183], v[232:235], a[136:139]
s_add_u32 m0, s46, 24576
v_mfma_f32_16x16x32_bf16 a[140:143], v[180:183], v[236:239], a[140:143]
s_waitcnt lgkmcnt(2)
buffer_load_dwordx4 v22, s[20:23], s42 offen offset:0 lds
v_mfma_f32_16x16x32_bf16 a[144:147], v[184:187], v[224:227], a[144:147]
ds_read_b64_tr_b16 v[160:161], v11 offset:49408
v_mfma_f32_16x16x32_bf16 a[148:151], v[184:187], v[228:231], a[148:151]
ds_read_b64_tr_b16 v[162:163], v11 offset:55552
v_mfma_f32_16x16x32_bf16 a[152:155], v[184:187], v[232:235], a[152:155]
buffer_load_dwordx4 v23, s[20:23], s42 offen offset:1024 lds
v_mfma_f32_16x16x32_bf16 a[156:159], v[184:187], v[236:239], a[156:159]
s_waitcnt lgkmcnt(2)
buffer_load_dwordx4 v24, s[20:23], s42 offen offset:2048 lds
v_mfma_f32_16x16x32_bf16 a[160:163], v[188:191], v[224:227], a[160:163]
ds_read_b64_tr_b16 v[164:165], v12 offset:49152
v_mfma_f32_16x16x32_bf16 a[164:167], v[188:191], v[228:231], a[164:167]
ds_read_b64_tr_b16 v[166:167], v12 offset:51200
v_mfma_f32_16x16x32_bf16 a[168:171], v[188:191], v[232:235], a[168:171]
v_mfma_f32_16x16x32_bf16 a[172:175], v[188:191], v[236:239], a[172:175]
s_waitcnt lgkmcnt(2)
v_mfma_f32_16x16x32_bf16 a[176:179], v[160:163], v[224:227], a[176:179]
ds_read_b64_tr_b16 v[168:169], v13 offset:49152
v_mfma_f32_16x16x32_bf16 a[180:183], v[160:163], v[228:231], a[180:183]
ds_read_b64_tr_b16 v[170:171], v13 offset:51200
v_mfma_f32_16x16x32_bf16 a[184:187], v[160:163], v[232:235], a[184:187]
v_mfma_f32_16x16x32_bf16 a[188:191], v[160:163], v[236:239], a[188:191]
s_waitcnt lgkmcnt(2)
v_mfma_f32_16x16x32_bf16 a[192:195], v[164:167], v[224:227], a[192:195]
ds_read_b64_tr_b16 v[172:173], v14 offset:49152
v_mfma_f32_16x16x32_bf16 a[196:199], v[164:167], v[228:231], a[196:199]
ds_read_b64_tr_b16 v[174:175], v14 offset:51200
v_mfma_f32_16x16x32_bf16 a[200:203], v[164:167], v[232:235], a[200:203]
v_mfma_f32_16x16x32_bf16 a[204:207], v[164:167], v[236:239], a[204:207]
s_waitcnt lgkmcnt(2)
v_mfma_f32_16x16x32_bf16 a[208:211], v[168:171], v[224:227], a[208:211]
ds_read_b64_tr_b16 v[176:177], v8 offset:0
v_mfma_f32_16x16x32_bf16 a[212:215], v[168:171], v[228:231], a[212:215]
ds_read_b64_tr_b16 v[178:179], v8 offset:6144
v_mfma_f32_16x16x32_bf16 a[216:219], v[168:171], v[232:235], a[216:219]
v_mfma_f32_16x16x32_bf16 a[220:223], v[168:171], v[236:239], a[220:223]
s_waitcnt lgkmcnt(2)
v_mfma_f32_16x16x32_bf16 a[224:227], v[172:175], v[224:227], a[224:227]
ds_read_b64_tr_b16 v[180:181], v9 offset:0
v_mfma_f32_16x16x32_bf16 a[228:231], v[172:175], v[228:231], a[228:231]
ds_read_b64_tr_b16 v[182:183], v9 offset:6144
v_mfma_f32_16x16x32_bf16 a[232:235], v[172:175], v[232:235], a[232:235]
v_mfma_f32_16x16x32_bf16 a[236:239], v[172:175], v[236:239], a[236:239]
s_waitcnt vmcnt(14) lgkmcnt(2)
v_mfma_f32_16x16x32_bf16 a[0:3], v[176:179], v[192:195], a[0:3]
s_barrier
ds_read_b64_tr_b16 v[184:185], v10 offset:0
v_mfma_f32_16x16x32_bf16 a[4:7], v[176:179], v[196:199], a[4:7]
ds_read_b64_tr_b16 v[186:187], v10 offset:6144
v_mfma_f32_16x16x32_bf16 a[8:11], v[176:179], v[200:203], a[8:11]
s_add_u32 m0, s44, 147456
v_mfma_f32_16x16x32_bf16 a[12:15], v[176:179], v[204:207], a[12:15]
s_waitcnt lgkmcnt(2)
buffer_load_dwordx4 v4, s[12:15], s40 offen offset:0 lds
v_mfma_f32_16x16x32_bf16 a[16:19], v[180:183], v[192:195], a[16:19]
ds_read_b64_tr_b16 v[188:189], v11 offset:0
v_mfma_f32_16x16x32_bf16 a[20:23], v[180:183], v[196:199], a[20:23]
ds_read_b64_tr_b16 v[190:191], v11 offset:6144
v_mfma_f32_16x16x32_bf16 a[24:27], v[180:183], v[200:203], a[24:27]
buffer_load_dwordx4 v5, s[12:15], s40 offen offset:1024 lds
v_mfma_f32_16x16x32_bf16 a[28:31], v[180:183], v[204:207], a[28:31]
s_waitcnt lgkmcnt(2)
buffer_load_dwordx4 v6, s[12:15], s40 offen offset:2048 lds
v_mfma_f32_16x16x32_bf16 a[32:35], v[184:187], v[192:195], a[32:35]
ds_read_b64_tr_b16 v[160:161], v8 offset:128
v_mfma_f32_16x16x32_bf16 a[36:39], v[184:187], v[196:199], a[36:39]
ds_read_b64_tr_b16 v[162:163], v8 offset:6272
v_mfma_f32_16x16x32_bf16 a[40:43], v[184:187], v[200:203], a[40:43]
s_add_u32 m0, s45, 147456
s_add_u32 s40, s40, 393216
v_mfma_f32_16x16x32_bf16 a[44:47], v[184:187], v[204:207], a[44:47]
s_waitcnt lgkmcnt(2)
buffer_load_dwordx4 v7, s[16:19], s41 offen lds
s_add_u32 s41, s41, 98304
v_mfma_f32_16x16x32_bf16 a[48:51], v[188:191], v[192:195], a[48:51]
ds_read_b64_tr_b16 v[164:165], v9 offset:128
v_mfma_f32_16x16x32_bf16 a[52:55], v[188:191], v[196:199], a[52:55]
ds_read_b64_tr_b16 v[166:167], v9 offset:6272
v_mfma_f32_16x16x32_bf16 a[56:59], v[188:191], v[200:203], a[56:59]
s_add_u32 s6, s75, 0
buffer_load_dwordx4 v[224:227], v2, s[8:11], s6 offen
v_mfma_f32_16x16x32_bf16 a[60:63], v[188:191], v[204:207], a[60:63]
s_waitcnt lgkmcnt(2)
v_mfma_f32_16x16x32_bf16 a[64:67], v[160:163], v[192:195], a[64:67]
ds_read_b64_tr_b16 v[168:169], v10 offset:128
v_mfma_f32_16x16x32_bf16 a[68:71], v[160:163], v[196:199], a[68:71]
ds_read_b64_tr_b16 v[170:171], v10 offset:6272
v_mfma_f32_16x16x32_bf16 a[72:75], v[160:163], v[200:203], a[72:75]
s_add_u32 s6, s75, 20480
buffer_load_dwordx4 v[228:231], v2, s[8:11], s6 offen
v_mfma_f32_16x16x32_bf16 a[76:79], v[160:163], v[204:207], a[76:79]
s_waitcnt lgkmcnt(2)
v_mfma_f32_16x16x32_bf16 a[80:83], v[164:167], v[192:195], a[80:83]
ds_read_b64_tr_b16 v[172:173], v11 offset:128
v_mfma_f32_16x16x32_bf16 a[84:87], v[164:167], v[196:199], a[84:87]
ds_read_b64_tr_b16 v[174:175], v11 offset:6272
v_mfma_f32_16x16x32_bf16 a[88:91], v[164:167], v[200:203], a[88:91]
s_add_u32 s6, s75, 40960
buffer_load_dwordx4 v[232:235], v2, s[8:11], s6 offen
v_mfma_f32_16x16x32_bf16 a[92:95], v[164:167], v[204:207], a[92:95]
s_waitcnt lgkmcnt(2)
v_mfma_f32_16x16x32_bf16 a[96:99], v[168:171], v[192:195], a[96:99]
ds_read_b64_tr_b16 v[176:177], v8 offset:256
v_mfma_f32_16x16x32_bf16 a[100:103], v[168:171], v[196:199], a[100:103]
ds_read_b64_tr_b16 v[178:179], v8 offset:6400
v_mfma_f32_16x16x32_bf16 a[104:107], v[168:171], v[200:203], a[104:107]
s_add_u32 s6, s75, 61440
buffer_load_dwordx4 v[236:239], v2, s[8:11], s6 offen
v_mfma_f32_16x16x32_bf16 a[108:111], v[168:171], v[204:207], a[108:111]
s_waitcnt lgkmcnt(2)
v_mfma_f32_16x16x32_bf16 a[112:115], v[172:175], v[192:195], a[112:115]
ds_read_b64_tr_b16 v[180:181], v9 offset:256
v_mfma_f32_16x16x32_bf16 a[116:119], v[172:175], v[196:199], a[116:119]
ds_read_b64_tr_b16 v[182:183], v9 offset:6400
v_mfma_f32_16x16x32_bf16 a[120:123], v[172:175], v[200:203], a[120:123]
s_add_u32 s75, s75, 1024
v_mfma_f32_16x16x32_bf16 a[124:127], v[172:175], v[204:207], a[124:127]
s_waitcnt lgkmcnt(2)
v_mfma_f32_16x16x32_bf16 a[128:131], v[176:179], v[192:195], a[128:131]
ds_read_b64_tr_b16 v[184:185], v10 offset:256
v_mfma_f32_16x16x32_bf16 a[132:135], v[176:179], v[196:199], a[132:135]
ds_read_b64_tr_b16 v[186:187], v10 offset:6400
v_mfma_f32_16x16x32_bf16 a[136:139], v[176:179], v[200:203], a[136:139]
s_add_u32 m0, s47, 12288
v_mfma_f32_16x16x32_bf16 a[140:143], v[176:179], v[204:207], a[140:143]
s_waitcnt lgkmcnt(2)
buffer_load_dwordx4 v25, s[24:27], s42 offen offset:0 lds
v_mfma_f32_16x16x32_bf16 a[144:147], v[180:183], v[192:195], a[144:147]
ds_read_b64_tr_b16 v[188:189], v11 offset:256
v_mfma_f32_16x16x32_bf16 a[148:151], v[180:183], v[196:199], a[148:151]
ds_read_b64_tr_b16 v[190:191], v11 offset:6400
v_mfma_f32_16x16x32_bf16 a[152:155], v[180:183], v[200:203], a[152:155]
buffer_load_dwordx4 v26, s[24:27], s42 offen offset:1024 lds
v_mfma_f32_16x16x32_bf16 a[156:159], v[180:183], v[204:207], a[156:159]
s_waitcnt lgkmcnt(2)
buffer_load_dwordx4 v27, s[24:27], s42 offen offset:2048 lds
v_mfma_f32_16x16x32_bf16 a[160:163], v[184:187], v[192:195], a[160:163]
ds_read_b64_tr_b16 v[160:161], v12 offset:0
v_mfma_f32_16x16x32_bf16 a[164:167], v[184:187], v[196:199], a[164:167]
ds_read_b64_tr_b16 v[162:163], v12 offset:2048
v_mfma_f32_16x16x32_bf16 a[168:171], v[184:187], v[200:203], a[168:171]
s_add_u32 s42, s42, 12288
v_mfma_f32_16x16x32_bf16 a[172:175], v[184:187], v[204:207], a[172:175]
s_waitcnt lgkmcnt(2)
v_mfma_f32_16x16x32_bf16 a[176:179], v[188:191], v[192:195], a[176:179]
ds_read_b64_tr_b16 v[164:165], v13 offset:0
v_mfma_f32_16x16x32_bf16 a[180:183], v[188:191], v[196:199], a[180:183]
ds_read_b64_tr_b16 v[166:167], v13 offset:2048
v_mfma_f32_16x16x32_bf16 a[184:187], v[188:191], v[200:203], a[184:187]
v_mfma_f32_16x16x32_bf16 a[188:191], v[188:191], v[204:207], a[188:191]
s_waitcnt lgkmcnt(2)
v_mfma_f32_16x16x32_bf16 a[192:195], v[160:163], v[192:195], a[192:195]
ds_read_b64_tr_b16 v[168:169], v14 offset:0
v_mfma_f32_16x16x32_bf16 a[196:199], v[160:163], v[196:199], a[196:199]
ds_read_b64_tr_b16 v[170:171], v14 offset:2048
v_mfma_f32_16x16x32_bf16 a[200:203], v[160:163], v[200:203], a[200:203]
v_mfma_f32_16x16x32_bf16 a[204:207], v[160:163], v[204:207], a[204:207]
s_waitcnt lgkmcnt(2)
v_mfma_f32_16x16x32_bf16 a[208:211], v[164:167], v[192:195], a[208:211]
ds_read_b64_tr_b16 v[172:173], v8 offset:16384
v_mfma_f32_16x16x32_bf16 a[212:215], v[164:167], v[196:199], a[212:215]
ds_read_b64_tr_b16 v[174:175], v8 offset:22528
v_mfma_f32_16x16x32_bf16 a[216:219], v[164:167], v[200:203], a[216:219]
v_mfma_f32_16x16x32_bf16 a[220:223], v[164:167], v[204:207], a[220:223]
s_waitcnt lgkmcnt(2)
v_mfma_f32_16x16x32_bf16 a[224:227], v[168:171], v[192:195], a[224:227]
ds_read_b64_tr_b16 v[176:177], v9 offset:16384
v_mfma_f32_16x16x32_bf16 a[228:231], v[168:171], v[196:199], a[228:231]
ds_read_b64_tr_b16 v[178:179], v9 offset:22528
v_mfma_f32_16x16x32_bf16 a[232:235], v[168:171], v[200:203], a[232:235]
v_mfma_f32_16x16x32_bf16 a[236:239], v[168:171], v[204:207], a[236:239]
s_waitcnt vmcnt(14) lgkmcnt(2)
v_mfma_f32_16x16x32_bf16 a[0:3], v[172:175], v[208:211], a[0:3]
s_barrier
ds_read_b64_tr_b16 v[180:181], v10 offset:16384
v_mfma_f32_16x16x32_bf16 a[4:7], v[172:175], v[212:215], a[4:7]
ds_read_b64_tr_b16 v[182:183], v10 offset:22528
v_mfma_f32_16x16x32_bf16 a[8:11], v[172:175], v[216:219], a[8:11]
s_add_u32 m0, s44, 98304
v_mfma_f32_16x16x32_bf16 a[12:15], v[172:175], v[220:223], a[12:15]
s_waitcnt lgkmcnt(2)
buffer_load_dwordx4 v4, s[12:15], s40 offen offset:0 lds
v_mfma_f32_16x16x32_bf16 a[16:19], v[176:179], v[208:211], a[16:19]
ds_read_b64_tr_b16 v[184:185], v11 offset:16384
v_mfma_f32_16x16x32_bf16 a[20:23], v[176:179], v[212:215], a[20:23]
ds_read_b64_tr_b16 v[186:187], v11 offset:22528
v_mfma_f32_16x16x32_bf16 a[24:27], v[176:179], v[216:219], a[24:27]
buffer_load_dwordx4 v5, s[12:15], s40 offen offset:1024 lds
v_mfma_f32_16x16x32_bf16 a[28:31], v[176:179], v[220:223], a[28:31]
s_waitcnt lgkmcnt(2)
buffer_load_dwordx4 v6, s[12:15], s40 offen offset:2048 lds
v_mfma_f32_16x16x32_bf16 a[32:35], v[180:183], v[208:211], a[32:35]
ds_read_b64_tr_b16 v[188:189], v8 offset:16512
v_mfma_f32_16x16x32_bf16 a[36:39], v[180:183], v[212:215], a[36:39]
ds_read_b64_tr_b16 v[190:191], v8 offset:22656
v_mfma_f32_16x16x32_bf16 a[40:43], v[180:183], v[216:219], a[40:43]
s_add_u32 m0, s45, 98304
s_add_u32 s40, s40, 393216
v_mfma_f32_16x16x32_bf16 a[44:47], v[180:183], v[220:223], a[44:47]
s_waitcnt lgkmcnt(2)
buffer_load_dwordx4 v7, s[16:19], s41 offen lds
s_add_u32 s41, s41, 98304
v_mfma_f32_16x16x32_bf16 a[48:51], v[184:187], v[208:211], a[48:51]
ds_read_b64_tr_b16 v[160:161], v9 offset:16512
v_mfma_f32_16x16x32_bf16 a[52:55], v[184:187], v[212:215], a[52:55]
ds_read_b64_tr_b16 v[162:163], v9 offset:22656
v_mfma_f32_16x16x32_bf16 a[56:59], v[184:187], v[216:219], a[56:59]
s_add_u32 s6, s75, 0
buffer_load_dwordx4 v[192:195], v2, s[8:11], s6 offen
v_mfma_f32_16x16x32_bf16 a[60:63], v[184:187], v[220:223], a[60:63]
s_waitcnt lgkmcnt(2)
v_mfma_f32_16x16x32_bf16 a[64:67], v[188:191], v[208:211], a[64:67]
ds_read_b64_tr_b16 v[164:165], v10 offset:16512
v_mfma_f32_16x16x32_bf16 a[68:71], v[188:191], v[212:215], a[68:71]
ds_read_b64_tr_b16 v[166:167], v10 offset:22656
v_mfma_f32_16x16x32_bf16 a[72:75], v[188:191], v[216:219], a[72:75]
s_add_u32 s6, s75, 20480
buffer_load_dwordx4 v[196:199], v2, s[8:11], s6 offen
v_mfma_f32_16x16x32_bf16 a[76:79], v[188:191], v[220:223], a[76:79]
s_waitcnt lgkmcnt(2)
v_mfma_f32_16x16x32_bf16 a[80:83], v[160:163], v[208:211], a[80:83]
ds_read_b64_tr_b16 v[168:169], v11 offset:16512
v_mfma_f32_16x16x32_bf16 a[84:87], v[160:163], v[212:215], a[84:87]
ds_read_b64_tr_b16 v[170:171], v11 offset:22656
v_mfma_f32_16x16x32_bf16 a[88:91], v[160:163], v[216:219], a[88:91]
s_add_u32 s6, s75, 40960
buffer_load_dwordx4 v[200:203], v2, s[8:11], s6 offen
v_mfma_f32_16x16x32_bf16 a[92:95], v[160:163], v[220:223], a[92:95]
s_waitcnt lgkmcnt(2)
v_mfma_f32_16x16x32_bf16 a[96:99], v[164:167], v[208:211], a[96:99]
ds_read_b64_tr_b16 v[172:173], v8 offset:16640
v_mfma_f32_16x16x32_bf16 a[100:103], v[164:167], v[212:215], a[100:103]
ds_read_b64_tr_b16 v[174:175], v8 offset:22784
v_mfma_f32_16x16x32_bf16 a[104:107], v[164:167], v[216:219], a[104:107]
s_add_u32 s6, s75, 61440
buffer_load_dwordx4 v[204:207], v2, s[8:11], s6 offen
v_mfma_f32_16x16x32_bf16 a[108:111], v[164:167], v[220:223], a[108:111]
s_waitcnt lgkmcnt(2)
v_mfma_f32_16x16x32_bf16 a[112:115], v[168:171], v[208:211], a[112:115]
ds_read_b64_tr_b16 v[176:177], v9 offset:16640
v_mfma_f32_16x16x32_bf16 a[116:119], v[168:171], v[212:215], a[116:119]
ds_read_b64_tr_b16 v[178:179], v9 offset:22784
v_mfma_f32_16x16x32_bf16 a[120:123], v[168:171], v[216:219], a[120:123]
s_add_u32 s75, s75, 1024
v_mfma_f32_16x16x32_bf16 a[124:127], v[168:171], v[220:223], a[124:127]
s_waitcnt lgkmcnt(2)
v_mfma_f32_16x16x32_bf16 a[128:131], v[172:175], v[208:211], a[128:131]
ds_read_b64_tr_b16 v[180:181], v10 offset:16640
v_mfma_f32_16x16x32_bf16 a[132:135], v[172:175], v[212:215], a[132:135]
ds_read_b64_tr_b16 v[182:183], v10 offset:22784
v_mfma_f32_16x16x32_bf16 a[136:139], v[172:175], v[216:219], a[136:139]
s_add_u32 m0, s46, 36864
v_mfma_f32_16x16x32_bf16 a[140:143], v[172:175], v[220:223], a[140:143]
s_waitcnt lgkmcnt(2)
buffer_load_dwordx4 v22, s[20:23], s42 offen offset:0 lds
v_mfma_f32_16x16x32_bf16 a[144:147], v[176:179], v[208:211], a[144:147]
ds_read_b64_tr_b16 v[184:185], v11 offset:16640
v_mfma_f32_16x16x32_bf16 a[148:151], v[176:179], v[212:215], a[148:151]
ds_read_b64_tr_b16 v[186:187], v11 offset:22784
v_mfma_f32_16x16x32_bf16 a[152:155], v[176:179], v[216:219], a[152:155]
buffer_load_dwordx4 v23, s[20:23], s42 offen offset:1024 lds
v_mfma_f32_16x16x32_bf16 a[156:159], v[176:179], v[220:223], a[156:159]
s_waitcnt lgkmcnt(2)
buffer_load_dwordx4 v24, s[20:23], s42 offen offset:2048 lds
v_mfma_f32_16x16x32_bf16 a[160:163], v[180:183], v[208:211], a[160:163]
ds_read_b64_tr_b16 v[188:189], v12 offset:16384
v_mfma_f32_16x16x32_bf16 a[164:167], v[180:183], v[212:215], a[164:167]
ds_read_b64_tr_b16 v[190:191], v12 offset:18432
v_mfma_f32_16x16x32_bf16 a[168:171], v[180:183], v[216:219], a[168:171]
s_add_u32 s42, s42, 12288
v_mfma_f32_16x16x32_bf16 a[172:175], v[180:183], v[220:223], a[172:175]
s_waitcnt lgkmcnt(2)
v_mfma_f32_16x16x32_bf16 a[176:179], v[184:187], v[208:211], a[176:179]
ds_read_b64_tr_b16 v[160:161], v13 offset:16384
v_mfma_f32_16x16x32_bf16 a[180:183], v[184:187], v[212:215], a[180:183]
ds_read_b64_tr_b16 v[162:163], v13 offset:18432
v_mfma_f32_16x16x32_bf16 a[184:187], v[184:187], v[216:219], a[184:187]
v_mfma_f32_16x16x32_bf16 a[188:191], v[184:187], v[220:223], a[188:191]
s_waitcnt lgkmcnt(2)
v_mfma_f32_16x16x32_bf16 a[192:195], v[188:191], v[208:211], a[192:195]
ds_read_b64_tr_b16 v[164:165], v14 offset:16384
v_mfma_f32_16x16x32_bf16 a[196:199], v[188:191], v[212:215], a[196:199]
ds_read_b64_tr_b16 v[166:167], v14 offset:18432
v_mfma_f32_16x16x32_bf16 a[200:203], v[188:191], v[216:219], a[200:203]
v_mfma_f32_16x16x32_bf16 a[204:207], v[188:191], v[220:223], a[204:207]
s_waitcnt lgkmcnt(2)
v_mfma_f32_16x16x32_bf16 a[208:211], v[160:163], v[208:211], a[208:211]
ds_read_b64_tr_b16 v[168:169], v8 offset:32768
v_mfma_f32_16x16x32_bf16 a[212:215], v[160:163], v[212:215], a[212:215]
ds_read_b64_tr_b16 v[170:171], v8 offset:38912
v_mfma_f32_16x16x32_bf16 a[216:219], v[160:163], v[216:219], a[216:219]
v_mfma_f32_16x16x32_bf16 a[220:223], v[160:163], v[220:223], a[220:223]
s_waitcnt lgkmcnt(2)
v_mfma_f32_16x16x32_bf16 a[224:227], v[164:167], v[208:211], a[224:227]
ds_read_b64_tr_b16 v[172:173], v9 offset:32768
v_mfma_f32_16x16x32_bf16 a[228:231], v[164:167], v[212:215], a[228:231]
ds_read_b64_tr_b16 v[174:175], v9 offset:38912
v_mfma_f32_16x16x32_bf16 a[232:235], v[164:167], v[216:219], a[232:235]
v_mfma_f32_16x16x32_bf16 a[236:239], v[164:167], v[220:223], a[236:239]
s_waitcnt vmcnt(14) lgkmcnt(2)
v_mfma_f32_16x16x32_bf16 a[0:3], v[168:171], v[224:227], a[0:3]
s_barrier
ds_read_b64_tr_b16 v[176:177], v10 offset:32768
v_mfma_f32_16x16x32_bf16 a[4:7], v[168:171], v[228:231], a[4:7]
ds_read_b64_tr_b16 v[178:179], v10 offset:38912
v_mfma_f32_16x16x32_bf16 a[8:11], v[168:171], v[232:235], a[8:11]
s_add_u32 m0, s44, 114688
v_mfma_f32_16x16x32_bf16 a[12:15], v[168:171], v[236:239], a[12:15]
s_waitcnt lgkmcnt(2)
buffer_load_dwordx4 v4, s[12:15], s40 offen offset:0 lds
v_mfma_f32_16x16x32_bf16 a[16:19], v[172:175], v[224:227], a[16:19]
ds_read_b64_tr_b16 v[180:181], v11 offset:32768
v_mfma_f32_16x16x32_bf16 a[20:23], v[172:175], v[228:231], a[20:23]
ds_read_b64_tr_b16 v[182:183], v11 offset:38912
v_mfma_f32_16x16x32_bf16 a[24:27], v[172:175], v[232:235], a[24:27]
buffer_load_dwordx4 v5, s[12:15], s40 offen offset:1024 lds
v_mfma_f32_16x16x32_bf16 a[28:31], v[172:175], v[236:239], a[28:31]
s_waitcnt lgkmcnt(2)
buffer_load_dwordx4 v6, s[12:15], s40 offen offset:2048 lds
v_mfma_f32_16x16x32_bf16 a[32:35], v[176:179], v[224:227], a[32:35]
ds_read_b64_tr_b16 v[184:185], v8 offset:32896
v_mfma_f32_16x16x32_bf16 a[36:39], v[176:179], v[228:231], a[36:39]
ds_read_b64_tr_b16 v[186:187], v8 offset:39040
v_mfma_f32_16x16x32_bf16 a[40:43], v[176:179], v[232:235], a[40:43]
s_add_u32 m0, s45, 114688
s_add_u32 s40, s40, 393216
v_mfma_f32_16x16x32_bf16 a[44:47], v[176:179], v[236:239], a[44:47]
s_waitcnt lgkmcnt(2)
buffer_load_dwordx4 v7, s[16:19], s41 offen lds
s_add_u32 s41, s41, 98304
v_mfma_f32_16x16x32_bf16 a[48:51], v[180:183], v[224:227], a[48:51]
ds_read_b64_tr_b16 v[188:189], v9 offset:32896
v_mfma_f32_16x16x32_bf16 a[52:55], v[180:183], v[228:231], a[52:55]
ds_read_b64_tr_b16 v[190:191], v9 offset:39040
v_mfma_f32_16x16x32_bf16 a[56:59], v[180:183], v[232:235], a[56:59]
s_add_u32 s6, s75, 0
buffer_load_dwordx4 v[208:211], v2, s[8:11], s6 offen
v_mfma_f32_16x16x32_bf16 a[60:63], v[180:183], v[236:239], a[60:63]
s_waitcnt lgkmcnt(2)
v_mfma_f32_16x16x32_bf16 a[64:67], v[184:187], v[224:227], a[64:67]
ds_read_b64_tr_b16 v[160:161], v10 offset:32896
v_mfma_f32_16x16x32_bf16 a[68:71], v[184:187], v[228:231], a[68:71]
ds_read_b64_tr_b16 v[162:163], v10 offset:39040
v_mfma_f32_16x16x32_bf16 a[72:75], v[184:187], v[232:235], a[72:75]
s_add_u32 s6, s75, 20480
buffer_load_dwordx4 v[212:215], v2, s[8:11], s6 offen
v_mfma_f32_16x16x32_bf16 a[76:79], v[184:187], v[236:239], a[76:79]
s_waitcnt lgkmcnt(2)
v_mfma_f32_16x16x32_bf16 a[80:83], v[188:191], v[224:227], a[80:83]
ds_read_b64_tr_b16 v[164:165], v11 offset:32896
v_mfma_f32_16x16x32_bf16 a[84:87], v[188:191], v[228:231], a[84:87]
ds_read_b64_tr_b16 v[166:167], v11 offset:39040
v_mfma_f32_16x16x32_bf16 a[88:91], v[188:191], v[232:235], a[88:91]
s_add_u32 s6, s75, 40960
buffer_load_dwordx4 v[216:219], v2, s[8:11], s6 offen
v_mfma_f32_16x16x32_bf16 a[92:95], v[188:191], v[236:239], a[92:95]
s_waitcnt lgkmcnt(2)
v_mfma_f32_16x16x32_bf16 a[96:99], v[160:163], v[224:227], a[96:99]
ds_read_b64_tr_b16 v[168:169], v8 offset:33024
v_mfma_f32_16x16x32_bf16 a[100:103], v[160:163], v[228:231], a[100:103]
ds_read_b64_tr_b16 v[170:171], v8 offset:39168
v_mfma_f32_16x16x32_bf16 a[104:107], v[160:163], v[232:235], a[104:107]
s_add_u32 s6, s75, 61440
buffer_load_dwordx4 v[220:223], v2, s[8:11], s6 offen
v_mfma_f32_16x16x32_bf16 a[108:111], v[160:163], v[236:239], a[108:111]
s_waitcnt lgkmcnt(2)
v_mfma_f32_16x16x32_bf16 a[112:115], v[164:167], v[224:227], a[112:115]
ds_read_b64_tr_b16 v[172:173], v9 offset:33024
v_mfma_f32_16x16x32_bf16 a[116:119], v[164:167], v[228:231], a[116:119]
ds_read_b64_tr_b16 v[174:175], v9 offset:39168
v_mfma_f32_16x16x32_bf16 a[120:123], v[164:167], v[232:235], a[120:123]
s_add_u32 s75, s75, 1024
v_mfma_f32_16x16x32_bf16 a[124:127], v[164:167], v[236:239], a[124:127]
s_waitcnt lgkmcnt(2)
v_mfma_f32_16x16x32_bf16 a[128:131], v[168:171], v[224:227], a[128:131]
ds_read_b64_tr_b16 v[176:177], v10 offset:33024
v_mfma_f32_16x16x32_bf16 a[132:135], v[168:171], v[228:231], a[132:135]
ds_read_b64_tr_b16 v[178:179], v10 offset:39168
v_mfma_f32_16x16x32_bf16 a[136:139], v[168:171], v[232:235], a[136:139]
s_add_u32 m0, s46, 49152
v_mfma_f32_16x16x32_bf16 a[140:143], v[168:171], v[236:239], a[140:143]
s_waitcnt lgkmcnt(2)
buffer_load_dwordx4 v22, s[20:23], s42 offen offset:0 lds
v_mfma_f32_16x16x32_bf16 a[144:147], v[172:175], v[224:227], a[144:147]
ds_read_b64_tr_b16 v[180:181], v11 offset:33024
v_mfma_f32_16x16x32_bf16 a[148:151], v[172:175], v[228:231], a[148:151]
ds_read_b64_tr_b16 v[182:183], v11 offset:39168
v_mfma_f32_16x16x32_bf16 a[152:155], v[172:175], v[232:235], a[152:155]
buffer_load_dwordx4 v23, s[20:23], s42 offen offset:1024 lds
v_mfma_f32_16x16x32_bf16 a[156:159], v[172:175], v[236:239], a[156:159]
s_waitcnt lgkmcnt(2)
buffer_load_dwordx4 v24, s[20:23], s42 offen offset:2048 lds
v_mfma_f32_16x16x32_bf16 a[160:163], v[176:179], v[224:227], a[160:163]
ds_read_b64_tr_b16 v[184:185], v12 offset:32768
v_mfma_f32_16x16x32_bf16 a[164:167], v[176:179], v[228:231], a[164:167]
ds_read_b64_tr_b16 v[186:187], v12 offset:34816
v_mfma_f32_16x16x32_bf16 a[168:171], v[176:179], v[232:235], a[168:171]
s_add_u32 s42, s42, 12288
v_mfma_f32_16x16x32_bf16 a[172:175], v[176:179], v[236:239], a[172:175]
s_waitcnt lgkmcnt(2)
v_mfma_f32_16x16x32_bf16 a[176:179], v[180:183], v[224:227], a[176:179]
ds_read_b64_tr_b16 v[188:189], v13 offset:32768
v_mfma_f32_16x16x32_bf16 a[180:183], v[180:183], v[228:231], a[180:183]
ds_read_b64_tr_b16 v[190:191], v13 offset:34816
v_mfma_f32_16x16x32_bf16 a[184:187], v[180:183], v[232:235], a[184:187]
v_mfma_f32_16x16x32_bf16 a[188:191], v[180:183], v[236:239], a[188:191]
s_waitcnt lgkmcnt(2)
v_mfma_f32_16x16x32_bf16 a[192:195], v[184:187], v[224:227], a[192:195]
ds_read_b64_tr_b16 v[160:161], v14 offset:32768
v_mfma_f32_16x16x32_bf16 a[196:199], v[184:187], v[228:231], a[196:199]
ds_read_b64_tr_b16 v[162:163], v14 offset:34816
v_mfma_f32_16x16x32_bf16 a[200:203], v[184:187], v[232:235], a[200:203]
v_mfma_f32_16x16x32_bf16 a[204:207], v[184:187], v[236:239], a[204:207]
s_waitcnt lgkmcnt(2)
v_mfma_f32_16x16x32_bf16 a[208:211], v[188:191], v[224:227], a[208:211]
ds_read_b64_tr_b16 v[164:165], v8 offset:49152
v_mfma_f32_16x16x32_bf16 a[212:215], v[188:191], v[228:231], a[212:215]
ds_read_b64_tr_b16 v[166:167], v8 offset:55296
v_mfma_f32_16x16x32_bf16 a[216:219], v[188:191], v[232:235], a[216:219]
v_mfma_f32_16x16x32_bf16 a[220:223], v[188:191], v[236:239], a[220:223]
s_waitcnt lgkmcnt(2)
v_mfma_f32_16x16x32_bf16 a[224:227], v[160:163], v[224:227], a[224:227]
ds_read_b64_tr_b16 v[168:169], v9 offset:49152
v_mfma_f32_16x16x32_bf16 a[228:231], v[160:163], v[228:231], a[228:231]
ds_read_b64_tr_b16 v[170:171], v9 offset:55296
v_mfma_f32_16x16x32_bf16 a[232:235], v[160:163], v[232:235], a[232:235]
v_mfma_f32_16x16x32_bf16 a[236:239], v[160:163], v[236:239], a[236:239]
s_waitcnt vmcnt(14) lgkmcnt(2)
v_mfma_f32_16x16x32_bf16 a[0:3], v[164:167], v[192:195], a[0:3]
s_barrier
ds_read_b64_tr_b16 v[172:173], v10 offset:49152
v_mfma_f32_16x16x32_bf16 a[4:7], v[164:167], v[196:199], a[4:7]
ds_read_b64_tr_b16 v[174:175], v10 offset:55296
v_mfma_f32_16x16x32_bf16 a[8:11], v[164:167], v[200:203], a[8:11]
s_add_u32 m0, s44, 131072
v_mfma_f32_16x16x32_bf16 a[12:15], v[164:167], v[204:207], a[12:15]
s_waitcnt lgkmcnt(2)
buffer_load_dwordx4 v4, s[12:15], s40 offen offset:0 lds
v_mfma_f32_16x16x32_bf16 a[16:19], v[168:171], v[192:195], a[16:19]
ds_read_b64_tr_b16 v[176:177], v11 offset:49152
v_mfma_f32_16x16x32_bf16 a[20:23], v[168:171], v[196:199], a[20:23]
ds_read_b64_tr_b16 v[178:179], v11 offset:55296
v_mfma_f32_16x16x32_bf16 a[24:27], v[168:171], v[200:203], a[24:27]
buffer_load_dwordx4 v5, s[12:15], s40 offen offset:1024 lds
v_mfma_f32_16x16x32_bf16 a[28:31], v[168:171], v[204:207], a[28:31]
s_waitcnt lgkmcnt(2)
buffer_load_dwordx4 v6, s[12:15], s40 offen offset:2048 lds
v_mfma_f32_16x16x32_bf16 a[32:35], v[172:175], v[192:195], a[32:35]
ds_read_b64_tr_b16 v[180:181], v8 offset:49280
v_mfma_f32_16x16x32_bf16 a[36:39], v[172:175], v[196:199], a[36:39]
ds_read_b64_tr_b16 v[182:183], v8 offset:55424
v_mfma_f32_16x16x32_bf16 a[40:43], v[172:175], v[200:203], a[40:43]
s_add_u32 m0, s45, 131072
s_add_u32 s40, s40, 393216
v_mfma_f32_16x16x32_bf16 a[44:47], v[172:175], v[204:207], a[44:47]
s_waitcnt lgkmcnt(2)
buffer_load_dwordx4 v7, s[16:19], s41 offen lds
s_add_u32 s41, s41, 98304
v_mfma_f32_16x16x32_bf16 a[48:51], v[176:179], v[192:195], a[48:51]
ds_read_b64_tr_b16 v[184:185], v9 offset:49280
v_mfma_f32_16x16x32_bf16 a[52:55], v[176:179], v[196:199], a[52:55]
ds_read_b64_tr_b16 v[186:187], v9 offset:55424
v_mfma_f32_16x16x32_bf16 a[56:59], v[176:179], v[200:203], a[56:59]
s_add_u32 s6, s75, 0
buffer_load_dwordx4 v[224:227], v2, s[8:11], s6 offen
v_mfma_f32_16x16x32_bf16 a[60:63], v[176:179], v[204:207], a[60:63]
s_waitcnt lgkmcnt(2)
v_mfma_f32_16x16x32_bf16 a[64:67], v[180:183], v[192:195], a[64:67]
ds_read_b64_tr_b16 v[188:189], v10 offset:49280
v_mfma_f32_16x16x32_bf16 a[68:71], v[180:183], v[196:199], a[68:71]
ds_read_b64_tr_b16 v[190:191], v10 offset:55424
v_mfma_f32_16x16x32_bf16 a[72:75], v[180:183], v[200:203], a[72:75]
s_add_u32 s6, s75, 20480
buffer_load_dwordx4 v[228:231], v2, s[8:11], s6 offen
v_mfma_f32_16x16x32_bf16 a[76:79], v[180:183], v[204:207], a[76:79]
s_waitcnt lgkmcnt(2)
v_mfma_f32_16x16x32_bf16 a[80:83], v[184:187], v[192:195], a[80:83]
ds_read_b64_tr_b16 v[160:161], v11 offset:49280
v_mfma_f32_16x16x32_bf16 a[84:87], v[184:187], v[196:199], a[84:87]
ds_read_b64_tr_b16 v[162:163], v11 offset:55424
v_mfma_f32_16x16x32_bf16 a[88:91], v[184:187], v[200:203], a[88:91]
s_add_u32 s6, s75, 40960
buffer_load_dwordx4 v[232:235], v2, s[8:11], s6 offen
v_mfma_f32_16x16x32_bf16 a[92:95], v[184:187], v[204:207], a[92:95]
s_waitcnt lgkmcnt(2)
v_mfma_f32_16x16x32_bf16 a[96:99], v[188:191], v[192:195], a[96:99]
ds_read_b64_tr_b16 v[164:165], v8 offset:49408
v_mfma_f32_16x16x32_bf16 a[100:103], v[188:191], v[196:199], a[100:103]
ds_read_b64_tr_b16 v[166:167], v8 offset:55552
v_mfma_f32_16x16x32_bf16 a[104:107], v[188:191], v[200:203], a[104:107]
s_add_u32 s6, s75, 61440
buffer_load_dwordx4 v[236:239], v2, s[8:11], s6 offen
v_mfma_f32_16x16x32_bf16 a[108:111], v[188:191], v[204:207], a[108:111]
s_waitcnt lgkmcnt(2)
v_mfma_f32_16x16x32_bf16 a[112:115], v[160:163], v[192:195], a[112:115]
ds_read_b64_tr_b16 v[168:169], v9 offset:49408
v_mfma_f32_16x16x32_bf16 a[116:119], v[160:163], v[196:199], a[116:119]
ds_read_b64_tr_b16 v[170:171], v9 offset:55552
v_mfma_f32_16x16x32_bf16 a[120:123], v[160:163], v[200:203], a[120:123]
s_add_u32 s75, s75, 1024
v_mfma_f32_16x16x32_bf16 a[124:127], v[160:163], v[204:207], a[124:127]
s_waitcnt lgkmcnt(2)
v_mfma_f32_16x16x32_bf16 a[128:131], v[164:167], v[192:195], a[128:131]
ds_read_b64_tr_b16 v[172:173], v10 offset:49408
v_mfma_f32_16x16x32_bf16 a[132:135], v[164:167], v[196:199], a[132:135]
ds_read_b64_tr_b16 v[174:175], v10 offset:55552
v_mfma_f32_16x16x32_bf16 a[136:139], v[164:167], v[200:203], a[136:139]
v_mfma_f32_16x16x32_bf16 a[140:143], v[164:167], v[204:207], a[140:143]
s_waitcnt lgkmcnt(2)
v_mfma_f32_16x16x32_bf16 a[144:147], v[168:171], v[192:195], a[144:147]
ds_read_b64_tr_b16 v[176:177], v11 offset:49408
v_mfma_f32_16x16x32_bf16 a[148:151], v[168:171], v[196:199], a[148:151]
ds_read_b64_tr_b16 v[178:179], v11 offset:55552
v_mfma_f32_16x16x32_bf16 a[152:155], v[168:171], v[200:203], a[152:155]
v_mfma_f32_16x16x32_bf16 a[156:159], v[168:171], v[204:207], a[156:159]
s_waitcnt lgkmcnt(2)
v_mfma_f32_16x16x32_bf16 a[160:163], v[172:175], v[192:195], a[160:163]
ds_read_b64_tr_b16 v[180:181], v12 offset:49152
v_mfma_f32_16x16x32_bf16 a[164:167], v[172:175], v[196:199], a[164:167]
ds_read_b64_tr_b16 v[182:183], v12 offset:51200
v_mfma_f32_16x16x32_bf16 a[168:171], v[172:175], v[200:203], a[168:171]
v_mfma_f32_16x16x32_bf16 a[172:175], v[172:175], v[204:207], a[172:175]
s_waitcnt lgkmcnt(2)
v_mfma_f32_16x16x32_bf16 a[176:179], v[176:179], v[192:195], a[176:179]
ds_read_b64_tr_b16 v[184:185], v13 offset:49152
v_mfma_f32_16x16x32_bf16 a[180:183], v[176:179], v[196:199], a[180:183]
ds_read_b64_tr_b16 v[186:187], v13 offset:51200
v_mfma_f32_16x16x32_bf16 a[184:187], v[176:179], v[200:203], a[184:187]
v_mfma_f32_16x16x32_bf16 a[188:191], v[176:179], v[204:207], a[188:191]
s_waitcnt lgkmcnt(2)
v_mfma_f32_16x16x32_bf16 a[192:195], v[180:183], v[192:195], a[192:195]
ds_read_b64_tr_b16 v[188:189], v14 offset:49152
v_mfma_f32_16x16x32_bf16 a[196:199], v[180:183], v[196:199], a[196:199]
ds_read_b64_tr_b16 v[190:191], v14 offset:51200
v_mfma_f32_16x16x32_bf16 a[200:203], v[180:183], v[200:203], a[200:203]
v_mfma_f32_16x16x32_bf16 a[204:207], v[180:183], v[204:207], a[204:207]
s_waitcnt lgkmcnt(2)
v_mfma_f32_16x16x32_bf16 a[208:211], v[184:187], v[192:195], a[208:211]
ds_read_b64_tr_b16 v[160:161], v8 offset:0
v_mfma_f32_16x16x32_bf16 a[212:215], v[184:187], v[196:199], a[212:215]
ds_read_b64_tr_b16 v[162:163], v8 offset:6144
v_mfma_f32_16x16x32_bf16 a[216:219], v[184:187], v[200:203], a[216:219]
v_mfma_f32_16x16x32_bf16 a[220:223], v[184:187], v[204:207], a[220:223]
s_waitcnt lgkmcnt(2)
v_mfma_f32_16x16x32_bf16 a[224:227], v[188:191], v[192:195], a[224:227]
ds_read_b64_tr_b16 v[164:165], v9 offset:0
v_mfma_f32_16x16x32_bf16 a[228:231], v[188:191], v[196:199], a[228:231]
ds_read_b64_tr_b16 v[166:167], v9 offset:6144
v_mfma_f32_16x16x32_bf16 a[232:235], v[188:191], v[200:203], a[232:235]
v_mfma_f32_16x16x32_bf16 a[236:239], v[188:191], v[204:207], a[236:239]
s_waitcnt vmcnt(11) lgkmcnt(2)
v_mfma_f32_16x16x32_bf16 a[0:3], v[160:163], v[208:211], a[0:3]
s_barrier
ds_read_b64_tr_b16 v[168:169], v10 offset:0
v_mfma_f32_16x16x32_bf16 a[4:7], v[160:163], v[212:215], a[4:7]
ds_read_b64_tr_b16 v[170:171], v10 offset:6144
v_mfma_f32_16x16x32_bf16 a[8:11], v[160:163], v[216:219], a[8:11]
s_add_u32 m0, s44, 147456
v_mfma_f32_16x16x32_bf16 a[12:15], v[160:163], v[220:223], a[12:15]
s_waitcnt lgkmcnt(2)
buffer_load_dwordx4 v4, s[12:15], s40 offen offset:0 lds
v_mfma_f32_16x16x32_bf16 a[16:19], v[164:167], v[208:211], a[16:19]
ds_read_b64_tr_b16 v[172:173], v11 offset:0
v_mfma_f32_16x16x32_bf16 a[20:23], v[164:167], v[212:215], a[20:23]
ds_read_b64_tr_b16 v[174:175], v11 offset:6144
v_mfma_f32_16x16x32_bf16 a[24:27], v[164:167], v[216:219], a[24:27]
buffer_load_dwordx4 v5, s[12:15], s40 offen offset:1024 lds
v_mfma_f32_16x16x32_bf16 a[28:31], v[164:167], v[220:223], a[28:31]
s_waitcnt lgkmcnt(2)
buffer_load_dwordx4 v6, s[12:15], s40 offen offset:2048 lds
v_mfma_f32_16x16x32_bf16 a[32:35], v[168:171], v[208:211], a[32:35]
ds_read_b64_tr_b16 v[176:177], v8 offset:128
v_mfma_f32_16x16x32_bf16 a[36:39], v[168:171], v[212:215], a[36:39]
ds_read_b64_tr_b16 v[178:179], v8 offset:6272
v_mfma_f32_16x16x32_bf16 a[40:43], v[168:171], v[216:219], a[40:43]
s_add_u32 m0, s45, 147456
s_add_u32 s40, s40, 393216
v_mfma_f32_16x16x32_bf16 a[44:47], v[168:171], v[220:223], a[44:47]
s_waitcnt lgkmcnt(2)
buffer_load_dwordx4 v7, s[16:19], s41 offen lds
s_add_u32 s41, s41, 98304
v_mfma_f32_16x16x32_bf16 a[48:51], v[172:175], v[208:211], a[48:51]
ds_read_b64_tr_b16 v[180:181], v9 offset:128
v_mfma_f32_16x16x32_bf16 a[52:55], v[172:175], v[212:215], a[52:55]
ds_read_b64_tr_b16 v[182:183], v9 offset:6272
v_mfma_f32_16x16x32_bf16 a[56:59], v[172:175], v[216:219], a[56:59]
s_add_u32 s6, s75, 0
buffer_load_dwordx4 v[192:195], v2, s[8:11], s6 offen
v_mfma_f32_16x16x32_bf16 a[60:63], v[172:175], v[220:223], a[60:63]
s_waitcnt lgkmcnt(2)
v_mfma_f32_16x16x32_bf16 a[64:67], v[176:179], v[208:211], a[64:67]
ds_read_b64_tr_b16 v[184:185], v10 offset:128
v_mfma_f32_16x16x32_bf16 a[68:71], v[176:179], v[212:215], a[68:71]
ds_read_b64_tr_b16 v[186:187], v10 offset:6272
v_mfma_f32_16x16x32_bf16 a[72:75], v[176:179], v[216:219], a[72:75]
s_add_u32 s6, s75, 20480
buffer_load_dwordx4 v[196:199], v2, s[8:11], s6 offen
v_mfma_f32_16x16x32_bf16 a[76:79], v[176:179], v[220:223], a[76:79]
s_waitcnt lgkmcnt(2)
v_mfma_f32_16x16x32_bf16 a[80:83], v[180:183], v[208:211], a[80:83]
ds_read_b64_tr_b16 v[188:189], v11 offset:128
v_mfma_f32_16x16x32_bf16 a[84:87], v[180:183], v[212:215], a[84:87]
ds_read_b64_tr_b16 v[190:191], v11 offset:6272
v_mfma_f32_16x16x32_bf16 a[88:91], v[180:183], v[216:219], a[88:91]
s_add_u32 s6, s75, 40960
buffer_load_dwordx4 v[200:203], v2, s[8:11], s6 offen
v_mfma_f32_16x16x32_bf16 a[92:95], v[180:183], v[220:223], a[92:95]
s_waitcnt lgkmcnt(2)
v_mfma_f32_16x16x32_bf16 a[96:99], v[184:187], v[208:211], a[96:99]
ds_read_b64_tr_b16 v[160:161], v8 offset:256
v_mfma_f32_16x16x32_bf16 a[100:103], v[184:187], v[212:215], a[100:103]
ds_read_b64_tr_b16 v[162:163], v8 offset:6400
v_mfma_f32_16x16x32_bf16 a[104:107], v[184:187], v[216:219], a[104:107]
s_add_u32 s6, s75, 61440
buffer_load_dwordx4 v[204:207], v2, s[8:11], s6 offen
v_mfma_f32_16x16x32_bf16 a[108:111], v[184:187], v[220:223], a[108:111]
s_waitcnt lgkmcnt(2)
v_mfma_f32_16x16x32_bf16 a[112:115], v[188:191], v[208:211], a[112:115]
ds_read_b64_tr_b16 v[164:165], v9 offset:256
v_mfma_f32_16x16x32_bf16 a[116:119], v[188:191], v[212:215], a[116:119]
ds_read_b64_tr_b16 v[166:167], v9 offset:6400
v_mfma_f32_16x16x32_bf16 a[120:123], v[188:191], v[216:219], a[120:123]
s_add_u32 s75, s75, 1024
v_mfma_f32_16x16x32_bf16 a[124:127], v[188:191], v[220:223], a[124:127]
s_waitcnt lgkmcnt(2)
v_mfma_f32_16x16x32_bf16 a[128:131], v[160:163], v[208:211], a[128:131]
ds_read_b64_tr_b16 v[168:169], v10 offset:256
v_mfma_f32_16x16x32_bf16 a[132:135], v[160:163], v[212:215], a[132:135]
ds_read_b64_tr_b16 v[170:171], v10 offset:6400
v_mfma_f32_16x16x32_bf16 a[136:139], v[160:163], v[216:219], a[136:139]
v_mfma_f32_16x16x32_bf16 a[140:143], v[160:163], v[220:223], a[140:143]
s_waitcnt lgkmcnt(2)
v_mfma_f32_16x16x32_bf16 a[144:147], v[164:167], v[208:211], a[144:147]
ds_read_b64_tr_b16 v[172:173], v11 offset:256
v_mfma_f32_16x16x32_bf16 a[148:151], v[164:167], v[212:215], a[148:151]
ds_read_b64_tr_b16 v[174:175], v11 offset:6400
v_mfma_f32_16x16x32_bf16 a[152:155], v[164:167], v[216:219], a[152:155]
v_mfma_f32_16x16x32_bf16 a[156:159], v[164:167], v[220:223], a[156:159]
s_waitcnt lgkmcnt(2)
v_mfma_f32_16x16x32_bf16 a[160:163], v[168:171], v[208:211], a[160:163]
ds_read_b64_tr_b16 v[176:177], v12 offset:0
v_mfma_f32_16x16x32_bf16 a[164:167], v[168:171], v[212:215], a[164:167]
ds_read_b64_tr_b16 v[178:179], v12 offset:2048
v_mfma_f32_16x16x32_bf16 a[168:171], v[168:171], v[216:219], a[168:171]
v_mfma_f32_16x16x32_bf16 a[172:175], v[168:171], v[220:223], a[172:175]
s_waitcnt lgkmcnt(2)
v_mfma_f32_16x16x32_bf16 a[176:179], v[172:175], v[208:211], a[176:179]
ds_read_b64_tr_b16 v[180:181], v13 offset:0
v_mfma_f32_16x16x32_bf16 a[180:183], v[172:175], v[212:215], a[180:183]
ds_read_b64_tr_b16 v[182:183], v13 offset:2048
v_mfma_f32_16x16x32_bf16 a[184:187], v[172:175], v[216:219], a[184:187]
v_mfma_f32_16x16x32_bf16 a[188:191], v[172:175], v[220:223], a[188:191]
s_waitcnt lgkmcnt(2)
v_mfma_f32_16x16x32_bf16 a[192:195], v[176:179], v[208:211], a[192:195]
ds_read_b64_tr_b16 v[184:185], v14 offset:0
v_mfma_f32_16x16x32_bf16 a[196:199], v[176:179], v[212:215], a[196:199]
ds_read_b64_tr_b16 v[186:187], v14 offset:2048
v_mfma_f32_16x16x32_bf16 a[200:203], v[176:179], v[216:219], a[200:203]
v_mfma_f32_16x16x32_bf16 a[204:207], v[176:179], v[220:223], a[204:207]
s_waitcnt lgkmcnt(2)
v_mfma_f32_16x16x32_bf16 a[208:211], v[180:183], v[208:211], a[208:211]
ds_read_b64_tr_b16 v[188:189], v8 offset:16384
v_mfma_f32_16x16x32_bf16 a[212:215], v[180:183], v[212:215], a[212:215]
ds_read_b64_tr_b16 v[190:191], v8 offset:22528
v_mfma_f32_16x16x32_bf16 a[216:219], v[180:183], v[216:219], a[216:219]
v_mfma_f32_16x16x32_bf16 a[220:223], v[180:183], v[220:223], a[220:223]
s_waitcnt lgkmcnt(2)
v_mfma_f32_16x16x32_bf16 a[224:227], v[184:187], v[208:211], a[224:227]
ds_read_b64_tr_b16 v[160:161], v9 offset:16384
v_mfma_f32_16x16x32_bf16 a[228:231], v[184:187], v[212:215], a[228:231]
ds_read_b64_tr_b16 v[162:163], v9 offset:22528
v_mfma_f32_16x16x32_bf16 a[232:235], v[184:187], v[216:219], a[232:235]
v_mfma_f32_16x16x32_bf16 a[236:239], v[184:187], v[220:223], a[236:239]
s_waitcnt vmcnt(8) lgkmcnt(2)
v_mfma_f32_16x16x32_bf16 a[0:3], v[188:191], v[224:227], a[0:3]
s_barrier
ds_read_b64_tr_b16 v[164:165], v10 offset:16384
v_mfma_f32_16x16x32_bf16 a[4:7], v[188:191], v[228:231], a[4:7]
ds_read_b64_tr_b16 v[166:167], v10 offset:22528
v_mfma_f32_16x16x32_bf16 a[8:11], v[188:191], v[232:235], a[8:11]
v_mfma_f32_16x16x32_bf16 a[12:15], v[188:191], v[236:239], a[12:15]
s_waitcnt lgkmcnt(2)
v_mfma_f32_16x16x32_bf16 a[16:19], v[160:163], v[224:227], a[16:19]
ds_read_b64_tr_b16 v[168:169], v11 offset:16384
v_mfma_f32_16x16x32_bf16 a[20:23], v[160:163], v[228:231], a[20:23]
ds_read_b64_tr_b16 v[170:171], v11 offset:22528
v_mfma_f32_16x16x32_bf16 a[24:27], v[160:163], v[232:235], a[24:27]
v_mfma_f32_16x16x32_bf16 a[28:31], v[160:163], v[236:239], a[28:31]
s_waitcnt lgkmcnt(2)
v_mfma_f32_16x16x32_bf16 a[32:35], v[164:167], v[224:227], a[32:35]
ds_read_b64_tr_b16 v[172:173], v8 offset:16512
v_mfma_f32_16x16x32_bf16 a[36:39], v[164:167], v[228:231], a[36:39]
ds_read_b64_tr_b16 v[174:175], v8 offset:22656
v_mfma_f32_16x16x32_bf16 a[40:43], v[164:167], v[232:235], a[40:43]
v_mfma_f32_16x16x32_bf16 a[44:47], v[164:167], v[236:239], a[44:47]
s_waitcnt lgkmcnt(2)
v_mfma_f32_16x16x32_bf16 a[48:51], v[168:171], v[224:227], a[48:51]
ds_read_b64_tr_b16 v[176:177], v9 offset:16512
v_mfma_f32_16x16x32_bf16 a[52:55], v[168:171], v[228:231], a[52:55]
ds_read_b64_tr_b16 v[178:179], v9 offset:22656
v_mfma_f32_16x16x32_bf16 a[56:59], v[168:171], v[232:235], a[56:59]
s_add_u32 s6, s75, 0
buffer_load_dwordx4 v[208:211], v2, s[8:11], s6 offen
v_mfma_f32_16x16x32_bf16 a[60:63], v[168:171], v[236:239], a[60:63]
s_waitcnt lgkmcnt(2)
v_mfma_f32_16x16x32_bf16 a[64:67], v[172:175], v[224:227], a[64:67]
ds_read_b64_tr_b16 v[180:181], v10 offset:16512
v_mfma_f32_16x16x32_bf16 a[68:71], v[172:175], v[228:231], a[68:71]
ds_read_b64_tr_b16 v[182:183], v10 offset:22656
v_mfma_f32_16x16x32_bf16 a[72:75], v[172:175], v[232:235], a[72:75]
s_add_u32 s6, s75, 20480
buffer_load_dwordx4 v[212:215], v2, s[8:11], s6 offen
v_mfma_f32_16x16x32_bf16 a[76:79], v[172:175], v[236:239], a[76:79]
s_waitcnt lgkmcnt(2)
v_mfma_f32_16x16x32_bf16 a[80:83], v[176:179], v[224:227], a[80:83]
ds_read_b64_tr_b16 v[184:185], v11 offset:16512
v_mfma_f32_16x16x32_bf16 a[84:87], v[176:179], v[228:231], a[84:87]
ds_read_b64_tr_b16 v[186:187], v11 offset:22656
v_mfma_f32_16x16x32_bf16 a[88:91], v[176:179], v[232:235], a[88:91]
s_add_u32 s6, s75, 40960
buffer_load_dwordx4 v[216:219], v2, s[8:11], s6 offen
v_mfma_f32_16x16x32_bf16 a[92:95], v[176:179], v[236:239], a[92:95]
s_waitcnt lgkmcnt(2)
v_mfma_f32_16x16x32_bf16 a[96:99], v[180:183], v[224:227], a[96:99]
ds_read_b64_tr_b16 v[188:189], v8 offset:16640
v_mfma_f32_16x16x32_bf16 a[100:103], v[180:183], v[228:231], a[100:103]
ds_read_b64_tr_b16 v[190:191], v8 offset:22784
v_mfma_f32_16x16x32_bf16 a[104:107], v[180:183], v[232:235], a[104:107]
s_add_u32 s6, s75, 61440
buffer_load_dwordx4 v[220:223], v2, s[8:11], s6 offen
v_mfma_f32_16x16x32_bf16 a[108:111], v[180:183], v[236:239], a[108:111]
s_waitcnt lgkmcnt(2)
v_mfma_f32_16x16x32_bf16 a[112:115], v[184:187], v[224:227], a[112:115]
ds_read_b64_tr_b16 v[160:161], v9 offset:16640
v_mfma_f32_16x16x32_bf16 a[116:119], v[184:187], v[228:231], a[116:119]
ds_read_b64_tr_b16 v[162:163], v9 offset:22784
v_mfma_f32_16x16x32_bf16 a[120:123], v[184:187], v[232:235], a[120:123]
s_add_u32 s75, s75, 1024
v_mfma_f32_16x16x32_bf16 a[124:127], v[184:187], v[236:239], a[124:127]
s_waitcnt lgkmcnt(2)
v_mfma_f32_16x16x32_bf16 a[128:131], v[188:191], v[224:227], a[128:131]
ds_read_b64_tr_b16 v[164:165], v10 offset:16640
v_mfma_f32_16x16x32_bf16 a[132:135], v[188:191], v[228:231], a[132:135]
ds_read_b64_tr_b16 v[166:167], v10 offset:22784
v_mfma_f32_16x16x32_bf16 a[136:139], v[188:191], v[232:235], a[136:139]
v_mfma_f32_16x16x32_bf16 a[140:143], v[188:191], v[236:239], a[140:143]
s_waitcnt lgkmcnt(2)
v_mfma_f32_16x16x32_bf16 a[144:147], v[160:163], v[224:227], a[144:147]
ds_read_b64_tr_b16 v[168:169], v11 offset:16640
v_mfma_f32_16x16x32_bf16 a[148:151], v[160:163], v[228:231], a[148:151]
ds_read_b64_tr_b16 v[170:171], v11 offset:22784
v_mfma_f32_16x16x32_bf16 a[152:155], v[160:163], v[232:235], a[152:155]
v_mfma_f32_16x16x32_bf16 a[156:159], v[160:163], v[236:239], a[156:159]
s_waitcnt lgkmcnt(2)
v_mfma_f32_16x16x32_bf16 a[160:163], v[164:167], v[224:227], a[160:163]
ds_read_b64_tr_b16 v[172:173], v12 offset:16384
v_mfma_f32_16x16x32_bf16 a[164:167], v[164:167], v[228:231], a[164:167]
ds_read_b64_tr_b16 v[174:175], v12 offset:18432
v_mfma_f32_16x16x32_bf16 a[168:171], v[164:167], v[232:235], a[168:171]
v_mfma_f32_16x16x32_bf16 a[172:175], v[164:167], v[236:239], a[172:175]
s_waitcnt lgkmcnt(2)
v_mfma_f32_16x16x32_bf16 a[176:179], v[168:171], v[224:227], a[176:179]
ds_read_b64_tr_b16 v[176:177], v13 offset:16384
v_mfma_f32_16x16x32_bf16 a[180:183], v[168:171], v[228:231], a[180:183]
ds_read_b64_tr_b16 v[178:179], v13 offset:18432
v_mfma_f32_16x16x32_bf16 a[184:187], v[168:171], v[232:235], a[184:187]
v_mfma_f32_16x16x32_bf16 a[188:191], v[168:171], v[236:239], a[188:191]
s_waitcnt lgkmcnt(2)
v_mfma_f32_16x16x32_bf16 a[192:195], v[172:175], v[224:227], a[192:195]
ds_read_b64_tr_b16 v[180:181], v14 offset:16384
v_mfma_f32_16x16x32_bf16 a[196:199], v[172:175], v[228:231], a[196:199]
ds_read_b64_tr_b16 v[182:183], v14 offset:18432
v_mfma_f32_16x16x32_bf16 a[200:203], v[172:175], v[232:235], a[200:203]
v_mfma_f32_16x16x32_bf16 a[204:207], v[172:175], v[236:239], a[204:207]
s_waitcnt lgkmcnt(2)
v_mfma_f32_16x16x32_bf16 a[208:211], v[176:179], v[224:227], a[208:211]
ds_read_b64_tr_b16 v[184:185], v8 offset:32768
v_mfma_f32_16x16x32_bf16 a[212:215], v[176:179], v[228:231], a[212:215]
ds_read_b64_tr_b16 v[186:187], v8 offset:38912
v_mfma_f32_16x16x32_bf16 a[216:219], v[176:179], v[232:235], a[216:219]
v_mfma_f32_16x16x32_bf16 a[220:223], v[176:179], v[236:239], a[220:223]
s_waitcnt lgkmcnt(2)
v_mfma_f32_16x16x32_bf16 a[224:227], v[180:183], v[224:227], a[224:227]
ds_read_b64_tr_b16 v[188:189], v9 offset:32768
v_mfma_f32_16x16x32_bf16 a[228:231], v[180:183], v[228:231], a[228:231]
ds_read_b64_tr_b16 v[190:191], v9 offset:38912
v_mfma_f32_16x16x32_bf16 a[232:235], v[180:183], v[232:235], a[232:235]
v_mfma_f32_16x16x32_bf16 a[236:239], v[180:183], v[236:239], a[236:239]
s_waitcnt vmcnt(4) lgkmcnt(2)
v_mfma_f32_16x16x32_bf16 a[0:3], v[184:187], v[192:195], a[0:3]
s_barrier
ds_read_b64_tr_b16 v[160:161], v10 offset:32768
v_mfma_f32_16x16x32_bf16 a[4:7], v[184:187], v[196:199], a[4:7]
ds_read_b64_tr_b16 v[162:163], v10 offset:38912
v_mfma_f32_16x16x32_bf16 a[8:11], v[184:187], v[200:203], a[8:11]
v_mfma_f32_16x16x32_bf16 a[12:15], v[184:187], v[204:207], a[12:15]
s_waitcnt lgkmcnt(2)
v_mfma_f32_16x16x32_bf16 a[16:19], v[188:191], v[192:195], a[16:19]
ds_read_b64_tr_b16 v[164:165], v11 offset:32768
v_mfma_f32_16x16x32_bf16 a[20:23], v[188:191], v[196:199], a[20:23]
ds_read_b64_tr_b16 v[166:167], v11 offset:38912
v_mfma_f32_16x16x32_bf16 a[24:27], v[188:191], v[200:203], a[24:27]
v_mfma_f32_16x16x32_bf16 a[28:31], v[188:191], v[204:207], a[28:31]
s_waitcnt lgkmcnt(2)
v_mfma_f32_16x16x32_bf16 a[32:35], v[160:163], v[192:195], a[32:35]
ds_read_b64_tr_b16 v[168:169], v8 offset:32896
v_mfma_f32_16x16x32_bf16 a[36:39], v[160:163], v[196:199], a[36:39]
ds_read_b64_tr_b16 v[170:171], v8 offset:39040
v_mfma_f32_16x16x32_bf16 a[40:43], v[160:163], v[200:203], a[40:43]
v_mfma_f32_16x16x32_bf16 a[44:47], v[160:163], v[204:207], a[44:47]
s_waitcnt lgkmcnt(2)
v_mfma_f32_16x16x32_bf16 a[48:51], v[164:167], v[192:195], a[48:51]
ds_read_b64_tr_b16 v[172:173], v9 offset:32896
v_mfma_f32_16x16x32_bf16 a[52:55], v[164:167], v[196:199], a[52:55]
ds_read_b64_tr_b16 v[174:175], v9 offset:39040
v_mfma_f32_16x16x32_bf16 a[56:59], v[164:167], v[200:203], a[56:59]
v_mfma_f32_16x16x32_bf16 a[60:63], v[164:167], v[204:207], a[60:63]
s_waitcnt lgkmcnt(2)
v_mfma_f32_16x16x32_bf16 a[64:67], v[168:171], v[192:195], a[64:67]
ds_read_b64_tr_b16 v[176:177], v10 offset:32896
v_mfma_f32_16x16x32_bf16 a[68:71], v[168:171], v[196:199], a[68:71]
ds_read_b64_tr_b16 v[178:179], v10 offset:39040
v_mfma_f32_16x16x32_bf16 a[72:75], v[168:171], v[200:203], a[72:75]
v_mfma_f32_16x16x32_bf16 a[76:79], v[168:171], v[204:207], a[76:79]
s_waitcnt lgkmcnt(2)
v_mfma_f32_16x16x32_bf16 a[80:83], v[172:175], v[192:195], a[80:83]
ds_read_b64_tr_b16 v[180:181], v11 offset:32896
v_mfma_f32_16x16x32_bf16 a[84:87], v[172:175], v[196:199], a[84:87]
ds_read_b64_tr_b16 v[182:183], v11 offset:39040
v_mfma_f32_16x16x32_bf16 a[88:91], v[172:175], v[200:203], a[88:91]
v_mfma_f32_16x16x32_bf16 a[92:95], v[172:175], v[204:207], a[92:95]
s_waitcnt lgkmcnt(2)
v_mfma_f32_16x16x32_bf16 a[96:99], v[176:179], v[192:195], a[96:99]
ds_read_b64_tr_b16 v[184:185], v8 offset:33024
v_mfma_f32_16x16x32_bf16 a[100:103], v[176:179], v[196:199], a[100:103]
ds_read_b64_tr_b16 v[186:187], v8 offset:39168
v_mfma_f32_16x16x32_bf16 a[104:107], v[176:179], v[200:203], a[104:107]
v_mfma_f32_16x16x32_bf16 a[108:111], v[176:179], v[204:207], a[108:111]
s_waitcnt lgkmcnt(2)
v_mfma_f32_16x16x32_bf16 a[112:115], v[180:183], v[192:195], a[112:115]
ds_read_b64_tr_b16 v[188:189], v9 offset:33024
v_mfma_f32_16x16x32_bf16 a[116:119], v[180:183], v[196:199], a[116:119]
ds_read_b64_tr_b16 v[190:191], v9 offset:39168
v_mfma_f32_16x16x32_bf16 a[120:123], v[180:183], v[200:203], a[120:123]
v_mfma_f32_16x16x32_bf16 a[124:127], v[180:183], v[204:207], a[124:127]
s_waitcnt lgkmcnt(2)
v_mfma_f32_16x16x32_bf16 a[128:131], v[184:187], v[192:195], a[128:131]
ds_read_b64_tr_b16 v[160:161], v10 offset:33024
v_mfma_f32_16x16x32_bf16 a[132:135], v[184:187], v[196:199], a[132:135]
ds_read_b64_tr_b16 v[162:163], v10 offset:39168
v_mfma_f32_16x16x32_bf16 a[136:139], v[184:187], v[200:203], a[136:139]
v_mfma_f32_16x16x32_bf16 a[140:143], v[184:187], v[204:207], a[140:143]
s_waitcnt lgkmcnt(2)
v_mfma_f32_16x16x32_bf16 a[144:147], v[188:191], v[192:195], a[144:147]
ds_read_b64_tr_b16 v[164:165], v11 offset:33024
v_mfma_f32_16x16x32_bf16 a[148:151], v[188:191], v[196:199], a[148:151]
ds_read_b64_tr_b16 v[166:167], v11 offset:39168
v_mfma_f32_16x16x32_bf16 a[152:155], v[188:191], v[200:203], a[152:155]
v_mfma_f32_16x16x32_bf16 a[156:159], v[188:191], v[204:207], a[156:159]
s_waitcnt lgkmcnt(2)
v_mfma_f32_16x16x32_bf16 a[160:163], v[160:163], v[192:195], a[160:163]
ds_read_b64_tr_b16 v[168:169], v12 offset:32768
v_mfma_f32_16x16x32_bf16 a[164:167], v[160:163], v[196:199], a[164:167]
ds_read_b64_tr_b16 v[170:171], v12 offset:34816
v_mfma_f32_16x16x32_bf16 a[168:171], v[160:163], v[200:203], a[168:171]
v_mfma_f32_16x16x32_bf16 a[172:175], v[160:163], v[204:207], a[172:175]
s_waitcnt lgkmcnt(2)
v_mfma_f32_16x16x32_bf16 a[176:179], v[164:167], v[192:195], a[176:179]
ds_read_b64_tr_b16 v[172:173], v13 offset:32768
v_mfma_f32_16x16x32_bf16 a[180:183], v[164:167], v[196:199], a[180:183]
ds_read_b64_tr_b16 v[174:175], v13 offset:34816
v_mfma_f32_16x16x32_bf16 a[184:187], v[164:167], v[200:203], a[184:187]
v_mfma_f32_16x16x32_bf16 a[188:191], v[164:167], v[204:207], a[188:191]
s_waitcnt lgkmcnt(2)
v_mfma_f32_16x16x32_bf16 a[192:195], v[168:171], v[192:195], a[192:195]
ds_read_b64_tr_b16 v[176:177], v14 offset:32768
v_mfma_f32_16x16x32_bf16 a[196:199], v[168:171], v[196:199], a[196:199]
ds_read_b64_tr_b16 v[178:179], v14 offset:34816
v_mfma_f32_16x16x32_bf16 a[200:203], v[168:171], v[200:203], a[200:203]
v_mfma_f32_16x16x32_bf16 a[204:207], v[168:171], v[204:207], a[204:207]
s_waitcnt lgkmcnt(2)
v_mfma_f32_16x16x32_bf16 a[208:211], v[172:175], v[192:195], a[208:211]
ds_read_b64_tr_b16 v[180:181], v8 offset:49152
v_mfma_f32_16x16x32_bf16 a[212:215], v[172:175], v[196:199], a[212:215]
ds_read_b64_tr_b16 v[182:183], v8 offset:55296
v_mfma_f32_16x16x32_bf16 a[216:219], v[172:175], v[200:203], a[216:219]
v_mfma_f32_16x16x32_bf16 a[220:223], v[172:175], v[204:207], a[220:223]
s_waitcnt lgkmcnt(2)
v_mfma_f32_16x16x32_bf16 a[224:227], v[176:179], v[192:195], a[224:227]
ds_read_b64_tr_b16 v[184:185], v9 offset:49152
v_mfma_f32_16x16x32_bf16 a[228:231], v[176:179], v[196:199], a[228:231]
ds_read_b64_tr_b16 v[186:187], v9 offset:55296
v_mfma_f32_16x16x32_bf16 a[232:235], v[176:179], v[200:203], a[232:235]
v_mfma_f32_16x16x32_bf16 a[236:239], v[176:179], v[204:207], a[236:239]
s_waitcnt vmcnt(0) lgkmcnt(2)
v_mfma_f32_16x16x32_bf16 a[0:3], v[180:183], v[208:211], a[0:3]
s_barrier
ds_read_b64_tr_b16 v[188:189], v10 offset:49152
v_mfma_f32_16x16x32_bf16 a[4:7], v[180:183], v[212:215], a[4:7]
ds_read_b64_tr_b16 v[190:191], v10 offset:55296
v_mfma_f32_16x16x32_bf16 a[8:11], v[180:183], v[216:219], a[8:11]
v_mfma_f32_16x16x32_bf16 a[12:15], v[180:183], v[220:223], a[12:15]
s_waitcnt lgkmcnt(2)
v_mfma_f32_16x16x32_bf16 a[16:19], v[184:187], v[208:211], a[16:19]
ds_read_b64_tr_b16 v[160:161], v11 offset:49152
v_mfma_f32_16x16x32_bf16 a[20:23], v[184:187], v[212:215], a[20:23]
ds_read_b64_tr_b16 v[162:163], v11 offset:55296
v_mfma_f32_16x16x32_bf16 a[24:27], v[184:187], v[216:219], a[24:27]
v_mfma_f32_16x16x32_bf16 a[28:31], v[184:187], v[220:223], a[28:31]
s_waitcnt lgkmcnt(2)
v_mfma_f32_16x16x32_bf16 a[32:35], v[188:191], v[208:211], a[32:35]
ds_read_b64_tr_b16 v[164:165], v8 offset:49280
v_mfma_f32_16x16x32_bf16 a[36:39], v[188:191], v[212:215], a[36:39]
ds_read_b64_tr_b16 v[166:167], v8 offset:55424
v_mfma_f32_16x16x32_bf16 a[40:43], v[188:191], v[216:219], a[40:43]
v_mfma_f32_16x16x32_bf16 a[44:47], v[188:191], v[220:223], a[44:47]
s_waitcnt lgkmcnt(2)
v_mfma_f32_16x16x32_bf16 a[48:51], v[160:163], v[208:211], a[48:51]
ds_read_b64_tr_b16 v[168:169], v9 offset:49280
v_mfma_f32_16x16x32_bf16 a[52:55], v[160:163], v[212:215], a[52:55]
ds_read_b64_tr_b16 v[170:171], v9 offset:55424
v_mfma_f32_16x16x32_bf16 a[56:59], v[160:163], v[216:219], a[56:59]
v_mfma_f32_16x16x32_bf16 a[60:63], v[160:163], v[220:223], a[60:63]
s_waitcnt lgkmcnt(2)
v_mfma_f32_16x16x32_bf16 a[64:67], v[164:167], v[208:211], a[64:67]
ds_read_b64_tr_b16 v[172:173], v10 offset:49280
v_mfma_f32_16x16x32_bf16 a[68:71], v[164:167], v[212:215], a[68:71]
ds_read_b64_tr_b16 v[174:175], v10 offset:55424
v_mfma_f32_16x16x32_bf16 a[72:75], v[164:167], v[216:219], a[72:75]
v_mfma_f32_16x16x32_bf16 a[76:79], v[164:167], v[220:223], a[76:79]
s_waitcnt lgkmcnt(2)
v_mfma_f32_16x16x32_bf16 a[80:83], v[168:171], v[208:211], a[80:83]
ds_read_b64_tr_b16 v[176:177], v11 offset:49280
v_mfma_f32_16x16x32_bf16 a[84:87], v[168:171], v[212:215], a[84:87]
ds_read_b64_tr_b16 v[178:179], v11 offset:55424
v_mfma_f32_16x16x32_bf16 a[88:91], v[168:171], v[216:219], a[88:91]
v_mfma_f32_16x16x32_bf16 a[92:95], v[168:171], v[220:223], a[92:95]
s_waitcnt lgkmcnt(2)
v_mfma_f32_16x16x32_bf16 a[96:99], v[172:175], v[208:211], a[96:99]
ds_read_b64_tr_b16 v[180:181], v8 offset:49408
v_mfma_f32_16x16x32_bf16 a[100:103], v[172:175], v[212:215], a[100:103]
ds_read_b64_tr_b16 v[182:183], v8 offset:55552
v_mfma_f32_16x16x32_bf16 a[104:107], v[172:175], v[216:219], a[104:107]
v_mfma_f32_16x16x32_bf16 a[108:111], v[172:175], v[220:223], a[108:111]
s_waitcnt lgkmcnt(2)
v_mfma_f32_16x16x32_bf16 a[112:115], v[176:179], v[208:211], a[112:115]
ds_read_b64_tr_b16 v[184:185], v9 offset:49408
v_mfma_f32_16x16x32_bf16 a[116:119], v[176:179], v[212:215], a[116:119]
ds_read_b64_tr_b16 v[186:187], v9 offset:55552
v_mfma_f32_16x16x32_bf16 a[120:123], v[176:179], v[216:219], a[120:123]
v_mfma_f32_16x16x32_bf16 a[124:127], v[176:179], v[220:223], a[124:127]
s_waitcnt lgkmcnt(2)
v_mfma_f32_16x16x32_bf16 a[128:131], v[180:183], v[208:211], a[128:131]
ds_read_b64_tr_b16 v[188:189], v10 offset:49408
v_mfma_f32_16x16x32_bf16 a[132:135], v[180:183], v[212:215], a[132:135]
ds_read_b64_tr_b16 v[190:191], v10 offset:55552
v_mfma_f32_16x16x32_bf16 a[136:139], v[180:183], v[216:219], a[136:139]
v_mfma_f32_16x16x32_bf16 a[140:143], v[180:183], v[220:223], a[140:143]
s_waitcnt lgkmcnt(2)
v_mfma_f32_16x16x32_bf16 a[144:147], v[184:187], v[208:211], a[144:147]
ds_read_b64_tr_b16 v[160:161], v11 offset:49408
v_mfma_f32_16x16x32_bf16 a[148:151], v[184:187], v[212:215], a[148:151]
ds_read_b64_tr_b16 v[162:163], v11 offset:55552
v_mfma_f32_16x16x32_bf16 a[152:155], v[184:187], v[216:219], a[152:155]
v_mfma_f32_16x16x32_bf16 a[156:159], v[184:187], v[220:223], a[156:159]
s_waitcnt lgkmcnt(2)
v_mfma_f32_16x16x32_bf16 a[160:163], v[188:191], v[208:211], a[160:163]
ds_read_b64_tr_b16 v[164:165], v12 offset:49152
v_mfma_f32_16x16x32_bf16 a[164:167], v[188:191], v[212:215], a[164:167]
ds_read_b64_tr_b16 v[166:167], v12 offset:51200
v_mfma_f32_16x16x32_bf16 a[168:171], v[188:191], v[216:219], a[168:171]
v_mfma_f32_16x16x32_bf16 a[172:175], v[188:191], v[220:223], a[172:175]
s_waitcnt lgkmcnt(2)
v_mfma_f32_16x16x32_bf16 a[176:179], v[160:163], v[208:211], a[176:179]
ds_read_b64_tr_b16 v[168:169], v13 offset:49152
v_mfma_f32_16x16x32_bf16 a[180:183], v[160:163], v[212:215], a[180:183]
ds_read_b64_tr_b16 v[170:171], v13 offset:51200
v_mfma_f32_16x16x32_bf16 a[184:187], v[160:163], v[216:219], a[184:187]
v_mfma_f32_16x16x32_bf16 a[188:191], v[160:163], v[220:223], a[188:191]
s_waitcnt lgkmcnt(2)
v_mfma_f32_16x16x32_bf16 a[192:195], v[164:167], v[208:211], a[192:195]
ds_read_b64_tr_b16 v[172:173], v14 offset:49152
v_mfma_f32_16x16x32_bf16 a[196:199], v[164:167], v[212:215], a[196:199]
ds_read_b64_tr_b16 v[174:175], v14 offset:51200
v_mfma_f32_16x16x32_bf16 a[200:203], v[164:167], v[216:219], a[200:203]
v_mfma_f32_16x16x32_bf16 a[204:207], v[164:167], v[220:223], a[204:207]
s_waitcnt lgkmcnt(2)
v_mfma_f32_16x16x32_bf16 a[208:211], v[168:171], v[208:211], a[208:211]
v_mfma_f32_16x16x32_bf16 a[212:215], v[168:171], v[212:215], a[212:215]
v_mfma_f32_16x16x32_bf16 a[216:219], v[168:171], v[216:219], a[216:219]
v_mfma_f32_16x16x32_bf16 a[220:223], v[168:171], v[220:223], a[220:223]
s_waitcnt lgkmcnt(0)
v_mfma_f32_16x16x32_bf16 a[224:227], v[172:175], v[208:211], a[224:227]
v_mfma_f32_16x16x32_bf16 a[228:231], v[172:175], v[212:215], a[228:231]
v_mfma_f32_16x16x32_bf16 a[232:235], v[172:175], v[216:219], a[232:235]
v_mfma_f32_16x16x32_bf16 a[236:239], v[172:175], v[220:223], a[236:239]
s_barrier
s_sub_u32 s43, s42, 24576
s_add_u32 m0, s47, 24576
s_nop 0
buffer_load_dwordx4 v25, s[24:27], s43 offen offset:0 lds
buffer_load_dwordx4 v26, s[24:27], s43 offen offset:1024 lds
buffer_load_dwordx4 v27, s[24:27], s43 offen offset:2048 lds
s_add_u32 s43, s43, 12288
s_add_u32 m0, s47, 36864
s_nop 0
buffer_load_dwordx4 v25, s[24:27], s43 offen offset:0 lds
buffer_load_dwordx4 v26, s[24:27], s43 offen offset:1024 lds
buffer_load_dwordx4 v27, s[24:27], s43 offen offset:2048 lds
s_add_u32 s43, s43, 12288
s_nop 7
s_mul_i32 s7, s74, 49152
v_lshlrev_b32 v35, 4, v1
v_add_u32 v31, s7, v35
v_lshlrev_b32 v40, 16, v240
v_and_b32 v41, 0xffff0000, v240
v_lshlrev_b32 v42, 16, v241
v_and_b32 v43, 0xffff0000, v241
v_lshlrev_b32 v44, 16, v242
v_and_b32 v45, 0xffff0000, v242
v_lshlrev_b32 v46, 16, v243
v_and_b32 v47, 0xffff0000, v243
v_lshlrev_b32 v48, 16, v244
v_and_b32 v49, 0xffff0000, v244
v_lshlrev_b32 v50, 16, v245
v_and_b32 v51, 0xffff0000, v245
s_mul_i32 s6, s3, 3
s_add_u32 s51, s6, 0
s_lshr_b32 s7, s51, 1
s_lshl_b32 s7, s7, 10
s_and_b32 s51, s51, 1
s_lshl_b32 s51, s51, 3
s_add_u32 s7, s7, s51
v_accvgpr_read_b32 v64, a192
v_accvgpr_read_b32 v65, a193
v_accvgpr_read_b32 v66, a194
v_accvgpr_read_b32 v67, a195
v_add_f32 v64, v64, v40
v_add_f32 v65, v65, v41
v_add_f32 v66, v66, v42
v_add_f32 v67, v67, v43
v_max_f32 v64, 0, v64
v_max_f32 v65, 0, v65
v_max_f32 v66, 0, v66
v_max_f32 v67, 0, v67
v_mul_f32 v64, v64, v64
v_mul_f32 v65, v65, v65
v_mul_f32 v66, v66, v66
v_mul_f32 v67, v67, v67
v_cvt_pk_bf16_f32 v80, v64, v65
v_cvt_pk_bf16_f32 v81, v66, v67
s_add_u32 s51, s7, 0
buffer_store_dwordx2 v[80:81], v31, s[32:35], s51 offen
v_accvgpr_read_b32 v72, a196
v_accvgpr_read_b32 v73, a197
v_accvgpr_read_b32 v74, a198
v_accvgpr_read_b32 v75, a199
v_add_f32 v72, v72, v40
v_add_f32 v73, v73, v41
v_add_f32 v74, v74, v42
v_add_f32 v75, v75, v43
v_max_f32 v72, 0, v72
v_max_f32 v73, 0, v73
v_max_f32 v74, 0, v74
v_max_f32 v75, 0, v75
v_mul_f32 v72, v72, v72
v_mul_f32 v73, v73, v73
v_mul_f32 v74, v74, v74
v_mul_f32 v75, v75, v75
v_cvt_pk_bf16_f32 v82, v72, v73
v_cvt_pk_bf16_f32 v83, v74, v75
s_add_u32 s51, s7, 49152
buffer_store_dwordx2 v[82:83], v31, s[32:35], s51 offen
v_accvgpr_read_b32 v64, a200
v_accvgpr_read_b32 v65, a201
v_accvgpr_read_b32 v66, a202
v_accvgpr_read_b32 v67, a203
v_add_f32 v64, v64, v40
v_add_f32 v65, v65, v41
v_add_f32 v66, v66, v42
v_add_f32 v67, v67, v43
v_max_f32 v64, 0, v64
v_max_f32 v65, 0, v65
v_max_f32 v66, 0, v66
v_max_f32 v67, 0, v67
v_mul_f32 v64, v64, v64
v_mul_f32 v65, v65, v65
v_mul_f32 v66, v66, v66
v_mul_f32 v67, v67, v67
v_cvt_pk_bf16_f32 v84, v64, v65
v_cvt_pk_bf16_f32 v85, v66, v67
s_add_u32 s51, s7, 98304
buffer_store_dwordx2 v[84:85], v31, s[32:35], s51 offen
v_accvgpr_read_b32 v72, a204
v_accvgpr_read_b32 v73, a205
v_accvgpr_read_b32 v74, a206
v_accvgpr_read_b32 v75, a207
v_add_f32 v72, v72, v40
v_add_f32 v73, v73, v41
v_add_f32 v74, v74, v42
v_add_f32 v75, v75, v43
v_max_f32 v72, 0, v72
v_max_f32 v73, 0, v73
v_max_f32 v74, 0, v74
v_max_f32 v75, 0, v75
v_mul_f32 v72, v72, v72
v_mul_f32 v73, v73, v73
v_mul_f32 v74, v74, v74
v_mul_f32 v75, v75, v75
v_cvt_pk_bf16_f32 v86, v72, v73
v_cvt_pk_bf16_f32 v87, v74, v75
s_add_u32 s51, s7, 147456
buffer_store_dwordx2 v[86:87], v31, s[32:35], s51 offen
s_add_u32 s51, s6, 1
s_lshr_b32 s7, s51, 1
s_lshl_b32 s7, s7, 10
s_and_b32 s51, s51, 1
s_lshl_b32 s51, s51, 3
s_add_u32 s7, s7, s51
v_accvgpr_read_b32 v64, a208
v_accvgpr_read_b32 v65, a209
v_accvgpr_read_b32 v66, a210
v_accvgpr_read_b32 v67, a211
v_add_f32 v64, v64, v44
v_add_f32 v65, v65, v45
v_add_f32 v66, v66, v46
v_add_f32 v67, v67, v47
v_max_f32 v64, 0, v64
v_max_f32 v65, 0, v65
v_max_f32 v66, 0, v66
v_max_f32 v67, 0, v67
v_mul_f32 v64, v64, v64
v_mul_f32 v65, v65, v65
v_mul_f32 v66, v66, v66
v_mul_f32 v67, v67, v67
v_cvt_pk_bf16_f32 v88, v64, v65
v_cvt_pk_bf16_f32 v89, v66, v67
s_add_u32 s51, s7, 0
buffer_store_dwordx2 v[88:89], v31, s[32:35], s51 offen
v_accvgpr_read_b32 v72, a212
v_accvgpr_read_b32 v73, a213
v_accvgpr_read_b32 v74, a214
v_accvgpr_read_b32 v75, a215
v_add_f32 v72, v72, v44
v_add_f32 v73, v73, v45
v_add_f32 v74, v74, v46
v_add_f32 v75, v75, v47
v_max_f32 v72, 0, v72
v_max_f32 v73, 0, v73
v_max_f32 v74, 0, v74
v_max_f32 v75, 0, v75
v_mul_f32 v72, v72, v72
v_mul_f32 v73, v73, v73
v_mul_f32 v74, v74, v74
v_mul_f32 v75, v75, v75
v_cvt_pk_bf16_f32 v90, v72, v73
v_cvt_pk_bf16_f32 v91, v74, v75
s_add_u32 s51, s7, 49152
buffer_store_dwordx2 v[90:91], v31, s[32:35], s51 offen
v_accvgpr_read_b32 v64, a216
v_accvgpr_read_b32 v65, a217
v_accvgpr_read_b32 v66, a218
v_accvgpr_read_b32 v67, a219
v_add_f32 v64, v64, v44
v_add_f32 v65, v65, v45
v_add_f32 v66, v66, v46
v_add_f32 v67, v67, v47
v_max_f32 v64, 0, v64
v_max_f32 v65, 0, v65
v_max_f32 v66, 0, v66
v_max_f32 v67, 0, v67
v_mul_f32 v64, v64, v64
v_mul_f32 v65, v65, v65
v_mul_f32 v66, v66, v66
v_mul_f32 v67, v67, v67
v_cvt_pk_bf16_f32 v92, v64, v65
v_cvt_pk_bf16_f32 v93, v66, v67
s_add_u32 s51, s7, 98304
buffer_store_dwordx2 v[92:93], v31, s[32:35], s51 offen
v_accvgpr_read_b32 v72, a220
v_accvgpr_read_b32 v73, a221
v_accvgpr_read_b32 v74, a222
v_accvgpr_read_b32 v75, a223
v_add_f32 v72, v72, v44
v_add_f32 v73, v73, v45
v_add_f32 v74, v74, v46
v_add_f32 v75, v75, v47
v_max_f32 v72, 0, v72
v_max_f32 v73, 0, v73
v_max_f32 v74, 0, v74
v_max_f32 v75, 0, v75
v_mul_f32 v72, v72, v72
v_mul_f32 v73, v73, v73
v_mul_f32 v74, v74, v74
v_mul_f32 v75, v75, v75
v_cvt_pk_bf16_f32 v94, v72, v73
v_cvt_pk_bf16_f32 v95, v74, v75
s_add_u32 s51, s7, 147456
buffer_store_dwordx2 v[94:95], v31, s[32:35], s51 offen
s_add_u32 s51, s6, 2
s_lshr_b32 s7, s51, 1
s_lshl_b32 s7, s7, 10
s_and_b32 s51, s51, 1
s_lshl_b32 s51, s51, 3
s_add_u32 s7, s7, s51
v_accvgpr_read_b32 v64, a224
v_accvgpr_read_b32 v65, a225
v_accvgpr_read_b32 v66, a226
v_accvgpr_read_b32 v67, a227
v_add_f32 v64, v64, v48
v_add_f32 v65, v65, v49
v_add_f32 v66, v66, v50
v_add_f32 v67, v67, v51
v_max_f32 v64, 0, v64
v_max_f32 v65, 0, v65
v_max_f32 v66, 0, v66
v_max_f32 v67, 0, v67
v_mul_f32 v64, v64, v64
v_mul_f32 v65, v65, v65
v_mul_f32 v66, v66, v66
v_mul_f32 v67, v67, v67
v_cvt_pk_bf16_f32 v96, v64, v65
v_cvt_pk_bf16_f32 v97, v66, v67
s_add_u32 s51, s7, 0
buffer_store_dwordx2 v[96:97], v31, s[32:35], s51 offen
v_accvgpr_read_b32 v72, a228
v_accvgpr_read_b32 v73, a229
v_accvgpr_read_b32 v74, a230
v_accvgpr_read_b32 v75, a231
v_add_f32 v72, v72, v48
v_add_f32 v73, v73, v49
v_add_f32 v74, v74, v50
v_add_f32 v75, v75, v51
v_max_f32 v72, 0, v72
v_max_f32 v73, 0, v73
v_max_f32 v74, 0, v74
v_max_f32 v75, 0, v75
v_mul_f32 v72, v72, v72
v_mul_f32 v73, v73, v73
v_mul_f32 v74, v74, v74
v_mul_f32 v75, v75, v75
v_cvt_pk_bf16_f32 v98, v72, v73
v_cvt_pk_bf16_f32 v99, v74, v75
s_add_u32 s51, s7, 49152
buffer_store_dwordx2 v[98:99], v31, s[32:35], s51 offen
v_accvgpr_read_b32 v64, a232
v_accvgpr_read_b32 v65, a233
v_accvgpr_read_b32 v66, a234
v_accvgpr_read_b32 v67, a235
v_add_f32 v64, v64, v48
v_add_f32 v65, v65, v49
v_add_f32 v66, v66, v50
v_add_f32 v67, v67, v51
v_max_f32 v64, 0, v64
v_max_f32 v65, 0, v65
v_max_f32 v66, 0, v66
v_max_f32 v67, 0, v67
v_mul_f32 v64, v64, v64
v_mul_f32 v65, v65, v65
v_mul_f32 v66, v66, v66
v_mul_f32 v67, v67, v67
v_cvt_pk_bf16_f32 v100, v64, v65
v_cvt_pk_bf16_f32 v101, v66, v67
s_add_u32 s51, s7, 98304
buffer_store_dwordx2 v[100:101], v31, s[32:35], s51 offen
v_accvgpr_read_b32 v72, a236
v_accvgpr_read_b32 v73, a237
v_accvgpr_read_b32 v74, a238
v_accvgpr_read_b32 v75, a239
v_add_f32 v72, v72, v48
v_add_f32 v73, v73, v49
v_add_f32 v74, v74, v50
v_add_f32 v75, v75, v51
v_max_f32 v72, 0, v72
v_max_f32 v73, 0, v73
v_max_f32 v74, 0, v74
v_max_f32 v75, 0, v75
v_mul_f32 v72, v72, v72
v_mul_f32 v73, v73, v73
v_mul_f32 v74, v74, v74
v_mul_f32 v75, v75, v75
v_cvt_pk_bf16_f32 v102, v72, v73
v_cvt_pk_bf16_f32 v103, v74, v75
s_add_u32 s51, s7, 147456
buffer_store_dwordx2 v[102:103], v31, s[32:35], s51 offen
s_mov_b32 s7, 0x3dd53b95
v_accvgpr_read_b32 v64, a0
v_accvgpr_read_b32 v65, a1
v_accvgpr_read_b32 v66, a2
v_accvgpr_read_b32 v67, a3
v_accvgpr_read_b32 v68, a16
v_accvgpr_read_b32 v69, a17
v_accvgpr_read_b32 v70, a18
v_accvgpr_read_b32 v71, a19
v_mul_f32 v64, s7, v64
v_mul_f32 v65, s7, v65
v_mul_f32 v66, s7, v66
v_mul_f32 v67, s7, v67
v_mul_f32 v68, s7, v68
v_mul_f32 v69, s7, v69
v_mul_f32 v70, s7, v70
v_mul_f32 v71, s7, v71
v_cvt_pk_bf16_f32 v112, v64, v65
v_cvt_pk_bf16_f32 v113, v66, v67
v_cvt_pk_bf16_f32 v114, v68, v69
v_cvt_pk_bf16_f32 v115, v70, v71
s_nop 1
v_permlane32_swap_b32 v112, v114
v_permlane32_swap_b32 v113, v115
s_nop 1
v_permlane16_swap_b32 v112, v114
v_permlane16_swap_b32 v113, v115
s_nop 1
v_accvgpr_write_b32 a192, v112
v_accvgpr_write_b32 a193, v113
v_accvgpr_write_b32 a194, v114
v_accvgpr_write_b32 a195, v115
v_accvgpr_read_b32 v72, a32
v_accvgpr_read_b32 v73, a33
v_accvgpr_read_b32 v74, a34
v_accvgpr_read_b32 v75, a35
v_accvgpr_read_b32 v76, a48
v_accvgpr_read_b32 v77, a49
v_accvgpr_read_b32 v78, a50
v_accvgpr_read_b32 v79, a51
v_mul_f32 v72, s7, v72
v_mul_f32 v73, s7, v73
v_mul_f32 v74, s7, v74
v_mul_f32 v75, s7, v75
v_mul_f32 v76, s7, v76
v_mul_f32 v77, s7, v77
v_mul_f32 v78, s7, v78
v_mul_f32 v79, s7, v79
v_cvt_pk_bf16_f32 v116, v72, v73
v_cvt_pk_bf16_f32 v117, v74, v75
v_cvt_pk_bf16_f32 v118, v76, v77
v_cvt_pk_bf16_f32 v119, v78, v79
s_nop 1
v_permlane32_swap_b32 v116, v118
v_permlane32_swap_b32 v117, v119
s_nop 1
v_permlane16_swap_b32 v116, v118
v_permlane16_swap_b32 v117, v119
s_nop 1
v_accvgpr_write_b32 a196, v116
v_accvgpr_write_b32 a197, v117
v_accvgpr_write_b32 a198, v118
v_accvgpr_write_b32 a199, v119
v_accvgpr_read_b32 v64, a64
v_accvgpr_read_b32 v65, a65
v_accvgpr_read_b32 v66, a66
v_accvgpr_read_b32 v67, a67
v_accvgpr_read_b32 v68, a80
v_accvgpr_read_b32 v69, a81
v_accvgpr_read_b32 v70, a82
v_accvgpr_read_b32 v71, a83
v_mul_f32 v64, s7, v64
v_mul_f32 v65, s7, v65
v_mul_f32 v66, s7, v66
v_mul_f32 v67, s7, v67
v_mul_f32 v68, s7, v68
v_mul_f32 v69, s7, v69
v_mul_f32 v70, s7, v70
v_mul_f32 v71, s7, v71
v_cvt_pk_bf16_f32 v112, v64, v65
v_cvt_pk_bf16_f32 v113, v66, v67
v_cvt_pk_bf16_f32 v114, v68, v69
v_cvt_pk_bf16_f32 v115, v70, v71
s_nop 1
v_permlane32_swap_b32 v112, v114
v_permlane32_swap_b32 v113, v115
s_nop 1
v_permlane16_swap_b32 v112, v114
v_permlane16_swap_b32 v113, v115
s_nop 1
v_accvgpr_write_b32 a200, v112
v_accvgpr_write_b32 a201, v113
v_accvgpr_write_b32 a202, v114
v_accvgpr_write_b32 a203, v115
v_accvgpr_read_b32 v72, a96
v_accvgpr_read_b32 v73, a97
v_accvgpr_read_b32 v74, a98
v_accvgpr_read_b32 v75, a99
v_accvgpr_read_b32 v76, a112
v_accvgpr_read_b32 v77, a113
v_accvgpr_read_b32 v78, a114
v_accvgpr_read_b32 v79, a115
v_mul_f32 v72, s7, v72
v_mul_f32 v73, s7, v73
v_mul_f32 v74, s7, v74
v_mul_f32 v75, s7, v75
v_mul_f32 v76, s7, v76
v_mul_f32 v77, s7, v77
v_mul_f32 v78, s7, v78
v_mul_f32 v79, s7, v79
v_cvt_pk_bf16_f32 v116, v72, v73
v_cvt_pk_bf16_f32 v117, v74, v75
v_cvt_pk_bf16_f32 v118, v76, v77
v_cvt_pk_bf16_f32 v119, v78, v79
s_nop 1
v_permlane32_swap_b32 v116, v118
v_permlane32_swap_b32 v117, v119
s_nop 1
v_permlane16_swap_b32 v116, v118
v_permlane16_swap_b32 v117, v119
s_nop 1
v_accvgpr_write_b32 a204, v116
v_accvgpr_write_b32 a205, v117
v_accvgpr_write_b32 a206, v118
v_accvgpr_write_b32 a207, v119
v_accvgpr_read_b32 v64, a128
v_accvgpr_read_b32 v65, a129
v_accvgpr_read_b32 v66, a130
v_accvgpr_read_b32 v67, a131
v_accvgpr_read_b32 v68, a144
v_accvgpr_read_b32 v69, a145
v_accvgpr_read_b32 v70, a146
v_accvgpr_read_b32 v71, a147
v_mul_f32 v64, s7, v64
v_mul_f32 v65, s7, v65
v_mul_f32 v66, s7, v66
v_mul_f32 v67, s7, v67
v_mul_f32 v68, s7, v68
v_mul_f32 v69, s7, v69
v_mul_f32 v70, s7, v70
v_mul_f32 v71, s7, v71
v_cvt_pk_bf16_f32 v112, v64, v65
v_cvt_pk_bf16_f32 v113, v66, v67
v_cvt_pk_bf16_f32 v114, v68, v69
v_cvt_pk_bf16_f32 v115, v70, v71
s_nop 1
v_permlane32_swap_b32 v112, v114
v_permlane32_swap_b32 v113, v115
s_nop 1
v_permlane16_swap_b32 v112, v114
v_permlane16_swap_b32 v113, v115
s_nop 1
v_accvgpr_write_b32 a208, v112
v_accvgpr_write_b32 a209, v113
v_accvgpr_write_b32 a210, v114
v_accvgpr_write_b32 a211, v115
v_accvgpr_read_b32 v72, a160
v_accvgpr_read_b32 v73, a161
v_accvgpr_read_b32 v74, a162
v_accvgpr_read_b32 v75, a163
v_accvgpr_read_b32 v76, a176
v_accvgpr_read_b32 v77, a177
v_accvgpr_read_b32 v78, a178
v_accvgpr_read_b32 v79, a179
v_mul_f32 v72, s7, v72
v_mul_f32 v73, s7, v73
v_mul_f32 v74, s7, v74
v_mul_f32 v75, s7, v75
v_mul_f32 v76, s7, v76
v_mul_f32 v77, s7, v77
v_mul_f32 v78, s7, v78
v_mul_f32 v79, s7, v79
v_cvt_pk_bf16_f32 v116, v72, v73
v_cvt_pk_bf16_f32 v117, v74, v75
v_cvt_pk_bf16_f32 v118, v76, v77
v_cvt_pk_bf16_f32 v119, v78, v79
s_nop 1
v_permlane32_swap_b32 v116, v118
v_permlane32_swap_b32 v117, v119
s_nop 1
v_permlane16_swap_b32 v116, v118
v_permlane16_swap_b32 v117, v119
s_nop 1
v_accvgpr_write_b32 a212, v116
v_accvgpr_write_b32 a213, v117
v_accvgpr_write_b32 a214, v118
v_accvgpr_write_b32 a215, v119
v_accvgpr_read_b32 v64, a4
v_accvgpr_read_b32 v65, a5
v_accvgpr_read_b32 v66, a6
v_accvgpr_read_b32 v67, a7
v_accvgpr_read_b32 v68, a20
v_accvgpr_read_b32 v69, a21
v_accvgpr_read_b32 v70, a22
v_accvgpr_read_b32 v71, a23
v_mul_f32 v64, s7, v64
v_mul_f32 v65, s7, v65
v_mul_f32 v66, s7, v66
v_mul_f32 v67, s7, v67
v_mul_f32 v68, s7, v68
v_mul_f32 v69, s7, v69
v_mul_f32 v70, s7, v70
v_mul_f32 v71, s7, v71
v_cvt_pk_bf16_f32 v112, v64, v65
v_cvt_pk_bf16_f32 v113, v66, v67
v_cvt_pk_bf16_f32 v114, v68, v69
v_cvt_pk_bf16_f32 v115, v70, v71
s_nop 1
v_permlane32_swap_b32 v112, v114
v_permlane32_swap_b32 v113, v115
s_nop 1
v_permlane16_swap_b32 v112, v114
v_permlane16_swap_b32 v113, v115
s_nop 1
v_accvgpr_write_b32 a216, v112
v_accvgpr_write_b32 a217, v113
v_accvgpr_write_b32 a218, v114
v_accvgpr_write_b32 a219, v115
v_accvgpr_read_b32 v72, a36
v_accvgpr_read_b32 v73, a37
v_accvgpr_read_b32 v74, a38
v_accvgpr_read_b32 v75, a39
v_accvgpr_read_b32 v76, a52
v_accvgpr_read_b32 v77, a53
v_accvgpr_read_b32 v78, a54
v_accvgpr_read_b32 v79, a55
v_mul_f32 v72, s7, v72
v_mul_f32 v73, s7, v73
v_mul_f32 v74, s7, v74
v_mul_f32 v75, s7, v75
v_mul_f32 v76, s7, v76
v_mul_f32 v77, s7, v77
v_mul_f32 v78, s7, v78
v_mul_f32 v79, s7, v79
v_cvt_pk_bf16_f32 v116, v72, v73
v_cvt_pk_bf16_f32 v117, v74, v75
v_cvt_pk_bf16_f32 v118, v76, v77
v_cvt_pk_bf16_f32 v119, v78, v79
s_nop 1
v_permlane32_swap_b32 v116, v118
v_permlane32_swap_b32 v117, v119
s_nop 1
v_permlane16_swap_b32 v116, v118
v_permlane16_swap_b32 v117, v119
s_nop 1
v_accvgpr_write_b32 a220, v116
v_accvgpr_write_b32 a221, v117
v_accvgpr_write_b32 a222, v118
v_accvgpr_write_b32 a223, v119
v_accvgpr_read_b32 v64, a68
v_accvgpr_read_b32 v65, a69
v_accvgpr_read_b32 v66, a70
v_accvgpr_read_b32 v67, a71
v_accvgpr_read_b32 v68, a84
v_accvgpr_read_b32 v69, a85
v_accvgpr_read_b32 v70, a86
v_accvgpr_read_b32 v71, a87
v_mul_f32 v64, s7, v64
v_mul_f32 v65, s7, v65
v_mul_f32 v66, s7, v66
v_mul_f32 v67, s7, v67
v_mul_f32 v68, s7, v68
v_mul_f32 v69, s7, v69
v_mul_f32 v70, s7, v70
v_mul_f32 v71, s7, v71
v_cvt_pk_bf16_f32 v112, v64, v65
v_cvt_pk_bf16_f32 v113, v66, v67
v_cvt_pk_bf16_f32 v114, v68, v69
v_cvt_pk_bf16_f32 v115, v70, v71
s_nop 1
v_permlane32_swap_b32 v112, v114
v_permlane32_swap_b32 v113, v115
s_nop 1
v_permlane16_swap_b32 v112, v114
v_permlane16_swap_b32 v113, v115
s_nop 1
v_accvgpr_write_b32 a224, v112
v_accvgpr_write_b32 a225, v113
v_accvgpr_write_b32 a226, v114
v_accvgpr_write_b32 a227, v115
v_accvgpr_read_b32 v72, a100
v_accvgpr_read_b32 v73, a101
v_accvgpr_read_b32 v74, a102
v_accvgpr_read_b32 v75, a103
v_accvgpr_read_b32 v76, a116
v_accvgpr_read_b32 v77, a117
v_accvgpr_read_b32 v78, a118
v_accvgpr_read_b32 v79, a119
v_mul_f32 v72, s7, v72
v_mul_f32 v73, s7, v73
v_mul_f32 v74, s7, v74
v_mul_f32 v75, s7, v75
v_mul_f32 v76, s7, v76
v_mul_f32 v77, s7, v77
v_mul_f32 v78, s7, v78
v_mul_f32 v79, s7, v79
v_cvt_pk_bf16_f32 v116, v72, v73
v_cvt_pk_bf16_f32 v117, v74, v75
v_cvt_pk_bf16_f32 v118, v76, v77
v_cvt_pk_bf16_f32 v119, v78, v79
s_nop 1
v_permlane32_swap_b32 v116, v118
v_permlane32_swap_b32 v117, v119
s_nop 1
v_permlane16_swap_b32 v116, v118
v_permlane16_swap_b32 v117, v119
s_nop 1
v_accvgpr_write_b32 a228, v116
v_accvgpr_write_b32 a229, v117
v_accvgpr_write_b32 a230, v118
v_accvgpr_write_b32 a231, v119
v_accvgpr_read_b32 v64, a132
v_accvgpr_read_b32 v65, a133
v_accvgpr_read_b32 v66, a134
v_accvgpr_read_b32 v67, a135
v_accvgpr_read_b32 v68, a148
v_accvgpr_read_b32 v69, a149
v_accvgpr_read_b32 v70, a150
v_accvgpr_read_b32 v71, a151
v_mul_f32 v64, s7, v64
v_mul_f32 v65, s7, v65
v_mul_f32 v66, s7, v66
v_mul_f32 v67, s7, v67
v_mul_f32 v68, s7, v68
v_mul_f32 v69, s7, v69
v_mul_f32 v70, s7, v70
v_mul_f32 v71, s7, v71
v_cvt_pk_bf16_f32 v112, v64, v65
v_cvt_pk_bf16_f32 v113, v66, v67
v_cvt_pk_bf16_f32 v114, v68, v69
v_cvt_pk_bf16_f32 v115, v70, v71
s_nop 1
v_permlane32_swap_b32 v112, v114
v_permlane32_swap_b32 v113, v115
s_nop 1
v_permlane16_swap_b32 v112, v114
v_permlane16_swap_b32 v113, v115
s_nop 1
v_accvgpr_write_b32 a232, v112
v_accvgpr_write_b32 a233, v113
v_accvgpr_write_b32 a234, v114
v_accvgpr_write_b32 a235, v115
v_accvgpr_read_b32 v72, a164
v_accvgpr_read_b32 v73, a165
v_accvgpr_read_b32 v74, a166
v_accvgpr_read_b32 v75, a167
v_accvgpr_read_b32 v76, a180
v_accvgpr_read_b32 v77, a181
v_accvgpr_read_b32 v78, a182
v_accvgpr_read_b32 v79, a183
v_mul_f32 v72, s7, v72
v_mul_f32 v73, s7, v73
v_mul_f32 v74, s7, v74
v_mul_f32 v75, s7, v75
v_mul_f32 v76, s7, v76
v_mul_f32 v77, s7, v77
v_mul_f32 v78, s7, v78
v_mul_f32 v79, s7, v79
v_cvt_pk_bf16_f32 v116, v72, v73
v_cvt_pk_bf16_f32 v117, v74, v75
v_cvt_pk_bf16_f32 v118, v76, v77
v_cvt_pk_bf16_f32 v119, v78, v79
s_nop 1
v_permlane32_swap_b32 v116, v118
v_permlane32_swap_b32 v117, v119
s_nop 1
v_permlane16_swap_b32 v116, v118
v_permlane16_swap_b32 v117, v119
s_nop 1
v_accvgpr_write_b32 a236, v116
v_accvgpr_write_b32 a237, v117
v_accvgpr_write_b32 a238, v118
v_accvgpr_write_b32 a239, v119
v_accvgpr_read_b32 v64, a8
v_accvgpr_read_b32 v65, a9
v_accvgpr_read_b32 v66, a10
v_accvgpr_read_b32 v67, a11
v_accvgpr_read_b32 v68, a24
v_accvgpr_read_b32 v69, a25
v_accvgpr_read_b32 v70, a26
v_accvgpr_read_b32 v71, a27
v_mul_f32 v64, s7, v64
v_mul_f32 v65, s7, v65
v_mul_f32 v66, s7, v66
v_mul_f32 v67, s7, v67
v_mul_f32 v68, s7, v68
v_mul_f32 v69, s7, v69
v_mul_f32 v70, s7, v70
v_mul_f32 v71, s7, v71
v_cvt_pk_bf16_f32 v112, v64, v65
v_cvt_pk_bf16_f32 v113, v66, v67
v_cvt_pk_bf16_f32 v114, v68, v69
v_cvt_pk_bf16_f32 v115, v70, v71
s_nop 1
v_permlane32_swap_b32 v112, v114
v_permlane32_swap_b32 v113, v115
s_nop 1
v_permlane16_swap_b32 v112, v114
v_permlane16_swap_b32 v113, v115
s_nop 1
v_accvgpr_write_b32 a240, v112
v_accvgpr_write_b32 a241, v113
v_accvgpr_write_b32 a242, v114
v_accvgpr_write_b32 a243, v115
v_accvgpr_read_b32 v72, a40
v_accvgpr_read_b32 v73, a41
v_accvgpr_read_b32 v74, a42
v_accvgpr_read_b32 v75, a43
v_accvgpr_read_b32 v76, a56
v_accvgpr_read_b32 v77, a57
v_accvgpr_read_b32 v78, a58
v_accvgpr_read_b32 v79, a59
v_mul_f32 v72, s7, v72
v_mul_f32 v73, s7, v73
v_mul_f32 v74, s7, v74
v_mul_f32 v75, s7, v75
v_mul_f32 v76, s7, v76
v_mul_f32 v77, s7, v77
v_mul_f32 v78, s7, v78
v_mul_f32 v79, s7, v79
v_cvt_pk_bf16_f32 v116, v72, v73
v_cvt_pk_bf16_f32 v117, v74, v75
v_cvt_pk_bf16_f32 v118, v76, v77
v_cvt_pk_bf16_f32 v119, v78, v79
s_nop 1
v_permlane32_swap_b32 v116, v118
v_permlane32_swap_b32 v117, v119
s_nop 1
v_permlane16_swap_b32 v116, v118
v_permlane16_swap_b32 v117, v119
s_nop 1
v_accvgpr_write_b32 a244, v116
v_accvgpr_write_b32 a245, v117
v_accvgpr_write_b32 a246, v118
v_accvgpr_write_b32 a247, v119
v_accvgpr_read_b32 v64, a72
v_accvgpr_read_b32 v65, a73
v_accvgpr_read_b32 v66, a74
v_accvgpr_read_b32 v67, a75
v_accvgpr_read_b32 v68, a88
v_accvgpr_read_b32 v69, a89
v_accvgpr_read_b32 v70, a90
v_accvgpr_read_b32 v71, a91
v_mul_f32 v64, s7, v64
v_mul_f32 v65, s7, v65
v_mul_f32 v66, s7, v66
v_mul_f32 v67, s7, v67
v_mul_f32 v68, s7, v68
v_mul_f32 v69, s7, v69
v_mul_f32 v70, s7, v70
v_mul_f32 v71, s7, v71
v_cvt_pk_bf16_f32 v112, v64, v65
v_cvt_pk_bf16_f32 v113, v66, v67
v_cvt_pk_bf16_f32 v114, v68, v69
v_cvt_pk_bf16_f32 v115, v70, v71
s_nop 1
v_permlane32_swap_b32 v112, v114
v_permlane32_swap_b32 v113, v115
s_nop 1
v_permlane16_swap_b32 v112, v114
v_permlane16_swap_b32 v113, v115
s_nop 1
v_accvgpr_write_b32 a248, v112
v_accvgpr_write_b32 a249, v113
v_accvgpr_write_b32 a250, v114
v_accvgpr_write_b32 a251, v115
v_accvgpr_read_b32 v72, a104
v_accvgpr_read_b32 v73, a105
v_accvgpr_read_b32 v74, a106
v_accvgpr_read_b32 v75, a107
v_accvgpr_read_b32 v76, a120
v_accvgpr_read_b32 v77, a121
v_accvgpr_read_b32 v78, a122
v_accvgpr_read_b32 v79, a123
v_mul_f32 v72, s7, v72
v_mul_f32 v73, s7, v73
v_mul_f32 v74, s7, v74
v_mul_f32 v75, s7, v75
v_mul_f32 v76, s7, v76
v_mul_f32 v77, s7, v77
v_mul_f32 v78, s7, v78
v_mul_f32 v79, s7, v79
v_cvt_pk_bf16_f32 v116, v72, v73
v_cvt_pk_bf16_f32 v117, v74, v75
v_cvt_pk_bf16_f32 v118, v76, v77
v_cvt_pk_bf16_f32 v119, v78, v79
s_nop 1
v_permlane32_swap_b32 v116, v118
v_permlane32_swap_b32 v117, v119
s_nop 1
v_permlane16_swap_b32 v116, v118
v_permlane16_swap_b32 v117, v119
s_nop 1
v_accvgpr_write_b32 a252, v116
v_accvgpr_write_b32 a253, v117
v_accvgpr_write_b32 a254, v118
v_accvgpr_write_b32 a255, v119
v_accvgpr_read_b32 v64, a136
v_accvgpr_read_b32 v65, a137
v_accvgpr_read_b32 v66, a138
v_accvgpr_read_b32 v67, a139
v_accvgpr_read_b32 v68, a152
v_accvgpr_read_b32 v69, a153
v_accvgpr_read_b32 v70, a154
v_accvgpr_read_b32 v71, a155
v_mul_f32 v64, s7, v64
v_mul_f32 v65, s7, v65
v_mul_f32 v66, s7, v66
v_mul_f32 v67, s7, v67
v_mul_f32 v68, s7, v68
v_mul_f32 v69, s7, v69
v_mul_f32 v70, s7, v70
v_mul_f32 v71, s7, v71
v_cvt_pk_bf16_f32 v128, v64, v65
v_cvt_pk_bf16_f32 v129, v66, v67
v_cvt_pk_bf16_f32 v130, v68, v69
v_cvt_pk_bf16_f32 v131, v70, v71
s_nop 1
v_permlane32_swap_b32 v128, v130
v_permlane32_swap_b32 v129, v131
s_nop 1
v_permlane16_swap_b32 v128, v130
v_permlane16_swap_b32 v129, v131
v_accvgpr_read_b32 v72, a168
v_accvgpr_read_b32 v73, a169
v_accvgpr_read_b32 v74, a170
v_accvgpr_read_b32 v75, a171
v_accvgpr_read_b32 v76, a184
v_accvgpr_read_b32 v77, a185
v_accvgpr_read_b32 v78, a186
v_accvgpr_read_b32 v79, a187
v_mul_f32 v72, s7, v72
v_mul_f32 v73, s7, v73
v_mul_f32 v74, s7, v74
v_mul_f32 v75, s7, v75
v_mul_f32 v76, s7, v76
v_mul_f32 v77, s7, v77
v_mul_f32 v78, s7, v78
v_mul_f32 v79, s7, v79
v_cvt_pk_bf16_f32 v132, v72, v73
v_cvt_pk_bf16_f32 v133, v74, v75
v_cvt_pk_bf16_f32 v134, v76, v77
v_cvt_pk_bf16_f32 v135, v78, v79
s_nop 1
v_permlane32_swap_b32 v132, v134
v_permlane32_swap_b32 v133, v135
s_nop 1
v_permlane16_swap_b32 v132, v134
v_permlane16_swap_b32 v133, v135
v_accvgpr_read_b32 v64, a12
v_accvgpr_read_b32 v65, a13
v_accvgpr_read_b32 v66, a14
v_accvgpr_read_b32 v67, a15
v_accvgpr_read_b32 v68, a28
v_accvgpr_read_b32 v69, a29
v_accvgpr_read_b32 v70, a30
v_accvgpr_read_b32 v71, a31
v_mul_f32 v64, s7, v64
v_mul_f32 v65, s7, v65
v_mul_f32 v66, s7, v66
v_mul_f32 v67, s7, v67
v_mul_f32 v68, s7, v68
v_mul_f32 v69, s7, v69
v_mul_f32 v70, s7, v70
v_mul_f32 v71, s7, v71
v_cvt_pk_bf16_f32 v136, v64, v65
v_cvt_pk_bf16_f32 v137, v66, v67
v_cvt_pk_bf16_f32 v138, v68, v69
v_cvt_pk_bf16_f32 v139, v70, v71
s_nop 1
v_permlane32_swap_b32 v136, v138
v_permlane32_swap_b32 v137, v139
s_nop 1
v_permlane16_swap_b32 v136, v138
v_permlane16_swap_b32 v137, v139
v_accvgpr_read_b32 v72, a44
v_accvgpr_read_b32 v73, a45
v_accvgpr_read_b32 v74, a46
v_accvgpr_read_b32 v75, a47
v_accvgpr_read_b32 v76, a60
v_accvgpr_read_b32 v77, a61
v_accvgpr_read_b32 v78, a62
v_accvgpr_read_b32 v79, a63
v_mul_f32 v72, s7, v72
v_mul_f32 v73, s7, v73
v_mul_f32 v74, s7, v74
v_mul_f32 v75, s7, v75
v_mul_f32 v76, s7, v76
v_mul_f32 v77, s7, v77
v_mul_f32 v78, s7, v78
v_mul_f32 v79, s7, v79
v_cvt_pk_bf16_f32 v140, v72, v73
v_cvt_pk_bf16_f32 v141, v74, v75
v_cvt_pk_bf16_f32 v142, v76, v77
v_cvt_pk_bf16_f32 v143, v78, v79
s_nop 1
v_permlane32_swap_b32 v140, v142
v_permlane32_swap_b32 v141, v143
s_nop 1
v_permlane16_swap_b32 v140, v142
v_permlane16_swap_b32 v141, v143
v_accvgpr_read_b32 v64, a76
v_accvgpr_read_b32 v65, a77
v_accvgpr_read_b32 v66, a78
v_accvgpr_read_b32 v67, a79
v_accvgpr_read_b32 v68, a92
v_accvgpr_read_b32 v69, a93
v_accvgpr_read_b32 v70, a94
v_accvgpr_read_b32 v71, a95
v_mul_f32 v64, s7, v64
v_mul_f32 v65, s7, v65
v_mul_f32 v66, s7, v66
v_mul_f32 v67, s7, v67
v_mul_f32 v68, s7, v68
v_mul_f32 v69, s7, v69
v_mul_f32 v70, s7, v70
v_mul_f32 v71, s7, v71
v_cvt_pk_bf16_f32 v144, v64, v65
v_cvt_pk_bf16_f32 v145, v66, v67
v_cvt_pk_bf16_f32 v146, v68, v69
v_cvt_pk_bf16_f32 v147, v70, v71
s_nop 1
v_permlane32_swap_b32 v144, v146
v_permlane32_swap_b32 v145, v147
s_nop 1
v_permlane16_swap_b32 v144, v146
v_permlane16_swap_b32 v145, v147
v_accvgpr_read_b32 v72, a108
v_accvgpr_read_b32 v73, a109
v_accvgpr_read_b32 v74, a110
v_accvgpr_read_b32 v75, a111
v_accvgpr_read_b32 v76, a124
v_accvgpr_read_b32 v77, a125
v_accvgpr_read_b32 v78, a126
v_accvgpr_read_b32 v79, a127
v_mul_f32 v72, s7, v72
v_mul_f32 v73, s7, v73
v_mul_f32 v74, s7, v74
v_mul_f32 v75, s7, v75
v_mul_f32 v76, s7, v76
v_mul_f32 v77, s7, v77
v_mul_f32 v78, s7, v78
v_mul_f32 v79, s7, v79
v_cvt_pk_bf16_f32 v148, v72, v73
v_cvt_pk_bf16_f32 v149, v74, v75
v_cvt_pk_bf16_f32 v150, v76, v77
v_cvt_pk_bf16_f32 v151, v78, v79
s_nop 1
v_permlane32_swap_b32 v148, v150
v_permlane32_swap_b32 v149, v151
s_nop 1
v_permlane16_swap_b32 v148, v150
v_permlane16_swap_b32 v149, v151
v_accvgpr_read_b32 v64, a140
v_accvgpr_read_b32 v65, a141
v_accvgpr_read_b32 v66, a142
v_accvgpr_read_b32 v67, a143
v_accvgpr_read_b32 v68, a156
v_accvgpr_read_b32 v69, a157
v_accvgpr_read_b32 v70, a158
v_accvgpr_read_b32 v71, a159
v_mul_f32 v64, s7, v64
v_mul_f32 v65, s7, v65
v_mul_f32 v66, s7, v66
v_mul_f32 v67, s7, v67
v_mul_f32 v68, s7, v68
v_mul_f32 v69, s7, v69
v_mul_f32 v70, s7, v70
v_mul_f32 v71, s7, v71
v_cvt_pk_bf16_f32 v152, v64, v65
v_cvt_pk_bf16_f32 v153, v66, v67
v_cvt_pk_bf16_f32 v154, v68, v69
v_cvt_pk_bf16_f32 v155, v70, v71
s_nop 1
v_permlane32_swap_b32 v152, v154
v_permlane32_swap_b32 v153, v155
s_nop 1
v_permlane16_swap_b32 v152, v154
v_permlane16_swap_b32 v153, v155
v_accvgpr_read_b32 v72, a172
v_accvgpr_read_b32 v73, a173
v_accvgpr_read_b32 v74, a174
v_accvgpr_read_b32 v75, a175
v_accvgpr_read_b32 v76, a188
v_accvgpr_read_b32 v77, a189
v_accvgpr_read_b32 v78, a190
v_accvgpr_read_b32 v79, a191
v_mul_f32 v72, s7, v72
v_mul_f32 v73, s7, v73
v_mul_f32 v74, s7, v74
v_mul_f32 v75, s7, v75
v_mul_f32 v76, s7, v76
v_mul_f32 v77, s7, v77
v_mul_f32 v78, s7, v78
v_mul_f32 v79, s7, v79
v_cvt_pk_bf16_f32 v156, v72, v73
v_cvt_pk_bf16_f32 v157, v74, v75
v_cvt_pk_bf16_f32 v158, v76, v77
v_cvt_pk_bf16_f32 v159, v78, v79
s_nop 1
v_permlane32_swap_b32 v156, v158
v_permlane32_swap_b32 v157, v159
s_nop 1
v_permlane16_swap_b32 v156, v158
v_permlane16_swap_b32 v157, v159
v_add_u32 v4, 36864, v16
v_add_u32 v5, 36864, v17
v_add_u32 v6, 36864, v18
v_add_u32 v7, 36864, v19
v_add_u32 v8, 36864, v20
v_add_u32 v9, 36864, v21
s_load_dwordx2 s[68:69], s[0:1], 32
s_load_dwordx2 s[70:71], s[0:1], 64
s_waitcnt lgkmcnt(0)
s_mov_b32 s84, s68
s_mov_b32 s85, s69
s_mov_b32 s86, 7864320
s_mov_b32 s87, 0x00020000
s_mov_b32 s88, s70
s_mov_b32 s89, s71
s_mov_b32 s90, 1966080
s_mov_b32 s91, 0x00020000
s_lshl_b32 s6, s2, 2
s_add_u32 s6, s6, s5
s_mul_i32 s7, s6, 7680
v_lshlrev_b32 v238, 4, v1
v_add_u32 v239, s7, v238
buffer_load_dwordx4 v[252:255], v239, s[84:87], 0 offen
v_add_u32 v239, 1024, v239
buffer_load_dwordx4 v[252:255], v239, s[84:87], 0 offen
v_add_u32 v239, 1024, v239
buffer_load_dwordx4 v[252:255], v239, s[84:87], 0 offen
v_add_u32 v239, 1024, v239
buffer_load_dwordx4 v[252:255], v239, s[84:87], 0 offen
v_add_u32 v239, 1024, v239
buffer_load_dwordx4 v[252:255], v239, s[84:87], 0 offen
v_add_u32 v239, 1024, v239
buffer_load_dwordx4 v[252:255], v239, s[84:87], 0 offen
v_add_u32 v239, 1024, v239
buffer_load_dwordx4 v[252:255], v239, s[84:87], 0 offen
v_add_u32 v239, 1024, v239
buffer_load_dwordx4 v[252:255], v239, s[84:87], 0 offen
v_add_u32 v239, 1024, v239
s_mul_i32 s7, s6, 1920
v_add_u32 v239, s7, v238
buffer_load_dwordx4 v[252:255], v239, s[88:91], 0 offen
v_add_u32 v239, 1024, v239
buffer_load_dwordx4 v[252:255], v239, s[88:91], 0 offen
v_add_u32 v239, 1024, v239
v_accvgpr_write_b32 a0, 0
v_accvgpr_write_b32 a1, 0
v_accvgpr_write_b32 a2, 0
v_accvgpr_write_b32 a3, 0
v_accvgpr_write_b32 a4, 0
v_accvgpr_write_b32 a5, 0
v_accvgpr_write_b32 a6, 0
v_accvgpr_write_b32 a7, 0
v_accvgpr_write_b32 a8, 0
v_accvgpr_write_b32 a9, 0
v_accvgpr_write_b32 a10, 0
v_accvgpr_write_b32 a11, 0
v_accvgpr_write_b32 a12, 0
v_accvgpr_write_b32 a13, 0
v_accvgpr_write_b32 a14, 0
v_accvgpr_write_b32 a15, 0
v_accvgpr_write_b32 a16, 0
v_accvgpr_write_b32 a17, 0
v_accvgpr_write_b32 a18, 0
v_accvgpr_write_b32 a19, 0
v_accvgpr_write_b32 a20, 0
v_accvgpr_write_b32 a21, 0
v_accvgpr_write_b32 a22, 0
v_accvgpr_write_b32 a23, 0
v_accvgpr_write_b32 a24, 0
v_accvgpr_write_b32 a25, 0
v_accvgpr_write_b32 a26, 0
v_accvgpr_write_b32 a27, 0
v_accvgpr_write_b32 a28, 0
v_accvgpr_write_b32 a29, 0
v_accvgpr_write_b32 a30, 0
v_accvgpr_write_b32 a31, 0
v_accvgpr_write_b32 a32, 0
v_accvgpr_write_b32 a33, 0
v_accvgpr_write_b32 a34, 0
v_accvgpr_write_b32 a35, 0
v_accvgpr_write_b32 a36, 0
v_accvgpr_write_b32 a37, 0
v_accvgpr_write_b32 a38, 0
v_accvgpr_write_b32 a39, 0
v_accvgpr_write_b32 a40, 0
v_accvgpr_write_b32 a41, 0
v_accvgpr_write_b32 a42, 0
v_accvgpr_write_b32 a43, 0
v_accvgpr_write_b32 a44, 0
v_accvgpr_write_b32 a45, 0
v_accvgpr_write_b32 a46, 0
v_accvgpr_write_b32 a47, 0
v_accvgpr_write_b32 a48, 0
v_accvgpr_write_b32 a49, 0
v_accvgpr_write_b32 a50, 0
v_accvgpr_write_b32 a51, 0
v_accvgpr_write_b32 a52, 0
v_accvgpr_write_b32 a53, 0
v_accvgpr_write_b32 a54, 0
v_accvgpr_write_b32 a55, 0
v_accvgpr_write_b32 a56, 0
v_accvgpr_write_b32 a57, 0
v_accvgpr_write_b32 a58, 0
v_accvgpr_write_b32 a59, 0
v_accvgpr_write_b32 a60, 0
v_accvgpr_write_b32 a61, 0
v_accvgpr_write_b32 a62, 0
v_accvgpr_write_b32 a63, 0
v_accvgpr_write_b32 a64, 0
v_accvgpr_write_b32 a65, 0
v_accvgpr_write_b32 a66, 0
v_accvgpr_write_b32 a67, 0
v_accvgpr_write_b32 a68, 0
v_accvgpr_write_b32 a69, 0
v_accvgpr_write_b32 a70, 0
v_accvgpr_write_b32 a71, 0
v_accvgpr_write_b32 a72, 0
v_accvgpr_write_b32 a73, 0
v_accvgpr_write_b32 a74, 0
v_accvgpr_write_b32 a75, 0
v_accvgpr_write_b32 a76, 0
v_accvgpr_write_b32 a77, 0
v_accvgpr_write_b32 a78, 0
v_accvgpr_write_b32 a79, 0
v_accvgpr_write_b32 a80, 0
v_accvgpr_write_b32 a81, 0
v_accvgpr_write_b32 a82, 0
v_accvgpr_write_b32 a83, 0
v_accvgpr_write_b32 a84, 0
v_accvgpr_write_b32 a85, 0
v_accvgpr_write_b32 a86, 0
v_accvgpr_write_b32 a87, 0
v_accvgpr_write_b32 a88, 0
v_accvgpr_write_b32 a89, 0
v_accvgpr_write_b32 a90, 0
v_accvgpr_write_b32 a91, 0
v_accvgpr_write_b32 a92, 0
v_accvgpr_write_b32 a93, 0
v_accvgpr_write_b32 a94, 0
v_accvgpr_write_b32 a95, 0
v_accvgpr_write_b32 a96, 0
v_accvgpr_write_b32 a97, 0
v_accvgpr_write_b32 a98, 0
v_accvgpr_write_b32 a99, 0
v_accvgpr_write_b32 a100, 0
v_accvgpr_write_b32 a101, 0
v_accvgpr_write_b32 a102, 0
v_accvgpr_write_b32 a103, 0
v_accvgpr_write_b32 a104, 0
v_accvgpr_write_b32 a105, 0
v_accvgpr_write_b32 a106, 0
v_accvgpr_write_b32 a107, 0
v_accvgpr_write_b32 a108, 0
v_accvgpr_write_b32 a109, 0
v_accvgpr_write_b32 a110, 0
v_accvgpr_write_b32 a111, 0
v_accvgpr_write_b32 a112, 0
v_accvgpr_write_b32 a113, 0
v_accvgpr_write_b32 a114, 0
v_accvgpr_write_b32 a115, 0
v_accvgpr_write_b32 a116, 0
v_accvgpr_write_b32 a117, 0
v_accvgpr_write_b32 a118, 0
v_accvgpr_write_b32 a119, 0
v_accvgpr_write_b32 a120, 0
v_accvgpr_write_b32 a121, 0
v_accvgpr_write_b32 a122, 0
v_accvgpr_write_b32 a123, 0
v_accvgpr_write_b32 a124, 0
v_accvgpr_write_b32 a125, 0
v_accvgpr_write_b32 a126, 0
v_accvgpr_write_b32 a127, 0
v_accvgpr_write_b32 a128, 0
v_accvgpr_write_b32 a129, 0
v_accvgpr_write_b32 a130, 0
v_accvgpr_write_b32 a131, 0
v_accvgpr_write_b32 a132, 0
v_accvgpr_write_b32 a133, 0
v_accvgpr_write_b32 a134, 0
v_accvgpr_write_b32 a135, 0
v_accvgpr_write_b32 a136, 0
v_accvgpr_write_b32 a137, 0
v_accvgpr_write_b32 a138, 0
v_accvgpr_write_b32 a139, 0
v_accvgpr_write_b32 a140, 0
v_accvgpr_write_b32 a141, 0
v_accvgpr_write_b32 a142, 0
v_accvgpr_write_b32 a143, 0
v_accvgpr_write_b32 a144, 0
v_accvgpr_write_b32 a145, 0
v_accvgpr_write_b32 a146, 0
v_accvgpr_write_b32 a147, 0
v_accvgpr_write_b32 a148, 0
v_accvgpr_write_b32 a149, 0
v_accvgpr_write_b32 a150, 0
v_accvgpr_write_b32 a151, 0
v_accvgpr_write_b32 a152, 0
v_accvgpr_write_b32 a153, 0
v_accvgpr_write_b32 a154, 0
v_accvgpr_write_b32 a155, 0
v_accvgpr_write_b32 a156, 0
v_accvgpr_write_b32 a157, 0
v_accvgpr_write_b32 a158, 0
v_accvgpr_write_b32 a159, 0
v_accvgpr_write_b32 a160, 0
v_accvgpr_write_b32 a161, 0
v_accvgpr_write_b32 a162, 0
v_accvgpr_write_b32 a163, 0
v_accvgpr_write_b32 a164, 0
v_accvgpr_write_b32 a165, 0
v_accvgpr_write_b32 a166, 0
v_accvgpr_write_b32 a167, 0
v_accvgpr_write_b32 a168, 0
v_accvgpr_write_b32 a169, 0
v_accvgpr_write_b32 a170, 0
v_accvgpr_write_b32 a171, 0
v_accvgpr_write_b32 a172, 0
v_accvgpr_write_b32 a173, 0
v_accvgpr_write_b32 a174, 0
v_accvgpr_write_b32 a175, 0
v_accvgpr_write_b32 a176, 0
v_accvgpr_write_b32 a177, 0
v_accvgpr_write_b32 a178, 0
v_accvgpr_write_b32 a179, 0
v_accvgpr_write_b32 a180, 0
v_accvgpr_write_b32 a181, 0
v_accvgpr_write_b32 a182, 0
v_accvgpr_write_b32 a183, 0
v_accvgpr_write_b32 a184, 0
v_accvgpr_write_b32 a185, 0
v_accvgpr_write_b32 a186, 0
v_accvgpr_write_b32 a187, 0
v_accvgpr_write_b32 a188, 0
v_accvgpr_write_b32 a189, 0
v_accvgpr_write_b32 a190, 0
v_accvgpr_write_b32 a191, 0
v_mov_b32 v96, 0
v_mov_b32 v97, 0
v_mov_b32 v98, 0
v_mov_b32 v99, 0
v_mov_b32 v100, 0
v_mov_b32 v101, 0
v_mov_b32 v102, 0
v_mov_b32 v103, 0
v_mov_b32 v104, 0
v_mov_b32 v105, 0
v_mov_b32 v106, 0
v_mov_b32 v107, 0
v_mov_b32 v108, 0
v_mov_b32 v109, 0
v_mov_b32 v110, 0
v_mov_b32 v111, 0
v_mov_b32 v3, 0
v_mov_b32 v112, 1.0
v_mov_b32 v15, 0
v_mov_b32 v113, 1.0
v_mov_b32 v29, 0
v_mov_b32 v114, 1.0
v_mov_b32 v30, 0
v_mov_b32 v115, 1.0
s_barrier
ds_read_b128 v[160:163], v16 offset:0
ds_read_b128 v[164:167], v16 offset:6144
ds_read_b128 v[168:171], v17 offset:0
ds_read_b128 v[172:175], v17 offset:6144
ds_read_b128 v[176:179], v16 offset:128
ds_read_b128 v[180:183], v16 offset:6272
s_nop 1
s_waitcnt lgkmcnt(2)
v_mfma_f32_16x16x32_bf16 v[32:35], v[160:163], a[192:195], v[96:99]
ds_read_b128 v[184:187], v17 offset:128
v_mfma_f32_16x16x32_bf16 v[40:43], v[160:163], a[216:219], v[100:103]
ds_read_b128 v[188:191], v17 offset:6272
v_mfma_f32_16x16x32_bf16 v[48:51], v[160:163], a[240:243], v[104:107]
v_mfma_f32_16x16x32_bf16 v[56:59], v[160:163], v[136:139], v[108:111]
v_mfma_f32_16x16x32_bf16 v[36:39], v[164:167], a[192:195], v[96:99]
ds_read_b128 v[160:163], v16 offset:256
v_mfma_f32_16x16x32_bf16 v[44:47], v[164:167], a[216:219], v[100:103]
v_mfma_f32_16x16x32_bf16 v[52:55], v[164:167], a[240:243], v[104:107]
v_mfma_f32_16x16x32_bf16 v[60:63], v[164:167], v[136:139], v[108:111]
v_mfma_f32_16x16x32_bf16 v[32:35], v[168:171], a[196:199], v[32:35]
ds_read_b128 v[164:167], v16 offset:6400
v_mfma_f32_16x16x32_bf16 v[40:43], v[168:171], a[220:223], v[40:43]
v_mfma_f32_16x16x32_bf16 v[48:51], v[168:171], a[244:247], v[48:51]
v_mfma_f32_16x16x32_bf16 v[56:59], v[168:171], v[140:143], v[56:59]
v_mfma_f32_16x16x32_bf16 v[36:39], v[172:175], a[196:199], v[36:39]
ds_read_b128 v[168:171], v17 offset:256
v_mfma_f32_16x16x32_bf16 v[44:47], v[172:175], a[220:223], v[44:47]
v_mfma_f32_16x16x32_bf16 v[52:55], v[172:175], a[244:247], v[52:55]
v_mfma_f32_16x16x32_bf16 v[60:63], v[172:175], v[140:143], v[60:63]
s_waitcnt lgkmcnt(3)
v_mfma_f32_16x16x32_bf16 v[32:35], v[176:179], a[200:203], v[32:35]
ds_read_b128 v[172:175], v17 offset:6400
v_mfma_f32_16x16x32_bf16 v[40:43], v[176:179], a[224:227], v[40:43]
v_mfma_f32_16x16x32_bf16 v[48:51], v[176:179], a[248:251], v[48:51]
v_mfma_f32_16x16x32_bf16 v[56:59], v[176:179], v[144:147], v[56:59]
v_mfma_f32_16x16x32_bf16 v[36:39], v[180:183], a[200:203], v[36:39]
v_mfma_f32_16x16x32_bf16 v[44:47], v[180:183], a[224:227], v[44:47]
v_mfma_f32_16x16x32_bf16 v[52:55], v[180:183], a[248:251], v[52:55]
v_mfma_f32_16x16x32_bf16 v[60:63], v[180:183], v[144:147], v[60:63]
v_mfma_f32_16x16x32_bf16 v[32:35], v[184:187], a[204:207], v[32:35]
v_mfma_f32_16x16x32_bf16 v[40:43], v[184:187], a[228:231], v[40:43]
v_mfma_f32_16x16x32_bf16 v[48:51], v[184:187], a[252:255], v[48:51]
v_mfma_f32_16x16x32_bf16 v[56:59], v[184:187], v[148:151], v[56:59]
v_mfma_f32_16x16x32_bf16 v[36:39], v[188:191], a[204:207], v[36:39]
v_mfma_f32_16x16x32_bf16 v[44:47], v[188:191], a[228:231], v[44:47]
v_mfma_f32_16x16x32_bf16 v[52:55], v[188:191], a[252:255], v[52:55]
v_mfma_f32_16x16x32_bf16 v[60:63], v[188:191], v[148:151], v[60:63]
s_waitcnt lgkmcnt(0)
v_mfma_f32_16x16x32_bf16 v[32:35], v[160:163], a[208:211], v[32:35]
v_mfma_f32_16x16x32_bf16 v[40:43], v[160:163], a[232:235], v[40:43]
v_mfma_f32_16x16x32_bf16 v[48:51], v[160:163], v[128:131], v[48:51]
v_mfma_f32_16x16x32_bf16 v[56:59], v[160:163], v[152:155], v[56:59]
v_mfma_f32_16x16x32_bf16 v[36:39], v[164:167], a[208:211], v[36:39]
v_mfma_f32_16x16x32_bf16 v[44:47], v[164:167], a[232:235], v[44:47]
v_mfma_f32_16x16x32_bf16 v[52:55], v[164:167], v[128:131], v[52:55]
v_mfma_f32_16x16x32_bf16 v[60:63], v[164:167], v[152:155], v[60:63]
v_mfma_f32_16x16x32_bf16 v[32:35], v[168:171], a[212:215], v[32:35]
v_mfma_f32_16x16x32_bf16 v[40:43], v[168:171], a[236:239], v[40:43]
v_mfma_f32_16x16x32_bf16 v[48:51], v[168:171], v[132:135], v[48:51]
v_mfma_f32_16x16x32_bf16 v[56:59], v[168:171], v[156:159], v[56:59]
v_mfma_f32_16x16x32_bf16 v[36:39], v[172:175], a[212:215], v[36:39]
v_mfma_f32_16x16x32_bf16 v[44:47], v[172:175], a[236:239], v[44:47]
v_mfma_f32_16x16x32_bf16 v[52:55], v[172:175], v[132:135], v[52:55]
v_mfma_f32_16x16x32_bf16 v[60:63], v[172:175], v[156:159], v[60:63]
s_nop 15
v_exp_f32 v120, v32
v_exp_f32 v121, v33
v_exp_f32 v122, v34
v_exp_f32 v123, v35
v_exp_f32 v124, v36
v_exp_f32 v125, v37
v_exp_f32 v126, v38
v_exp_f32 v127, v39
v_add_f32 v116, v120, v121
v_cvt_pk_bf16_f32 v200, v120, v121
v_exp_f32 v120, v40
v_exp_f32 v121, v41
v_add_f32 v116, v116, v122
v_add_f32 v116, v116, v123
v_cvt_pk_bf16_f32 v201, v122, v123
v_exp_f32 v122, v42
ds_read_b128 v[160:163], v16 offset:12288
v_add_f32 v116, v116, v124
v_exp_f32 v123, v43
v_add_f32 v116, v116, v125
v_cvt_pk_bf16_f32 v202, v124, v125
ds_read_b128 v[164:167], v16 offset:18432
v_add_f32 v116, v116, v126
v_exp_f32 v124, v44
v_exp_f32 v125, v45
v_add_f32 v116, v116, v127
ds_read_b128 v[168:171], v17 offset:12288
v_cvt_pk_bf16_f32 v203, v126, v127
v_exp_f32 v126, v46
v_exp_f32 v127, v47
v_add_f32 v117, v120, v121
ds_read_b128 v[172:175], v17 offset:18432
v_cvt_pk_bf16_f32 v204, v120, v121
v_exp_f32 v120, v48
v_exp_f32 v121, v49
v_add_f32 v117, v117, v122
ds_read_b128 v[176:179], v16 offset:12416
v_add_f32 v117, v117, v123
v_cvt_pk_bf16_f32 v205, v122, v123
v_exp_f32 v122, v50
v_exp_f32 v123, v51
ds_read_b128 v[180:183], v16 offset:18560
v_add_f32 v117, v117, v124
v_add_f32 v117, v117, v125
v_cvt_pk_bf16_f32 v206, v124, v125
v_exp_f32 v124, v52
s_mov_b32 s48, 0
.p2align 6
K1_LOOP:
s_waitcnt lgkmcnt(2)
v_mfma_f32_16x16x32_bf16 v[64:67], v[160:163], a[192:195], v[96:99]
s_waitcnt vmcnt(9)
s_barrier
ds_read_b128 v[184:187], v17 offset:12416
v_add_f32 v117, v117, v126
v_mfma_f32_16x16x32_bf16 v[72:75], v[160:163], a[216:219], v[100:103]
s_add_u32 m0, s46, 61440
ds_read_b128 v[188:191], v17 offset:18560
v_add_f32 v117, v117, v127
v_mfma_f32_16x16x32_bf16 v[80:83], v[160:163], a[240:243], v[104:107]
v_exp_f32 v125, v53
v_mfma_f32_16x16x32_bf16 v[88:91], v[160:163], v[136:139], v[108:111]
buffer_load_dwordx4 v22, s[20:23], s42 offen offset:0 lds
v_cvt_pk_bf16_f32 v207, v126, v127
v_mfma_f32_16x16x32_bf16 v[68:71], v[164:167], a[192:195], v[96:99]
ds_read_b128 v[160:163], v16 offset:12544
v_add_f32 v118, v120, v121
v_mfma_f32_16x16x32_bf16 v[76:79], v[164:167], a[216:219], v[100:103]
v_exp_f32 v126, v54
v_mfma_f32_16x16x32_bf16 v[84:87], v[164:167], a[240:243], v[104:107]
v_exp_f32 v127, v55
v_mfma_f32_16x16x32_bf16 v[92:95], v[164:167], v[136:139], v[108:111]
v_cvt_pk_bf16_f32 v208, v120, v121
v_mfma_f32_16x16x32_bf16 v[64:67], v[168:171], a[196:199], v[64:67]
ds_read_b128 v[164:167], v16 offset:18688
v_add_f32 v118, v118, v122
v_mfma_f32_16x16x32_bf16 v[72:75], v[168:171], a[220:223], v[72:75]
v_exp_f32 v120, v56
v_mfma_f32_16x16x32_bf16 v[80:83], v[168:171], a[244:247], v[80:83]
v_exp_f32 v121, v57
v_mfma_f32_16x16x32_bf16 v[88:91], v[168:171], v[140:143], v[88:91]
v_add_f32 v118, v118, v123
v_mfma_f32_16x16x32_bf16 v[68:71], v[172:175], a[196:199], v[68:71]
ds_read_b128 v[168:171], v17 offset:12544
v_cvt_pk_bf16_f32 v209, v122, v123
v_mfma_f32_16x16x32_bf16 v[76:79], v[172:175], a[220:223], v[76:79]
v_exp_f32 v122, v58
v_mfma_f32_16x16x32_bf16 v[84:87], v[172:175], a[244:247], v[84:87]
v_exp_f32 v123, v59
v_mfma_f32_16x16x32_bf16 v[92:95], v[172:175], v[140:143], v[92:95]
s_waitcnt lgkmcnt(3)
buffer_load_dwordx4 v23, s[20:23], s42 offen offset:1024 lds
v_add_f32 v118, v118, v124
v_mfma_f32_16x16x32_bf16 v[64:67], v[176:179], a[200:203], v[64:67]
ds_read_b128 v[172:175], v17 offset:18688
v_add_f32 v118, v118, v125
v_mfma_f32_16x16x32_bf16 v[72:75], v[176:179], a[224:227], v[72:75]
v_cvt_pk_bf16_f32 v210, v124, v125
v_mfma_f32_16x16x32_bf16 v[80:83], v[176:179], a[248:251], v[80:83]
v_exp_f32 v124, v60
v_mfma_f32_16x16x32_bf16 v[88:91], v[176:179], v[144:147], v[88:91]
v_exp_f32 v125, v61
v_mfma_f32_16x16x32_bf16 v[68:71], v[180:183], a[200:203], v[68:71]
ds_read_b64_tr_b16 v[176:177], v18 offset:0
v_add_f32 v118, v118, v126
v_mfma_f32_16x16x32_bf16 v[76:79], v[180:183], a[224:227], v[76:79]
ds_read_b64_tr_b16 v[178:179], v18 offset:6144
v_add_f32 v118, v118, v127
v_mfma_f32_16x16x32_bf16 v[84:87], v[180:183], a[248:251], v[84:87]
v_cvt_pk_bf16_f32 v211, v126, v127
v_mfma_f32_16x16x32_bf16 v[92:95], v[180:183], v[144:147], v[92:95]
v_exp_f32 v126, v62
v_mfma_f32_16x16x32_bf16 v[64:67], v[184:187], a[204:207], v[64:67]
ds_read_b64_tr_b16 v[180:181], v19 offset:0
v_add_f32 v119, v120, v121
v_mfma_f32_16x16x32_bf16 v[72:75], v[184:187], a[228:231], v[72:75]
ds_read_b64_tr_b16 v[182:183], v19 offset:6144
v_cvt_pk_bf16_f32 v212, v120, v121
v_mfma_f32_16x16x32_bf16 v[80:83], v[184:187], a[252:255], v[80:83]
v_exp_f32 v127, v63
v_mfma_f32_16x16x32_bf16 v[88:91], v[184:187], v[148:151], v[88:91]
buffer_load_dwordx4 v24, s[20:23], s42 offen offset:2048 lds
v_add_f32 v119, v119, v122
v_mfma_f32_16x16x32_bf16 v[68:71], v[188:191], a[204:207], v[68:71]
ds_read_b64_tr_b16 v[184:185], v20 offset:0
v_add_f32 v119, v119, v123
v_mfma_f32_16x16x32_bf16 v[76:79], v[188:191], a[228:231], v[76:79]
ds_read_b64_tr_b16 v[186:187], v20 offset:6144
v_cvt_pk_bf16_f32 v213, v122, v123
v_mfma_f32_16x16x32_bf16 v[84:87], v[188:191], a[252:255], v[84:87]
v_add_f32 v119, v119, v124
v_mfma_f32_16x16x32_bf16 v[92:95], v[188:191], v[148:151], v[92:95]
s_waitcnt lgkmcnt(6)
v_add_f32 v119, v119, v125
v_mfma_f32_16x16x32_bf16 v[64:67], v[160:163], a[208:211], v[64:67]
ds_read_b64_tr_b16 v[188:189], v21 offset:0
v_cvt_pk_bf16_f32 v214, v124, v125
v_mfma_f32_16x16x32_bf16 v[72:75], v[160:163], a[232:235], v[72:75]
ds_read_b64_tr_b16 v[190:191], v21 offset:6144
v_add_f32 v119, v119, v126
v_mfma_f32_16x16x32_bf16 v[80:83], v[160:163], v[128:131], v[80:83]
v_add_f32 v119, v119, v127
v_mfma_f32_16x16x32_bf16 v[88:91], v[160:163], v[152:155], v[88:91]
v_cvt_pk_bf16_f32 v215, v126, v127
v_mfma_f32_16x16x32_bf16 v[68:71], v[164:167], a[208:211], v[68:71]
ds_read_b64_tr_b16 v[160:161], v18 offset:128
v_mfma_f32_16x16x32_bf16 v[76:79], v[164:167], a[232:235], v[76:79]
s_add_u32 m0, s47, 49152
ds_read_b64_tr_b16 v[162:163], v18 offset:6272
v_mfma_f32_16x16x32_bf16 v[84:87], v[164:167], v[128:131], v[84:87]
v_mfma_f32_16x16x32_bf16 v[92:95], v[164:167], v[152:155], v[92:95]
buffer_load_dwordx4 v25, s[24:27], s42 offen offset:0 lds
v_mfma_f32_16x16x32_bf16 v[64:67], v[168:171], a[212:215], v[64:67]
ds_read_b64_tr_b16 v[164:165], v19 offset:128
v_mfma_f32_16x16x32_bf16 v[72:75], v[168:171], a[236:239], v[72:75]
ds_read_b64_tr_b16 v[166:167], v19 offset:6272
v_mfma_f32_16x16x32_bf16 v[80:83], v[168:171], v[132:135], v[80:83]
v_mfma_f32_16x16x32_bf16 v[88:91], v[168:171], v[156:159], v[88:91]
v_max3_f32 v28, v116, v117, v118
v_mfma_f32_16x16x32_bf16 v[68:71], v[172:175], a[212:215], v[68:71]
ds_read_b64_tr_b16 v[168:169], v20 offset:128
v_max_f32 v28, v28, v119
v_mfma_f32_16x16x32_bf16 v[76:79], v[172:175], a[236:239], v[76:79]
ds_read_b64_tr_b16 v[170:171], v20 offset:6272
v_cmp_lt_f32 vcc, s64, v28
v_mfma_f32_16x16x32_bf16 v[84:87], v[172:175], v[132:135], v[84:87]
v_mfma_f32_16x16x32_bf16 v[92:95], v[172:175], v[156:159], v[92:95]
s_cbranch_vccnz RSTUB0
RBACK0:
s_waitcnt lgkmcnt(6)
v_mfma_f32_16x16x32_bf16 a[0:3], v[176:179], v[200:203], a[0:3]
ds_read_b64_tr_b16 v[172:173], v21 offset:128
v_add_f32 v3, v3, v116
v_mfma_f32_16x16x32_bf16 a[4:7], v[176:179], v[204:207], a[4:7]
ds_read_b64_tr_b16 v[174:175], v21 offset:6272
v_add_f32 v15, v15, v117
v_mfma_f32_16x16x32_bf16 a[8:11], v[176:179], v[208:211], a[8:11]
v_add_f32 v29, v29, v118
v_mfma_f32_16x16x32_bf16 a[12:15], v[176:179], v[212:215], a[12:15]
buffer_load_dwordx4 v26, s[24:27], s42 offen offset:1024 lds
v_add_f32 v30, v30, v119
v_mfma_f32_16x16x32_bf16 a[16:19], v[180:183], v[200:203], a[16:19]
ds_read_b64_tr_b16 v[176:177], v18 offset:256
v_mfma_f32_16x16x32_bf16 a[20:23], v[180:183], v[204:207], a[20:23]
ds_read_b64_tr_b16 v[178:179], v18 offset:6400
v_mfma_f32_16x16x32_bf16 a[24:27], v[180:183], v[208:211], a[24:27]
v_exp_f32 v120, v64
v_mfma_f32_16x16x32_bf16 a[28:31], v[180:183], v[212:215], a[28:31]
v_exp_f32 v121, v65
v_mfma_f32_16x16x32_bf16 a[32:35], v[184:187], v[200:203], a[32:35]
ds_read_b64_tr_b16 v[180:181], v19 offset:256
v_add_f32 v116, v120, v121
v_mfma_f32_16x16x32_bf16 a[36:39], v[184:187], v[204:207], a[36:39]
ds_read_b64_tr_b16 v[182:183], v19 offset:6400
v_cvt_pk_bf16_f32 v216, v120, v121
v_mfma_f32_16x16x32_bf16 a[40:43], v[184:187], v[208:211], a[40:43]
v_exp_f32 v122, v66
v_mfma_f32_16x16x32_bf16 a[44:47], v[184:187], v[212:215], a[44:47]
v_exp_f32 v123, v67
v_mfma_f32_16x16x32_bf16 a[48:51], v[188:191], v[200:203], a[48:51]
ds_read_b64_tr_b16 v[184:185], v20 offset:256
v_add_f32 v116, v116, v122
v_mfma_f32_16x16x32_bf16 a[52:55], v[188:191], v[204:207], a[52:55]
ds_read_b64_tr_b16 v[186:187], v20 offset:6400
v_add_f32 v116, v116, v123
v_mfma_f32_16x16x32_bf16 a[56:59], v[188:191], v[208:211], a[56:59]
v_exp_f32 v124, v68
v_mfma_f32_16x16x32_bf16 a[60:63], v[188:191], v[212:215], a[60:63]
s_waitcnt lgkmcnt(6)
buffer_load_dwordx4 v27, s[24:27], s42 offen offset:2048 lds
v_cvt_pk_bf16_f32 v217, v122, v123
v_mfma_f32_16x16x32_bf16 a[64:67], v[160:163], v[200:203], a[64:67]
ds_read_b64_tr_b16 v[188:189], v21 offset:256
v_mfma_f32_16x16x32_bf16 a[68:71], v[160:163], v[204:207], a[68:71]
s_add_u32 s42, s42, 12288
ds_read_b64_tr_b16 v[190:191], v21 offset:6400
v_mfma_f32_16x16x32_bf16 a[72:75], v[160:163], v[208:211], a[72:75]
v_exp_f32 v125, v69
v_mfma_f32_16x16x32_bf16 a[76:79], v[160:163], v[212:215], a[76:79]
v_exp_f32 v126, v70
v_mfma_f32_16x16x32_bf16 a[80:83], v[164:167], v[200:203], a[80:83]
ds_read_b128 v[160:163], v16 offset:24576
v_add_f32 v116, v116, v124
v_mfma_f32_16x16x32_bf16 a[84:87], v[164:167], v[204:207], a[84:87]
v_exp_f32 v127, v71
v_mfma_f32_16x16x32_bf16 a[88:91], v[164:167], v[208:211], a[88:91]
v_exp_f32 v120, v72
v_mfma_f32_16x16x32_bf16 a[92:95], v[164:167], v[212:215], a[92:95]
v_exp_f32 v121, v73
v_mfma_f32_16x16x32_bf16 a[96:99], v[168:171], v[200:203], a[96:99]
ds_read_b128 v[164:167], v16 offset:30720
v_add_f32 v116, v116, v125
v_mfma_f32_16x16x32_bf16 a[100:103], v[168:171], v[204:207], a[100:103]
v_exp_f32 v122, v74
v_mfma_f32_16x16x32_bf16 a[104:107], v[168:171], v[208:211], a[104:107]
v_exp_f32 v123, v75
v_mfma_f32_16x16x32_bf16 a[108:111], v[168:171], v[212:215], a[108:111]
v_cvt_pk_bf16_f32 v218, v124, v125
v_mfma_f32_16x16x32_bf16 a[112:115], v[172:175], v[200:203], a[112:115]
ds_read_b128 v[168:171], v17 offset:24576
v_add_f32 v116, v116, v126
v_mfma_f32_16x16x32_bf16 a[116:119], v[172:175], v[204:207], a[116:119]
v_exp_f32 v124, v76
v_mfma_f32_16x16x32_bf16 a[120:123], v[172:175], v[208:211], a[120:123]
v_exp_f32 v125, v77
v_mfma_f32_16x16x32_bf16 a[124:127], v[172:175], v[212:215], a[124:127]
s_waitcnt lgkmcnt(3)
v_add_f32 v116, v116, v127
v_mfma_f32_16x16x32_bf16 a[128:131], v[176:179], v[200:203], a[128:131]
ds_read_b128 v[172:175], v17 offset:30720
v_cvt_pk_bf16_f32 v219, v126, v127
v_mfma_f32_16x16x32_bf16 a[132:135], v[176:179], v[204:207], a[132:135]
v_exp_f32 v126, v78
v_mfma_f32_16x16x32_bf16 a[136:139], v[176:179], v[208:211], a[136:139]
v_exp_f32 v127, v79
v_mfma_f32_16x16x32_bf16 a[140:143], v[176:179], v[212:215], a[140:143]
v_add_f32 v117, v120, v121
v_mfma_f32_16x16x32_bf16 a[144:147], v[180:183], v[200:203], a[144:147]
ds_read_b128 v[176:179], v16 offset:24704
v_cvt_pk_bf16_f32 v220, v120, v121
v_mfma_f32_16x16x32_bf16 a[148:151], v[180:183], v[204:207], a[148:151]
v_exp_f32 v120, v80
v_mfma_f32_16x16x32_bf16 a[152:155], v[180:183], v[208:211], a[152:155]
v_exp_f32 v121, v81
v_mfma_f32_16x16x32_bf16 a[156:159], v[180:183], v[212:215], a[156:159]
v_add_f32 v117, v117, v122
v_mfma_f32_16x16x32_bf16 a[160:163], v[184:187], v[200:203], a[160:163]
ds_read_b128 v[180:183], v16 offset:30848
v_add_f32 v117, v117, v123
v_mfma_f32_16x16x32_bf16 a[164:167], v[184:187], v[204:207], a[164:167]
v_cvt_pk_bf16_f32 v221, v122, v123
v_mfma_f32_16x16x32_bf16 a[168:171], v[184:187], v[208:211], a[168:171]
v_exp_f32 v122, v82
v_mfma_f32_16x16x32_bf16 a[172:175], v[184:187], v[212:215], a[172:175]
v_exp_f32 v123, v83
v_mfma_f32_16x16x32_bf16 a[176:179], v[188:191], v[200:203], a[176:179]
v_add_f32 v117, v117, v124
v_mfma_f32_16x16x32_bf16 a[180:183], v[188:191], v[204:207], a[180:183]
v_add_f32 v117, v117, v125
v_mfma_f32_16x16x32_bf16 a[184:187], v[188:191], v[208:211], a[184:187]
v_cvt_pk_bf16_f32 v222, v124, v125
v_mfma_f32_16x16x32_bf16 a[188:191], v[188:191], v[212:215], a[188:191]
s_waitcnt lgkmcnt(2)
v_exp_f32 v124, v84
v_mfma_f32_16x16x32_bf16 v[32:35], v[160:163], a[192:195], v[96:99]
ds_read_b128 v[184:187], v17 offset:24704
v_add_f32 v117, v117, v126
v_mfma_f32_16x16x32_bf16 v[40:43], v[160:163], a[216:219], v[100:103]
s_add_u32 m0, s46, 0
ds_read_b128 v[188:191], v17 offset:30848
v_add_f32 v117, v117, v127
v_mfma_f32_16x16x32_bf16 v[48:51], v[160:163], a[240:243], v[104:107]
v_exp_f32 v125, v85
v_mfma_f32_16x16x32_bf16 v[56:59], v[160:163], v[136:139], v[108:111]
buffer_load_dwordx4 v22, s[20:23], s42 offen offset:0 lds
v_cvt_pk_bf16_f32 v223, v126, v127
v_mfma_f32_16x16x32_bf16 v[36:39], v[164:167], a[192:195], v[96:99]
ds_read_b128 v[160:163], v16 offset:24832
v_add_f32 v118, v120, v121
v_mfma_f32_16x16x32_bf16 v[44:47], v[164:167], a[216:219], v[100:103]
v_exp_f32 v126, v86
v_mfma_f32_16x16x32_bf16 v[52:55], v[164:167], a[240:243], v[104:107]
v_exp_f32 v127, v87
v_mfma_f32_16x16x32_bf16 v[60:63], v[164:167], v[136:139], v[108:111]
v_cvt_pk_bf16_f32 v224, v120, v121
v_mfma_f32_16x16x32_bf16 v[32:35], v[168:171], a[196:199], v[32:35]
ds_read_b128 v[164:167], v16 offset:30976
v_add_f32 v118, v118, v122
v_mfma_f32_16x16x32_bf16 v[40:43], v[168:171], a[220:223], v[40:43]
v_exp_f32 v120, v88
v_mfma_f32_16x16x32_bf16 v[48:51], v[168:171], a[244:247], v[48:51]
v_exp_f32 v121, v89
v_mfma_f32_16x16x32_bf16 v[56:59], v[168:171], v[140:143], v[56:59]
v_add_f32 v118, v118, v123
v_mfma_f32_16x16x32_bf16 v[36:39], v[172:175], a[196:199], v[36:39]
ds_read_b128 v[168:171], v17 offset:24832
v_cvt_pk_bf16_f32 v225, v122, v123
v_mfma_f32_16x16x32_bf16 v[44:47], v[172:175], a[220:223], v[44:47]
v_exp_f32 v122, v90
v_mfma_f32_16x16x32_bf16 v[52:55], v[172:175], a[244:247], v[52:55]
v_exp_f32 v123, v91
v_mfma_f32_16x16x32_bf16 v[60:63], v[172:175], v[140:143], v[60:63]
s_waitcnt lgkmcnt(3)
buffer_load_dwordx4 v23, s[20:23], s42 offen offset:1024 lds
v_add_f32 v118, v118, v124
v_mfma_f32_16x16x32_bf16 v[32:35], v[176:179], a[200:203], v[32:35]
ds_read_b128 v[172:175], v17 offset:30976
v_add_f32 v118, v118, v125
v_mfma_f32_16x16x32_bf16 v[40:43], v[176:179], a[224:227], v[40:43]
v_cvt_pk_bf16_f32 v226, v124, v125
v_mfma_f32_16x16x32_bf16 v[48:51], v[176:179], a[248:251], v[48:51]
v_exp_f32 v124, v92
v_mfma_f32_16x16x32_bf16 v[56:59], v[176:179], v[144:147], v[56:59]
v_exp_f32 v125, v93
v_mfma_f32_16x16x32_bf16 v[36:39], v[180:183], a[200:203], v[36:39]
ds_read_b64_tr_b16 v[176:177], v18 offset:12288
v_add_f32 v118, v118, v126
v_mfma_f32_16x16x32_bf16 v[44:47], v[180:183], a[224:227], v[44:47]
ds_read_b64_tr_b16 v[178:179], v18 offset:18432
v_add_f32 v118, v118, v127
v_mfma_f32_16x16x32_bf16 v[52:55], v[180:183], a[248:251], v[52:55]
v_cvt_pk_bf16_f32 v227, v126, v127
v_mfma_f32_16x16x32_bf16 v[60:63], v[180:183], v[144:147], v[60:63]
v_exp_f32 v126, v94
v_mfma_f32_16x16x32_bf16 v[32:35], v[184:187], a[204:207], v[32:35]
ds_read_b64_tr_b16 v[180:181], v19 offset:12288
v_add_f32 v119, v120, v121
v_mfma_f32_16x16x32_bf16 v[40:43], v[184:187], a[228:231], v[40:43]
ds_read_b64_tr_b16 v[182:183], v19 offset:18432
v_cvt_pk_bf16_f32 v228, v120, v121
v_mfma_f32_16x16x32_bf16 v[48:51], v[184:187], a[252:255], v[48:51]
v_exp_f32 v127, v95
v_mfma_f32_16x16x32_bf16 v[56:59], v[184:187], v[148:151], v[56:59]
buffer_load_dwordx4 v24, s[20:23], s42 offen offset:2048 lds
v_add_f32 v119, v119, v122
v_mfma_f32_16x16x32_bf16 v[36:39], v[188:191], a[204:207], v[36:39]
ds_read_b64_tr_b16 v[184:185], v20 offset:12288
v_add_f32 v119, v119, v123
v_mfma_f32_16x16x32_bf16 v[44:47], v[188:191], a[228:231], v[44:47]
ds_read_b64_tr_b16 v[186:187], v20 offset:18432
v_cvt_pk_bf16_f32 v229, v122, v123
v_mfma_f32_16x16x32_bf16 v[52:55], v[188:191], a[252:255], v[52:55]
v_add_f32 v119, v119, v124
v_mfma_f32_16x16x32_bf16 v[60:63], v[188:191], v[148:151], v[60:63]
s_waitcnt lgkmcnt(6)
v_add_f32 v119, v119, v125
v_mfma_f32_16x16x32_bf16 v[32:35], v[160:163], a[208:211], v[32:35]
ds_read_b64_tr_b16 v[188:189], v21 offset:12288
v_cvt_pk_bf16_f32 v230, v124, v125
v_mfma_f32_16x16x32_bf16 v[40:43], v[160:163], a[232:235], v[40:43]
ds_read_b64_tr_b16 v[190:191], v21 offset:18432
v_add_f32 v119, v119, v126
v_mfma_f32_16x16x32_bf16 v[48:51], v[160:163], v[128:131], v[48:51]
v_add_f32 v119, v119, v127
v_mfma_f32_16x16x32_bf16 v[56:59], v[160:163], v[152:155], v[56:59]
v_cvt_pk_bf16_f32 v231, v126, v127
v_mfma_f32_16x16x32_bf16 v[36:39], v[164:167], a[208:211], v[36:39]
ds_read_b64_tr_b16 v[160:161], v18 offset:12416
v_mfma_f32_16x16x32_bf16 v[44:47], v[164:167], a[232:235], v[44:47]
s_add_u32 m0, s47, 61440
ds_read_b64_tr_b16 v[162:163], v18 offset:18560
v_mfma_f32_16x16x32_bf16 v[52:55], v[164:167], v[128:131], v[52:55]
v_mfma_f32_16x16x32_bf16 v[60:63], v[164:167], v[152:155], v[60:63]
buffer_load_dwordx4 v25, s[24:27], s42 offen offset:0 lds
v_mfma_f32_16x16x32_bf16 v[32:35], v[168:171], a[212:215], v[32:35]
ds_read_b64_tr_b16 v[164:165], v19 offset:12416
v_mfma_f32_16x16x32_bf16 v[40:43], v[168:171], a[236:239], v[40:43]
ds_read_b64_tr_b16 v[166:167], v19 offset:18560
v_mfma_f32_16x16x32_bf16 v[48:51], v[168:171], v[132:135], v[48:51]
v_mfma_f32_16x16x32_bf16 v[56:59], v[168:171], v[156:159], v[56:59]
v_max3_f32 v28, v116, v117, v118
v_mfma_f32_16x16x32_bf16 v[36:39], v[172:175], a[212:215], v[36:39]
ds_read_b64_tr_b16 v[168:169], v20 offset:12416
v_max_f32 v28, v28, v119
v_mfma_f32_16x16x32_bf16 v[44:47], v[172:175], a[236:239], v[44:47]
ds_read_b64_tr_b16 v[170:171], v20 offset:18560
v_cmp_lt_f32 vcc, s64, v28
v_mfma_f32_16x16x32_bf16 v[52:55], v[172:175], v[132:135], v[52:55]
v_mfma_f32_16x16x32_bf16 v[60:63], v[172:175], v[156:159], v[60:63]
s_cbranch_vccnz RSTUB1
RBACK1:
s_waitcnt lgkmcnt(6)
v_mfma_f32_16x16x32_bf16 a[0:3], v[176:179], v[216:219], a[0:3]
ds_read_b64_tr_b16 v[172:173], v21 offset:12416
v_add_f32 v3, v3, v116
v_mfma_f32_16x16x32_bf16 a[4:7], v[176:179], v[220:223], a[4:7]
ds_read_b64_tr_b16 v[174:175], v21 offset:18560
v_add_f32 v15, v15, v117
v_mfma_f32_16x16x32_bf16 a[8:11], v[176:179], v[224:227], a[8:11]
v_add_f32 v29, v29, v118
v_mfma_f32_16x16x32_bf16 a[12:15], v[176:179], v[228:231], a[12:15]
buffer_load_dwordx4 v26, s[24:27], s42 offen offset:1024 lds
v_add_f32 v30, v30, v119
v_mfma_f32_16x16x32_bf16 a[16:19], v[180:183], v[216:219], a[16:19]
ds_read_b64_tr_b16 v[176:177], v18 offset:12544
v_mfma_f32_16x16x32_bf16 a[20:23], v[180:183], v[220:223], a[20:23]
ds_read_b64_tr_b16 v[178:179], v18 offset:18688
v_mfma_f32_16x16x32_bf16 a[24:27], v[180:183], v[224:227], a[24:27]
v_exp_f32 v120, v32
v_mfma_f32_16x16x32_bf16 a[28:31], v[180:183], v[228:231], a[28:31]
v_exp_f32 v121, v33
v_mfma_f32_16x16x32_bf16 a[32:35], v[184:187], v[216:219], a[32:35]
ds_read_b64_tr_b16 v[180:181], v19 offset:12544
v_add_f32 v116, v120, v121
v_mfma_f32_16x16x32_bf16 a[36:39], v[184:187], v[220:223], a[36:39]
ds_read_b64_tr_b16 v[182:183], v19 offset:18688
v_cvt_pk_bf16_f32 v200, v120, v121
v_mfma_f32_16x16x32_bf16 a[40:43], v[184:187], v[224:227], a[40:43]
v_exp_f32 v122, v34
v_mfma_f32_16x16x32_bf16 a[44:47], v[184:187], v[228:231], a[44:47]
v_exp_f32 v123, v35
v_mfma_f32_16x16x32_bf16 a[48:51], v[188:191], v[216:219], a[48:51]
ds_read_b64_tr_b16 v[184:185], v20 offset:12544
v_add_f32 v116, v116, v122
v_mfma_f32_16x16x32_bf16 a[52:55], v[188:191], v[220:223], a[52:55]
ds_read_b64_tr_b16 v[186:187], v20 offset:18688
v_add_f32 v116, v116, v123
v_mfma_f32_16x16x32_bf16 a[56:59], v[188:191], v[224:227], a[56:59]
v_exp_f32 v124, v36
v_mfma_f32_16x16x32_bf16 a[60:63], v[188:191], v[228:231], a[60:63]
s_waitcnt lgkmcnt(6)
buffer_load_dwordx4 v27, s[24:27], s42 offen offset:2048 lds
v_cvt_pk_bf16_f32 v201, v122, v123
v_mfma_f32_16x16x32_bf16 a[64:67], v[160:163], v[216:219], a[64:67]
ds_read_b64_tr_b16 v[188:189], v21 offset:12544
v_mfma_f32_16x16x32_bf16 a[68:71], v[160:163], v[220:223], a[68:71]
s_add_u32 s42, s42, 12288
ds_read_b64_tr_b16 v[190:191], v21 offset:18688
v_mfma_f32_16x16x32_bf16 a[72:75], v[160:163], v[224:227], a[72:75]
v_exp_f32 v125, v37
v_mfma_f32_16x16x32_bf16 a[76:79], v[160:163], v[228:231], a[76:79]
v_exp_f32 v126, v38
v_mfma_f32_16x16x32_bf16 a[80:83], v[164:167], v[216:219], a[80:83]
ds_read_b128 v[160:163], v4 offset:0
v_add_f32 v116, v116, v124
v_mfma_f32_16x16x32_bf16 a[84:87], v[164:167], v[220:223], a[84:87]
v_exp_f32 v127, v39
v_mfma_f32_16x16x32_bf16 a[88:91], v[164:167], v[224:227], a[88:91]
v_exp_f32 v120, v40
v_mfma_f32_16x16x32_bf16 a[92:95], v[164:167], v[228:231], a[92:95]
v_exp_f32 v121, v41
v_mfma_f32_16x16x32_bf16 a[96:99], v[168:171], v[216:219], a[96:99]
ds_read_b128 v[164:167], v4 offset:6144
v_add_f32 v116, v116, v125
v_mfma_f32_16x16x32_bf16 a[100:103], v[168:171], v[220:223], a[100:103]
v_exp_f32 v122, v42
v_mfma_f32_16x16x32_bf16 a[104:107], v[168:171], v[224:227], a[104:107]
v_exp_f32 v123, v43
v_mfma_f32_16x16x32_bf16 a[108:111], v[168:171], v[228:231], a[108:111]
v_cvt_pk_bf16_f32 v202, v124, v125
v_mfma_f32_16x16x32_bf16 a[112:115], v[172:175], v[216:219], a[112:115]
ds_read_b128 v[168:171], v5 offset:0
v_add_f32 v116, v116, v126
v_mfma_f32_16x16x32_bf16 a[116:119], v[172:175], v[220:223], a[116:119]
v_exp_f32 v124, v44
v_mfma_f32_16x16x32_bf16 a[120:123], v[172:175], v[224:227], a[120:123]
v_exp_f32 v125, v45
v_mfma_f32_16x16x32_bf16 a[124:127], v[172:175], v[228:231], a[124:127]
s_waitcnt lgkmcnt(3)
v_add_f32 v116, v116, v127
v_mfma_f32_16x16x32_bf16 a[128:131], v[176:179], v[216:219], a[128:131]
ds_read_b128 v[172:175], v5 offset:6144
v_cvt_pk_bf16_f32 v203, v126, v127
v_mfma_f32_16x16x32_bf16 a[132:135], v[176:179], v[220:223], a[132:135]
v_exp_f32 v126, v46
v_mfma_f32_16x16x32_bf16 a[136:139], v[176:179], v[224:227], a[136:139]
v_exp_f32 v127, v47
v_mfma_f32_16x16x32_bf16 a[140:143], v[176:179], v[228:231], a[140:143]
v_add_f32 v117, v120, v121
v_mfma_f32_16x16x32_bf16 a[144:147], v[180:183], v[216:219], a[144:147]
ds_read_b128 v[176:179], v4 offset:128
v_cvt_pk_bf16_f32 v204, v120, v121
v_mfma_f32_16x16x32_bf16 a[148:151], v[180:183], v[220:223], a[148:151]
v_exp_f32 v120, v48
v_mfma_f32_16x16x32_bf16 a[152:155], v[180:183], v[224:227], a[152:155]
v_exp_f32 v121, v49
v_mfma_f32_16x16x32_bf16 a[156:159], v[180:183], v[228:231], a[156:159]
v_add_f32 v117, v117, v122
v_mfma_f32_16x16x32_bf16 a[160:163], v[184:187], v[216:219], a[160:163]
ds_read_b128 v[180:183], v4 offset:6272
v_add_f32 v117, v117, v123
v_mfma_f32_16x16x32_bf16 a[164:167], v[184:187], v[220:223], a[164:167]
v_cvt_pk_bf16_f32 v205, v122, v123
v_mfma_f32_16x16x32_bf16 a[168:171], v[184:187], v[224:227], a[168:171]
v_exp_f32 v122, v50
v_mfma_f32_16x16x32_bf16 a[172:175], v[184:187], v[228:231], a[172:175]
v_exp_f32 v123, v51
v_mfma_f32_16x16x32_bf16 a[176:179], v[188:191], v[216:219], a[176:179]
v_add_f32 v117, v117, v124
v_mfma_f32_16x16x32_bf16 a[180:183], v[188:191], v[220:223], a[180:183]
v_add_f32 v117, v117, v125
v_mfma_f32_16x16x32_bf16 a[184:187], v[188:191], v[224:227], a[184:187]
v_cvt_pk_bf16_f32 v206, v124, v125
v_mfma_f32_16x16x32_bf16 a[188:191], v[188:191], v[228:231], a[188:191]
s_waitcnt lgkmcnt(2)
v_exp_f32 v124, v52
v_mfma_f32_16x16x32_bf16 v[64:67], v[160:163], a[192:195], v[96:99]
s_waitcnt vmcnt(9)
s_barrier
ds_read_b128 v[184:187], v5 offset:128
v_add_f32 v117, v117, v126
v_mfma_f32_16x16x32_bf16 v[72:75], v[160:163], a[216:219], v[100:103]
s_add_u32 m0, s46, 12288
ds_read_b128 v[188:191], v5 offset:6272
v_add_f32 v117, v117, v127
v_mfma_f32_16x16x32_bf16 v[80:83], v[160:163], a[240:243], v[104:107]
v_exp_f32 v125, v53
v_mfma_f32_16x16x32_bf16 v[88:91], v[160:163], v[136:139], v[108:111]
buffer_load_dwordx4 v22, s[20:23], s42 offen offset:0 lds
v_cvt_pk_bf16_f32 v207, v126, v127
v_mfma_f32_16x16x32_bf16 v[68:71], v[164:167], a[192:195], v[96:99]
ds_read_b128 v[160:163], v4 offset:256
v_add_f32 v118, v120, v121
v_mfma_f32_16x16x32_bf16 v[76:79], v[164:167], a[216:219], v[100:103]
v_exp_f32 v126, v54
v_mfma_f32_16x16x32_bf16 v[84:87], v[164:167], a[240:243], v[104:107]
v_exp_f32 v127, v55
v_mfma_f32_16x16x32_bf16 v[92:95], v[164:167], v[136:139], v[108:111]
v_cvt_pk_bf16_f32 v208, v120, v121
v_mfma_f32_16x16x32_bf16 v[64:67], v[168:171], a[196:199], v[64:67]
ds_read_b128 v[164:167], v4 offset:6400
v_add_f32 v118, v118, v122
v_mfma_f32_16x16x32_bf16 v[72:75], v[168:171], a[220:223], v[72:75]
v_exp_f32 v120, v56
v_mfma_f32_16x16x32_bf16 v[80:83], v[168:171], a[244:247], v[80:83]
v_exp_f32 v121, v57
v_mfma_f32_16x16x32_bf16 v[88:91], v[168:171], v[140:143], v[88:91]
v_add_f32 v118, v118, v123
v_mfma_f32_16x16x32_bf16 v[68:71], v[172:175], a[196:199], v[68:71]
ds_read_b128 v[168:171], v5 offset:256
v_cvt_pk_bf16_f32 v209, v122, v123
v_mfma_f32_16x16x32_bf16 v[76:79], v[172:175], a[220:223], v[76:79]
v_exp_f32 v122, v58
v_mfma_f32_16x16x32_bf16 v[84:87], v[172:175], a[244:247], v[84:87]
v_exp_f32 v123, v59
v_mfma_f32_16x16x32_bf16 v[92:95], v[172:175], v[140:143], v[92:95]
s_waitcnt lgkmcnt(3)
buffer_load_dwordx4 v23, s[20:23], s42 offen offset:1024 lds
v_add_f32 v118, v118, v124
v_mfma_f32_16x16x32_bf16 v[64:67], v[176:179], a[200:203], v[64:67]
ds_read_b128 v[172:175], v5 offset:6400
v_add_f32 v118, v118, v125
v_mfma_f32_16x16x32_bf16 v[72:75], v[176:179], a[224:227], v[72:75]
v_cvt_pk_bf16_f32 v210, v124, v125
v_mfma_f32_16x16x32_bf16 v[80:83], v[176:179], a[248:251], v[80:83]
v_exp_f32 v124, v60
v_mfma_f32_16x16x32_bf16 v[88:91], v[176:179], v[144:147], v[88:91]
v_exp_f32 v125, v61
v_mfma_f32_16x16x32_bf16 v[68:71], v[180:183], a[200:203], v[68:71]
ds_read_b64_tr_b16 v[176:177], v18 offset:24576
v_add_f32 v118, v118, v126
v_mfma_f32_16x16x32_bf16 v[76:79], v[180:183], a[224:227], v[76:79]
ds_read_b64_tr_b16 v[178:179], v18 offset:30720
v_add_f32 v118, v118, v127
v_mfma_f32_16x16x32_bf16 v[84:87], v[180:183], a[248:251], v[84:87]
v_cvt_pk_bf16_f32 v211, v126, v127
v_mfma_f32_16x16x32_bf16 v[92:95], v[180:183], v[144:147], v[92:95]
v_exp_f32 v126, v62
v_mfma_f32_16x16x32_bf16 v[64:67], v[184:187], a[204:207], v[64:67]
ds_read_b64_tr_b16 v[180:181], v19 offset:24576
v_add_f32 v119, v120, v121
v_mfma_f32_16x16x32_bf16 v[72:75], v[184:187], a[228:231], v[72:75]
ds_read_b64_tr_b16 v[182:183], v19 offset:30720
v_cvt_pk_bf16_f32 v212, v120, v121
v_mfma_f32_16x16x32_bf16 v[80:83], v[184:187], a[252:255], v[80:83]
v_exp_f32 v127, v63
v_mfma_f32_16x16x32_bf16 v[88:91], v[184:187], v[148:151], v[88:91]
buffer_load_dwordx4 v24, s[20:23], s42 offen offset:2048 lds
v_add_f32 v119, v119, v122
v_mfma_f32_16x16x32_bf16 v[68:71], v[188:191], a[204:207], v[68:71]
ds_read_b64_tr_b16 v[184:185], v20 offset:24576
v_add_f32 v119, v119, v123
v_mfma_f32_16x16x32_bf16 v[76:79], v[188:191], a[228:231], v[76:79]
ds_read_b64_tr_b16 v[186:187], v20 offset:30720
v_cvt_pk_bf16_f32 v213, v122, v123
v_mfma_f32_16x16x32_bf16 v[84:87], v[188:191], a[252:255], v[84:87]
v_add_f32 v119, v119, v124
v_mfma_f32_16x16x32_bf16 v[92:95], v[188:191], v[148:151], v[92:95]
s_waitcnt lgkmcnt(6)
v_add_f32 v119, v119, v125
v_mfma_f32_16x16x32_bf16 v[64:67], v[160:163], a[208:211], v[64:67]
ds_read_b64_tr_b16 v[188:189], v21 offset:24576
v_cvt_pk_bf16_f32 v214, v124, v125
v_mfma_f32_16x16x32_bf16 v[72:75], v[160:163], a[232:235], v[72:75]
ds_read_b64_tr_b16 v[190:191], v21 offset:30720
v_add_f32 v119, v119, v126
v_mfma_f32_16x16x32_bf16 v[80:83], v[160:163], v[128:131], v[80:83]
v_add_f32 v119, v119, v127
v_mfma_f32_16x16x32_bf16 v[88:91], v[160:163], v[152:155], v[88:91]
v_cvt_pk_bf16_f32 v215, v126, v127
v_mfma_f32_16x16x32_bf16 v[68:71], v[164:167], a[208:211], v[68:71]
ds_read_b64_tr_b16 v[160:161], v18 offset:24704
v_mfma_f32_16x16x32_bf16 v[76:79], v[164:167], a[232:235], v[76:79]
s_add_u32 m0, s47, 0
ds_read_b64_tr_b16 v[162:163], v18 offset:30848
v_mfma_f32_16x16x32_bf16 v[84:87], v[164:167], v[128:131], v[84:87]
v_mfma_f32_16x16x32_bf16 v[92:95], v[164:167], v[152:155], v[92:95]
buffer_load_dwordx4 v25, s[24:27], s42 offen offset:0 lds
v_mfma_f32_16x16x32_bf16 v[64:67], v[168:171], a[212:215], v[64:67]
ds_read_b64_tr_b16 v[164:165], v19 offset:24704
v_mfma_f32_16x16x32_bf16 v[72:75], v[168:171], a[236:239], v[72:75]
ds_read_b64_tr_b16 v[166:167], v19 offset:30848
v_mfma_f32_16x16x32_bf16 v[80:83], v[168:171], v[132:135], v[80:83]
v_mfma_f32_16x16x32_bf16 v[88:91], v[168:171], v[156:159], v[88:91]
v_max3_f32 v28, v116, v117, v118
v_mfma_f32_16x16x32_bf16 v[68:71], v[172:175], a[212:215], v[68:71]
ds_read_b64_tr_b16 v[168:169], v20 offset:24704
v_max_f32 v28, v28, v119
v_mfma_f32_16x16x32_bf16 v[76:79], v[172:175], a[236:239], v[76:79]
ds_read_b64_tr_b16 v[170:171], v20 offset:30848
v_cmp_lt_f32 vcc, s64, v28
v_mfma_f32_16x16x32_bf16 v[84:87], v[172:175], v[132:135], v[84:87]
v_mfma_f32_16x16x32_bf16 v[92:95], v[172:175], v[156:159], v[92:95]
s_cbranch_vccnz RSTUB2
RBACK2:
s_waitcnt lgkmcnt(6)
v_mfma_f32_16x16x32_bf16 a[0:3], v[176:179], v[200:203], a[0:3]
ds_read_b64_tr_b16 v[172:173], v21 offset:24704
v_add_f32 v3, v3, v116
v_mfma_f32_16x16x32_bf16 a[4:7], v[176:179], v[204:207], a[4:7]
ds_read_b64_tr_b16 v[174:175], v21 offset:30848
v_add_f32 v15, v15, v117
v_mfma_f32_16x16x32_bf16 a[8:11], v[176:179], v[208:211], a[8:11]
v_add_f32 v29, v29, v118
v_mfma_f32_16x16x32_bf16 a[12:15], v[176:179], v[212:215], a[12:15]
buffer_load_dwordx4 v26, s[24:27], s42 offen offset:1024 lds
v_add_f32 v30, v30, v119
v_mfma_f32_16x16x32_bf16 a[16:19], v[180:183], v[200:203], a[16:19]
ds_read_b64_tr_b16 v[176:177], v18 offset:24832
v_mfma_f32_16x16x32_bf16 a[20:23], v[180:183], v[204:207], a[20:23]
ds_read_b64_tr_b16 v[178:179], v18 offset:30976
v_mfma_f32_16x16x32_bf16 a[24:27], v[180:183], v[208:211], a[24:27]
v_exp_f32 v120, v64
v_mfma_f32_16x16x32_bf16 a[28:31], v[180:183], v[212:215], a[28:31]
v_exp_f32 v121, v65
v_mfma_f32_16x16x32_bf16 a[32:35], v[184:187], v[200:203], a[32:35]
ds_read_b64_tr_b16 v[180:181], v19 offset:24832
v_add_f32 v116, v120, v121
v_mfma_f32_16x16x32_bf16 a[36:39], v[184:187], v[204:207], a[36:39]
ds_read_b64_tr_b16 v[182:183], v19 offset:30976
v_cvt_pk_bf16_f32 v216, v120, v121
v_mfma_f32_16x16x32_bf16 a[40:43], v[184:187], v[208:211], a[40:43]
v_exp_f32 v122, v66
v_mfma_f32_16x16x32_bf16 a[44:47], v[184:187], v[212:215], a[44:47]
v_exp_f32 v123, v67
v_mfma_f32_16x16x32_bf16 a[48:51], v[188:191], v[200:203], a[48:51]
ds_read_b64_tr_b16 v[184:185], v20 offset:24832
v_add_f32 v116, v116, v122
v_mfma_f32_16x16x32_bf16 a[52:55], v[188:191], v[204:207], a[52:55]
ds_read_b64_tr_b16 v[186:187], v20 offset:30976
v_add_f32 v116, v116, v123
v_mfma_f32_16x16x32_bf16 a[56:59], v[188:191], v[208:211], a[56:59]
v_exp_f32 v124, v68
v_mfma_f32_16x16x32_bf16 a[60:63], v[188:191], v[212:215], a[60:63]
s_waitcnt lgkmcnt(6)
buffer_load_dwordx4 v27, s[24:27], s42 offen offset:2048 lds
v_cvt_pk_bf16_f32 v217, v122, v123
v_mfma_f32_16x16x32_bf16 a[64:67], v[160:163], v[200:203], a[64:67]
ds_read_b64_tr_b16 v[188:189], v21 offset:24832
v_mfma_f32_16x16x32_bf16 a[68:71], v[160:163], v[204:207], a[68:71]
s_add_u32 s42, s42, 12288
ds_read_b64_tr_b16 v[190:191], v21 offset:30976
v_mfma_f32_16x16x32_bf16 a[72:75], v[160:163], v[208:211], a[72:75]
v_exp_f32 v125, v69
v_mfma_f32_16x16x32_bf16 a[76:79], v[160:163], v[212:215], a[76:79]
v_exp_f32 v126, v70
v_mfma_f32_16x16x32_bf16 a[80:83], v[164:167], v[200:203], a[80:83]
ds_read_b128 v[160:163], v4 offset:12288
v_add_f32 v116, v116, v124
v_mfma_f32_16x16x32_bf16 a[84:87], v[164:167], v[204:207], a[84:87]
v_exp_f32 v127, v71
v_mfma_f32_16x16x32_bf16 a[88:91], v[164:167], v[208:211], a[88:91]
v_exp_f32 v120, v72
v_mfma_f32_16x16x32_bf16 a[92:95], v[164:167], v[212:215], a[92:95]
v_exp_f32 v121, v73
v_mfma_f32_16x16x32_bf16 a[96:99], v[168:171], v[200:203], a[96:99]
ds_read_b128 v[164:167], v4 offset:18432
v_add_f32 v116, v116, v125
v_mfma_f32_16x16x32_bf16 a[100:103], v[168:171], v[204:207], a[100:103]
v_exp_f32 v122, v74
v_mfma_f32_16x16x32_bf16 a[104:107], v[168:171], v[208:211], a[104:107]
v_exp_f32 v123, v75
v_mfma_f32_16x16x32_bf16 a[108:111], v[168:171], v[212:215], a[108:111]
v_cvt_pk_bf16_f32 v218, v124, v125
v_mfma_f32_16x16x32_bf16 a[112:115], v[172:175], v[200:203], a[112:115]
ds_read_b128 v[168:171], v5 offset:12288
v_add_f32 v116, v116, v126
v_mfma_f32_16x16x32_bf16 a[116:119], v[172:175], v[204:207], a[116:119]
v_exp_f32 v124, v76
v_mfma_f32_16x16x32_bf16 a[120:123], v[172:175], v[208:211], a[120:123]
v_exp_f32 v125, v77
v_mfma_f32_16x16x32_bf16 a[124:127], v[172:175], v[212:215], a[124:127]
s_waitcnt lgkmcnt(3)
v_add_f32 v116, v116, v127
v_mfma_f32_16x16x32_bf16 a[128:131], v[176:179], v[200:203], a[128:131]
ds_read_b128 v[172:175], v5 offset:18432
v_cvt_pk_bf16_f32 v219, v126, v127
v_mfma_f32_16x16x32_bf16 a[132:135], v[176:179], v[204:207], a[132:135]
v_exp_f32 v126, v78
v_mfma_f32_16x16x32_bf16 a[136:139], v[176:179], v[208:211], a[136:139]
v_exp_f32 v127, v79
v_mfma_f32_16x16x32_bf16 a[140:143], v[176:179], v[212:215], a[140:143]
v_add_f32 v117, v120, v121
v_mfma_f32_16x16x32_bf16 a[144:147], v[180:183], v[200:203], a[144:147]
ds_read_b128 v[176:179], v4 offset:12416
v_cvt_pk_bf16_f32 v220, v120, v121
v_mfma_f32_16x16x32_bf16 a[148:151], v[180:183], v[204:207], a[148:151]
v_exp_f32 v120, v80
v_mfma_f32_16x16x32_bf16 a[152:155], v[180:183], v[208:211], a[152:155]
v_exp_f32 v121, v81
v_mfma_f32_16x16x32_bf16 a[156:159], v[180:183], v[212:215], a[156:159]
v_add_f32 v117, v117, v122
v_mfma_f32_16x16x32_bf16 a[160:163], v[184:187], v[200:203], a[160:163]
ds_read_b128 v[180:183], v4 offset:18560
v_add_f32 v117, v117, v123
v_mfma_f32_16x16x32_bf16 a[164:167], v[184:187], v[204:207], a[164:167]
v_cvt_pk_bf16_f32 v221, v122, v123
v_mfma_f32_16x16x32_bf16 a[168:171], v[184:187], v[208:211], a[168:171]
v_exp_f32 v122, v82
v_mfma_f32_16x16x32_bf16 a[172:175], v[184:187], v[212:215], a[172:175]
v_exp_f32 v123, v83
v_mfma_f32_16x16x32_bf16 a[176:179], v[188:191], v[200:203], a[176:179]
v_add_f32 v117, v117, v124
v_mfma_f32_16x16x32_bf16 a[180:183], v[188:191], v[204:207], a[180:183]
v_add_f32 v117, v117, v125
v_mfma_f32_16x16x32_bf16 a[184:187], v[188:191], v[208:211], a[184:187]
v_cvt_pk_bf16_f32 v222, v124, v125
v_mfma_f32_16x16x32_bf16 a[188:191], v[188:191], v[212:215], a[188:191]
s_waitcnt lgkmcnt(2)
v_exp_f32 v124, v84
v_mfma_f32_16x16x32_bf16 v[32:35], v[160:163], a[192:195], v[96:99]
ds_read_b128 v[184:187], v5 offset:12416
v_add_f32 v117, v117, v126
v_mfma_f32_16x16x32_bf16 v[40:43], v[160:163], a[216:219], v[100:103]
s_add_u32 m0, s46, 24576
ds_read_b128 v[188:191], v5 offset:18560
v_add_f32 v117, v117, v127
v_mfma_f32_16x16x32_bf16 v[48:51], v[160:163], a[240:243], v[104:107]
v_exp_f32 v125, v85
v_mfma_f32_16x16x32_bf16 v[56:59], v[160:163], v[136:139], v[108:111]
buffer_load_dwordx4 v22, s[20:23], s42 offen offset:0 lds
v_cvt_pk_bf16_f32 v223, v126, v127
v_mfma_f32_16x16x32_bf16 v[36:39], v[164:167], a[192:195], v[96:99]
ds_read_b128 v[160:163], v4 offset:12544
v_add_f32 v118, v120, v121
v_mfma_f32_16x16x32_bf16 v[44:47], v[164:167], a[216:219], v[100:103]
v_exp_f32 v126, v86
v_mfma_f32_16x16x32_bf16 v[52:55], v[164:167], a[240:243], v[104:107]
v_exp_f32 v127, v87
v_mfma_f32_16x16x32_bf16 v[60:63], v[164:167], v[136:139], v[108:111]
v_cvt_pk_bf16_f32 v224, v120, v121
v_mfma_f32_16x16x32_bf16 v[32:35], v[168:171], a[196:199], v[32:35]
ds_read_b128 v[164:167], v4 offset:18688
v_add_f32 v118, v118, v122
v_mfma_f32_16x16x32_bf16 v[40:43], v[168:171], a[220:223], v[40:43]
v_exp_f32 v120, v88
v_mfma_f32_16x16x32_bf16 v[48:51], v[168:171], a[244:247], v[48:51]
v_exp_f32 v121, v89
v_mfma_f32_16x16x32_bf16 v[56:59], v[168:171], v[140:143], v[56:59]
v_add_f32 v118, v118, v123
v_mfma_f32_16x16x32_bf16 v[36:39], v[172:175], a[196:199], v[36:39]
ds_read_b128 v[168:171], v5 offset:12544
v_cvt_pk_bf16_f32 v225, v122, v123
v_mfma_f32_16x16x32_bf16 v[44:47], v[172:175], a[220:223], v[44:47]
v_exp_f32 v122, v90
v_mfma_f32_16x16x32_bf16 v[52:55], v[172:175], a[244:247], v[52:55]
v_exp_f32 v123, v91
v_mfma_f32_16x16x32_bf16 v[60:63], v[172:175], v[140:143], v[60:63]
s_waitcnt lgkmcnt(3)
buffer_load_dwordx4 v23, s[20:23], s42 offen offset:1024 lds
v_add_f32 v118, v118, v124
v_mfma_f32_16x16x32_bf16 v[32:35], v[176:179], a[200:203], v[32:35]
ds_read_b128 v[172:175], v5 offset:18688
v_add_f32 v118, v118, v125
v_mfma_f32_16x16x32_bf16 v[40:43], v[176:179], a[224:227], v[40:43]
v_cvt_pk_bf16_f32 v226, v124, v125
v_mfma_f32_16x16x32_bf16 v[48:51], v[176:179], a[248:251], v[48:51]
v_exp_f32 v124, v92
v_mfma_f32_16x16x32_bf16 v[56:59], v[176:179], v[144:147], v[56:59]
v_exp_f32 v125, v93
v_mfma_f32_16x16x32_bf16 v[36:39], v[180:183], a[200:203], v[36:39]
ds_read_b64_tr_b16 v[176:177], v6 offset:0
v_add_f32 v118, v118, v126
v_mfma_f32_16x16x32_bf16 v[44:47], v[180:183], a[224:227], v[44:47]
ds_read_b64_tr_b16 v[178:179], v6 offset:6144
v_add_f32 v118, v118, v127
v_mfma_f32_16x16x32_bf16 v[52:55], v[180:183], a[248:251], v[52:55]
v_cvt_pk_bf16_f32 v227, v126, v127
v_mfma_f32_16x16x32_bf16 v[60:63], v[180:183], v[144:147], v[60:63]
v_exp_f32 v126, v94
v_mfma_f32_16x16x32_bf16 v[32:35], v[184:187], a[204:207], v[32:35]
ds_read_b64_tr_b16 v[180:181], v7 offset:0
v_add_f32 v119, v120, v121
v_mfma_f32_16x16x32_bf16 v[40:43], v[184:187], a[228:231], v[40:43]
ds_read_b64_tr_b16 v[182:183], v7 offset:6144
v_cvt_pk_bf16_f32 v228, v120, v121
v_mfma_f32_16x16x32_bf16 v[48:51], v[184:187], a[252:255], v[48:51]
v_exp_f32 v127, v95
v_mfma_f32_16x16x32_bf16 v[56:59], v[184:187], v[148:151], v[56:59]
buffer_load_dwordx4 v24, s[20:23], s42 offen offset:2048 lds
v_add_f32 v119, v119, v122
v_mfma_f32_16x16x32_bf16 v[36:39], v[188:191], a[204:207], v[36:39]
ds_read_b64_tr_b16 v[184:185], v8 offset:0
v_add_f32 v119, v119, v123
v_mfma_f32_16x16x32_bf16 v[44:47], v[188:191], a[228:231], v[44:47]
ds_read_b64_tr_b16 v[186:187], v8 offset:6144
v_cvt_pk_bf16_f32 v229, v122, v123
v_mfma_f32_16x16x32_bf16 v[52:55], v[188:191], a[252:255], v[52:55]
v_add_f32 v119, v119, v124
v_mfma_f32_16x16x32_bf16 v[60:63], v[188:191], v[148:151], v[60:63]
s_waitcnt lgkmcnt(6)
v_add_f32 v119, v119, v125
v_mfma_f32_16x16x32_bf16 v[32:35], v[160:163], a[208:211], v[32:35]
ds_read_b64_tr_b16 v[188:189], v9 offset:0
v_cvt_pk_bf16_f32 v230, v124, v125
v_mfma_f32_16x16x32_bf16 v[40:43], v[160:163], a[232:235], v[40:43]
ds_read_b64_tr_b16 v[190:191], v9 offset:6144
v_add_f32 v119, v119, v126
v_mfma_f32_16x16x32_bf16 v[48:51], v[160:163], v[128:131], v[48:51]
v_add_f32 v119, v119, v127
v_mfma_f32_16x16x32_bf16 v[56:59], v[160:163], v[152:155], v[56:59]
v_cvt_pk_bf16_f32 v231, v126, v127
v_mfma_f32_16x16x32_bf16 v[36:39], v[164:167], a[208:211], v[36:39]
ds_read_b64_tr_b16 v[160:161], v6 offset:128
v_mfma_f32_16x16x32_bf16 v[44:47], v[164:167], a[232:235], v[44:47]
s_add_u32 m0, s47, 12288
ds_read_b64_tr_b16 v[162:163], v6 offset:6272
v_mfma_f32_16x16x32_bf16 v[52:55], v[164:167], v[128:131], v[52:55]
v_mfma_f32_16x16x32_bf16 v[60:63], v[164:167], v[152:155], v[60:63]
buffer_load_dwordx4 v25, s[24:27], s42 offen offset:0 lds
v_mfma_f32_16x16x32_bf16 v[32:35], v[168:171], a[212:215], v[32:35]
ds_read_b64_tr_b16 v[164:165], v7 offset:128
v_mfma_f32_16x16x32_bf16 v[40:43], v[168:171], a[236:239], v[40:43]
ds_read_b64_tr_b16 v[166:167], v7 offset:6272
v_mfma_f32_16x16x32_bf16 v[48:51], v[168:171], v[132:135], v[48:51]
v_mfma_f32_16x16x32_bf16 v[56:59], v[168:171], v[156:159], v[56:59]
v_max3_f32 v28, v116, v117, v118
v_mfma_f32_16x16x32_bf16 v[36:39], v[172:175], a[212:215], v[36:39]
ds_read_b64_tr_b16 v[168:169], v8 offset:128
v_max_f32 v28, v28, v119
v_mfma_f32_16x16x32_bf16 v[44:47], v[172:175], a[236:239], v[44:47]
ds_read_b64_tr_b16 v[170:171], v8 offset:6272
v_cmp_lt_f32 vcc, s64, v28
v_mfma_f32_16x16x32_bf16 v[52:55], v[172:175], v[132:135], v[52:55]
v_mfma_f32_16x16x32_bf16 v[60:63], v[172:175], v[156:159], v[60:63]
s_cbranch_vccnz RSTUB3
RBACK3:
s_waitcnt lgkmcnt(6)
v_mfma_f32_16x16x32_bf16 a[0:3], v[176:179], v[216:219], a[0:3]
ds_read_b64_tr_b16 v[172:173], v9 offset:128
v_add_f32 v3, v3, v116
v_mfma_f32_16x16x32_bf16 a[4:7], v[176:179], v[220:223], a[4:7]
ds_read_b64_tr_b16 v[174:175], v9 offset:6272
v_add_f32 v15, v15, v117
v_mfma_f32_16x16x32_bf16 a[8:11], v[176:179], v[224:227], a[8:11]
v_add_f32 v29, v29, v118
v_mfma_f32_16x16x32_bf16 a[12:15], v[176:179], v[228:231], a[12:15]
buffer_load_dwordx4 v26, s[24:27], s42 offen offset:1024 lds
v_add_f32 v30, v30, v119
v_mfma_f32_16x16x32_bf16 a[16:19], v[180:183], v[216:219], a[16:19]
ds_read_b64_tr_b16 v[176:177], v6 offset:256
v_mfma_f32_16x16x32_bf16 a[20:23], v[180:183], v[220:223], a[20:23]
ds_read_b64_tr_b16 v[178:179], v6 offset:6400
v_mfma_f32_16x16x32_bf16 a[24:27], v[180:183], v[224:227], a[24:27]
v_exp_f32 v120, v32
v_mfma_f32_16x16x32_bf16 a[28:31], v[180:183], v[228:231], a[28:31]
v_exp_f32 v121, v33
v_mfma_f32_16x16x32_bf16 a[32:35], v[184:187], v[216:219], a[32:35]
ds_read_b64_tr_b16 v[180:181], v7 offset:256
v_add_f32 v116, v120, v121
v_mfma_f32_16x16x32_bf16 a[36:39], v[184:187], v[220:223], a[36:39]
ds_read_b64_tr_b16 v[182:183], v7 offset:6400
v_cvt_pk_bf16_f32 v200, v120, v121
v_mfma_f32_16x16x32_bf16 a[40:43], v[184:187], v[224:227], a[40:43]
v_exp_f32 v122, v34
v_mfma_f32_16x16x32_bf16 a[44:47], v[184:187], v[228:231], a[44:47]
v_exp_f32 v123, v35
v_mfma_f32_16x16x32_bf16 a[48:51], v[188:191], v[216:219], a[48:51]
ds_read_b64_tr_b16 v[184:185], v8 offset:256
v_add_f32 v116, v116, v122
v_mfma_f32_16x16x32_bf16 a[52:55], v[188:191], v[220:223], a[52:55]
ds_read_b64_tr_b16 v[186:187], v8 offset:6400
v_add_f32 v116, v116, v123
v_mfma_f32_16x16x32_bf16 a[56:59], v[188:191], v[224:227], a[56:59]
v_exp_f32 v124, v36
v_mfma_f32_16x16x32_bf16 a[60:63], v[188:191], v[228:231], a[60:63]
s_waitcnt lgkmcnt(6)
buffer_load_dwordx4 v27, s[24:27], s42 offen offset:2048 lds
v_cvt_pk_bf16_f32 v201, v122, v123
v_mfma_f32_16x16x32_bf16 a[64:67], v[160:163], v[216:219], a[64:67]
ds_read_b64_tr_b16 v[188:189], v9 offset:256
v_mfma_f32_16x16x32_bf16 a[68:71], v[160:163], v[220:223], a[68:71]
s_add_u32 s42, s42, 12288
ds_read_b64_tr_b16 v[190:191], v9 offset:6400
v_mfma_f32_16x16x32_bf16 a[72:75], v[160:163], v[224:227], a[72:75]
v_exp_f32 v125, v37
v_mfma_f32_16x16x32_bf16 a[76:79], v[160:163], v[228:231], a[76:79]
v_exp_f32 v126, v38
v_mfma_f32_16x16x32_bf16 a[80:83], v[164:167], v[216:219], a[80:83]
ds_read_b128 v[160:163], v4 offset:24576
v_add_f32 v116, v116, v124
v_mfma_f32_16x16x32_bf16 a[84:87], v[164:167], v[220:223], a[84:87]
v_exp_f32 v127, v39
v_mfma_f32_16x16x32_bf16 a[88:91], v[164:167], v[224:227], a[88:91]
v_exp_f32 v120, v40
v_mfma_f32_16x16x32_bf16 a[92:95], v[164:167], v[228:231], a[92:95]
v_exp_f32 v121, v41
v_mfma_f32_16x16x32_bf16 a[96:99], v[168:171], v[216:219], a[96:99]
ds_read_b128 v[164:167], v4 offset:30720
v_add_f32 v116, v116, v125
v_mfma_f32_16x16x32_bf16 a[100:103], v[168:171], v[220:223], a[100:103]
v_exp_f32 v122, v42
v_mfma_f32_16x16x32_bf16 a[104:107], v[168:171], v[224:227], a[104:107]
v_exp_f32 v123, v43
v_mfma_f32_16x16x32_bf16 a[108:111], v[168:171], v[228:231], a[108:111]
v_cvt_pk_bf16_f32 v202, v124, v125
v_mfma_f32_16x16x32_bf16 a[112:115], v[172:175], v[216:219], a[112:115]
ds_read_b128 v[168:171], v5 offset:24576
v_add_f32 v116, v116, v126
v_mfma_f32_16x16x32_bf16 a[116:119], v[172:175], v[220:223], a[116:119]
v_exp_f32 v124, v44
v_mfma_f32_16x16x32_bf16 a[120:123], v[172:175], v[224:227], a[120:123]
v_exp_f32 v125, v45
v_mfma_f32_16x16x32_bf16 a[124:127], v[172:175], v[228:231], a[124:127]
s_waitcnt lgkmcnt(3)
v_add_f32 v116, v116, v127
v_mfma_f32_16x16x32_bf16 a[128:131], v[176:179], v[216:219], a[128:131]
ds_read_b128 v[172:175], v5 offset:30720
v_cvt_pk_bf16_f32 v203, v126, v127
v_mfma_f32_16x16x32_bf16 a[132:135], v[176:179], v[220:223], a[132:135]
v_exp_f32 v126, v46
v_mfma_f32_16x16x32_bf16 a[136:139], v[176:179], v[224:227], a[136:139]
v_exp_f32 v127, v47
v_mfma_f32_16x16x32_bf16 a[140:143], v[176:179], v[228:231], a[140:143]
v_add_f32 v117, v120, v121
v_mfma_f32_16x16x32_bf16 a[144:147], v[180:183], v[216:219], a[144:147]
ds_read_b128 v[176:179], v4 offset:24704
v_cvt_pk_bf16_f32 v204, v120, v121
v_mfma_f32_16x16x32_bf16 a[148:151], v[180:183], v[220:223], a[148:151]
v_exp_f32 v120, v48
v_mfma_f32_16x16x32_bf16 a[152:155], v[180:183], v[224:227], a[152:155]
v_exp_f32 v121, v49
v_mfma_f32_16x16x32_bf16 a[156:159], v[180:183], v[228:231], a[156:159]
v_add_f32 v117, v117, v122
v_mfma_f32_16x16x32_bf16 a[160:163], v[184:187], v[216:219], a[160:163]
ds_read_b128 v[180:183], v4 offset:30848
v_add_f32 v117, v117, v123
v_mfma_f32_16x16x32_bf16 a[164:167], v[184:187], v[220:223], a[164:167]
v_cvt_pk_bf16_f32 v205, v122, v123
v_mfma_f32_16x16x32_bf16 a[168:171], v[184:187], v[224:227], a[168:171]
v_exp_f32 v122, v50
v_mfma_f32_16x16x32_bf16 a[172:175], v[184:187], v[228:231], a[172:175]
v_exp_f32 v123, v51
v_mfma_f32_16x16x32_bf16 a[176:179], v[188:191], v[216:219], a[176:179]
v_add_f32 v117, v117, v124
v_mfma_f32_16x16x32_bf16 a[180:183], v[188:191], v[220:223], a[180:183]
v_add_f32 v117, v117, v125
v_mfma_f32_16x16x32_bf16 a[184:187], v[188:191], v[224:227], a[184:187]
v_cvt_pk_bf16_f32 v206, v124, v125
v_mfma_f32_16x16x32_bf16 a[188:191], v[188:191], v[228:231], a[188:191]
s_waitcnt lgkmcnt(2)
v_exp_f32 v124, v52
v_mfma_f32_16x16x32_bf16 v[64:67], v[160:163], a[192:195], v[96:99]
s_waitcnt vmcnt(9)
s_barrier
ds_read_b128 v[184:187], v5 offset:24704
v_add_f32 v117, v117, v126
v_mfma_f32_16x16x32_bf16 v[72:75], v[160:163], a[216:219], v[100:103]
s_add_u32 m0, s46, 36864
ds_read_b128 v[188:191], v5 offset:30848
v_add_f32 v117, v117, v127
v_mfma_f32_16x16x32_bf16 v[80:83], v[160:163], a[240:243], v[104:107]
v_exp_f32 v125, v53
v_mfma_f32_16x16x32_bf16 v[88:91], v[160:163], v[136:139], v[108:111]
buffer_load_dwordx4 v22, s[20:23], s42 offen offset:0 lds
v_cvt_pk_bf16_f32 v207, v126, v127
v_mfma_f32_16x16x32_bf16 v[68:71], v[164:167], a[192:195], v[96:99]
ds_read_b128 v[160:163], v4 offset:24832
v_add_f32 v118, v120, v121
v_mfma_f32_16x16x32_bf16 v[76:79], v[164:167], a[216:219], v[100:103]
v_exp_f32 v126, v54
v_mfma_f32_16x16x32_bf16 v[84:87], v[164:167], a[240:243], v[104:107]
v_exp_f32 v127, v55
v_mfma_f32_16x16x32_bf16 v[92:95], v[164:167], v[136:139], v[108:111]
v_cvt_pk_bf16_f32 v208, v120, v121
v_mfma_f32_16x16x32_bf16 v[64:67], v[168:171], a[196:199], v[64:67]
ds_read_b128 v[164:167], v4 offset:30976
v_add_f32 v118, v118, v122
v_mfma_f32_16x16x32_bf16 v[72:75], v[168:171], a[220:223], v[72:75]
v_exp_f32 v120, v56
v_mfma_f32_16x16x32_bf16 v[80:83], v[168:171], a[244:247], v[80:83]
v_exp_f32 v121, v57
v_mfma_f32_16x16x32_bf16 v[88:91], v[168:171], v[140:143], v[88:91]
v_add_f32 v118, v118, v123
v_mfma_f32_16x16x32_bf16 v[68:71], v[172:175], a[196:199], v[68:71]
ds_read_b128 v[168:171], v5 offset:24832
v_cvt_pk_bf16_f32 v209, v122, v123
v_mfma_f32_16x16x32_bf16 v[76:79], v[172:175], a[220:223], v[76:79]
v_exp_f32 v122, v58
v_mfma_f32_16x16x32_bf16 v[84:87], v[172:175], a[244:247], v[84:87]
v_exp_f32 v123, v59
v_mfma_f32_16x16x32_bf16 v[92:95], v[172:175], v[140:143], v[92:95]
s_waitcnt lgkmcnt(3)
buffer_load_dwordx4 v23, s[20:23], s42 offen offset:1024 lds
v_add_f32 v118, v118, v124
v_mfma_f32_16x16x32_bf16 v[64:67], v[176:179], a[200:203], v[64:67]
ds_read_b128 v[172:175], v5 offset:30976
v_add_f32 v118, v118, v125
v_mfma_f32_16x16x32_bf16 v[72:75], v[176:179], a[224:227], v[72:75]
v_cvt_pk_bf16_f32 v210, v124, v125
v_mfma_f32_16x16x32_bf16 v[80:83], v[176:179], a[248:251], v[80:83]
v_exp_f32 v124, v60
v_mfma_f32_16x16x32_bf16 v[88:91], v[176:179], v[144:147], v[88:91]
v_exp_f32 v125, v61
v_mfma_f32_16x16x32_bf16 v[68:71], v[180:183], a[200:203], v[68:71]
ds_read_b64_tr_b16 v[176:177], v6 offset:12288
v_add_f32 v118, v118, v126
v_mfma_f32_16x16x32_bf16 v[76:79], v[180:183], a[224:227], v[76:79]
ds_read_b64_tr_b16 v[178:179], v6 offset:18432
v_add_f32 v118, v118, v127
v_mfma_f32_16x16x32_bf16 v[84:87], v[180:183], a[248:251], v[84:87]
v_cvt_pk_bf16_f32 v211, v126, v127
v_mfma_f32_16x16x32_bf16 v[92:95], v[180:183], v[144:147], v[92:95]
v_exp_f32 v126, v62
v_mfma_f32_16x16x32_bf16 v[64:67], v[184:187], a[204:207], v[64:67]
ds_read_b64_tr_b16 v[180:181], v7 offset:12288
v_add_f32 v119, v120, v121
v_mfma_f32_16x16x32_bf16 v[72:75], v[184:187], a[228:231], v[72:75]
ds_read_b64_tr_b16 v[182:183], v7 offset:18432
v_cvt_pk_bf16_f32 v212, v120, v121
v_mfma_f32_16x16x32_bf16 v[80:83], v[184:187], a[252:255], v[80:83]
v_exp_f32 v127, v63
v_mfma_f32_16x16x32_bf16 v[88:91], v[184:187], v[148:151], v[88:91]
buffer_load_dwordx4 v24, s[20:23], s42 offen offset:2048 lds
v_add_f32 v119, v119, v122
v_mfma_f32_16x16x32_bf16 v[68:71], v[188:191], a[204:207], v[68:71]
ds_read_b64_tr_b16 v[184:185], v8 offset:12288
v_add_f32 v119, v119, v123
v_mfma_f32_16x16x32_bf16 v[76:79], v[188:191], a[228:231], v[76:79]
ds_read_b64_tr_b16 v[186:187], v8 offset:18432
v_cvt_pk_bf16_f32 v213, v122, v123
v_mfma_f32_16x16x32_bf16 v[84:87], v[188:191], a[252:255], v[84:87]
v_add_f32 v119, v119, v124
v_mfma_f32_16x16x32_bf16 v[92:95], v[188:191], v[148:151], v[92:95]
s_waitcnt lgkmcnt(6)
v_add_f32 v119, v119, v125
v_mfma_f32_16x16x32_bf16 v[64:67], v[160:163], a[208:211], v[64:67]
ds_read_b64_tr_b16 v[188:189], v9 offset:12288
v_cvt_pk_bf16_f32 v214, v124, v125
v_mfma_f32_16x16x32_bf16 v[72:75], v[160:163], a[232:235], v[72:75]
ds_read_b64_tr_b16 v[190:191], v9 offset:18432
v_add_f32 v119, v119, v126
v_mfma_f32_16x16x32_bf16 v[80:83], v[160:163], v[128:131], v[80:83]
v_add_f32 v119, v119, v127
v_mfma_f32_16x16x32_bf16 v[88:91], v[160:163], v[152:155], v[88:91]
v_cvt_pk_bf16_f32 v215, v126, v127
v_mfma_f32_16x16x32_bf16 v[68:71], v[164:167], a[208:211], v[68:71]
ds_read_b64_tr_b16 v[160:161], v6 offset:12416
v_mfma_f32_16x16x32_bf16 v[76:79], v[164:167], a[232:235], v[76:79]
s_add_u32 m0, s47, 24576
ds_read_b64_tr_b16 v[162:163], v6 offset:18560
v_mfma_f32_16x16x32_bf16 v[84:87], v[164:167], v[128:131], v[84:87]
v_mfma_f32_16x16x32_bf16 v[92:95], v[164:167], v[152:155], v[92:95]
buffer_load_dwordx4 v25, s[24:27], s42 offen offset:0 lds
v_mfma_f32_16x16x32_bf16 v[64:67], v[168:171], a[212:215], v[64:67]
ds_read_b64_tr_b16 v[164:165], v7 offset:12416
v_mfma_f32_16x16x32_bf16 v[72:75], v[168:171], a[236:239], v[72:75]
ds_read_b64_tr_b16 v[166:167], v7 offset:18560
v_mfma_f32_16x16x32_bf16 v[80:83], v[168:171], v[132:135], v[80:83]
v_mfma_f32_16x16x32_bf16 v[88:91], v[168:171], v[156:159], v[88:91]
v_max3_f32 v28, v116, v117, v118
v_mfma_f32_16x16x32_bf16 v[68:71], v[172:175], a[212:215], v[68:71]
ds_read_b64_tr_b16 v[168:169], v8 offset:12416
v_max_f32 v28, v28, v119
v_mfma_f32_16x16x32_bf16 v[76:79], v[172:175], a[236:239], v[76:79]
ds_read_b64_tr_b16 v[170:171], v8 offset:18560
v_cmp_lt_f32 vcc, s64, v28
v_mfma_f32_16x16x32_bf16 v[84:87], v[172:175], v[132:135], v[84:87]
v_mfma_f32_16x16x32_bf16 v[92:95], v[172:175], v[156:159], v[92:95]
s_cbranch_vccnz RSTUB4
RBACK4:
s_waitcnt lgkmcnt(6)
v_mfma_f32_16x16x32_bf16 a[0:3], v[176:179], v[200:203], a[0:3]
ds_read_b64_tr_b16 v[172:173], v9 offset:12416
v_add_f32 v3, v3, v116
v_mfma_f32_16x16x32_bf16 a[4:7], v[176:179], v[204:207], a[4:7]
ds_read_b64_tr_b16 v[174:175], v9 offset:18560
v_add_f32 v15, v15, v117
v_mfma_f32_16x16x32_bf16 a[8:11], v[176:179], v[208:211], a[8:11]
v_add_f32 v29, v29, v118
v_mfma_f32_16x16x32_bf16 a[12:15], v[176:179], v[212:215], a[12:15]
buffer_load_dwordx4 v26, s[24:27], s42 offen offset:1024 lds
v_add_f32 v30, v30, v119
v_mfma_f32_16x16x32_bf16 a[16:19], v[180:183], v[200:203], a[16:19]
ds_read_b64_tr_b16 v[176:177], v6 offset:12544
v_mfma_f32_16x16x32_bf16 a[20:23], v[180:183], v[204:207], a[20:23]
ds_read_b64_tr_b16 v[178:179], v6 offset:18688
v_mfma_f32_16x16x32_bf16 a[24:27], v[180:183], v[208:211], a[24:27]
v_exp_f32 v120, v64
v_mfma_f32_16x16x32_bf16 a[28:31], v[180:183], v[212:215], a[28:31]
v_exp_f32 v121, v65
v_mfma_f32_16x16x32_bf16 a[32:35], v[184:187], v[200:203], a[32:35]
ds_read_b64_tr_b16 v[180:181], v7 offset:12544
v_add_f32 v116, v120, v121
v_mfma_f32_16x16x32_bf16 a[36:39], v[184:187], v[204:207], a[36:39]
ds_read_b64_tr_b16 v[182:183], v7 offset:18688
v_cvt_pk_bf16_f32 v216, v120, v121
v_mfma_f32_16x16x32_bf16 a[40:43], v[184:187], v[208:211], a[40:43]
v_exp_f32 v122, v66
v_mfma_f32_16x16x32_bf16 a[44:47], v[184:187], v[212:215], a[44:47]
v_exp_f32 v123, v67
v_mfma_f32_16x16x32_bf16 a[48:51], v[188:191], v[200:203], a[48:51]
ds_read_b64_tr_b16 v[184:185], v8 offset:12544
v_add_f32 v116, v116, v122
v_mfma_f32_16x16x32_bf16 a[52:55], v[188:191], v[204:207], a[52:55]
ds_read_b64_tr_b16 v[186:187], v8 offset:18688
v_add_f32 v116, v116, v123
v_mfma_f32_16x16x32_bf16 a[56:59], v[188:191], v[208:211], a[56:59]
v_exp_f32 v124, v68
v_mfma_f32_16x16x32_bf16 a[60:63], v[188:191], v[212:215], a[60:63]
s_waitcnt lgkmcnt(6)
buffer_load_dwordx4 v27, s[24:27], s42 offen offset:2048 lds
v_cvt_pk_bf16_f32 v217, v122, v123
v_mfma_f32_16x16x32_bf16 a[64:67], v[160:163], v[200:203], a[64:67]
ds_read_b64_tr_b16 v[188:189], v9 offset:12544
v_mfma_f32_16x16x32_bf16 a[68:71], v[160:163], v[204:207], a[68:71]
s_add_u32 s42, s42, 12288
ds_read_b64_tr_b16 v[190:191], v9 offset:18688
v_mfma_f32_16x16x32_bf16 a[72:75], v[160:163], v[208:211], a[72:75]
v_exp_f32 v125, v69
v_mfma_f32_16x16x32_bf16 a[76:79], v[160:163], v[212:215], a[76:79]
v_exp_f32 v126, v70
v_mfma_f32_16x16x32_bf16 a[80:83], v[164:167], v[200:203], a[80:83]
ds_read_b128 v[160:163], v16 offset:0
v_add_f32 v116, v116, v124
v_mfma_f32_16x16x32_bf16 a[84:87], v[164:167], v[204:207], a[84:87]
v_exp_f32 v127, v71
v_mfma_f32_16x16x32_bf16 a[88:91], v[164:167], v[208:211], a[88:91]
v_exp_f32 v120, v72
v_mfma_f32_16x16x32_bf16 a[92:95], v[164:167], v[212:215], a[92:95]
v_exp_f32 v121, v73
v_mfma_f32_16x16x32_bf16 a[96:99], v[168:171], v[200:203], a[96:99]
ds_read_b128 v[164:167], v16 offset:6144
v_add_f32 v116, v116, v125
v_mfma_f32_16x16x32_bf16 a[100:103], v[168:171], v[204:207], a[100:103]
v_exp_f32 v122, v74
v_mfma_f32_16x16x32_bf16 a[104:107], v[168:171], v[208:211], a[104:107]
v_exp_f32 v123, v75
v_mfma_f32_16x16x32_bf16 a[108:111], v[168:171], v[212:215], a[108:111]
v_cvt_pk_bf16_f32 v218, v124, v125
v_mfma_f32_16x16x32_bf16 a[112:115], v[172:175], v[200:203], a[112:115]
ds_read_b128 v[168:171], v17 offset:0
v_add_f32 v116, v116, v126
v_mfma_f32_16x16x32_bf16 a[116:119], v[172:175], v[204:207], a[116:119]
v_exp_f32 v124, v76
v_mfma_f32_16x16x32_bf16 a[120:123], v[172:175], v[208:211], a[120:123]
v_exp_f32 v125, v77
v_mfma_f32_16x16x32_bf16 a[124:127], v[172:175], v[212:215], a[124:127]
s_waitcnt lgkmcnt(3)
v_add_f32 v116, v116, v127
v_mfma_f32_16x16x32_bf16 a[128:131], v[176:179], v[200:203], a[128:131]
ds_read_b128 v[172:175], v17 offset:6144
v_cvt_pk_bf16_f32 v219, v126, v127
v_mfma_f32_16x16x32_bf16 a[132:135], v[176:179], v[204:207], a[132:135]
v_exp_f32 v126, v78
v_mfma_f32_16x16x32_bf16 a[136:139], v[176:179], v[208:211], a[136:139]
v_exp_f32 v127, v79
v_mfma_f32_16x16x32_bf16 a[140:143], v[176:179], v[212:215], a[140:143]
v_add_f32 v117, v120, v121
v_mfma_f32_16x16x32_bf16 a[144:147], v[180:183], v[200:203], a[144:147]
ds_read_b128 v[176:179], v16 offset:128
v_cvt_pk_bf16_f32 v220, v120, v121
v_mfma_f32_16x16x32_bf16 a[148:151], v[180:183], v[204:207], a[148:151]
v_exp_f32 v120, v80
v_mfma_f32_16x16x32_bf16 a[152:155], v[180:183], v[208:211], a[152:155]
v_exp_f32 v121, v81
v_mfma_f32_16x16x32_bf16 a[156:159], v[180:183], v[212:215], a[156:159]
v_add_f32 v117, v117, v122
v_mfma_f32_16x16x32_bf16 a[160:163], v[184:187], v[200:203], a[160:163]
ds_read_b128 v[180:183], v16 offset:6272
v_add_f32 v117, v117, v123
v_mfma_f32_16x16x32_bf16 a[164:167], v[184:187], v[204:207], a[164:167]
v_cvt_pk_bf16_f32 v221, v122, v123
v_mfma_f32_16x16x32_bf16 a[168:171], v[184:187], v[208:211], a[168:171]
v_exp_f32 v122, v82
v_mfma_f32_16x16x32_bf16 a[172:175], v[184:187], v[212:215], a[172:175]
v_exp_f32 v123, v83
v_mfma_f32_16x16x32_bf16 a[176:179], v[188:191], v[200:203], a[176:179]
v_add_f32 v117, v117, v124
v_mfma_f32_16x16x32_bf16 a[180:183], v[188:191], v[204:207], a[180:183]
v_add_f32 v117, v117, v125
v_mfma_f32_16x16x32_bf16 a[184:187], v[188:191], v[208:211], a[184:187]
v_cvt_pk_bf16_f32 v222, v124, v125
v_mfma_f32_16x16x32_bf16 a[188:191], v[188:191], v[212:215], a[188:191]
s_waitcnt lgkmcnt(2)
v_exp_f32 v124, v84
v_mfma_f32_16x16x32_bf16 v[32:35], v[160:163], a[192:195], v[96:99]
ds_read_b128 v[184:187], v17 offset:128
v_add_f32 v117, v117, v126
v_mfma_f32_16x16x32_bf16 v[40:43], v[160:163], a[216:219], v[100:103]
s_add_u32 m0, s46, 49152
ds_read_b128 v[188:191], v17 offset:6272
v_add_f32 v117, v117, v127
v_mfma_f32_16x16x32_bf16 v[48:51], v[160:163], a[240:243], v[104:107]
v_exp_f32 v125, v85
v_mfma_f32_16x16x32_bf16 v[56:59], v[160:163], v[136:139], v[108:111]
buffer_load_dwordx4 v22, s[20:23], s42 offen offset:0 lds
v_cvt_pk_bf16_f32 v223, v126, v127
v_mfma_f32_16x16x32_bf16 v[36:39], v[164:167], a[192:195], v[96:99]
ds_read_b128 v[160:163], v16 offset:256
v_add_f32 v118, v120, v121
v_mfma_f32_16x16x32_bf16 v[44:47], v[164:167], a[216:219], v[100:103]
v_exp_f32 v126, v86
v_mfma_f32_16x16x32_bf16 v[52:55], v[164:167], a[240:243], v[104:107]
v_exp_f32 v127, v87
v_mfma_f32_16x16x32_bf16 v[60:63], v[164:167], v[136:139], v[108:111]
v_cvt_pk_bf16_f32 v224, v120, v121
v_mfma_f32_16x16x32_bf16 v[32:35], v[168:171], a[196:199], v[32:35]
ds_read_b128 v[164:167], v16 offset:6400
v_add_f32 v118, v118, v122
v_mfma_f32_16x16x32_bf16 v[40:43], v[168:171], a[220:223], v[40:43]
v_exp_f32 v120, v88
v_mfma_f32_16x16x32_bf16 v[48:51], v[168:171], a[244:247], v[48:51]
v_exp_f32 v121, v89
v_mfma_f32_16x16x32_bf16 v[56:59], v[168:171], v[140:143], v[56:59]
v_add_f32 v118, v118, v123
v_mfma_f32_16x16x32_bf16 v[36:39], v[172:175], a[196:199], v[36:39]
ds_read_b128 v[168:171], v17 offset:256
v_cvt_pk_bf16_f32 v225, v122, v123
v_mfma_f32_16x16x32_bf16 v[44:47], v[172:175], a[220:223], v[44:47]
v_exp_f32 v122, v90
v_mfma_f32_16x16x32_bf16 v[52:55], v[172:175], a[244:247], v[52:55]
v_exp_f32 v123, v91
v_mfma_f32_16x16x32_bf16 v[60:63], v[172:175], v[140:143], v[60:63]
s_waitcnt lgkmcnt(3)
buffer_load_dwordx4 v23, s[20:23], s42 offen offset:1024 lds
v_add_f32 v118, v118, v124
v_mfma_f32_16x16x32_bf16 v[32:35], v[176:179], a[200:203], v[32:35]
ds_read_b128 v[172:175], v17 offset:6400
v_add_f32 v118, v118, v125
v_mfma_f32_16x16x32_bf16 v[40:43], v[176:179], a[224:227], v[40:43]
v_cvt_pk_bf16_f32 v226, v124, v125
v_mfma_f32_16x16x32_bf16 v[48:51], v[176:179], a[248:251], v[48:51]
v_exp_f32 v124, v92
v_mfma_f32_16x16x32_bf16 v[56:59], v[176:179], v[144:147], v[56:59]
v_exp_f32 v125, v93
v_mfma_f32_16x16x32_bf16 v[36:39], v[180:183], a[200:203], v[36:39]
ds_read_b64_tr_b16 v[176:177], v6 offset:24576
v_add_f32 v118, v118, v126
v_mfma_f32_16x16x32_bf16 v[44:47], v[180:183], a[224:227], v[44:47]
ds_read_b64_tr_b16 v[178:179], v6 offset:30720
v_add_f32 v118, v118, v127
v_mfma_f32_16x16x32_bf16 v[52:55], v[180:183], a[248:251], v[52:55]
v_cvt_pk_bf16_f32 v227, v126, v127
v_mfma_f32_16x16x32_bf16 v[60:63], v[180:183], v[144:147], v[60:63]
v_exp_f32 v126, v94
v_mfma_f32_16x16x32_bf16 v[32:35], v[184:187], a[204:207], v[32:35]
ds_read_b64_tr_b16 v[180:181], v7 offset:24576
v_add_f32 v119, v120, v121
v_mfma_f32_16x16x32_bf16 v[40:43], v[184:187], a[228:231], v[40:43]
ds_read_b64_tr_b16 v[182:183], v7 offset:30720
v_cvt_pk_bf16_f32 v228, v120, v121
v_mfma_f32_16x16x32_bf16 v[48:51], v[184:187], a[252:255], v[48:51]
v_exp_f32 v127, v95
v_mfma_f32_16x16x32_bf16 v[56:59], v[184:187], v[148:151], v[56:59]
buffer_load_dwordx4 v24, s[20:23], s42 offen offset:2048 lds
v_add_f32 v119, v119, v122
v_mfma_f32_16x16x32_bf16 v[36:39], v[188:191], a[204:207], v[36:39]
ds_read_b64_tr_b16 v[184:185], v8 offset:24576
v_add_f32 v119, v119, v123
v_mfma_f32_16x16x32_bf16 v[44:47], v[188:191], a[228:231], v[44:47]
ds_read_b64_tr_b16 v[186:187], v8 offset:30720
v_cvt_pk_bf16_f32 v229, v122, v123
v_mfma_f32_16x16x32_bf16 v[52:55], v[188:191], a[252:255], v[52:55]
v_add_f32 v119, v119, v124
v_mfma_f32_16x16x32_bf16 v[60:63], v[188:191], v[148:151], v[60:63]
s_waitcnt lgkmcnt(6)
v_add_f32 v119, v119, v125
v_mfma_f32_16x16x32_bf16 v[32:35], v[160:163], a[208:211], v[32:35]
ds_read_b64_tr_b16 v[188:189], v9 offset:24576
v_cvt_pk_bf16_f32 v230, v124, v125
v_mfma_f32_16x16x32_bf16 v[40:43], v[160:163], a[232:235], v[40:43]
ds_read_b64_tr_b16 v[190:191], v9 offset:30720
v_add_f32 v119, v119, v126
v_mfma_f32_16x16x32_bf16 v[48:51], v[160:163], v[128:131], v[48:51]
v_add_f32 v119, v119, v127
v_mfma_f32_16x16x32_bf16 v[56:59], v[160:163], v[152:155], v[56:59]
v_cvt_pk_bf16_f32 v231, v126, v127
v_mfma_f32_16x16x32_bf16 v[36:39], v[164:167], a[208:211], v[36:39]
ds_read_b64_tr_b16 v[160:161], v6 offset:24704
v_mfma_f32_16x16x32_bf16 v[44:47], v[164:167], a[232:235], v[44:47]
s_add_u32 m0, s47, 36864
ds_read_b64_tr_b16 v[162:163], v6 offset:30848
v_mfma_f32_16x16x32_bf16 v[52:55], v[164:167], v[128:131], v[52:55]
v_mfma_f32_16x16x32_bf16 v[60:63], v[164:167], v[152:155], v[60:63]
buffer_load_dwordx4 v25, s[24:27], s42 offen offset:0 lds
v_mfma_f32_16x16x32_bf16 v[32:35], v[168:171], a[212:215], v[32:35]
ds_read_b64_tr_b16 v[164:165], v7 offset:24704
v_mfma_f32_16x16x32_bf16 v[40:43], v[168:171], a[236:239], v[40:43]
ds_read_b64_tr_b16 v[166:167], v7 offset:30848
v_mfma_f32_16x16x32_bf16 v[48:51], v[168:171], v[132:135], v[48:51]
v_mfma_f32_16x16x32_bf16 v[56:59], v[168:171], v[156:159], v[56:59]
v_max3_f32 v28, v116, v117, v118
v_mfma_f32_16x16x32_bf16 v[36:39], v[172:175], a[212:215], v[36:39]
ds_read_b64_tr_b16 v[168:169], v8 offset:24704
v_max_f32 v28, v28, v119
v_mfma_f32_16x16x32_bf16 v[44:47], v[172:175], a[236:239], v[44:47]
ds_read_b64_tr_b16 v[170:171], v8 offset:30848
v_cmp_lt_f32 vcc, s64, v28
v_mfma_f32_16x16x32_bf16 v[52:55], v[172:175], v[132:135], v[52:55]
v_mfma_f32_16x16x32_bf16 v[60:63], v[172:175], v[156:159], v[60:63]
s_cbranch_vccnz RSTUB5
RBACK5:
s_waitcnt lgkmcnt(6)
v_mfma_f32_16x16x32_bf16 a[0:3], v[176:179], v[216:219], a[0:3]
ds_read_b64_tr_b16 v[172:173], v9 offset:24704
v_add_f32 v3, v3, v116
v_mfma_f32_16x16x32_bf16 a[4:7], v[176:179], v[220:223], a[4:7]
ds_read_b64_tr_b16 v[174:175], v9 offset:30848
v_add_f32 v15, v15, v117
v_mfma_f32_16x16x32_bf16 a[8:11], v[176:179], v[224:227], a[8:11]
v_add_f32 v29, v29, v118
v_mfma_f32_16x16x32_bf16 a[12:15], v[176:179], v[228:231], a[12:15]
buffer_load_dwordx4 v26, s[24:27], s42 offen offset:1024 lds
v_add_f32 v30, v30, v119
v_mfma_f32_16x16x32_bf16 a[16:19], v[180:183], v[216:219], a[16:19]
ds_read_b64_tr_b16 v[176:177], v6 offset:24832
v_mfma_f32_16x16x32_bf16 a[20:23], v[180:183], v[220:223], a[20:23]
ds_read_b64_tr_b16 v[178:179], v6 offset:30976
v_mfma_f32_16x16x32_bf16 a[24:27], v[180:183], v[224:227], a[24:27]
v_exp_f32 v120, v32
v_mfma_f32_16x16x32_bf16 a[28:31], v[180:183], v[228:231], a[28:31]
v_exp_f32 v121, v33
v_mfma_f32_16x16x32_bf16 a[32:35], v[184:187], v[216:219], a[32:35]
ds_read_b64_tr_b16 v[180:181], v7 offset:24832
v_add_f32 v116, v120, v121
v_mfma_f32_16x16x32_bf16 a[36:39], v[184:187], v[220:223], a[36:39]
ds_read_b64_tr_b16 v[182:183], v7 offset:30976
v_cvt_pk_bf16_f32 v200, v120, v121
v_mfma_f32_16x16x32_bf16 a[40:43], v[184:187], v[224:227], a[40:43]
v_exp_f32 v122, v34
v_mfma_f32_16x16x32_bf16 a[44:47], v[184:187], v[228:231], a[44:47]
v_exp_f32 v123, v35
v_mfma_f32_16x16x32_bf16 a[48:51], v[188:191], v[216:219], a[48:51]
ds_read_b64_tr_b16 v[184:185], v8 offset:24832
v_add_f32 v116, v116, v122
v_mfma_f32_16x16x32_bf16 a[52:55], v[188:191], v[220:223], a[52:55]
ds_read_b64_tr_b16 v[186:187], v8 offset:30976
v_add_f32 v116, v116, v123
v_mfma_f32_16x16x32_bf16 a[56:59], v[188:191], v[224:227], a[56:59]
v_exp_f32 v124, v36
v_mfma_f32_16x16x32_bf16 a[60:63], v[188:191], v[228:231], a[60:63]
s_waitcnt lgkmcnt(6)
buffer_load_dwordx4 v27, s[24:27], s42 offen offset:2048 lds
v_cvt_pk_bf16_f32 v201, v122, v123
v_mfma_f32_16x16x32_bf16 a[64:67], v[160:163], v[216:219], a[64:67]
ds_read_b64_tr_b16 v[188:189], v9 offset:24832
v_mfma_f32_16x16x32_bf16 a[68:71], v[160:163], v[220:223], a[68:71]
s_add_u32 s42, s42, 12288
ds_read_b64_tr_b16 v[190:191], v9 offset:30976
v_mfma_f32_16x16x32_bf16 a[72:75], v[160:163], v[224:227], a[72:75]
v_exp_f32 v125, v37
v_mfma_f32_16x16x32_bf16 a[76:79], v[160:163], v[228:231], a[76:79]
v_exp_f32 v126, v38
v_mfma_f32_16x16x32_bf16 a[80:83], v[164:167], v[216:219], a[80:83]
ds_read_b128 v[160:163], v16 offset:12288
v_add_f32 v116, v116, v124
v_mfma_f32_16x16x32_bf16 a[84:87], v[164:167], v[220:223], a[84:87]
v_exp_f32 v127, v39
v_mfma_f32_16x16x32_bf16 a[88:91], v[164:167], v[224:227], a[88:91]
v_exp_f32 v120, v40
v_mfma_f32_16x16x32_bf16 a[92:95], v[164:167], v[228:231], a[92:95]
v_exp_f32 v121, v41
v_mfma_f32_16x16x32_bf16 a[96:99], v[168:171], v[216:219], a[96:99]
ds_read_b128 v[164:167], v16 offset:18432
v_add_f32 v116, v116, v125
v_mfma_f32_16x16x32_bf16 a[100:103], v[168:171], v[220:223], a[100:103]
v_exp_f32 v122, v42
v_mfma_f32_16x16x32_bf16 a[104:107], v[168:171], v[224:227], a[104:107]
v_exp_f32 v123, v43
v_mfma_f32_16x16x32_bf16 a[108:111], v[168:171], v[228:231], a[108:111]
v_cvt_pk_bf16_f32 v202, v124, v125
v_mfma_f32_16x16x32_bf16 a[112:115], v[172:175], v[216:219], a[112:115]
ds_read_b128 v[168:171], v17 offset:12288
v_add_f32 v116, v116, v126
v_mfma_f32_16x16x32_bf16 a[116:119], v[172:175], v[220:223], a[116:119]
v_exp_f32 v124, v44
v_mfma_f32_16x16x32_bf16 a[120:123], v[172:175], v[224:227], a[120:123]
v_exp_f32 v125, v45
v_mfma_f32_16x16x32_bf16 a[124:127], v[172:175], v[228:231], a[124:127]
s_waitcnt lgkmcnt(3)
v_add_f32 v116, v116, v127
v_mfma_f32_16x16x32_bf16 a[128:131], v[176:179], v[216:219], a[128:131]
ds_read_b128 v[172:175], v17 offset:18432
v_cvt_pk_bf16_f32 v203, v126, v127
v_mfma_f32_16x16x32_bf16 a[132:135], v[176:179], v[220:223], a[132:135]
v_exp_f32 v126, v46
v_mfma_f32_16x16x32_bf16 a[136:139], v[176:179], v[224:227], a[136:139]
v_exp_f32 v127, v47
v_mfma_f32_16x16x32_bf16 a[140:143], v[176:179], v[228:231], a[140:143]
v_add_f32 v117, v120, v121
v_mfma_f32_16x16x32_bf16 a[144:147], v[180:183], v[216:219], a[144:147]
ds_read_b128 v[176:179], v16 offset:12416
v_cvt_pk_bf16_f32 v204, v120, v121
v_mfma_f32_16x16x32_bf16 a[148:151], v[180:183], v[220:223], a[148:151]
v_exp_f32 v120, v48
v_mfma_f32_16x16x32_bf16 a[152:155], v[180:183], v[224:227], a[152:155]
v_exp_f32 v121, v49
v_mfma_f32_16x16x32_bf16 a[156:159], v[180:183], v[228:231], a[156:159]
v_add_f32 v117, v117, v122
v_mfma_f32_16x16x32_bf16 a[160:163], v[184:187], v[216:219], a[160:163]
ds_read_b128 v[180:183], v16 offset:18560
v_add_f32 v117, v117, v123
v_mfma_f32_16x16x32_bf16 a[164:167], v[184:187], v[220:223], a[164:167]
v_cvt_pk_bf16_f32 v205, v122, v123
v_mfma_f32_16x16x32_bf16 a[168:171], v[184:187], v[224:227], a[168:171]
v_exp_f32 v122, v50
v_mfma_f32_16x16x32_bf16 a[172:175], v[184:187], v[228:231], a[172:175]
v_exp_f32 v123, v51
v_mfma_f32_16x16x32_bf16 a[176:179], v[188:191], v[216:219], a[176:179]
v_add_f32 v117, v117, v124
v_mfma_f32_16x16x32_bf16 a[180:183], v[188:191], v[220:223], a[180:183]
v_add_f32 v117, v117, v125
v_mfma_f32_16x16x32_bf16 a[184:187], v[188:191], v[224:227], a[184:187]
v_cvt_pk_bf16_f32 v206, v124, v125
v_mfma_f32_16x16x32_bf16 a[188:191], v[188:191], v[228:231], a[188:191]
v_exp_f32 v124, v52
s_add_u32 s48, s48, 1
s_cmp_lt_u32 s48, 10
s_cbranch_scc1 K1_LOOP
s_waitcnt lgkmcnt(2)
v_mfma_f32_16x16x32_bf16 v[64:67], v[160:163], a[192:195], v[96:99]
s_waitcnt vmcnt(9)
s_barrier
ds_read_b128 v[184:187], v17 offset:12416
v_add_f32 v117, v117, v126
v_mfma_f32_16x16x32_bf16 v[72:75], v[160:163], a[216:219], v[100:103]
ds_read_b128 v[188:191], v17 offset:18560
v_add_f32 v117, v117, v127
v_mfma_f32_16x16x32_bf16 v[80:83], v[160:163], a[240:243], v[104:107]
v_exp_f32 v125, v53
v_mfma_f32_16x16x32_bf16 v[88:91], v[160:163], v[136:139], v[108:111]
v_cvt_pk_bf16_f32 v207, v126, v127
v_mfma_f32_16x16x32_bf16 v[68:71], v[164:167], a[192:195], v[96:99]
ds_read_b128 v[160:163], v16 offset:12544
v_add_f32 v118, v120, v121
v_mfma_f32_16x16x32_bf16 v[76:79], v[164:167], a[216:219], v[100:103]
v_exp_f32 v126, v54
v_mfma_f32_16x16x32_bf16 v[84:87], v[164:167], a[240:243], v[104:107]
v_exp_f32 v127, v55
v_mfma_f32_16x16x32_bf16 v[92:95], v[164:167], v[136:139], v[108:111]
v_cvt_pk_bf16_f32 v208, v120, v121
v_mfma_f32_16x16x32_bf16 v[64:67], v[168:171], a[196:199], v[64:67]
ds_read_b128 v[164:167], v16 offset:18688
v_add_f32 v118, v118, v122
v_mfma_f32_16x16x32_bf16 v[72:75], v[168:171], a[220:223], v[72:75]
v_exp_f32 v120, v56
v_mfma_f32_16x16x32_bf16 v[80:83], v[168:171], a[244:247], v[80:83]
v_exp_f32 v121, v57
v_mfma_f32_16x16x32_bf16 v[88:91], v[168:171], v[140:143], v[88:91]
v_add_f32 v118, v118, v123
v_mfma_f32_16x16x32_bf16 v[68:71], v[172:175], a[196:199], v[68:71]
ds_read_b128 v[168:171], v17 offset:12544
v_cvt_pk_bf16_f32 v209, v122, v123
v_mfma_f32_16x16x32_bf16 v[76:79], v[172:175], a[220:223], v[76:79]
v_exp_f32 v122, v58
v_mfma_f32_16x16x32_bf16 v[84:87], v[172:175], a[244:247], v[84:87]
v_exp_f32 v123, v59
v_mfma_f32_16x16x32_bf16 v[92:95], v[172:175], v[140:143], v[92:95]
s_waitcnt lgkmcnt(3)
v_add_f32 v118, v118, v124
v_mfma_f32_16x16x32_bf16 v[64:67], v[176:179], a[200:203], v[64:67]
ds_read_b128 v[172:175], v17 offset:18688
v_add_f32 v118, v118, v125
v_mfma_f32_16x16x32_bf16 v[72:75], v[176:179], a[224:227], v[72:75]
v_cvt_pk_bf16_f32 v210, v124, v125
v_mfma_f32_16x16x32_bf16 v[80:83], v[176:179], a[248:251], v[80:83]
v_exp_f32 v124, v60
v_mfma_f32_16x16x32_bf16 v[88:91], v[176:179], v[144:147], v[88:91]
v_exp_f32 v125, v61
v_mfma_f32_16x16x32_bf16 v[68:71], v[180:183], a[200:203], v[68:71]
ds_read_b64_tr_b16 v[176:177], v18 offset:0
v_add_f32 v118, v118, v126
v_mfma_f32_16x16x32_bf16 v[76:79], v[180:183], a[224:227], v[76:79]
ds_read_b64_tr_b16 v[178:179], v18 offset:6144
v_add_f32 v118, v118, v127
v_mfma_f32_16x16x32_bf16 v[84:87], v[180:183], a[248:251], v[84:87]
v_cvt_pk_bf16_f32 v211, v126, v127
v_mfma_f32_16x16x32_bf16 v[92:95], v[180:183], v[144:147], v[92:95]
v_exp_f32 v126, v62
v_mfma_f32_16x16x32_bf16 v[64:67], v[184:187], a[204:207], v[64:67]
ds_read_b64_tr_b16 v[180:181], v19 offset:0
v_add_f32 v119, v120, v121
v_mfma_f32_16x16x32_bf16 v[72:75], v[184:187], a[228:231], v[72:75]
ds_read_b64_tr_b16 v[182:183], v19 offset:6144
v_cvt_pk_bf16_f32 v212, v120, v121
v_mfma_f32_16x16x32_bf16 v[80:83], v[184:187], a[252:255], v[80:83]
v_exp_f32 v127, v63
v_mfma_f32_16x16x32_bf16 v[88:91], v[184:187], v[148:151], v[88:91]
v_add_f32 v119, v119, v122
v_mfma_f32_16x16x32_bf16 v[68:71], v[188:191], a[204:207], v[68:71]
ds_read_b64_tr_b16 v[184:185], v20 offset:0
v_add_f32 v119, v119, v123
v_mfma_f32_16x16x32_bf16 v[76:79], v[188:191], a[228:231], v[76:79]
ds_read_b64_tr_b16 v[186:187], v20 offset:6144
v_cvt_pk_bf16_f32 v213, v122, v123
v_mfma_f32_16x16x32_bf16 v[84:87], v[188:191], a[252:255], v[84:87]
v_add_f32 v119, v119, v124
v_mfma_f32_16x16x32_bf16 v[92:95], v[188:191], v[148:151], v[92:95]
s_waitcnt lgkmcnt(6)
v_add_f32 v119, v119, v125
v_mfma_f32_16x16x32_bf16 v[64:67], v[160:163], a[208:211], v[64:67]
ds_read_b64_tr_b16 v[188:189], v21 offset:0
v_cvt_pk_bf16_f32 v214, v124, v125
v_mfma_f32_16x16x32_bf16 v[72:75], v[160:163], a[232:235], v[72:75]
ds_read_b64_tr_b16 v[190:191], v21 offset:6144
v_add_f32 v119, v119, v126
v_mfma_f32_16x16x32_bf16 v[80:83], v[160:163], v[128:131], v[80:83]
v_add_f32 v119, v119, v127
v_mfma_f32_16x16x32_bf16 v[88:91], v[160:163], v[152:155], v[88:91]
v_cvt_pk_bf16_f32 v215, v126, v127
v_mfma_f32_16x16x32_bf16 v[68:71], v[164:167], a[208:211], v[68:71]
ds_read_b64_tr_b16 v[160:161], v18 offset:128
v_mfma_f32_16x16x32_bf16 v[76:79], v[164:167], a[232:235], v[76:79]
ds_read_b64_tr_b16 v[162:163], v18 offset:6272
v_mfma_f32_16x16x32_bf16 v[84:87], v[164:167], v[128:131], v[84:87]
v_mfma_f32_16x16x32_bf16 v[92:95], v[164:167], v[152:155], v[92:95]
v_mfma_f32_16x16x32_bf16 v[64:67], v[168:171], a[212:215], v[64:67]
ds_read_b64_tr_b16 v[164:165], v19 offset:128
v_mfma_f32_16x16x32_bf16 v[72:75], v[168:171], a[236:239], v[72:75]
ds_read_b64_tr_b16 v[166:167], v19 offset:6272
v_mfma_f32_16x16x32_bf16 v[80:83], v[168:171], v[132:135], v[80:83]
v_mfma_f32_16x16x32_bf16 v[88:91], v[168:171], v[156:159], v[88:91]
v_max3_f32 v28, v116, v117, v118
v_mfma_f32_16x16x32_bf16 v[68:71], v[172:175], a[212:215], v[68:71]
ds_read_b64_tr_b16 v[168:169], v20 offset:128
v_max_f32 v28, v28, v119
v_mfma_f32_16x16x32_bf16 v[76:79], v[172:175], a[236:239], v[76:79]
ds_read_b64_tr_b16 v[170:171], v20 offset:6272
v_cmp_lt_f32 vcc, s64, v28
v_mfma_f32_16x16x32_bf16 v[84:87], v[172:175], v[132:135], v[84:87]
v_mfma_f32_16x16x32_bf16 v[92:95], v[172:175], v[156:159], v[92:95]
s_cbranch_vccnz RSTUB6
RBACK6:
s_waitcnt lgkmcnt(6)
v_mfma_f32_16x16x32_bf16 a[0:3], v[176:179], v[200:203], a[0:3]
ds_read_b64_tr_b16 v[172:173], v21 offset:128
v_add_f32 v3, v3, v116
v_mfma_f32_16x16x32_bf16 a[4:7], v[176:179], v[204:207], a[4:7]
ds_read_b64_tr_b16 v[174:175], v21 offset:6272
v_add_f32 v15, v15, v117
v_mfma_f32_16x16x32_bf16 a[8:11], v[176:179], v[208:211], a[8:11]
v_add_f32 v29, v29, v118
v_mfma_f32_16x16x32_bf16 a[12:15], v[176:179], v[212:215], a[12:15]
v_add_f32 v30, v30, v119
v_mfma_f32_16x16x32_bf16 a[16:19], v[180:183], v[200:203], a[16:19]
ds_read_b64_tr_b16 v[176:177], v18 offset:256
v_mfma_f32_16x16x32_bf16 a[20:23], v[180:183], v[204:207], a[20:23]
ds_read_b64_tr_b16 v[178:179], v18 offset:6400
v_mfma_f32_16x16x32_bf16 a[24:27], v[180:183], v[208:211], a[24:27]
v_exp_f32 v120, v64
v_mfma_f32_16x16x32_bf16 a[28:31], v[180:183], v[212:215], a[28:31]
v_exp_f32 v121, v65
v_mfma_f32_16x16x32_bf16 a[32:35], v[184:187], v[200:203], a[32:35]
ds_read_b64_tr_b16 v[180:181], v19 offset:256
v_add_f32 v116, v120, v121
v_mfma_f32_16x16x32_bf16 a[36:39], v[184:187], v[204:207], a[36:39]
ds_read_b64_tr_b16 v[182:183], v19 offset:6400
v_cvt_pk_bf16_f32 v216, v120, v121
v_mfma_f32_16x16x32_bf16 a[40:43], v[184:187], v[208:211], a[40:43]
v_exp_f32 v122, v66
v_mfma_f32_16x16x32_bf16 a[44:47], v[184:187], v[212:215], a[44:47]
v_exp_f32 v123, v67
v_mfma_f32_16x16x32_bf16 a[48:51], v[188:191], v[200:203], a[48:51]
ds_read_b64_tr_b16 v[184:185], v20 offset:256
v_add_f32 v116, v116, v122
v_mfma_f32_16x16x32_bf16 a[52:55], v[188:191], v[204:207], a[52:55]
ds_read_b64_tr_b16 v[186:187], v20 offset:6400
v_add_f32 v116, v116, v123
v_mfma_f32_16x16x32_bf16 a[56:59], v[188:191], v[208:211], a[56:59]
v_exp_f32 v124, v68
v_mfma_f32_16x16x32_bf16 a[60:63], v[188:191], v[212:215], a[60:63]
s_waitcnt lgkmcnt(6)
v_exp_f32 v125, v69
v_mfma_f32_16x16x32_bf16 a[64:67], v[160:163], v[200:203], a[64:67]
ds_read_b64_tr_b16 v[188:189], v21 offset:256
v_cvt_pk_bf16_f32 v217, v122, v123
v_mfma_f32_16x16x32_bf16 a[68:71], v[160:163], v[204:207], a[68:71]
ds_read_b64_tr_b16 v[190:191], v21 offset:6400
v_add_f32 v116, v116, v124
v_mfma_f32_16x16x32_bf16 a[72:75], v[160:163], v[208:211], a[72:75]
v_exp_f32 v126, v70
v_mfma_f32_16x16x32_bf16 a[76:79], v[160:163], v[212:215], a[76:79]
v_exp_f32 v127, v71
v_mfma_f32_16x16x32_bf16 a[80:83], v[164:167], v[200:203], a[80:83]
ds_read_b128 v[160:163], v16 offset:24576
v_add_f32 v116, v116, v125
v_mfma_f32_16x16x32_bf16 a[84:87], v[164:167], v[204:207], a[84:87]
v_exp_f32 v120, v72
v_mfma_f32_16x16x32_bf16 a[88:91], v[164:167], v[208:211], a[88:91]
v_exp_f32 v121, v73
v_mfma_f32_16x16x32_bf16 a[92:95], v[164:167], v[212:215], a[92:95]
v_exp_f32 v122, v74
v_mfma_f32_16x16x32_bf16 a[96:99], v[168:171], v[200:203], a[96:99]
ds_read_b128 v[164:167], v16 offset:30720
v_cvt_pk_bf16_f32 v218, v124, v125
v_mfma_f32_16x16x32_bf16 a[100:103], v[168:171], v[204:207], a[100:103]
v_exp_f32 v123, v75
v_mfma_f32_16x16x32_bf16 a[104:107], v[168:171], v[208:211], a[104:107]
v_exp_f32 v124, v76
v_mfma_f32_16x16x32_bf16 a[108:111], v[168:171], v[212:215], a[108:111]
v_exp_f32 v125, v77
v_mfma_f32_16x16x32_bf16 a[112:115], v[172:175], v[200:203], a[112:115]
ds_read_b128 v[168:171], v17 offset:24576
v_add_f32 v116, v116, v126
v_mfma_f32_16x16x32_bf16 a[116:119], v[172:175], v[204:207], a[116:119]
v_add_f32 v116, v116, v127
v_mfma_f32_16x16x32_bf16 a[120:123], v[172:175], v[208:211], a[120:123]
v_cvt_pk_bf16_f32 v219, v126, v127
v_mfma_f32_16x16x32_bf16 a[124:127], v[172:175], v[212:215], a[124:127]
s_waitcnt lgkmcnt(3)
v_exp_f32 v126, v78
v_mfma_f32_16x16x32_bf16 a[128:131], v[176:179], v[200:203], a[128:131]
ds_read_b128 v[172:175], v17 offset:30720
v_add_f32 v117, v120, v121
v_mfma_f32_16x16x32_bf16 a[132:135], v[176:179], v[204:207], a[132:135]
v_exp_f32 v127, v79
v_mfma_f32_16x16x32_bf16 a[136:139], v[176:179], v[208:211], a[136:139]
v_cvt_pk_bf16_f32 v220, v120, v121
v_mfma_f32_16x16x32_bf16 a[140:143], v[176:179], v[212:215], a[140:143]
v_exp_f32 v120, v80
v_mfma_f32_16x16x32_bf16 a[144:147], v[180:183], v[200:203], a[144:147]
ds_read_b128 v[176:179], v16 offset:24704
v_add_f32 v117, v117, v122
v_mfma_f32_16x16x32_bf16 a[148:151], v[180:183], v[204:207], a[148:151]
v_exp_f32 v121, v81
v_mfma_f32_16x16x32_bf16 a[152:155], v[180:183], v[208:211], a[152:155]
v_add_f32 v117, v117, v123
v_mfma_f32_16x16x32_bf16 a[156:159], v[180:183], v[212:215], a[156:159]
v_cvt_pk_bf16_f32 v221, v122, v123
v_mfma_f32_16x16x32_bf16 a[160:163], v[184:187], v[200:203], a[160:163]
ds_read_b128 v[180:183], v16 offset:30848
v_add_f32 v117, v117, v124
v_mfma_f32_16x16x32_bf16 a[164:167], v[184:187], v[204:207], a[164:167]
v_exp_f32 v122, v82
v_mfma_f32_16x16x32_bf16 a[168:171], v[184:187], v[208:211], a[168:171]
v_exp_f32 v123, v83
v_mfma_f32_16x16x32_bf16 a[172:175], v[184:187], v[212:215], a[172:175]
v_add_f32 v117, v117, v125
v_mfma_f32_16x16x32_bf16 a[176:179], v[188:191], v[200:203], a[176:179]
v_cvt_pk_bf16_f32 v222, v124, v125
v_mfma_f32_16x16x32_bf16 a[180:183], v[188:191], v[204:207], a[180:183]
v_exp_f32 v124, v84
v_mfma_f32_16x16x32_bf16 a[184:187], v[188:191], v[208:211], a[184:187]
v_mfma_f32_16x16x32_bf16 a[188:191], v[188:191], v[212:215], a[188:191]
s_waitcnt lgkmcnt(2)
v_mfma_f32_16x16x32_bf16 v[32:35], v[160:163], a[192:195], v[96:99]
ds_read_b128 v[184:187], v17 offset:24704
v_add_f32 v117, v117, v126
v_mfma_f32_16x16x32_bf16 v[40:43], v[160:163], a[216:219], v[100:103]
ds_read_b128 v[188:191], v17 offset:30848
v_add_f32 v117, v117, v127
v_mfma_f32_16x16x32_bf16 v[48:51], v[160:163], a[240:243], v[104:107]
v_exp_f32 v125, v85
v_mfma_f32_16x16x32_bf16 v[56:59], v[160:163], v[136:139], v[108:111]
v_cvt_pk_bf16_f32 v223, v126, v127
v_mfma_f32_16x16x32_bf16 v[36:39], v[164:167], a[192:195], v[96:99]
ds_read_b128 v[160:163], v16 offset:24832
v_add_f32 v118, v120, v121
v_mfma_f32_16x16x32_bf16 v[44:47], v[164:167], a[216:219], v[100:103]
v_exp_f32 v126, v86
v_mfma_f32_16x16x32_bf16 v[52:55], v[164:167], a[240:243], v[104:107]
v_exp_f32 v127, v87
v_mfma_f32_16x16x32_bf16 v[60:63], v[164:167], v[136:139], v[108:111]
v_cvt_pk_bf16_f32 v224, v120, v121
v_mfma_f32_16x16x32_bf16 v[32:35], v[168:171], a[196:199], v[32:35]
ds_read_b128 v[164:167], v16 offset:30976
v_add_f32 v118, v118, v122
v_mfma_f32_16x16x32_bf16 v[40:43], v[168:171], a[220:223], v[40:43]
v_exp_f32 v120, v88
v_mfma_f32_16x16x32_bf16 v[48:51], v[168:171], a[244:247], v[48:51]
v_exp_f32 v121, v89
v_mfma_f32_16x16x32_bf16 v[56:59], v[168:171], v[140:143], v[56:59]
v_add_f32 v118, v118, v123
v_mfma_f32_16x16x32_bf16 v[36:39], v[172:175], a[196:199], v[36:39]
ds_read_b128 v[168:171], v17 offset:24832
v_cvt_pk_bf16_f32 v225, v122, v123
v_mfma_f32_16x16x32_bf16 v[44:47], v[172:175], a[220:223], v[44:47]
v_exp_f32 v122, v90
v_mfma_f32_16x16x32_bf16 v[52:55], v[172:175], a[244:247], v[52:55]
v_exp_f32 v123, v91
v_mfma_f32_16x16x32_bf16 v[60:63], v[172:175], v[140:143], v[60:63]
s_waitcnt lgkmcnt(3)
v_add_f32 v118, v118, v124
v_mfma_f32_16x16x32_bf16 v[32:35], v[176:179], a[200:203], v[32:35]
ds_read_b128 v[172:175], v17 offset:30976
v_add_f32 v118, v118, v125
v_mfma_f32_16x16x32_bf16 v[40:43], v[176:179], a[224:227], v[40:43]
v_cvt_pk_bf16_f32 v226, v124, v125
v_mfma_f32_16x16x32_bf16 v[48:51], v[176:179], a[248:251], v[48:51]
v_exp_f32 v124, v92
v_mfma_f32_16x16x32_bf16 v[56:59], v[176:179], v[144:147], v[56:59]
v_exp_f32 v125, v93
v_mfma_f32_16x16x32_bf16 v[36:39], v[180:183], a[200:203], v[36:39]
ds_read_b64_tr_b16 v[176:177], v18 offset:12288
v_add_f32 v118, v118, v126
v_mfma_f32_16x16x32_bf16 v[44:47], v[180:183], a[224:227], v[44:47]
ds_read_b64_tr_b16 v[178:179], v18 offset:18432
v_add_f32 v118, v118, v127
v_mfma_f32_16x16x32_bf16 v[52:55], v[180:183], a[248:251], v[52:55]
v_cvt_pk_bf16_f32 v227, v126, v127
v_mfma_f32_16x16x32_bf16 v[60:63], v[180:183], v[144:147], v[60:63]
v_exp_f32 v126, v94
v_mfma_f32_16x16x32_bf16 v[32:35], v[184:187], a[204:207], v[32:35]
ds_read_b64_tr_b16 v[180:181], v19 offset:12288
v_add_f32 v119, v120, v121
v_mfma_f32_16x16x32_bf16 v[40:43], v[184:187], a[228:231], v[40:43]
ds_read_b64_tr_b16 v[182:183], v19 offset:18432
v_cvt_pk_bf16_f32 v228, v120, v121
v_mfma_f32_16x16x32_bf16 v[48:51], v[184:187], a[252:255], v[48:51]
v_exp_f32 v127, v95
v_mfma_f32_16x16x32_bf16 v[56:59], v[184:187], v[148:151], v[56:59]
v_add_f32 v119, v119, v122
v_mfma_f32_16x16x32_bf16 v[36:39], v[188:191], a[204:207], v[36:39]
ds_read_b64_tr_b16 v[184:185], v20 offset:12288
v_add_f32 v119, v119, v123
v_mfma_f32_16x16x32_bf16 v[44:47], v[188:191], a[228:231], v[44:47]
ds_read_b64_tr_b16 v[186:187], v20 offset:18432
v_cvt_pk_bf16_f32 v229, v122, v123
v_mfma_f32_16x16x32_bf16 v[52:55], v[188:191], a[252:255], v[52:55]
v_add_f32 v119, v119, v124
v_mfma_f32_16x16x32_bf16 v[60:63], v[188:191], v[148:151], v[60:63]
s_waitcnt lgkmcnt(6)
v_add_f32 v119, v119, v125
v_mfma_f32_16x16x32_bf16 v[32:35], v[160:163], a[208:211], v[32:35]
ds_read_b64_tr_b16 v[188:189], v21 offset:12288
v_cvt_pk_bf16_f32 v230, v124, v125
v_mfma_f32_16x16x32_bf16 v[40:43], v[160:163], a[232:235], v[40:43]
ds_read_b64_tr_b16 v[190:191], v21 offset:18432
v_add_f32 v119, v119, v126
v_mfma_f32_16x16x32_bf16 v[48:51], v[160:163], v[128:131], v[48:51]
v_add_f32 v119, v119, v127
v_mfma_f32_16x16x32_bf16 v[56:59], v[160:163], v[152:155], v[56:59]
v_cvt_pk_bf16_f32 v231, v126, v127
v_mfma_f32_16x16x32_bf16 v[36:39], v[164:167], a[208:211], v[36:39]
ds_read_b64_tr_b16 v[160:161], v18 offset:12416
v_mfma_f32_16x16x32_bf16 v[44:47], v[164:167], a[232:235], v[44:47]
ds_read_b64_tr_b16 v[162:163], v18 offset:18560
v_mfma_f32_16x16x32_bf16 v[52:55], v[164:167], v[128:131], v[52:55]
v_mfma_f32_16x16x32_bf16 v[60:63], v[164:167], v[152:155], v[60:63]
v_mfma_f32_16x16x32_bf16 v[32:35], v[168:171], a[212:215], v[32:35]
ds_read_b64_tr_b16 v[164:165], v19 offset:12416
v_mfma_f32_16x16x32_bf16 v[40:43], v[168:171], a[236:239], v[40:43]
ds_read_b64_tr_b16 v[166:167], v19 offset:18560
v_mfma_f32_16x16x32_bf16 v[48:51], v[168:171], v[132:135], v[48:51]
v_mfma_f32_16x16x32_bf16 v[56:59], v[168:171], v[156:159], v[56:59]
v_max3_f32 v28, v116, v117, v118
v_mfma_f32_16x16x32_bf16 v[36:39], v[172:175], a[212:215], v[36:39]
ds_read_b64_tr_b16 v[168:169], v20 offset:12416
v_max_f32 v28, v28, v119
v_mfma_f32_16x16x32_bf16 v[44:47], v[172:175], a[236:239], v[44:47]
ds_read_b64_tr_b16 v[170:171], v20 offset:18560
v_cmp_lt_f32 vcc, s64, v28
v_mfma_f32_16x16x32_bf16 v[52:55], v[172:175], v[132:135], v[52:55]
v_mfma_f32_16x16x32_bf16 v[60:63], v[172:175], v[156:159], v[60:63]
s_cbranch_vccnz RSTUB7
RBACK7:
s_waitcnt lgkmcnt(6)
v_mfma_f32_16x16x32_bf16 a[0:3], v[176:179], v[216:219], a[0:3]
ds_read_b64_tr_b16 v[172:173], v21 offset:12416
v_add_f32 v3, v3, v116
v_mfma_f32_16x16x32_bf16 a[4:7], v[176:179], v[220:223], a[4:7]
ds_read_b64_tr_b16 v[174:175], v21 offset:18560
v_add_f32 v15, v15, v117
v_mfma_f32_16x16x32_bf16 a[8:11], v[176:179], v[224:227], a[8:11]
v_add_f32 v29, v29, v118
v_mfma_f32_16x16x32_bf16 a[12:15], v[176:179], v[228:231], a[12:15]
v_add_f32 v30, v30, v119
v_mfma_f32_16x16x32_bf16 a[16:19], v[180:183], v[216:219], a[16:19]
ds_read_b64_tr_b16 v[176:177], v18 offset:12544
v_mfma_f32_16x16x32_bf16 a[20:23], v[180:183], v[220:223], a[20:23]
ds_read_b64_tr_b16 v[178:179], v18 offset:18688
v_mfma_f32_16x16x32_bf16 a[24:27], v[180:183], v[224:227], a[24:27]
v_exp_f32 v120, v32
v_mfma_f32_16x16x32_bf16 a[28:31], v[180:183], v[228:231], a[28:31]
v_exp_f32 v121, v33
v_mfma_f32_16x16x32_bf16 a[32:35], v[184:187], v[216:219], a[32:35]
ds_read_b64_tr_b16 v[180:181], v19 offset:12544
v_add_f32 v116, v120, v121
v_mfma_f32_16x16x32_bf16 a[36:39], v[184:187], v[220:223], a[36:39]
ds_read_b64_tr_b16 v[182:183], v19 offset:18688
v_cvt_pk_bf16_f32 v200, v120, v121
v_mfma_f32_16x16x32_bf16 a[40:43], v[184:187], v[224:227], a[40:43]
v_exp_f32 v122, v34
v_mfma_f32_16x16x32_bf16 a[44:47], v[184:187], v[228:231], a[44:47]
v_exp_f32 v123, v35
v_mfma_f32_16x16x32_bf16 a[48:51], v[188:191], v[216:219], a[48:51]
ds_read_b64_tr_b16 v[184:185], v20 offset:12544
v_add_f32 v116, v116, v122
v_mfma_f32_16x16x32_bf16 a[52:55], v[188:191], v[220:223], a[52:55]
ds_read_b64_tr_b16 v[186:187], v20 offset:18688
v_add_f32 v116, v116, v123
v_mfma_f32_16x16x32_bf16 a[56:59], v[188:191], v[224:227], a[56:59]
v_exp_f32 v124, v36
v_mfma_f32_16x16x32_bf16 a[60:63], v[188:191], v[228:231], a[60:63]
s_waitcnt lgkmcnt(6)
v_exp_f32 v125, v37
v_mfma_f32_16x16x32_bf16 a[64:67], v[160:163], v[216:219], a[64:67]
ds_read_b64_tr_b16 v[188:189], v21 offset:12544
v_cvt_pk_bf16_f32 v201, v122, v123
v_mfma_f32_16x16x32_bf16 a[68:71], v[160:163], v[220:223], a[68:71]
ds_read_b64_tr_b16 v[190:191], v21 offset:18688
v_add_f32 v116, v116, v124
v_mfma_f32_16x16x32_bf16 a[72:75], v[160:163], v[224:227], a[72:75]
v_exp_f32 v126, v38
v_mfma_f32_16x16x32_bf16 a[76:79], v[160:163], v[228:231], a[76:79]
v_exp_f32 v127, v39
v_mfma_f32_16x16x32_bf16 a[80:83], v[164:167], v[216:219], a[80:83]
ds_read_b128 v[160:163], v4 offset:0
v_add_f32 v116, v116, v125
v_mfma_f32_16x16x32_bf16 a[84:87], v[164:167], v[220:223], a[84:87]
v_exp_f32 v120, v40
v_mfma_f32_16x16x32_bf16 a[88:91], v[164:167], v[224:227], a[88:91]
v_exp_f32 v121, v41
v_mfma_f32_16x16x32_bf16 a[92:95], v[164:167], v[228:231], a[92:95]
v_exp_f32 v122, v42
v_mfma_f32_16x16x32_bf16 a[96:99], v[168:171], v[216:219], a[96:99]
ds_read_b128 v[164:167], v4 offset:6144
v_cvt_pk_bf16_f32 v202, v124, v125
v_mfma_f32_16x16x32_bf16 a[100:103], v[168:171], v[220:223], a[100:103]
v_exp_f32 v123, v43
v_mfma_f32_16x16x32_bf16 a[104:107], v[168:171], v[224:227], a[104:107]
v_exp_f32 v124, v44
v_mfma_f32_16x16x32_bf16 a[108:111], v[168:171], v[228:231], a[108:111]
v_exp_f32 v125, v45
v_mfma_f32_16x16x32_bf16 a[112:115], v[172:175], v[216:219], a[112:115]
ds_read_b128 v[168:171], v5 offset:0
v_add_f32 v116, v116, v126
v_mfma_f32_16x16x32_bf16 a[116:119], v[172:175], v[220:223], a[116:119]
v_add_f32 v116, v116, v127
v_mfma_f32_16x16x32_bf16 a[120:123], v[172:175], v[224:227], a[120:123]
v_cvt_pk_bf16_f32 v203, v126, v127
v_mfma_f32_16x16x32_bf16 a[124:127], v[172:175], v[228:231], a[124:127]
s_waitcnt lgkmcnt(3)
v_exp_f32 v126, v46
v_mfma_f32_16x16x32_bf16 a[128:131], v[176:179], v[216:219], a[128:131]
ds_read_b128 v[172:175], v5 offset:6144
v_add_f32 v117, v120, v121
v_mfma_f32_16x16x32_bf16 a[132:135], v[176:179], v[220:223], a[132:135]
v_exp_f32 v127, v47
v_mfma_f32_16x16x32_bf16 a[136:139], v[176:179], v[224:227], a[136:139]
v_cvt_pk_bf16_f32 v204, v120, v121
v_mfma_f32_16x16x32_bf16 a[140:143], v[176:179], v[228:231], a[140:143]
v_exp_f32 v120, v48
v_mfma_f32_16x16x32_bf16 a[144:147], v[180:183], v[216:219], a[144:147]
ds_read_b128 v[176:179], v4 offset:128
v_add_f32 v117, v117, v122
v_mfma_f32_16x16x32_bf16 a[148:151], v[180:183], v[220:223], a[148:151]
v_exp_f32 v121, v49
v_mfma_f32_16x16x32_bf16 a[152:155], v[180:183], v[224:227], a[152:155]
v_add_f32 v117, v117, v123
v_mfma_f32_16x16x32_bf16 a[156:159], v[180:183], v[228:231], a[156:159]
v_cvt_pk_bf16_f32 v205, v122, v123
v_mfma_f32_16x16x32_bf16 a[160:163], v[184:187], v[216:219], a[160:163]
ds_read_b128 v[180:183], v4 offset:6272
v_add_f32 v117, v117, v124
v_mfma_f32_16x16x32_bf16 a[164:167], v[184:187], v[220:223], a[164:167]
v_exp_f32 v122, v50
v_mfma_f32_16x16x32_bf16 a[168:171], v[184:187], v[224:227], a[168:171]
v_exp_f32 v123, v51
v_mfma_f32_16x16x32_bf16 a[172:175], v[184:187], v[228:231], a[172:175]
v_add_f32 v117, v117, v125
v_mfma_f32_16x16x32_bf16 a[176:179], v[188:191], v[216:219], a[176:179]
v_cvt_pk_bf16_f32 v206, v124, v125
v_mfma_f32_16x16x32_bf16 a[180:183], v[188:191], v[220:223], a[180:183]
v_exp_f32 v124, v52
v_mfma_f32_16x16x32_bf16 a[184:187], v[188:191], v[224:227], a[184:187]
v_mfma_f32_16x16x32_bf16 a[188:191], v[188:191], v[228:231], a[188:191]
s_waitcnt lgkmcnt(2)
v_mfma_f32_16x16x32_bf16 v[64:67], v[160:163], a[192:195], v[96:99]
s_waitcnt vmcnt(0)
s_barrier
ds_read_b128 v[184:187], v5 offset:128
v_add_f32 v117, v117, v126
v_mfma_f32_16x16x32_bf16 v[72:75], v[160:163], a[216:219], v[100:103]
ds_read_b128 v[188:191], v5 offset:6272
v_add_f32 v117, v117, v127
v_mfma_f32_16x16x32_bf16 v[80:83], v[160:163], a[240:243], v[104:107]
v_exp_f32 v125, v53
v_mfma_f32_16x16x32_bf16 v[88:91], v[160:163], v[136:139], v[108:111]
v_cvt_pk_bf16_f32 v207, v126, v127
v_mfma_f32_16x16x32_bf16 v[68:71], v[164:167], a[192:195], v[96:99]
ds_read_b128 v[160:163], v4 offset:256
v_add_f32 v118, v120, v121
v_mfma_f32_16x16x32_bf16 v[76:79], v[164:167], a[216:219], v[100:103]
v_exp_f32 v126, v54
v_mfma_f32_16x16x32_bf16 v[84:87], v[164:167], a[240:243], v[104:107]
v_exp_f32 v127, v55
v_mfma_f32_16x16x32_bf16 v[92:95], v[164:167], v[136:139], v[108:111]
v_cvt_pk_bf16_f32 v208, v120, v121
v_mfma_f32_16x16x32_bf16 v[64:67], v[168:171], a[196:199], v[64:67]
ds_read_b128 v[164:167], v4 offset:6400
v_add_f32 v118, v118, v122
v_mfma_f32_16x16x32_bf16 v[72:75], v[168:171], a[220:223], v[72:75]
v_exp_f32 v120, v56
v_mfma_f32_16x16x32_bf16 v[80:83], v[168:171], a[244:247], v[80:83]
v_exp_f32 v121, v57
v_mfma_f32_16x16x32_bf16 v[88:91], v[168:171], v[140:143], v[88:91]
v_add_f32 v118, v118, v123
v_mfma_f32_16x16x32_bf16 v[68:71], v[172:175], a[196:199], v[68:71]
ds_read_b128 v[168:171], v5 offset:256
v_cvt_pk_bf16_f32 v209, v122, v123
v_mfma_f32_16x16x32_bf16 v[76:79], v[172:175], a[220:223], v[76:79]
v_exp_f32 v122, v58
v_mfma_f32_16x16x32_bf16 v[84:87], v[172:175], a[244:247], v[84:87]
v_exp_f32 v123, v59
v_mfma_f32_16x16x32_bf16 v[92:95], v[172:175], v[140:143], v[92:95]
s_waitcnt lgkmcnt(3)
v_add_f32 v118, v118, v124
v_mfma_f32_16x16x32_bf16 v[64:67], v[176:179], a[200:203], v[64:67]
ds_read_b128 v[172:175], v5 offset:6400
v_add_f32 v118, v118, v125
v_mfma_f32_16x16x32_bf16 v[72:75], v[176:179], a[224:227], v[72:75]
v_cvt_pk_bf16_f32 v210, v124, v125
v_mfma_f32_16x16x32_bf16 v[80:83], v[176:179], a[248:251], v[80:83]
v_exp_f32 v124, v60
v_mfma_f32_16x16x32_bf16 v[88:91], v[176:179], v[144:147], v[88:91]
v_exp_f32 v125, v61
v_mfma_f32_16x16x32_bf16 v[68:71], v[180:183], a[200:203], v[68:71]
ds_read_b64_tr_b16 v[176:177], v18 offset:24576
v_add_f32 v118, v118, v126
v_mfma_f32_16x16x32_bf16 v[76:79], v[180:183], a[224:227], v[76:79]
ds_read_b64_tr_b16 v[178:179], v18 offset:30720
v_add_f32 v118, v118, v127
v_mfma_f32_16x16x32_bf16 v[84:87], v[180:183], a[248:251], v[84:87]
v_cvt_pk_bf16_f32 v211, v126, v127
v_mfma_f32_16x16x32_bf16 v[92:95], v[180:183], v[144:147], v[92:95]
v_exp_f32 v126, v62
v_mfma_f32_16x16x32_bf16 v[64:67], v[184:187], a[204:207], v[64:67]
ds_read_b64_tr_b16 v[180:181], v19 offset:24576
v_add_f32 v119, v120, v121
v_mfma_f32_16x16x32_bf16 v[72:75], v[184:187], a[228:231], v[72:75]
ds_read_b64_tr_b16 v[182:183], v19 offset:30720
v_cvt_pk_bf16_f32 v212, v120, v121
v_mfma_f32_16x16x32_bf16 v[80:83], v[184:187], a[252:255], v[80:83]
v_exp_f32 v127, v63
v_mfma_f32_16x16x32_bf16 v[88:91], v[184:187], v[148:151], v[88:91]
v_add_f32 v119, v119, v122
v_mfma_f32_16x16x32_bf16 v[68:71], v[188:191], a[204:207], v[68:71]
ds_read_b64_tr_b16 v[184:185], v20 offset:24576
v_add_f32 v119, v119, v123
v_mfma_f32_16x16x32_bf16 v[76:79], v[188:191], a[228:231], v[76:79]
ds_read_b64_tr_b16 v[186:187], v20 offset:30720
v_cvt_pk_bf16_f32 v213, v122, v123
v_mfma_f32_16x16x32_bf16 v[84:87], v[188:191], a[252:255], v[84:87]
v_add_f32 v119, v119, v124
v_mfma_f32_16x16x32_bf16 v[92:95], v[188:191], v[148:151], v[92:95]
s_waitcnt lgkmcnt(6)
v_add_f32 v119, v119, v125
v_mfma_f32_16x16x32_bf16 v[64:67], v[160:163], a[208:211], v[64:67]
ds_read_b64_tr_b16 v[188:189], v21 offset:24576
v_cvt_pk_bf16_f32 v214, v124, v125
v_mfma_f32_16x16x32_bf16 v[72:75], v[160:163], a[232:235], v[72:75]
ds_read_b64_tr_b16 v[190:191], v21 offset:30720
v_add_f32 v119, v119, v126
v_mfma_f32_16x16x32_bf16 v[80:83], v[160:163], v[128:131], v[80:83]
v_add_f32 v119, v119, v127
v_mfma_f32_16x16x32_bf16 v[88:91], v[160:163], v[152:155], v[88:91]
v_cvt_pk_bf16_f32 v215, v126, v127
v_mfma_f32_16x16x32_bf16 v[68:71], v[164:167], a[208:211], v[68:71]
ds_read_b64_tr_b16 v[160:161], v18 offset:24704
v_mfma_f32_16x16x32_bf16 v[76:79], v[164:167], a[232:235], v[76:79]
ds_read_b64_tr_b16 v[162:163], v18 offset:30848
v_mfma_f32_16x16x32_bf16 v[84:87], v[164:167], v[128:131], v[84:87]
v_mfma_f32_16x16x32_bf16 v[92:95], v[164:167], v[152:155], v[92:95]
v_mfma_f32_16x16x32_bf16 v[64:67], v[168:171], a[212:215], v[64:67]
ds_read_b64_tr_b16 v[164:165], v19 offset:24704
v_mfma_f32_16x16x32_bf16 v[72:75], v[168:171], a[236:239], v[72:75]
ds_read_b64_tr_b16 v[166:167], v19 offset:30848
v_mfma_f32_16x16x32_bf16 v[80:83], v[168:171], v[132:135], v[80:83]
v_mfma_f32_16x16x32_bf16 v[88:91], v[168:171], v[156:159], v[88:91]
v_max3_f32 v28, v116, v117, v118
v_mfma_f32_16x16x32_bf16 v[68:71], v[172:175], a[212:215], v[68:71]
ds_read_b64_tr_b16 v[168:169], v20 offset:24704
v_max_f32 v28, v28, v119
v_mfma_f32_16x16x32_bf16 v[76:79], v[172:175], a[236:239], v[76:79]
ds_read_b64_tr_b16 v[170:171], v20 offset:30848
v_cmp_lt_f32 vcc, s64, v28
v_mfma_f32_16x16x32_bf16 v[84:87], v[172:175], v[132:135], v[84:87]
v_mfma_f32_16x16x32_bf16 v[92:95], v[172:175], v[156:159], v[92:95]
s_cbranch_vccnz RSTUB8
RBACK8:
s_waitcnt lgkmcnt(6)
v_mfma_f32_16x16x32_bf16 a[0:3], v[176:179], v[200:203], a[0:3]
ds_read_b64_tr_b16 v[172:173], v21 offset:24704
v_add_f32 v3, v3, v116
v_mfma_f32_16x16x32_bf16 a[4:7], v[176:179], v[204:207], a[4:7]
ds_read_b64_tr_b16 v[174:175], v21 offset:30848
v_add_f32 v15, v15, v117
v_mfma_f32_16x16x32_bf16 a[8:11], v[176:179], v[208:211], a[8:11]
v_add_f32 v29, v29, v118
v_mfma_f32_16x16x32_bf16 a[12:15], v[176:179], v[212:215], a[12:15]
v_add_f32 v30, v30, v119
v_mfma_f32_16x16x32_bf16 a[16:19], v[180:183], v[200:203], a[16:19]
ds_read_b64_tr_b16 v[176:177], v18 offset:24832
v_mfma_f32_16x16x32_bf16 a[20:23], v[180:183], v[204:207], a[20:23]
ds_read_b64_tr_b16 v[178:179], v18 offset:30976
v_mfma_f32_16x16x32_bf16 a[24:27], v[180:183], v[208:211], a[24:27]
v_exp_f32 v120, v64
v_mfma_f32_16x16x32_bf16 a[28:31], v[180:183], v[212:215], a[28:31]
v_exp_f32 v121, v65
v_mfma_f32_16x16x32_bf16 a[32:35], v[184:187], v[200:203], a[32:35]
ds_read_b64_tr_b16 v[180:181], v19 offset:24832
v_add_f32 v116, v120, v121
v_mfma_f32_16x16x32_bf16 a[36:39], v[184:187], v[204:207], a[36:39]
ds_read_b64_tr_b16 v[182:183], v19 offset:30976
v_cvt_pk_bf16_f32 v216, v120, v121
v_mfma_f32_16x16x32_bf16 a[40:43], v[184:187], v[208:211], a[40:43]
v_exp_f32 v122, v66
v_mfma_f32_16x16x32_bf16 a[44:47], v[184:187], v[212:215], a[44:47]
v_exp_f32 v123, v67
v_mfma_f32_16x16x32_bf16 a[48:51], v[188:191], v[200:203], a[48:51]
ds_read_b64_tr_b16 v[184:185], v20 offset:24832
v_add_f32 v116, v116, v122
v_mfma_f32_16x16x32_bf16 a[52:55], v[188:191], v[204:207], a[52:55]
ds_read_b64_tr_b16 v[186:187], v20 offset:30976
v_add_f32 v116, v116, v123
v_mfma_f32_16x16x32_bf16 a[56:59], v[188:191], v[208:211], a[56:59]
v_exp_f32 v124, v68
v_mfma_f32_16x16x32_bf16 a[60:63], v[188:191], v[212:215], a[60:63]
s_waitcnt lgkmcnt(6)
v_exp_f32 v125, v69
v_mfma_f32_16x16x32_bf16 a[64:67], v[160:163], v[200:203], a[64:67]
ds_read_b64_tr_b16 v[188:189], v21 offset:24832
v_cvt_pk_bf16_f32 v217, v122, v123
v_mfma_f32_16x16x32_bf16 a[68:71], v[160:163], v[204:207], a[68:71]
ds_read_b64_tr_b16 v[190:191], v21 offset:30976
v_add_f32 v116, v116, v124
v_mfma_f32_16x16x32_bf16 a[72:75], v[160:163], v[208:211], a[72:75]
v_exp_f32 v126, v70
v_mfma_f32_16x16x32_bf16 a[76:79], v[160:163], v[212:215], a[76:79]
v_exp_f32 v127, v71
v_mfma_f32_16x16x32_bf16 a[80:83], v[164:167], v[200:203], a[80:83]
v_exp_f32 v120, v72
v_mfma_f32_16x16x32_bf16 a[84:87], v[164:167], v[204:207], a[84:87]
v_exp_f32 v121, v73
v_mfma_f32_16x16x32_bf16 a[88:91], v[164:167], v[208:211], a[88:91]
v_exp_f32 v122, v74
v_mfma_f32_16x16x32_bf16 a[92:95], v[164:167], v[212:215], a[92:95]
v_exp_f32 v123, v75
v_mfma_f32_16x16x32_bf16 a[96:99], v[168:171], v[200:203], a[96:99]
v_add_f32 v116, v116, v125
v_mfma_f32_16x16x32_bf16 a[100:103], v[168:171], v[204:207], a[100:103]
v_cvt_pk_bf16_f32 v218, v124, v125
v_mfma_f32_16x16x32_bf16 a[104:107], v[168:171], v[208:211], a[104:107]
v_exp_f32 v124, v76
v_mfma_f32_16x16x32_bf16 a[108:111], v[168:171], v[212:215], a[108:111]
v_exp_f32 v125, v77
v_mfma_f32_16x16x32_bf16 a[112:115], v[172:175], v[200:203], a[112:115]
v_add_f32 v116, v116, v126
v_mfma_f32_16x16x32_bf16 a[116:119], v[172:175], v[204:207], a[116:119]
v_add_f32 v116, v116, v127
v_mfma_f32_16x16x32_bf16 a[120:123], v[172:175], v[208:211], a[120:123]
v_cvt_pk_bf16_f32 v219, v126, v127
v_mfma_f32_16x16x32_bf16 a[124:127], v[172:175], v[212:215], a[124:127]
s_waitcnt lgkmcnt(0)
v_exp_f32 v126, v78
v_mfma_f32_16x16x32_bf16 a[128:131], v[176:179], v[200:203], a[128:131]
v_exp_f32 v127, v79
v_mfma_f32_16x16x32_bf16 a[132:135], v[176:179], v[204:207], a[132:135]
v_add_f32 v117, v120, v121
v_mfma_f32_16x16x32_bf16 a[136:139], v[176:179], v[208:211], a[136:139]
v_cvt_pk_bf16_f32 v220, v120, v121
v_mfma_f32_16x16x32_bf16 a[140:143], v[176:179], v[212:215], a[140:143]
v_exp_f32 v120, v80
v_mfma_f32_16x16x32_bf16 a[144:147], v[180:183], v[200:203], a[144:147]
v_exp_f32 v121, v81
v_mfma_f32_16x16x32_bf16 a[148:151], v[180:183], v[204:207], a[148:151]
v_add_f32 v117, v117, v122
v_mfma_f32_16x16x32_bf16 a[152:155], v[180:183], v[208:211], a[152:155]
v_add_f32 v117, v117, v123
v_mfma_f32_16x16x32_bf16 a[156:159], v[180:183], v[212:215], a[156:159]
v_cvt_pk_bf16_f32 v221, v122, v123
v_mfma_f32_16x16x32_bf16 a[160:163], v[184:187], v[200:203], a[160:163]
v_exp_f32 v122, v82
v_mfma_f32_16x16x32_bf16 a[164:167], v[184:187], v[204:207], a[164:167]
v_exp_f32 v123, v83
v_mfma_f32_16x16x32_bf16 a[168:171], v[184:187], v[208:211], a[168:171]
v_add_f32 v117, v117, v124
v_mfma_f32_16x16x32_bf16 a[172:175], v[184:187], v[212:215], a[172:175]
v_add_f32 v117, v117, v125
v_mfma_f32_16x16x32_bf16 a[176:179], v[188:191], v[200:203], a[176:179]
v_cvt_pk_bf16_f32 v222, v124, v125
v_mfma_f32_16x16x32_bf16 a[180:183], v[188:191], v[204:207], a[180:183]
v_exp_f32 v124, v84
v_mfma_f32_16x16x32_bf16 a[184:187], v[188:191], v[208:211], a[184:187]
v_mfma_f32_16x16x32_bf16 a[188:191], v[188:191], v[212:215], a[188:191]
v_exp_f32 v125, v85
v_add_f32 v117, v117, v126
v_add_f32 v117, v117, v127
v_cvt_pk_bf16_f32 v223, v126, v127
v_exp_f32 v126, v86
v_exp_f32 v127, v87
v_add_f32 v118, v120, v121
v_cvt_pk_bf16_f32 v224, v120, v121
v_exp_f32 v120, v88
v_exp_f32 v121, v89
v_add_f32 v118, v118, v122
v_add_f32 v118, v118, v123
v_cvt_pk_bf16_f32 v225, v122, v123
v_exp_f32 v122, v90
v_exp_f32 v123, v91
v_add_f32 v118, v118, v124
v_add_f32 v118, v118, v125
v_cvt_pk_bf16_f32 v226, v124, v125
v_exp_f32 v124, v92
v_exp_f32 v125, v93
ds_read_b64_tr_b16 v[176:177], v6 offset:0
v_add_f32 v118, v118, v126
ds_read_b64_tr_b16 v[178:179], v6 offset:6144
v_add_f32 v118, v118, v127
v_cvt_pk_bf16_f32 v227, v126, v127
v_exp_f32 v126, v94
ds_read_b64_tr_b16 v[180:181], v7 offset:0
v_add_f32 v119, v120, v121
ds_read_b64_tr_b16 v[182:183], v7 offset:6144
v_cvt_pk_bf16_f32 v228, v120, v121
v_exp_f32 v127, v95
v_add_f32 v119, v119, v122
ds_read_b64_tr_b16 v[184:185], v8 offset:0
v_add_f32 v119, v119, v123
ds_read_b64_tr_b16 v[186:187], v8 offset:6144
v_cvt_pk_bf16_f32 v229, v122, v123
v_add_f32 v119, v119, v124
v_add_f32 v119, v119, v125
ds_read_b64_tr_b16 v[188:189], v9 offset:0
v_cvt_pk_bf16_f32 v230, v124, v125
ds_read_b64_tr_b16 v[190:191], v9 offset:6144
v_add_f32 v119, v119, v126
v_add_f32 v119, v119, v127
v_cvt_pk_bf16_f32 v231, v126, v127
ds_read_b64_tr_b16 v[160:161], v6 offset:128
ds_read_b64_tr_b16 v[162:163], v6 offset:6272
ds_read_b64_tr_b16 v[164:165], v7 offset:128
ds_read_b64_tr_b16 v[166:167], v7 offset:6272
v_max3_f32 v28, v116, v117, v118
ds_read_b64_tr_b16 v[168:169], v8 offset:128
v_max_f32 v28, v28, v119
ds_read_b64_tr_b16 v[170:171], v8 offset:6272
v_cmp_lt_f32 vcc, s64, v28
s_cbranch_vccnz RSTUB9
RBACK9:
s_waitcnt lgkmcnt(6)
v_mfma_f32_16x16x32_bf16 a[0:3], v[176:179], v[216:219], a[0:3]
ds_read_b64_tr_b16 v[172:173], v9 offset:128
v_add_f32 v3, v3, v116
v_mfma_f32_16x16x32_bf16 a[4:7], v[176:179], v[220:223], a[4:7]
ds_read_b64_tr_b16 v[174:175], v9 offset:6272
v_add_f32 v15, v15, v117
v_mfma_f32_16x16x32_bf16 a[8:11], v[176:179], v[224:227], a[8:11]
v_add_f32 v29, v29, v118
v_mfma_f32_16x16x32_bf16 a[12:15], v[176:179], v[228:231], a[12:15]
v_add_f32 v30, v30, v119
v_mfma_f32_16x16x32_bf16 a[16:19], v[180:183], v[216:219], a[16:19]
ds_read_b64_tr_b16 v[176:177], v6 offset:256
v_mfma_f32_16x16x32_bf16 a[20:23], v[180:183], v[220:223], a[20:23]
ds_read_b64_tr_b16 v[178:179], v6 offset:6400
v_mfma_f32_16x16x32_bf16 a[24:27], v[180:183], v[224:227], a[24:27]
v_mfma_f32_16x16x32_bf16 a[28:31], v[180:183], v[228:231], a[28:31]
v_mfma_f32_16x16x32_bf16 a[32:35], v[184:187], v[216:219], a[32:35]
ds_read_b64_tr_b16 v[180:181], v7 offset:256
v_mfma_f32_16x16x32_bf16 a[36:39], v[184:187], v[220:223], a[36:39]
ds_read_b64_tr_b16 v[182:183], v7 offset:6400
v_mfma_f32_16x16x32_bf16 a[40:43], v[184:187], v[224:227], a[40:43]
v_mfma_f32_16x16x32_bf16 a[44:47], v[184:187], v[228:231], a[44:47]
v_mfma_f32_16x16x32_bf16 a[48:51], v[188:191], v[216:219], a[48:51]
ds_read_b64_tr_b16 v[184:185], v8 offset:256
v_mfma_f32_16x16x32_bf16 a[52:55], v[188:191], v[220:223], a[52:55]
ds_read_b64_tr_b16 v[186:187], v8 offset:6400
v_mfma_f32_16x16x32_bf16 a[56:59], v[188:191], v[224:227], a[56:59]
v_mfma_f32_16x16x32_bf16 a[60:63], v[188:191], v[228:231], a[60:63]
s_waitcnt lgkmcnt(6)
v_mfma_f32_16x16x32_bf16 a[64:67], v[160:163], v[216:219], a[64:67]
ds_read_b64_tr_b16 v[188:189], v9 offset:256
v_mfma_f32_16x16x32_bf16 a[68:71], v[160:163], v[220:223], a[68:71]
ds_read_b64_tr_b16 v[190:191], v9 offset:6400
v_mfma_f32_16x16x32_bf16 a[72:75], v[160:163], v[224:227], a[72:75]
v_mfma_f32_16x16x32_bf16 a[76:79], v[160:163], v[228:231], a[76:79]
v_mfma_f32_16x16x32_bf16 a[80:83], v[164:167], v[216:219], a[80:83]
v_mfma_f32_16x16x32_bf16 a[84:87], v[164:167], v[220:223], a[84:87]
v_mfma_f32_16x16x32_bf16 a[88:91], v[164:167], v[224:227], a[88:91]
v_mfma_f32_16x16x32_bf16 a[92:95], v[164:167], v[228:231], a[92:95]
v_mfma_f32_16x16x32_bf16 a[96:99], v[168:171], v[216:219], a[96:99]
v_mfma_f32_16x16x32_bf16 a[100:103], v[168:171], v[220:223], a[100:103]
v_mfma_f32_16x16x32_bf16 a[104:107], v[168:171], v[224:227], a[104:107]
v_mfma_f32_16x16x32_bf16 a[108:111], v[168:171], v[228:231], a[108:111]
v_mfma_f32_16x16x32_bf16 a[112:115], v[172:175], v[216:219], a[112:115]
v_mfma_f32_16x16x32_bf16 a[116:119], v[172:175], v[220:223], a[116:119]
v_mfma_f32_16x16x32_bf16 a[120:123], v[172:175], v[224:227], a[120:123]
v_mfma_f32_16x16x32_bf16 a[124:127], v[172:175], v[228:231], a[124:127]
s_waitcnt lgkmcnt(0)
v_mfma_f32_16x16x32_bf16 a[128:131], v[176:179], v[216:219], a[128:131]
v_mfma_f32_16x16x32_bf16 a[132:135], v[176:179], v[220:223], a[132:135]
v_mfma_f32_16x16x32_bf16 a[136:139], v[176:179], v[224:227], a[136:139]
v_mfma_f32_16x16x32_bf16 a[140:143], v[176:179], v[228:231], a[140:143]
v_mfma_f32_16x16x32_bf16 a[144:147], v[180:183], v[216:219], a[144:147]
v_mfma_f32_16x16x32_bf16 a[148:151], v[180:183], v[220:223], a[148:151]
v_mfma_f32_16x16x32_bf16 a[152:155], v[180:183], v[224:227], a[152:155]
v_mfma_f32_16x16x32_bf16 a[156:159], v[180:183], v[228:231], a[156:159]
v_mfma_f32_16x16x32_bf16 a[160:163], v[184:187], v[216:219], a[160:163]
v_mfma_f32_16x16x32_bf16 a[164:167], v[184:187], v[220:223], a[164:167]
v_mfma_f32_16x16x32_bf16 a[168:171], v[184:187], v[224:227], a[168:171]
v_mfma_f32_16x16x32_bf16 a[172:175], v[184:187], v[228:231], a[172:175]
v_mfma_f32_16x16x32_bf16 a[176:179], v[188:191], v[216:219], a[176:179]
v_mfma_f32_16x16x32_bf16 a[180:183], v[188:191], v[220:223], a[180:183]
v_mfma_f32_16x16x32_bf16 a[184:187], v[188:191], v[224:227], a[184:187]
v_mfma_f32_16x16x32_bf16 a[188:191], v[188:191], v[228:231], a[188:191]
s_nop 7
v_mov_b32 v116, v3
s_nop 1
v_permlane32_swap_b32 v3, v116
v_add_f32 v3, v3, v116
v_mov_b32 v116, v3
s_nop 1
v_permlane16_swap_b32 v3, v116
v_add_f32 v3, v3, v116
v_rcp_f32 v3, v3
v_mov_b32 v117, v15
s_nop 1
v_permlane32_swap_b32 v15, v117
v_add_f32 v15, v15, v117
v_mov_b32 v117, v15
s_nop 1
v_permlane16_swap_b32 v15, v117
v_add_f32 v15, v15, v117
v_rcp_f32 v15, v15
v_mov_b32 v118, v29
s_nop 1
v_permlane32_swap_b32 v29, v118
v_add_f32 v29, v29, v118
v_mov_b32 v118, v29
s_nop 1
v_permlane16_swap_b32 v29, v118
v_add_f32 v29, v29, v118
v_rcp_f32 v29, v29
v_mov_b32 v119, v30
s_nop 1
v_permlane32_swap_b32 v30, v119
v_add_f32 v30, v30, v119
v_mov_b32 v119, v30
s_nop 1
v_permlane16_swap_b32 v30, v119
v_add_f32 v30, v30, v119
v_rcp_f32 v30, v30
s_mul_i32 s7, s74, 196608
v_lshlrev_b32 v35, 4, v1
v_add_u32 v35, s7, v35
s_mul_i32 s6, s3, 6144
v_accvgpr_read_b32 v64, a0
v_accvgpr_read_b32 v65, a1
v_accvgpr_read_b32 v66, a2
v_accvgpr_read_b32 v67, a3
v_accvgpr_read_b32 v68, a16
v_accvgpr_read_b32 v69, a17
v_accvgpr_read_b32 v70, a18
v_accvgpr_read_b32 v71, a19
v_mul_f32 v64, v64, v3
v_mul_f32 v65, v65, v3
v_mul_f32 v66, v66, v3
v_mul_f32 v67, v67, v3
v_mul_f32 v68, v68, v3
v_mul_f32 v69, v69, v3
v_mul_f32 v70, v70, v3
v_mul_f32 v71, v71, v3
v_cvt_pk_bf16_f32 v96, v64, v65
v_cvt_pk_bf16_f32 v97, v66, v67
v_cvt_pk_bf16_f32 v98, v68, v69
v_cvt_pk_bf16_f32 v99, v70, v71
s_add_u32 s51, s6, 0
buffer_store_dwordx4 v[96:99], v35, s[28:31], s51 offen
v_accvgpr_read_b32 v72, a32
v_accvgpr_read_b32 v73, a33
v_accvgpr_read_b32 v74, a34
v_accvgpr_read_b32 v75, a35
v_accvgpr_read_b32 v76, a48
v_accvgpr_read_b32 v77, a49
v_accvgpr_read_b32 v78, a50
v_accvgpr_read_b32 v79, a51
v_mul_f32 v72, v72, v3
v_mul_f32 v73, v73, v3
v_mul_f32 v74, v74, v3
v_mul_f32 v75, v75, v3
v_mul_f32 v76, v76, v3
v_mul_f32 v77, v77, v3
v_mul_f32 v78, v78, v3
v_mul_f32 v79, v79, v3
v_cvt_pk_bf16_f32 v100, v72, v73
v_cvt_pk_bf16_f32 v101, v74, v75
v_cvt_pk_bf16_f32 v102, v76, v77
v_cvt_pk_bf16_f32 v103, v78, v79
s_add_u32 s51, s6, 1024
buffer_store_dwordx4 v[100:103], v35, s[28:31], s51 offen
v_accvgpr_read_b32 v64, a64
v_accvgpr_read_b32 v65, a65
v_accvgpr_read_b32 v66, a66
v_accvgpr_read_b32 v67, a67
v_accvgpr_read_b32 v68, a80
v_accvgpr_read_b32 v69, a81
v_accvgpr_read_b32 v70, a82
v_accvgpr_read_b32 v71, a83
v_mul_f32 v64, v64, v3
v_mul_f32 v65, v65, v3
v_mul_f32 v66, v66, v3
v_mul_f32 v67, v67, v3
v_mul_f32 v68, v68, v3
v_mul_f32 v69, v69, v3
v_mul_f32 v70, v70, v3
v_mul_f32 v71, v71, v3
v_cvt_pk_bf16_f32 v104, v64, v65
v_cvt_pk_bf16_f32 v105, v66, v67
v_cvt_pk_bf16_f32 v106, v68, v69
v_cvt_pk_bf16_f32 v107, v70, v71
s_add_u32 s51, s6, 2048
buffer_store_dwordx4 v[104:107], v35, s[28:31], s51 offen
v_accvgpr_read_b32 v72, a96
v_accvgpr_read_b32 v73, a97
v_accvgpr_read_b32 v74, a98
v_accvgpr_read_b32 v75, a99
v_accvgpr_read_b32 v76, a112
v_accvgpr_read_b32 v77, a113
v_accvgpr_read_b32 v78, a114
v_accvgpr_read_b32 v79, a115
v_mul_f32 v72, v72, v3
v_mul_f32 v73, v73, v3
v_mul_f32 v74, v74, v3
v_mul_f32 v75, v75, v3
v_mul_f32 v76, v76, v3
v_mul_f32 v77, v77, v3
v_mul_f32 v78, v78, v3
v_mul_f32 v79, v79, v3
v_cvt_pk_bf16_f32 v108, v72, v73
v_cvt_pk_bf16_f32 v109, v74, v75
v_cvt_pk_bf16_f32 v110, v76, v77
v_cvt_pk_bf16_f32 v111, v78, v79
s_add_u32 s51, s6, 3072
buffer_store_dwordx4 v[108:111], v35, s[28:31], s51 offen
v_accvgpr_read_b32 v64, a128
v_accvgpr_read_b32 v65, a129
v_accvgpr_read_b32 v66, a130
v_accvgpr_read_b32 v67, a131
v_accvgpr_read_b32 v68, a144
v_accvgpr_read_b32 v69, a145
v_accvgpr_read_b32 v70, a146
v_accvgpr_read_b32 v71, a147
v_mul_f32 v64, v64, v3
v_mul_f32 v65, v65, v3
v_mul_f32 v66, v66, v3
v_mul_f32 v67, v67, v3
v_mul_f32 v68, v68, v3
v_mul_f32 v69, v69, v3
v_mul_f32 v70, v70, v3
v_mul_f32 v71, v71, v3
v_cvt_pk_bf16_f32 v96, v64, v65
v_cvt_pk_bf16_f32 v97, v66, v67
v_cvt_pk_bf16_f32 v98, v68, v69
v_cvt_pk_bf16_f32 v99, v70, v71
s_add_u32 s51, s6, 4096
buffer_store_dwordx4 v[96:99], v35, s[28:31], s51 offen
v_accvgpr_read_b32 v72, a160
v_accvgpr_read_b32 v73, a161
v_accvgpr_read_b32 v74, a162
v_accvgpr_read_b32 v75, a163
v_accvgpr_read_b32 v76, a176
v_accvgpr_read_b32 v77, a177
v_accvgpr_read_b32 v78, a178
v_accvgpr_read_b32 v79, a179
v_mul_f32 v72, v72, v3
v_mul_f32 v73, v73, v3
v_mul_f32 v74, v74, v3
v_mul_f32 v75, v75, v3
v_mul_f32 v76, v76, v3
v_mul_f32 v77, v77, v3
v_mul_f32 v78, v78, v3
v_mul_f32 v79, v79, v3
v_cvt_pk_bf16_f32 v100, v72, v73
v_cvt_pk_bf16_f32 v101, v74, v75
v_cvt_pk_bf16_f32 v102, v76, v77
v_cvt_pk_bf16_f32 v103, v78, v79
s_add_u32 s51, s6, 5120
buffer_store_dwordx4 v[100:103], v35, s[28:31], s51 offen
v_accvgpr_read_b32 v64, a4
v_accvgpr_read_b32 v65, a5
v_accvgpr_read_b32 v66, a6
v_accvgpr_read_b32 v67, a7
v_accvgpr_read_b32 v68, a20
v_accvgpr_read_b32 v69, a21
v_accvgpr_read_b32 v70, a22
v_accvgpr_read_b32 v71, a23
v_mul_f32 v64, v64, v15
v_mul_f32 v65, v65, v15
v_mul_f32 v66, v66, v15
v_mul_f32 v67, v67, v15
v_mul_f32 v68, v68, v15
v_mul_f32 v69, v69, v15
v_mul_f32 v70, v70, v15
v_mul_f32 v71, v71, v15
v_cvt_pk_bf16_f32 v104, v64, v65
v_cvt_pk_bf16_f32 v105, v66, v67
v_cvt_pk_bf16_f32 v106, v68, v69
v_cvt_pk_bf16_f32 v107, v70, v71
s_add_u32 s51, s6, 196608
buffer_store_dwordx4 v[104:107], v35, s[28:31], s51 offen
v_accvgpr_read_b32 v72, a36
v_accvgpr_read_b32 v73, a37
v_accvgpr_read_b32 v74, a38
v_accvgpr_read_b32 v75, a39
v_accvgpr_read_b32 v76, a52
v_accvgpr_read_b32 v77, a53
v_accvgpr_read_b32 v78, a54
v_accvgpr_read_b32 v79, a55
v_mul_f32 v72, v72, v15
v_mul_f32 v73, v73, v15
v_mul_f32 v74, v74, v15
v_mul_f32 v75, v75, v15
v_mul_f32 v76, v76, v15
v_mul_f32 v77, v77, v15
v_mul_f32 v78, v78, v15
v_mul_f32 v79, v79, v15
v_cvt_pk_bf16_f32 v108, v72, v73
v_cvt_pk_bf16_f32 v109, v74, v75
v_cvt_pk_bf16_f32 v110, v76, v77
v_cvt_pk_bf16_f32 v111, v78, v79
s_add_u32 s51, s6, 197632
buffer_store_dwordx4 v[108:111], v35, s[28:31], s51 offen
v_accvgpr_read_b32 v64, a68
v_accvgpr_read_b32 v65, a69
v_accvgpr_read_b32 v66, a70
v_accvgpr_read_b32 v67, a71
v_accvgpr_read_b32 v68, a84
v_accvgpr_read_b32 v69, a85
v_accvgpr_read_b32 v70, a86
v_accvgpr_read_b32 v71, a87
v_mul_f32 v64, v64, v15
v_mul_f32 v65, v65, v15
v_mul_f32 v66, v66, v15
v_mul_f32 v67, v67, v15
v_mul_f32 v68, v68, v15
v_mul_f32 v69, v69, v15
v_mul_f32 v70, v70, v15
v_mul_f32 v71, v71, v15
v_cvt_pk_bf16_f32 v96, v64, v65
v_cvt_pk_bf16_f32 v97, v66, v67
v_cvt_pk_bf16_f32 v98, v68, v69
v_cvt_pk_bf16_f32 v99, v70, v71
s_add_u32 s51, s6, 198656
buffer_store_dwordx4 v[96:99], v35, s[28:31], s51 offen
v_accvgpr_read_b32 v72, a100
v_accvgpr_read_b32 v73, a101
v_accvgpr_read_b32 v74, a102
v_accvgpr_read_b32 v75, a103
v_accvgpr_read_b32 v76, a116
v_accvgpr_read_b32 v77, a117
v_accvgpr_read_b32 v78, a118
v_accvgpr_read_b32 v79, a119
v_mul_f32 v72, v72, v15
v_mul_f32 v73, v73, v15
v_mul_f32 v74, v74, v15
v_mul_f32 v75, v75, v15
v_mul_f32 v76, v76, v15
v_mul_f32 v77, v77, v15
v_mul_f32 v78, v78, v15
v_mul_f32 v79, v79, v15
v_cvt_pk_bf16_f32 v100, v72, v73
v_cvt_pk_bf16_f32 v101, v74, v75
v_cvt_pk_bf16_f32 v102, v76, v77
v_cvt_pk_bf16_f32 v103, v78, v79
s_add_u32 s51, s6, 199680
buffer_store_dwordx4 v[100:103], v35, s[28:31], s51 offen
v_accvgpr_read_b32 v64, a132
v_accvgpr_read_b32 v65, a133
v_accvgpr_read_b32 v66, a134
v_accvgpr_read_b32 v67, a135
v_accvgpr_read_b32 v68, a148
v_accvgpr_read_b32 v69, a149
v_accvgpr_read_b32 v70, a150
v_accvgpr_read_b32 v71, a151
v_mul_f32 v64, v64, v15
v_mul_f32 v65, v65, v15
v_mul_f32 v66, v66, v15
v_mul_f32 v67, v67, v15
v_mul_f32 v68, v68, v15
v_mul_f32 v69, v69, v15
v_mul_f32 v70, v70, v15
v_mul_f32 v71, v71, v15
v_cvt_pk_bf16_f32 v104, v64, v65
v_cvt_pk_bf16_f32 v105, v66, v67
v_cvt_pk_bf16_f32 v106, v68, v69
v_cvt_pk_bf16_f32 v107, v70, v71
s_add_u32 s51, s6, 200704
buffer_store_dwordx4 v[104:107], v35, s[28:31], s51 offen
v_accvgpr_read_b32 v72, a164
v_accvgpr_read_b32 v73, a165
v_accvgpr_read_b32 v74, a166
v_accvgpr_read_b32 v75, a167
v_accvgpr_read_b32 v76, a180
v_accvgpr_read_b32 v77, a181
v_accvgpr_read_b32 v78, a182
v_accvgpr_read_b32 v79, a183
v_mul_f32 v72, v72, v15
v_mul_f32 v73, v73, v15
v_mul_f32 v74, v74, v15
v_mul_f32 v75, v75, v15
v_mul_f32 v76, v76, v15
v_mul_f32 v77, v77, v15
v_mul_f32 v78, v78, v15
v_mul_f32 v79, v79, v15
v_cvt_pk_bf16_f32 v108, v72, v73
v_cvt_pk_bf16_f32 v109, v74, v75
v_cvt_pk_bf16_f32 v110, v76, v77
v_cvt_pk_bf16_f32 v111, v78, v79
s_add_u32 s51, s6, 201728
buffer_store_dwordx4 v[108:111], v35, s[28:31], s51 offen
v_accvgpr_read_b32 v64, a8
v_accvgpr_read_b32 v65, a9
v_accvgpr_read_b32 v66, a10
v_accvgpr_read_b32 v67, a11
v_accvgpr_read_b32 v68, a24
v_accvgpr_read_b32 v69, a25
v_accvgpr_read_b32 v70, a26
v_accvgpr_read_b32 v71, a27
v_mul_f32 v64, v64, v29
v_mul_f32 v65, v65, v29
v_mul_f32 v66, v66, v29
v_mul_f32 v67, v67, v29
v_mul_f32 v68, v68, v29
v_mul_f32 v69, v69, v29
v_mul_f32 v70, v70, v29
v_mul_f32 v71, v71, v29
v_cvt_pk_bf16_f32 v96, v64, v65
v_cvt_pk_bf16_f32 v97, v66, v67
v_cvt_pk_bf16_f32 v98, v68, v69
v_cvt_pk_bf16_f32 v99, v70, v71
s_add_u32 s51, s6, 393216
buffer_store_dwordx4 v[96:99], v35, s[28:31], s51 offen
v_accvgpr_read_b32 v72, a40
v_accvgpr_read_b32 v73, a41
v_accvgpr_read_b32 v74, a42
v_accvgpr_read_b32 v75, a43
v_accvgpr_read_b32 v76, a56
v_accvgpr_read_b32 v77, a57
v_accvgpr_read_b32 v78, a58
v_accvgpr_read_b32 v79, a59
v_mul_f32 v72, v72, v29
v_mul_f32 v73, v73, v29
v_mul_f32 v74, v74, v29
v_mul_f32 v75, v75, v29
v_mul_f32 v76, v76, v29
v_mul_f32 v77, v77, v29
v_mul_f32 v78, v78, v29
v_mul_f32 v79, v79, v29
v_cvt_pk_bf16_f32 v100, v72, v73
v_cvt_pk_bf16_f32 v101, v74, v75
v_cvt_pk_bf16_f32 v102, v76, v77
v_cvt_pk_bf16_f32 v103, v78, v79
s_add_u32 s51, s6, 394240
buffer_store_dwordx4 v[100:103], v35, s[28:31], s51 offen
v_accvgpr_read_b32 v64, a72
v_accvgpr_read_b32 v65, a73
v_accvgpr_read_b32 v66, a74
v_accvgpr_read_b32 v67, a75
v_accvgpr_read_b32 v68, a88
v_accvgpr_read_b32 v69, a89
v_accvgpr_read_b32 v70, a90
v_accvgpr_read_b32 v71, a91
v_mul_f32 v64, v64, v29
v_mul_f32 v65, v65, v29
v_mul_f32 v66, v66, v29
v_mul_f32 v67, v67, v29
v_mul_f32 v68, v68, v29
v_mul_f32 v69, v69, v29
v_mul_f32 v70, v70, v29
v_mul_f32 v71, v71, v29
v_cvt_pk_bf16_f32 v104, v64, v65
v_cvt_pk_bf16_f32 v105, v66, v67
v_cvt_pk_bf16_f32 v106, v68, v69
v_cvt_pk_bf16_f32 v107, v70, v71
s_add_u32 s51, s6, 395264
buffer_store_dwordx4 v[104:107], v35, s[28:31], s51 offen
v_accvgpr_read_b32 v72, a104
v_accvgpr_read_b32 v73, a105
v_accvgpr_read_b32 v74, a106
v_accvgpr_read_b32 v75, a107
v_accvgpr_read_b32 v76, a120
v_accvgpr_read_b32 v77, a121
v_accvgpr_read_b32 v78, a122
v_accvgpr_read_b32 v79, a123
v_mul_f32 v72, v72, v29
v_mul_f32 v73, v73, v29
v_mul_f32 v74, v74, v29
v_mul_f32 v75, v75, v29
v_mul_f32 v76, v76, v29
v_mul_f32 v77, v77, v29
v_mul_f32 v78, v78, v29
v_mul_f32 v79, v79, v29
v_cvt_pk_bf16_f32 v108, v72, v73
v_cvt_pk_bf16_f32 v109, v74, v75
v_cvt_pk_bf16_f32 v110, v76, v77
v_cvt_pk_bf16_f32 v111, v78, v79
s_add_u32 s51, s6, 396288
buffer_store_dwordx4 v[108:111], v35, s[28:31], s51 offen
v_accvgpr_read_b32 v64, a136
v_accvgpr_read_b32 v65, a137
v_accvgpr_read_b32 v66, a138
v_accvgpr_read_b32 v67, a139
v_accvgpr_read_b32 v68, a152
v_accvgpr_read_b32 v69, a153
v_accvgpr_read_b32 v70, a154
v_accvgpr_read_b32 v71, a155
v_mul_f32 v64, v64, v29
v_mul_f32 v65, v65, v29
v_mul_f32 v66, v66, v29
v_mul_f32 v67, v67, v29
v_mul_f32 v68, v68, v29
v_mul_f32 v69, v69, v29
v_mul_f32 v70, v70, v29
v_mul_f32 v71, v71, v29
v_cvt_pk_bf16_f32 v96, v64, v65
v_cvt_pk_bf16_f32 v97, v66, v67
v_cvt_pk_bf16_f32 v98, v68, v69
v_cvt_pk_bf16_f32 v99, v70, v71
s_add_u32 s51, s6, 397312
buffer_store_dwordx4 v[96:99], v35, s[28:31], s51 offen
v_accvgpr_read_b32 v72, a168
v_accvgpr_read_b32 v73, a169
v_accvgpr_read_b32 v74, a170
v_accvgpr_read_b32 v75, a171
v_accvgpr_read_b32 v76, a184
v_accvgpr_read_b32 v77, a185
v_accvgpr_read_b32 v78, a186
v_accvgpr_read_b32 v79, a187
v_mul_f32 v72, v72, v29
v_mul_f32 v73, v73, v29
v_mul_f32 v74, v74, v29
v_mul_f32 v75, v75, v29
v_mul_f32 v76, v76, v29
v_mul_f32 v77, v77, v29
v_mul_f32 v78, v78, v29
v_mul_f32 v79, v79, v29
v_cvt_pk_bf16_f32 v100, v72, v73
v_cvt_pk_bf16_f32 v101, v74, v75
v_cvt_pk_bf16_f32 v102, v76, v77
v_cvt_pk_bf16_f32 v103, v78, v79
s_add_u32 s51, s6, 398336
buffer_store_dwordx4 v[100:103], v35, s[28:31], s51 offen
v_accvgpr_read_b32 v64, a12
v_accvgpr_read_b32 v65, a13
v_accvgpr_read_b32 v66, a14
v_accvgpr_read_b32 v67, a15
v_accvgpr_read_b32 v68, a28
v_accvgpr_read_b32 v69, a29
v_accvgpr_read_b32 v70, a30
v_accvgpr_read_b32 v71, a31
v_mul_f32 v64, v64, v30
v_mul_f32 v65, v65, v30
v_mul_f32 v66, v66, v30
v_mul_f32 v67, v67, v30
v_mul_f32 v68, v68, v30
v_mul_f32 v69, v69, v30
v_mul_f32 v70, v70, v30
v_mul_f32 v71, v71, v30
v_cvt_pk_bf16_f32 v104, v64, v65
v_cvt_pk_bf16_f32 v105, v66, v67
v_cvt_pk_bf16_f32 v106, v68, v69
v_cvt_pk_bf16_f32 v107, v70, v71
s_add_u32 s51, s6, 589824
buffer_store_dwordx4 v[104:107], v35, s[28:31], s51 offen
v_accvgpr_read_b32 v72, a44
v_accvgpr_read_b32 v73, a45
v_accvgpr_read_b32 v74, a46
v_accvgpr_read_b32 v75, a47
v_accvgpr_read_b32 v76, a60
v_accvgpr_read_b32 v77, a61
v_accvgpr_read_b32 v78, a62
v_accvgpr_read_b32 v79, a63
v_mul_f32 v72, v72, v30
v_mul_f32 v73, v73, v30
v_mul_f32 v74, v74, v30
v_mul_f32 v75, v75, v30
v_mul_f32 v76, v76, v30
v_mul_f32 v77, v77, v30
v_mul_f32 v78, v78, v30
v_mul_f32 v79, v79, v30
v_cvt_pk_bf16_f32 v108, v72, v73
v_cvt_pk_bf16_f32 v109, v74, v75
v_cvt_pk_bf16_f32 v110, v76, v77
v_cvt_pk_bf16_f32 v111, v78, v79
s_add_u32 s51, s6, 590848
buffer_store_dwordx4 v[108:111], v35, s[28:31], s51 offen
v_accvgpr_read_b32 v64, a76
v_accvgpr_read_b32 v65, a77
v_accvgpr_read_b32 v66, a78
v_accvgpr_read_b32 v67, a79
v_accvgpr_read_b32 v68, a92
v_accvgpr_read_b32 v69, a93
v_accvgpr_read_b32 v70, a94
v_accvgpr_read_b32 v71, a95
v_mul_f32 v64, v64, v30
v_mul_f32 v65, v65, v30
v_mul_f32 v66, v66, v30
v_mul_f32 v67, v67, v30
v_mul_f32 v68, v68, v30
v_mul_f32 v69, v69, v30
v_mul_f32 v70, v70, v30
v_mul_f32 v71, v71, v30
v_cvt_pk_bf16_f32 v96, v64, v65
v_cvt_pk_bf16_f32 v97, v66, v67
v_cvt_pk_bf16_f32 v98, v68, v69
v_cvt_pk_bf16_f32 v99, v70, v71
s_add_u32 s51, s6, 591872
buffer_store_dwordx4 v[96:99], v35, s[28:31], s51 offen
v_accvgpr_read_b32 v72, a108
v_accvgpr_read_b32 v73, a109
v_accvgpr_read_b32 v74, a110
v_accvgpr_read_b32 v75, a111
v_accvgpr_read_b32 v76, a124
v_accvgpr_read_b32 v77, a125
v_accvgpr_read_b32 v78, a126
v_accvgpr_read_b32 v79, a127
v_mul_f32 v72, v72, v30
v_mul_f32 v73, v73, v30
v_mul_f32 v74, v74, v30
v_mul_f32 v75, v75, v30
v_mul_f32 v76, v76, v30
v_mul_f32 v77, v77, v30
v_mul_f32 v78, v78, v30
v_mul_f32 v79, v79, v30
v_cvt_pk_bf16_f32 v100, v72, v73
v_cvt_pk_bf16_f32 v101, v74, v75
v_cvt_pk_bf16_f32 v102, v76, v77
v_cvt_pk_bf16_f32 v103, v78, v79
s_add_u32 s51, s6, 592896
buffer_store_dwordx4 v[100:103], v35, s[28:31], s51 offen
v_accvgpr_read_b32 v64, a140
v_accvgpr_read_b32 v65, a141
v_accvgpr_read_b32 v66, a142
v_accvgpr_read_b32 v67, a143
v_accvgpr_read_b32 v68, a156
v_accvgpr_read_b32 v69, a157
v_accvgpr_read_b32 v70, a158
v_accvgpr_read_b32 v71, a159
v_mul_f32 v64, v64, v30
v_mul_f32 v65, v65, v30
v_mul_f32 v66, v66, v30
v_mul_f32 v67, v67, v30
v_mul_f32 v68, v68, v30
v_mul_f32 v69, v69, v30
v_mul_f32 v70, v70, v30
v_mul_f32 v71, v71, v30
v_cvt_pk_bf16_f32 v104, v64, v65
v_cvt_pk_bf16_f32 v105, v66, v67
v_cvt_pk_bf16_f32 v106, v68, v69
v_cvt_pk_bf16_f32 v107, v70, v71
s_add_u32 s51, s6, 593920
buffer_store_dwordx4 v[104:107], v35, s[28:31], s51 offen
v_accvgpr_read_b32 v72, a172
v_accvgpr_read_b32 v73, a173
v_accvgpr_read_b32 v74, a174
v_accvgpr_read_b32 v75, a175
v_accvgpr_read_b32 v76, a188
v_accvgpr_read_b32 v77, a189
v_accvgpr_read_b32 v78, a190
v_accvgpr_read_b32 v79, a191
v_mul_f32 v72, v72, v30
v_mul_f32 v73, v73, v30
v_mul_f32 v74, v74, v30
v_mul_f32 v75, v75, v30
v_mul_f32 v76, v76, v30
v_mul_f32 v77, v77, v30
v_mul_f32 v78, v78, v30
v_mul_f32 v79, v79, v30
v_cvt_pk_bf16_f32 v108, v72, v73
v_cvt_pk_bf16_f32 v109, v74, v75
v_cvt_pk_bf16_f32 v110, v76, v77
v_cvt_pk_bf16_f32 v111, v78, v79
s_add_u32 s51, s6, 594944
buffer_store_dwordx4 v[108:111], v35, s[28:31], s51 offen
s_waitcnt vmcnt(0)
s_endpgm
RSTUB0:
s_mov_b32 s50, 0
s_branch RARE0
RSTUB1:
s_mov_b32 s50, 1
s_branch RARE1
RSTUB2:
s_mov_b32 s50, 2
s_branch RARE0
RSTUB3:
s_mov_b32 s50, 3
s_branch RARE1
RSTUB4:
s_mov_b32 s50, 4
s_branch RARE0
RSTUB5:
s_mov_b32 s50, 5
s_branch RARE1
RSTUB6:
s_mov_b32 s50, 6
s_branch RARE0
RSTUB7:
s_mov_b32 s50, 7
s_branch RARE1
RSTUB8:
s_mov_b32 s50, 8
s_branch RARE0
RSTUB9:
s_mov_b32 s50, 9
s_branch RARE1
RARE0:
s_nop 15
v_max3_f32 v232, v32, v33, v34
v_max3_f32 v232, v232, v35, v36
v_max3_f32 v232, v232, v37, v38
v_max_f32 v232, v232, v39
v_mov_b32 v233, v232
s_nop 1
v_permlane32_swap_b32 v232, v233
v_max_f32 v232, v232, v233
v_mov_b32 v233, v232
s_nop 1
v_permlane16_swap_b32 v232, v233
v_max_f32 v232, v232, v233
v_max_f32 v232, s66, v232
v_min_f32_e64 v233, -v232, 0
v_exp_f32 v112, v233
v_sub_f32 v32, v32, v232
v_sub_f32 v33, v33, v232
v_sub_f32 v34, v34, v232
v_sub_f32 v35, v35, v232
v_sub_f32 v36, v36, v232
v_sub_f32 v37, v37, v232
v_sub_f32 v38, v38, v232
v_sub_f32 v39, v39, v232
v_sub_f32 v64, v64, v232
v_sub_f32 v65, v65, v232
v_sub_f32 v66, v66, v232
v_sub_f32 v67, v67, v232
v_sub_f32 v68, v68, v232
v_sub_f32 v69, v69, v232
v_sub_f32 v70, v70, v232
v_sub_f32 v71, v71, v232
v_sub_f32 v96, v96, v232
v_sub_f32 v97, v97, v232
v_sub_f32 v98, v98, v232
v_sub_f32 v99, v99, v232
v_exp_f32 v234, v32
v_exp_f32 v235, v33
v_exp_f32 v236, v34
v_exp_f32 v237, v35
v_exp_f32 v238, v36
v_exp_f32 v239, v37
v_exp_f32 v240, v38
v_exp_f32 v241, v39
v_mul_f32 v3, v3, v112
v_add_f32 v116, v234, v235
v_add_f32 v116, v116, v236
v_add_f32 v116, v116, v237
v_add_f32 v116, v116, v238
v_add_f32 v116, v116, v239
v_add_f32 v116, v116, v240
v_add_f32 v116, v116, v241
v_cvt_pk_bf16_f32 v200, v234, v235
v_cvt_pk_bf16_f32 v201, v236, v237
v_cvt_pk_bf16_f32 v202, v238, v239
v_cvt_pk_bf16_f32 v203, v240, v241
v_accvgpr_read_b32 v242, a0
v_accvgpr_read_b32 v243, a1
v_accvgpr_read_b32 v244, a2
v_accvgpr_read_b32 v245, a3
v_mul_f32 v242, v242, v112
v_mul_f32 v243, v243, v112
v_mul_f32 v244, v244, v112
v_mul_f32 v245, v245, v112
v_accvgpr_write_b32 a0, v242
v_accvgpr_write_b32 a1, v243
v_accvgpr_write_b32 a2, v244
v_accvgpr_write_b32 a3, v245
v_accvgpr_read_b32 v246, a16
v_accvgpr_read_b32 v247, a17
v_accvgpr_read_b32 v248, a18
v_accvgpr_read_b32 v249, a19
v_mul_f32 v246, v246, v112
v_mul_f32 v247, v247, v112
v_mul_f32 v248, v248, v112
v_mul_f32 v249, v249, v112
v_accvgpr_write_b32 a16, v246
v_accvgpr_write_b32 a17, v247
v_accvgpr_write_b32 a18, v248
v_accvgpr_write_b32 a19, v249
v_accvgpr_read_b32 v242, a32
v_accvgpr_read_b32 v243, a33
v_accvgpr_read_b32 v244, a34
v_accvgpr_read_b32 v245, a35
v_mul_f32 v242, v242, v112
v_mul_f32 v243, v243, v112
v_mul_f32 v244, v244, v112
v_mul_f32 v245, v245, v112
v_accvgpr_write_b32 a32, v242
v_accvgpr_write_b32 a33, v243
v_accvgpr_write_b32 a34, v244
v_accvgpr_write_b32 a35, v245
v_accvgpr_read_b32 v246, a48
v_accvgpr_read_b32 v247, a49
v_accvgpr_read_b32 v248, a50
v_accvgpr_read_b32 v249, a51
v_mul_f32 v246, v246, v112
v_mul_f32 v247, v247, v112
v_mul_f32 v248, v248, v112
v_mul_f32 v249, v249, v112
v_accvgpr_write_b32 a48, v246
v_accvgpr_write_b32 a49, v247
v_accvgpr_write_b32 a50, v248
v_accvgpr_write_b32 a51, v249
v_accvgpr_read_b32 v242, a64
v_accvgpr_read_b32 v243, a65
v_accvgpr_read_b32 v244, a66
v_accvgpr_read_b32 v245, a67
v_mul_f32 v242, v242, v112
v_mul_f32 v243, v243, v112
v_mul_f32 v244, v244, v112
v_mul_f32 v245, v245, v112
v_accvgpr_write_b32 a64, v242
v_accvgpr_write_b32 a65, v243
v_accvgpr_write_b32 a66, v244
v_accvgpr_write_b32 a67, v245
v_accvgpr_read_b32 v246, a80
v_accvgpr_read_b32 v247, a81
v_accvgpr_read_b32 v248, a82
v_accvgpr_read_b32 v249, a83
v_mul_f32 v246, v246, v112
v_mul_f32 v247, v247, v112
v_mul_f32 v248, v248, v112
v_mul_f32 v249, v249, v112
v_accvgpr_write_b32 a80, v246
v_accvgpr_write_b32 a81, v247
v_accvgpr_write_b32 a82, v248
v_accvgpr_write_b32 a83, v249
v_accvgpr_read_b32 v242, a96
v_accvgpr_read_b32 v243, a97
v_accvgpr_read_b32 v244, a98
v_accvgpr_read_b32 v245, a99
v_mul_f32 v242, v242, v112
v_mul_f32 v243, v243, v112
v_mul_f32 v244, v244, v112
v_mul_f32 v245, v245, v112
v_accvgpr_write_b32 a96, v242
v_accvgpr_write_b32 a97, v243
v_accvgpr_write_b32 a98, v244
v_accvgpr_write_b32 a99, v245
v_accvgpr_read_b32 v246, a112
v_accvgpr_read_b32 v247, a113
v_accvgpr_read_b32 v248, a114
v_accvgpr_read_b32 v249, a115
v_mul_f32 v246, v246, v112
v_mul_f32 v247, v247, v112
v_mul_f32 v248, v248, v112
v_mul_f32 v249, v249, v112
v_accvgpr_write_b32 a112, v246
v_accvgpr_write_b32 a113, v247
v_accvgpr_write_b32 a114, v248
v_accvgpr_write_b32 a115, v249
v_accvgpr_read_b32 v242, a128
v_accvgpr_read_b32 v243, a129
v_accvgpr_read_b32 v244, a130
v_accvgpr_read_b32 v245, a131
v_mul_f32 v242, v242, v112
v_mul_f32 v243, v243, v112
v_mul_f32 v244, v244, v112
v_mul_f32 v245, v245, v112
v_accvgpr_write_b32 a128, v242
v_accvgpr_write_b32 a129, v243
v_accvgpr_write_b32 a130, v244
v_accvgpr_write_b32 a131, v245
v_accvgpr_read_b32 v246, a144
v_accvgpr_read_b32 v247, a145
v_accvgpr_read_b32 v248, a146
v_accvgpr_read_b32 v249, a147
v_mul_f32 v246, v246, v112
v_mul_f32 v247, v247, v112
v_mul_f32 v248, v248, v112
v_mul_f32 v249, v249, v112
v_accvgpr_write_b32 a144, v246
v_accvgpr_write_b32 a145, v247
v_accvgpr_write_b32 a146, v248
v_accvgpr_write_b32 a147, v249
v_accvgpr_read_b32 v242, a160
v_accvgpr_read_b32 v243, a161
v_accvgpr_read_b32 v244, a162
v_accvgpr_read_b32 v245, a163
v_mul_f32 v242, v242, v112
v_mul_f32 v243, v243, v112
v_mul_f32 v244, v244, v112
v_mul_f32 v245, v245, v112
v_accvgpr_write_b32 a160, v242
v_accvgpr_write_b32 a161, v243
v_accvgpr_write_b32 a162, v244
v_accvgpr_write_b32 a163, v245
v_accvgpr_read_b32 v246, a176
v_accvgpr_read_b32 v247, a177
v_accvgpr_read_b32 v248, a178
v_accvgpr_read_b32 v249, a179
v_mul_f32 v246, v246, v112
v_mul_f32 v247, v247, v112
v_mul_f32 v248, v248, v112
v_mul_f32 v249, v249, v112
v_accvgpr_write_b32 a176, v246
v_accvgpr_write_b32 a177, v247
v_accvgpr_write_b32 a178, v248
v_accvgpr_write_b32 a179, v249
v_max3_f32 v232, v40, v41, v42
v_max3_f32 v232, v232, v43, v44
v_max3_f32 v232, v232, v45, v46
v_max_f32 v232, v232, v47
v_mov_b32 v233, v232
s_nop 1
v_permlane32_swap_b32 v232, v233
v_max_f32 v232, v232, v233
v_mov_b32 v233, v232
s_nop 1
v_permlane16_swap_b32 v232, v233
v_max_f32 v232, v232, v233
v_max_f32 v232, s66, v232
v_min_f32_e64 v233, -v232, 0
v_exp_f32 v113, v233
v_sub_f32 v40, v40, v232
v_sub_f32 v41, v41, v232
v_sub_f32 v42, v42, v232
v_sub_f32 v43, v43, v232
v_sub_f32 v44, v44, v232
v_sub_f32 v45, v45, v232
v_sub_f32 v46, v46, v232
v_sub_f32 v47, v47, v232
v_sub_f32 v72, v72, v232
v_sub_f32 v73, v73, v232
v_sub_f32 v74, v74, v232
v_sub_f32 v75, v75, v232
v_sub_f32 v76, v76, v232
v_sub_f32 v77, v77, v232
v_sub_f32 v78, v78, v232
v_sub_f32 v79, v79, v232
v_sub_f32 v100, v100, v232
v_sub_f32 v101, v101, v232
v_sub_f32 v102, v102, v232
v_sub_f32 v103, v103, v232
v_exp_f32 v234, v40
v_exp_f32 v235, v41
v_exp_f32 v236, v42
v_exp_f32 v237, v43
v_exp_f32 v238, v44
v_exp_f32 v239, v45
v_exp_f32 v240, v46
v_exp_f32 v241, v47
v_mul_f32 v15, v15, v113
v_add_f32 v117, v234, v235
v_add_f32 v117, v117, v236
v_add_f32 v117, v117, v237
v_add_f32 v117, v117, v238
v_add_f32 v117, v117, v239
v_add_f32 v117, v117, v240
v_add_f32 v117, v117, v241
v_cvt_pk_bf16_f32 v204, v234, v235
v_cvt_pk_bf16_f32 v205, v236, v237
v_cvt_pk_bf16_f32 v206, v238, v239
v_cvt_pk_bf16_f32 v207, v240, v241
v_accvgpr_read_b32 v242, a4
v_accvgpr_read_b32 v243, a5
v_accvgpr_read_b32 v244, a6
v_accvgpr_read_b32 v245, a7
v_mul_f32 v242, v242, v113
v_mul_f32 v243, v243, v113
v_mul_f32 v244, v244, v113
v_mul_f32 v245, v245, v113
v_accvgpr_write_b32 a4, v242
v_accvgpr_write_b32 a5, v243
v_accvgpr_write_b32 a6, v244
v_accvgpr_write_b32 a7, v245
v_accvgpr_read_b32 v246, a20
v_accvgpr_read_b32 v247, a21
v_accvgpr_read_b32 v248, a22
v_accvgpr_read_b32 v249, a23
v_mul_f32 v246, v246, v113
v_mul_f32 v247, v247, v113
v_mul_f32 v248, v248, v113
v_mul_f32 v249, v249, v113
v_accvgpr_write_b32 a20, v246
v_accvgpr_write_b32 a21, v247
v_accvgpr_write_b32 a22, v248
v_accvgpr_write_b32 a23, v249
v_accvgpr_read_b32 v242, a36
v_accvgpr_read_b32 v243, a37
v_accvgpr_read_b32 v244, a38
v_accvgpr_read_b32 v245, a39
v_mul_f32 v242, v242, v113
v_mul_f32 v243, v243, v113
v_mul_f32 v244, v244, v113
v_mul_f32 v245, v245, v113
v_accvgpr_write_b32 a36, v242
v_accvgpr_write_b32 a37, v243
v_accvgpr_write_b32 a38, v244
v_accvgpr_write_b32 a39, v245
v_accvgpr_read_b32 v246, a52
v_accvgpr_read_b32 v247, a53
v_accvgpr_read_b32 v248, a54
v_accvgpr_read_b32 v249, a55
v_mul_f32 v246, v246, v113
v_mul_f32 v247, v247, v113
v_mul_f32 v248, v248, v113
v_mul_f32 v249, v249, v113
v_accvgpr_write_b32 a52, v246
v_accvgpr_write_b32 a53, v247
v_accvgpr_write_b32 a54, v248
v_accvgpr_write_b32 a55, v249
v_accvgpr_read_b32 v242, a68
v_accvgpr_read_b32 v243, a69
v_accvgpr_read_b32 v244, a70
v_accvgpr_read_b32 v245, a71
v_mul_f32 v242, v242, v113
v_mul_f32 v243, v243, v113
v_mul_f32 v244, v244, v113
v_mul_f32 v245, v245, v113
v_accvgpr_write_b32 a68, v242
v_accvgpr_write_b32 a69, v243
v_accvgpr_write_b32 a70, v244
v_accvgpr_write_b32 a71, v245
v_accvgpr_read_b32 v246, a84
v_accvgpr_read_b32 v247, a85
v_accvgpr_read_b32 v248, a86
v_accvgpr_read_b32 v249, a87
v_mul_f32 v246, v246, v113
v_mul_f32 v247, v247, v113
v_mul_f32 v248, v248, v113
v_mul_f32 v249, v249, v113
v_accvgpr_write_b32 a84, v246
v_accvgpr_write_b32 a85, v247
v_accvgpr_write_b32 a86, v248
v_accvgpr_write_b32 a87, v249
v_accvgpr_read_b32 v242, a100
v_accvgpr_read_b32 v243, a101
v_accvgpr_read_b32 v244, a102
v_accvgpr_read_b32 v245, a103
v_mul_f32 v242, v242, v113
v_mul_f32 v243, v243, v113
v_mul_f32 v244, v244, v113
v_mul_f32 v245, v245, v113
v_accvgpr_write_b32 a100, v242
v_accvgpr_write_b32 a101, v243
v_accvgpr_write_b32 a102, v244
v_accvgpr_write_b32 a103, v245
v_accvgpr_read_b32 v246, a116
v_accvgpr_read_b32 v247, a117
v_accvgpr_read_b32 v248, a118
v_accvgpr_read_b32 v249, a119
v_mul_f32 v246, v246, v113
v_mul_f32 v247, v247, v113
v_mul_f32 v248, v248, v113
v_mul_f32 v249, v249, v113
v_accvgpr_write_b32 a116, v246
v_accvgpr_write_b32 a117, v247
v_accvgpr_write_b32 a118, v248
v_accvgpr_write_b32 a119, v249
v_accvgpr_read_b32 v242, a132
v_accvgpr_read_b32 v243, a133
v_accvgpr_read_b32 v244, a134
v_accvgpr_read_b32 v245, a135
v_mul_f32 v242, v242, v113
v_mul_f32 v243, v243, v113
v_mul_f32 v244, v244, v113
v_mul_f32 v245, v245, v113
v_accvgpr_write_b32 a132, v242
v_accvgpr_write_b32 a133, v243
v_accvgpr_write_b32 a134, v244
v_accvgpr_write_b32 a135, v245
v_accvgpr_read_b32 v246, a148
v_accvgpr_read_b32 v247, a149
v_accvgpr_read_b32 v248, a150
v_accvgpr_read_b32 v249, a151
v_mul_f32 v246, v246, v113
v_mul_f32 v247, v247, v113
v_mul_f32 v248, v248, v113
v_mul_f32 v249, v249, v113
v_accvgpr_write_b32 a148, v246
v_accvgpr_write_b32 a149, v247
v_accvgpr_write_b32 a150, v248
v_accvgpr_write_b32 a151, v249
v_accvgpr_read_b32 v242, a164
v_accvgpr_read_b32 v243, a165
v_accvgpr_read_b32 v244, a166
v_accvgpr_read_b32 v245, a167
v_mul_f32 v242, v242, v113
v_mul_f32 v243, v243, v113
v_mul_f32 v244, v244, v113
v_mul_f32 v245, v245, v113
v_accvgpr_write_b32 a164, v242
v_accvgpr_write_b32 a165, v243
v_accvgpr_write_b32 a166, v244
v_accvgpr_write_b32 a167, v245
v_accvgpr_read_b32 v246, a180
v_accvgpr_read_b32 v247, a181
v_accvgpr_read_b32 v248, a182
v_accvgpr_read_b32 v249, a183
v_mul_f32 v246, v246, v113
v_mul_f32 v247, v247, v113
v_mul_f32 v248, v248, v113
v_mul_f32 v249, v249, v113
v_accvgpr_write_b32 a180, v246
v_accvgpr_write_b32 a181, v247
v_accvgpr_write_b32 a182, v248
v_accvgpr_write_b32 a183, v249
v_max3_f32 v232, v48, v49, v50
v_max3_f32 v232, v232, v51, v52
v_max3_f32 v232, v232, v53, v54
v_max_f32 v232, v232, v55
v_mov_b32 v233, v232
s_nop 1
v_permlane32_swap_b32 v232, v233
v_max_f32 v232, v232, v233
v_mov_b32 v233, v232
s_nop 1
v_permlane16_swap_b32 v232, v233
v_max_f32 v232, v232, v233
v_max_f32 v232, s66, v232
v_min_f32_e64 v233, -v232, 0
v_exp_f32 v114, v233
v_sub_f32 v48, v48, v232
v_sub_f32 v49, v49, v232
v_sub_f32 v50, v50, v232
v_sub_f32 v51, v51, v232
v_sub_f32 v52, v52, v232
v_sub_f32 v53, v53, v232
v_sub_f32 v54, v54, v232
v_sub_f32 v55, v55, v232
v_sub_f32 v80, v80, v232
v_sub_f32 v81, v81, v232
v_sub_f32 v82, v82, v232
v_sub_f32 v83, v83, v232
v_sub_f32 v84, v84, v232
v_sub_f32 v85, v85, v232
v_sub_f32 v86, v86, v232
v_sub_f32 v87, v87, v232
v_sub_f32 v104, v104, v232
v_sub_f32 v105, v105, v232
v_sub_f32 v106, v106, v232
v_sub_f32 v107, v107, v232
v_exp_f32 v234, v48
v_exp_f32 v235, v49
v_exp_f32 v236, v50
v_exp_f32 v237, v51
v_exp_f32 v238, v52
v_exp_f32 v239, v53
v_exp_f32 v240, v54
v_exp_f32 v241, v55
v_mul_f32 v29, v29, v114
v_add_f32 v118, v234, v235
v_add_f32 v118, v118, v236
v_add_f32 v118, v118, v237
v_add_f32 v118, v118, v238
v_add_f32 v118, v118, v239
v_add_f32 v118, v118, v240
v_add_f32 v118, v118, v241
v_cvt_pk_bf16_f32 v208, v234, v235
v_cvt_pk_bf16_f32 v209, v236, v237
v_cvt_pk_bf16_f32 v210, v238, v239
v_cvt_pk_bf16_f32 v211, v240, v241
v_accvgpr_read_b32 v242, a8
v_accvgpr_read_b32 v243, a9
v_accvgpr_read_b32 v244, a10
v_accvgpr_read_b32 v245, a11
v_mul_f32 v242, v242, v114
v_mul_f32 v243, v243, v114
v_mul_f32 v244, v244, v114
v_mul_f32 v245, v245, v114
v_accvgpr_write_b32 a8, v242
v_accvgpr_write_b32 a9, v243
v_accvgpr_write_b32 a10, v244
v_accvgpr_write_b32 a11, v245
v_accvgpr_read_b32 v246, a24
v_accvgpr_read_b32 v247, a25
v_accvgpr_read_b32 v248, a26
v_accvgpr_read_b32 v249, a27
v_mul_f32 v246, v246, v114
v_mul_f32 v247, v247, v114
v_mul_f32 v248, v248, v114
v_mul_f32 v249, v249, v114
v_accvgpr_write_b32 a24, v246
v_accvgpr_write_b32 a25, v247
v_accvgpr_write_b32 a26, v248
v_accvgpr_write_b32 a27, v249
v_accvgpr_read_b32 v242, a40
v_accvgpr_read_b32 v243, a41
v_accvgpr_read_b32 v244, a42
v_accvgpr_read_b32 v245, a43
v_mul_f32 v242, v242, v114
v_mul_f32 v243, v243, v114
v_mul_f32 v244, v244, v114
v_mul_f32 v245, v245, v114
v_accvgpr_write_b32 a40, v242
v_accvgpr_write_b32 a41, v243
v_accvgpr_write_b32 a42, v244
v_accvgpr_write_b32 a43, v245
v_accvgpr_read_b32 v246, a56
v_accvgpr_read_b32 v247, a57
v_accvgpr_read_b32 v248, a58
v_accvgpr_read_b32 v249, a59
v_mul_f32 v246, v246, v114
v_mul_f32 v247, v247, v114
v_mul_f32 v248, v248, v114
v_mul_f32 v249, v249, v114
v_accvgpr_write_b32 a56, v246
v_accvgpr_write_b32 a57, v247
v_accvgpr_write_b32 a58, v248
v_accvgpr_write_b32 a59, v249
v_accvgpr_read_b32 v242, a72
v_accvgpr_read_b32 v243, a73
v_accvgpr_read_b32 v244, a74
v_accvgpr_read_b32 v245, a75
v_mul_f32 v242, v242, v114
v_mul_f32 v243, v243, v114
v_mul_f32 v244, v244, v114
v_mul_f32 v245, v245, v114
v_accvgpr_write_b32 a72, v242
v_accvgpr_write_b32 a73, v243
v_accvgpr_write_b32 a74, v244
v_accvgpr_write_b32 a75, v245
v_accvgpr_read_b32 v246, a88
v_accvgpr_read_b32 v247, a89
v_accvgpr_read_b32 v248, a90
v_accvgpr_read_b32 v249, a91
v_mul_f32 v246, v246, v114
v_mul_f32 v247, v247, v114
v_mul_f32 v248, v248, v114
v_mul_f32 v249, v249, v114
v_accvgpr_write_b32 a88, v246
v_accvgpr_write_b32 a89, v247
v_accvgpr_write_b32 a90, v248
v_accvgpr_write_b32 a91, v249
v_accvgpr_read_b32 v242, a104
v_accvgpr_read_b32 v243, a105
v_accvgpr_read_b32 v244, a106
v_accvgpr_read_b32 v245, a107
v_mul_f32 v242, v242, v114
v_mul_f32 v243, v243, v114
v_mul_f32 v244, v244, v114
v_mul_f32 v245, v245, v114
v_accvgpr_write_b32 a104, v242
v_accvgpr_write_b32 a105, v243
v_accvgpr_write_b32 a106, v244
v_accvgpr_write_b32 a107, v245
v_accvgpr_read_b32 v246, a120
v_accvgpr_read_b32 v247, a121
v_accvgpr_read_b32 v248, a122
v_accvgpr_read_b32 v249, a123
v_mul_f32 v246, v246, v114
v_mul_f32 v247, v247, v114
v_mul_f32 v248, v248, v114
v_mul_f32 v249, v249, v114
v_accvgpr_write_b32 a120, v246
v_accvgpr_write_b32 a121, v247
v_accvgpr_write_b32 a122, v248
v_accvgpr_write_b32 a123, v249
v_accvgpr_read_b32 v242, a136
v_accvgpr_read_b32 v243, a137
v_accvgpr_read_b32 v244, a138
v_accvgpr_read_b32 v245, a139
v_mul_f32 v242, v242, v114
v_mul_f32 v243, v243, v114
v_mul_f32 v244, v244, v114
v_mul_f32 v245, v245, v114
v_accvgpr_write_b32 a136, v242
v_accvgpr_write_b32 a137, v243
v_accvgpr_write_b32 a138, v244
v_accvgpr_write_b32 a139, v245
v_accvgpr_read_b32 v246, a152
v_accvgpr_read_b32 v247, a153
v_accvgpr_read_b32 v248, a154
v_accvgpr_read_b32 v249, a155
v_mul_f32 v246, v246, v114
v_mul_f32 v247, v247, v114
v_mul_f32 v248, v248, v114
v_mul_f32 v249, v249, v114
v_accvgpr_write_b32 a152, v246
v_accvgpr_write_b32 a153, v247
v_accvgpr_write_b32 a154, v248
v_accvgpr_write_b32 a155, v249
v_accvgpr_read_b32 v242, a168
v_accvgpr_read_b32 v243, a169
v_accvgpr_read_b32 v244, a170
v_accvgpr_read_b32 v245, a171
v_mul_f32 v242, v242, v114
v_mul_f32 v243, v243, v114
v_mul_f32 v244, v244, v114
v_mul_f32 v245, v245, v114
v_accvgpr_write_b32 a168, v242
v_accvgpr_write_b32 a169, v243
v_accvgpr_write_b32 a170, v244
v_accvgpr_write_b32 a171, v245
v_accvgpr_read_b32 v246, a184
v_accvgpr_read_b32 v247, a185
v_accvgpr_read_b32 v248, a186
v_accvgpr_read_b32 v249, a187
v_mul_f32 v246, v246, v114
v_mul_f32 v247, v247, v114
v_mul_f32 v248, v248, v114
v_mul_f32 v249, v249, v114
v_accvgpr_write_b32 a184, v246
v_accvgpr_write_b32 a185, v247
v_accvgpr_write_b32 a186, v248
v_accvgpr_write_b32 a187, v249
v_max3_f32 v232, v56, v57, v58
v_max3_f32 v232, v232, v59, v60
v_max3_f32 v232, v232, v61, v62
v_max_f32 v232, v232, v63
v_mov_b32 v233, v232
s_nop 1
v_permlane32_swap_b32 v232, v233
v_max_f32 v232, v232, v233
v_mov_b32 v233, v232
s_nop 1
v_permlane16_swap_b32 v232, v233
v_max_f32 v232, v232, v233
v_max_f32 v232, s66, v232
v_min_f32_e64 v233, -v232, 0
v_exp_f32 v115, v233
v_sub_f32 v56, v56, v232
v_sub_f32 v57, v57, v232
v_sub_f32 v58, v58, v232
v_sub_f32 v59, v59, v232
v_sub_f32 v60, v60, v232
v_sub_f32 v61, v61, v232
v_sub_f32 v62, v62, v232
v_sub_f32 v63, v63, v232
v_sub_f32 v88, v88, v232
v_sub_f32 v89, v89, v232
v_sub_f32 v90, v90, v232
v_sub_f32 v91, v91, v232
v_sub_f32 v92, v92, v232
v_sub_f32 v93, v93, v232
v_sub_f32 v94, v94, v232
v_sub_f32 v95, v95, v232
v_sub_f32 v108, v108, v232
v_sub_f32 v109, v109, v232
v_sub_f32 v110, v110, v232
v_sub_f32 v111, v111, v232
v_exp_f32 v234, v56
v_exp_f32 v235, v57
v_exp_f32 v236, v58
v_exp_f32 v237, v59
v_exp_f32 v238, v60
v_exp_f32 v239, v61
v_exp_f32 v240, v62
v_exp_f32 v241, v63
v_mul_f32 v30, v30, v115
v_add_f32 v119, v234, v235
v_add_f32 v119, v119, v236
v_add_f32 v119, v119, v237
v_add_f32 v119, v119, v238
v_add_f32 v119, v119, v239
v_add_f32 v119, v119, v240
v_add_f32 v119, v119, v241
v_cvt_pk_bf16_f32 v212, v234, v235
v_cvt_pk_bf16_f32 v213, v236, v237
v_cvt_pk_bf16_f32 v214, v238, v239
v_cvt_pk_bf16_f32 v215, v240, v241
v_accvgpr_read_b32 v242, a12
v_accvgpr_read_b32 v243, a13
v_accvgpr_read_b32 v244, a14
v_accvgpr_read_b32 v245, a15
v_mul_f32 v242, v242, v115
v_mul_f32 v243, v243, v115
v_mul_f32 v244, v244, v115
v_mul_f32 v245, v245, v115
v_accvgpr_write_b32 a12, v242
v_accvgpr_write_b32 a13, v243
v_accvgpr_write_b32 a14, v244
v_accvgpr_write_b32 a15, v245
v_accvgpr_read_b32 v246, a28
v_accvgpr_read_b32 v247, a29
v_accvgpr_read_b32 v248, a30
v_accvgpr_read_b32 v249, a31
v_mul_f32 v246, v246, v115
v_mul_f32 v247, v247, v115
v_mul_f32 v248, v248, v115
v_mul_f32 v249, v249, v115
v_accvgpr_write_b32 a28, v246
v_accvgpr_write_b32 a29, v247
v_accvgpr_write_b32 a30, v248
v_accvgpr_write_b32 a31, v249
v_accvgpr_read_b32 v242, a44
v_accvgpr_read_b32 v243, a45
v_accvgpr_read_b32 v244, a46
v_accvgpr_read_b32 v245, a47
v_mul_f32 v242, v242, v115
v_mul_f32 v243, v243, v115
v_mul_f32 v244, v244, v115
v_mul_f32 v245, v245, v115
v_accvgpr_write_b32 a44, v242
v_accvgpr_write_b32 a45, v243
v_accvgpr_write_b32 a46, v244
v_accvgpr_write_b32 a47, v245
v_accvgpr_read_b32 v246, a60
v_accvgpr_read_b32 v247, a61
v_accvgpr_read_b32 v248, a62
v_accvgpr_read_b32 v249, a63
v_mul_f32 v246, v246, v115
v_mul_f32 v247, v247, v115
v_mul_f32 v248, v248, v115
v_mul_f32 v249, v249, v115
v_accvgpr_write_b32 a60, v246
v_accvgpr_write_b32 a61, v247
v_accvgpr_write_b32 a62, v248
v_accvgpr_write_b32 a63, v249
v_accvgpr_read_b32 v242, a76
v_accvgpr_read_b32 v243, a77
v_accvgpr_read_b32 v244, a78
v_accvgpr_read_b32 v245, a79
v_mul_f32 v242, v242, v115
v_mul_f32 v243, v243, v115
v_mul_f32 v244, v244, v115
v_mul_f32 v245, v245, v115
v_accvgpr_write_b32 a76, v242
v_accvgpr_write_b32 a77, v243
v_accvgpr_write_b32 a78, v244
v_accvgpr_write_b32 a79, v245
v_accvgpr_read_b32 v246, a92
v_accvgpr_read_b32 v247, a93
v_accvgpr_read_b32 v248, a94
v_accvgpr_read_b32 v249, a95
v_mul_f32 v246, v246, v115
v_mul_f32 v247, v247, v115
v_mul_f32 v248, v248, v115
v_mul_f32 v249, v249, v115
v_accvgpr_write_b32 a92, v246
v_accvgpr_write_b32 a93, v247
v_accvgpr_write_b32 a94, v248
v_accvgpr_write_b32 a95, v249
v_accvgpr_read_b32 v242, a108
v_accvgpr_read_b32 v243, a109
v_accvgpr_read_b32 v244, a110
v_accvgpr_read_b32 v245, a111
v_mul_f32 v242, v242, v115
v_mul_f32 v243, v243, v115
v_mul_f32 v244, v244, v115
v_mul_f32 v245, v245, v115
v_accvgpr_write_b32 a108, v242
v_accvgpr_write_b32 a109, v243
v_accvgpr_write_b32 a110, v244
v_accvgpr_write_b32 a111, v245
v_accvgpr_read_b32 v246, a124
v_accvgpr_read_b32 v247, a125
v_accvgpr_read_b32 v248, a126
v_accvgpr_read_b32 v249, a127
v_mul_f32 v246, v246, v115
v_mul_f32 v247, v247, v115
v_mul_f32 v248, v248, v115
v_mul_f32 v249, v249, v115
v_accvgpr_write_b32 a124, v246
v_accvgpr_write_b32 a125, v247
v_accvgpr_write_b32 a126, v248
v_accvgpr_write_b32 a127, v249
v_accvgpr_read_b32 v242, a140
v_accvgpr_read_b32 v243, a141
v_accvgpr_read_b32 v244, a142
v_accvgpr_read_b32 v245, a143
v_mul_f32 v242, v242, v115
v_mul_f32 v243, v243, v115
v_mul_f32 v244, v244, v115
v_mul_f32 v245, v245, v115
v_accvgpr_write_b32 a140, v242
v_accvgpr_write_b32 a141, v243
v_accvgpr_write_b32 a142, v244
v_accvgpr_write_b32 a143, v245
v_accvgpr_read_b32 v246, a156
v_accvgpr_read_b32 v247, a157
v_accvgpr_read_b32 v248, a158
v_accvgpr_read_b32 v249, a159
v_mul_f32 v246, v246, v115
v_mul_f32 v247, v247, v115
v_mul_f32 v248, v248, v115
v_mul_f32 v249, v249, v115
v_accvgpr_write_b32 a156, v246
v_accvgpr_write_b32 a157, v247
v_accvgpr_write_b32 a158, v248
v_accvgpr_write_b32 a159, v249
v_accvgpr_read_b32 v242, a172
v_accvgpr_read_b32 v243, a173
v_accvgpr_read_b32 v244, a174
v_accvgpr_read_b32 v245, a175
v_mul_f32 v242, v242, v115
v_mul_f32 v243, v243, v115
v_mul_f32 v244, v244, v115
v_mul_f32 v245, v245, v115
v_accvgpr_write_b32 a172, v242
v_accvgpr_write_b32 a173, v243
v_accvgpr_write_b32 a174, v244
v_accvgpr_write_b32 a175, v245
v_accvgpr_read_b32 v246, a188
v_accvgpr_read_b32 v247, a189
v_accvgpr_read_b32 v248, a190
v_accvgpr_read_b32 v249, a191
v_mul_f32 v246, v246, v115
v_mul_f32 v247, v247, v115
v_mul_f32 v248, v248, v115
v_mul_f32 v249, v249, v115
v_accvgpr_write_b32 a188, v246
v_accvgpr_write_b32 a189, v247
v_accvgpr_write_b32 a190, v248
v_accvgpr_write_b32 a191, v249
s_mov_b32 s64, 0x43800000
s_mov_b32 s66, 0
s_nop 1
s_cmp_eq_u32 s50, 0
s_cbranch_scc1 RBACK0
s_cmp_eq_u32 s50, 2
s_cbranch_scc1 RBACK2
s_cmp_eq_u32 s50, 4
s_cbranch_scc1 RBACK4
s_cmp_eq_u32 s50, 6
s_cbranch_scc1 RBACK6
s_cmp_eq_u32 s50, 8
s_cbranch_scc1 RBACK8
s_endpgm
RARE1:
s_nop 15
v_max3_f32 v232, v64, v65, v66
v_max3_f32 v232, v232, v67, v68
v_max3_f32 v232, v232, v69, v70
v_max_f32 v232, v232, v71
v_mov_b32 v233, v232
s_nop 1
v_permlane32_swap_b32 v232, v233
v_max_f32 v232, v232, v233
v_mov_b32 v233, v232
s_nop 1
v_permlane16_swap_b32 v232, v233
v_max_f32 v232, v232, v233
v_max_f32 v232, s66, v232
v_min_f32_e64 v233, -v232, 0
v_exp_f32 v112, v233
v_sub_f32 v64, v64, v232
v_sub_f32 v65, v65, v232
v_sub_f32 v66, v66, v232
v_sub_f32 v67, v67, v232
v_sub_f32 v68, v68, v232
v_sub_f32 v69, v69, v232
v_sub_f32 v70, v70, v232
v_sub_f32 v71, v71, v232
v_sub_f32 v32, v32, v232
v_sub_f32 v33, v33, v232
v_sub_f32 v34, v34, v232
v_sub_f32 v35, v35, v232
v_sub_f32 v36, v36, v232
v_sub_f32 v37, v37, v232
v_sub_f32 v38, v38, v232
v_sub_f32 v39, v39, v232
v_sub_f32 v96, v96, v232
v_sub_f32 v97, v97, v232
v_sub_f32 v98, v98, v232
v_sub_f32 v99, v99, v232
v_exp_f32 v234, v64
v_exp_f32 v235, v65
v_exp_f32 v236, v66
v_exp_f32 v237, v67
v_exp_f32 v238, v68
v_exp_f32 v239, v69
v_exp_f32 v240, v70
v_exp_f32 v241, v71
v_mul_f32 v3, v3, v112
v_add_f32 v116, v234, v235
v_add_f32 v116, v116, v236
v_add_f32 v116, v116, v237
v_add_f32 v116, v116, v238
v_add_f32 v116, v116, v239
v_add_f32 v116, v116, v240
v_add_f32 v116, v116, v241
v_cvt_pk_bf16_f32 v216, v234, v235
v_cvt_pk_bf16_f32 v217, v236, v237
v_cvt_pk_bf16_f32 v218, v238, v239
v_cvt_pk_bf16_f32 v219, v240, v241
v_accvgpr_read_b32 v242, a0
v_accvgpr_read_b32 v243, a1
v_accvgpr_read_b32 v244, a2
v_accvgpr_read_b32 v245, a3
v_mul_f32 v242, v242, v112
v_mul_f32 v243, v243, v112
v_mul_f32 v244, v244, v112
v_mul_f32 v245, v245, v112
v_accvgpr_write_b32 a0, v242
v_accvgpr_write_b32 a1, v243
v_accvgpr_write_b32 a2, v244
v_accvgpr_write_b32 a3, v245
v_accvgpr_read_b32 v246, a16
v_accvgpr_read_b32 v247, a17
v_accvgpr_read_b32 v248, a18
v_accvgpr_read_b32 v249, a19
v_mul_f32 v246, v246, v112
v_mul_f32 v247, v247, v112
v_mul_f32 v248, v248, v112
v_mul_f32 v249, v249, v112
v_accvgpr_write_b32 a16, v246
v_accvgpr_write_b32 a17, v247
v_accvgpr_write_b32 a18, v248
v_accvgpr_write_b32 a19, v249
v_accvgpr_read_b32 v242, a32
v_accvgpr_read_b32 v243, a33
v_accvgpr_read_b32 v244, a34
v_accvgpr_read_b32 v245, a35
v_mul_f32 v242, v242, v112
v_mul_f32 v243, v243, v112
v_mul_f32 v244, v244, v112
v_mul_f32 v245, v245, v112
v_accvgpr_write_b32 a32, v242
v_accvgpr_write_b32 a33, v243
v_accvgpr_write_b32 a34, v244
v_accvgpr_write_b32 a35, v245
v_accvgpr_read_b32 v246, a48
v_accvgpr_read_b32 v247, a49
v_accvgpr_read_b32 v248, a50
v_accvgpr_read_b32 v249, a51
v_mul_f32 v246, v246, v112
v_mul_f32 v247, v247, v112
v_mul_f32 v248, v248, v112
v_mul_f32 v249, v249, v112
v_accvgpr_write_b32 a48, v246
v_accvgpr_write_b32 a49, v247
v_accvgpr_write_b32 a50, v248
v_accvgpr_write_b32 a51, v249
v_accvgpr_read_b32 v242, a64
v_accvgpr_read_b32 v243, a65
v_accvgpr_read_b32 v244, a66
v_accvgpr_read_b32 v245, a67
v_mul_f32 v242, v242, v112
v_mul_f32 v243, v243, v112
v_mul_f32 v244, v244, v112
v_mul_f32 v245, v245, v112
v_accvgpr_write_b32 a64, v242
v_accvgpr_write_b32 a65, v243
v_accvgpr_write_b32 a66, v244
v_accvgpr_write_b32 a67, v245
v_accvgpr_read_b32 v246, a80
v_accvgpr_read_b32 v247, a81
v_accvgpr_read_b32 v248, a82
v_accvgpr_read_b32 v249, a83
v_mul_f32 v246, v246, v112
v_mul_f32 v247, v247, v112
v_mul_f32 v248, v248, v112
v_mul_f32 v249, v249, v112
v_accvgpr_write_b32 a80, v246
v_accvgpr_write_b32 a81, v247
v_accvgpr_write_b32 a82, v248
v_accvgpr_write_b32 a83, v249
v_accvgpr_read_b32 v242, a96
v_accvgpr_read_b32 v243, a97
v_accvgpr_read_b32 v244, a98
v_accvgpr_read_b32 v245, a99
v_mul_f32 v242, v242, v112
v_mul_f32 v243, v243, v112
v_mul_f32 v244, v244, v112
v_mul_f32 v245, v245, v112
v_accvgpr_write_b32 a96, v242
v_accvgpr_write_b32 a97, v243
v_accvgpr_write_b32 a98, v244
v_accvgpr_write_b32 a99, v245
v_accvgpr_read_b32 v246, a112
v_accvgpr_read_b32 v247, a113
v_accvgpr_read_b32 v248, a114
v_accvgpr_read_b32 v249, a115
v_mul_f32 v246, v246, v112
v_mul_f32 v247, v247, v112
v_mul_f32 v248, v248, v112
v_mul_f32 v249, v249, v112
v_accvgpr_write_b32 a112, v246
v_accvgpr_write_b32 a113, v247
v_accvgpr_write_b32 a114, v248
v_accvgpr_write_b32 a115, v249
v_accvgpr_read_b32 v242, a128
v_accvgpr_read_b32 v243, a129
v_accvgpr_read_b32 v244, a130
v_accvgpr_read_b32 v245, a131
v_mul_f32 v242, v242, v112
v_mul_f32 v243, v243, v112
v_mul_f32 v244, v244, v112
v_mul_f32 v245, v245, v112
v_accvgpr_write_b32 a128, v242
v_accvgpr_write_b32 a129, v243
v_accvgpr_write_b32 a130, v244
v_accvgpr_write_b32 a131, v245
v_accvgpr_read_b32 v246, a144
v_accvgpr_read_b32 v247, a145
v_accvgpr_read_b32 v248, a146
v_accvgpr_read_b32 v249, a147
v_mul_f32 v246, v246, v112
v_mul_f32 v247, v247, v112
v_mul_f32 v248, v248, v112
v_mul_f32 v249, v249, v112
v_accvgpr_write_b32 a144, v246
v_accvgpr_write_b32 a145, v247
v_accvgpr_write_b32 a146, v248
v_accvgpr_write_b32 a147, v249
v_accvgpr_read_b32 v242, a160
v_accvgpr_read_b32 v243, a161
v_accvgpr_read_b32 v244, a162
v_accvgpr_read_b32 v245, a163
v_mul_f32 v242, v242, v112
v_mul_f32 v243, v243, v112
v_mul_f32 v244, v244, v112
v_mul_f32 v245, v245, v112
v_accvgpr_write_b32 a160, v242
v_accvgpr_write_b32 a161, v243
v_accvgpr_write_b32 a162, v244
v_accvgpr_write_b32 a163, v245
v_accvgpr_read_b32 v246, a176
v_accvgpr_read_b32 v247, a177
v_accvgpr_read_b32 v248, a178
v_accvgpr_read_b32 v249, a179
v_mul_f32 v246, v246, v112
v_mul_f32 v247, v247, v112
v_mul_f32 v248, v248, v112
v_mul_f32 v249, v249, v112
v_accvgpr_write_b32 a176, v246
v_accvgpr_write_b32 a177, v247
v_accvgpr_write_b32 a178, v248
v_accvgpr_write_b32 a179, v249
v_max3_f32 v232, v72, v73, v74
v_max3_f32 v232, v232, v75, v76
v_max3_f32 v232, v232, v77, v78
v_max_f32 v232, v232, v79
v_mov_b32 v233, v232
s_nop 1
v_permlane32_swap_b32 v232, v233
v_max_f32 v232, v232, v233
v_mov_b32 v233, v232
s_nop 1
v_permlane16_swap_b32 v232, v233
v_max_f32 v232, v232, v233
v_max_f32 v232, s66, v232
v_min_f32_e64 v233, -v232, 0
v_exp_f32 v113, v233
v_sub_f32 v72, v72, v232
v_sub_f32 v73, v73, v232
v_sub_f32 v74, v74, v232
v_sub_f32 v75, v75, v232
v_sub_f32 v76, v76, v232
v_sub_f32 v77, v77, v232
v_sub_f32 v78, v78, v232
v_sub_f32 v79, v79, v232
v_sub_f32 v40, v40, v232
v_sub_f32 v41, v41, v232
v_sub_f32 v42, v42, v232
v_sub_f32 v43, v43, v232
v_sub_f32 v44, v44, v232
v_sub_f32 v45, v45, v232
v_sub_f32 v46, v46, v232
v_sub_f32 v47, v47, v232
v_sub_f32 v100, v100, v232
v_sub_f32 v101, v101, v232
v_sub_f32 v102, v102, v232
v_sub_f32 v103, v103, v232
v_exp_f32 v234, v72
v_exp_f32 v235, v73
v_exp_f32 v236, v74
v_exp_f32 v237, v75
v_exp_f32 v238, v76
v_exp_f32 v239, v77
v_exp_f32 v240, v78
v_exp_f32 v241, v79
v_mul_f32 v15, v15, v113
v_add_f32 v117, v234, v235
v_add_f32 v117, v117, v236
v_add_f32 v117, v117, v237
v_add_f32 v117, v117, v238
v_add_f32 v117, v117, v239
v_add_f32 v117, v117, v240
v_add_f32 v117, v117, v241
v_cvt_pk_bf16_f32 v220, v234, v235
v_cvt_pk_bf16_f32 v221, v236, v237
v_cvt_pk_bf16_f32 v222, v238, v239
v_cvt_pk_bf16_f32 v223, v240, v241
v_accvgpr_read_b32 v242, a4
v_accvgpr_read_b32 v243, a5
v_accvgpr_read_b32 v244, a6
v_accvgpr_read_b32 v245, a7
v_mul_f32 v242, v242, v113
v_mul_f32 v243, v243, v113
v_mul_f32 v244, v244, v113
v_mul_f32 v245, v245, v113
v_accvgpr_write_b32 a4, v242
v_accvgpr_write_b32 a5, v243
v_accvgpr_write_b32 a6, v244
v_accvgpr_write_b32 a7, v245
v_accvgpr_read_b32 v246, a20
v_accvgpr_read_b32 v247, a21
v_accvgpr_read_b32 v248, a22
v_accvgpr_read_b32 v249, a23
v_mul_f32 v246, v246, v113
v_mul_f32 v247, v247, v113
v_mul_f32 v248, v248, v113
v_mul_f32 v249, v249, v113
v_accvgpr_write_b32 a20, v246
v_accvgpr_write_b32 a21, v247
v_accvgpr_write_b32 a22, v248
v_accvgpr_write_b32 a23, v249
v_accvgpr_read_b32 v242, a36
v_accvgpr_read_b32 v243, a37
v_accvgpr_read_b32 v244, a38
v_accvgpr_read_b32 v245, a39
v_mul_f32 v242, v242, v113
v_mul_f32 v243, v243, v113
v_mul_f32 v244, v244, v113
v_mul_f32 v245, v245, v113
v_accvgpr_write_b32 a36, v242
v_accvgpr_write_b32 a37, v243
v_accvgpr_write_b32 a38, v244
v_accvgpr_write_b32 a39, v245
v_accvgpr_read_b32 v246, a52
v_accvgpr_read_b32 v247, a53
v_accvgpr_read_b32 v248, a54
v_accvgpr_read_b32 v249, a55
v_mul_f32 v246, v246, v113
v_mul_f32 v247, v247, v113
v_mul_f32 v248, v248, v113
v_mul_f32 v249, v249, v113
v_accvgpr_write_b32 a52, v246
v_accvgpr_write_b32 a53, v247
v_accvgpr_write_b32 a54, v248
v_accvgpr_write_b32 a55, v249
v_accvgpr_read_b32 v242, a68
v_accvgpr_read_b32 v243, a69
v_accvgpr_read_b32 v244, a70
v_accvgpr_read_b32 v245, a71
v_mul_f32 v242, v242, v113
v_mul_f32 v243, v243, v113
v_mul_f32 v244, v244, v113
v_mul_f32 v245, v245, v113
v_accvgpr_write_b32 a68, v242
v_accvgpr_write_b32 a69, v243
v_accvgpr_write_b32 a70, v244
v_accvgpr_write_b32 a71, v245
v_accvgpr_read_b32 v246, a84
v_accvgpr_read_b32 v247, a85
v_accvgpr_read_b32 v248, a86
v_accvgpr_read_b32 v249, a87
v_mul_f32 v246, v246, v113
v_mul_f32 v247, v247, v113
v_mul_f32 v248, v248, v113
v_mul_f32 v249, v249, v113
v_accvgpr_write_b32 a84, v246
v_accvgpr_write_b32 a85, v247
v_accvgpr_write_b32 a86, v248
v_accvgpr_write_b32 a87, v249
v_accvgpr_read_b32 v242, a100
v_accvgpr_read_b32 v243, a101
v_accvgpr_read_b32 v244, a102
v_accvgpr_read_b32 v245, a103
v_mul_f32 v242, v242, v113
v_mul_f32 v243, v243, v113
v_mul_f32 v244, v244, v113
v_mul_f32 v245, v245, v113
v_accvgpr_write_b32 a100, v242
v_accvgpr_write_b32 a101, v243
v_accvgpr_write_b32 a102, v244
v_accvgpr_write_b32 a103, v245
v_accvgpr_read_b32 v246, a116
v_accvgpr_read_b32 v247, a117
v_accvgpr_read_b32 v248, a118
v_accvgpr_read_b32 v249, a119
v_mul_f32 v246, v246, v113
v_mul_f32 v247, v247, v113
v_mul_f32 v248, v248, v113
v_mul_f32 v249, v249, v113
v_accvgpr_write_b32 a116, v246
v_accvgpr_write_b32 a117, v247
v_accvgpr_write_b32 a118, v248
v_accvgpr_write_b32 a119, v249
v_accvgpr_read_b32 v242, a132
v_accvgpr_read_b32 v243, a133
v_accvgpr_read_b32 v244, a134
v_accvgpr_read_b32 v245, a135
v_mul_f32 v242, v242, v113
v_mul_f32 v243, v243, v113
v_mul_f32 v244, v244, v113
v_mul_f32 v245, v245, v113
v_accvgpr_write_b32 a132, v242
v_accvgpr_write_b32 a133, v243
v_accvgpr_write_b32 a134, v244
v_accvgpr_write_b32 a135, v245
v_accvgpr_read_b32 v246, a148
v_accvgpr_read_b32 v247, a149
v_accvgpr_read_b32 v248, a150
v_accvgpr_read_b32 v249, a151
v_mul_f32 v246, v246, v113
v_mul_f32 v247, v247, v113
v_mul_f32 v248, v248, v113
v_mul_f32 v249, v249, v113
v_accvgpr_write_b32 a148, v246
v_accvgpr_write_b32 a149, v247
v_accvgpr_write_b32 a150, v248
v_accvgpr_write_b32 a151, v249
v_accvgpr_read_b32 v242, a164
v_accvgpr_read_b32 v243, a165
v_accvgpr_read_b32 v244, a166
v_accvgpr_read_b32 v245, a167
v_mul_f32 v242, v242, v113
v_mul_f32 v243, v243, v113
v_mul_f32 v244, v244, v113
v_mul_f32 v245, v245, v113
v_accvgpr_write_b32 a164, v242
v_accvgpr_write_b32 a165, v243
v_accvgpr_write_b32 a166, v244
v_accvgpr_write_b32 a167, v245
v_accvgpr_read_b32 v246, a180
v_accvgpr_read_b32 v247, a181
v_accvgpr_read_b32 v248, a182
v_accvgpr_read_b32 v249, a183
v_mul_f32 v246, v246, v113
v_mul_f32 v247, v247, v113
v_mul_f32 v248, v248, v113
v_mul_f32 v249, v249, v113
v_accvgpr_write_b32 a180, v246
v_accvgpr_write_b32 a181, v247
v_accvgpr_write_b32 a182, v248
v_accvgpr_write_b32 a183, v249
v_max3_f32 v232, v80, v81, v82
v_max3_f32 v232, v232, v83, v84
v_max3_f32 v232, v232, v85, v86
v_max_f32 v232, v232, v87
v_mov_b32 v233, v232
s_nop 1
v_permlane32_swap_b32 v232, v233
v_max_f32 v232, v232, v233
v_mov_b32 v233, v232
s_nop 1
v_permlane16_swap_b32 v232, v233
v_max_f32 v232, v232, v233
v_max_f32 v232, s66, v232
v_min_f32_e64 v233, -v232, 0
v_exp_f32 v114, v233
v_sub_f32 v80, v80, v232
v_sub_f32 v81, v81, v232
v_sub_f32 v82, v82, v232
v_sub_f32 v83, v83, v232
v_sub_f32 v84, v84, v232
v_sub_f32 v85, v85, v232
v_sub_f32 v86, v86, v232
v_sub_f32 v87, v87, v232
v_sub_f32 v48, v48, v232
v_sub_f32 v49, v49, v232
v_sub_f32 v50, v50, v232
v_sub_f32 v51, v51, v232
v_sub_f32 v52, v52, v232
v_sub_f32 v53, v53, v232
v_sub_f32 v54, v54, v232
v_sub_f32 v55, v55, v232
v_sub_f32 v104, v104, v232
v_sub_f32 v105, v105, v232
v_sub_f32 v106, v106, v232
v_sub_f32 v107, v107, v232
v_exp_f32 v234, v80
v_exp_f32 v235, v81
v_exp_f32 v236, v82
v_exp_f32 v237, v83
v_exp_f32 v238, v84
v_exp_f32 v239, v85
v_exp_f32 v240, v86
v_exp_f32 v241, v87
v_mul_f32 v29, v29, v114
v_add_f32 v118, v234, v235
v_add_f32 v118, v118, v236
v_add_f32 v118, v118, v237
v_add_f32 v118, v118, v238
v_add_f32 v118, v118, v239
v_add_f32 v118, v118, v240
v_add_f32 v118, v118, v241
v_cvt_pk_bf16_f32 v224, v234, v235
v_cvt_pk_bf16_f32 v225, v236, v237
v_cvt_pk_bf16_f32 v226, v238, v239
v_cvt_pk_bf16_f32 v227, v240, v241
v_accvgpr_read_b32 v242, a8
v_accvgpr_read_b32 v243, a9
v_accvgpr_read_b32 v244, a10
v_accvgpr_read_b32 v245, a11
v_mul_f32 v242, v242, v114
v_mul_f32 v243, v243, v114
v_mul_f32 v244, v244, v114
v_mul_f32 v245, v245, v114
v_accvgpr_write_b32 a8, v242
v_accvgpr_write_b32 a9, v243
v_accvgpr_write_b32 a10, v244
v_accvgpr_write_b32 a11, v245
v_accvgpr_read_b32 v246, a24
v_accvgpr_read_b32 v247, a25
v_accvgpr_read_b32 v248, a26
v_accvgpr_read_b32 v249, a27
v_mul_f32 v246, v246, v114
v_mul_f32 v247, v247, v114
v_mul_f32 v248, v248, v114
v_mul_f32 v249, v249, v114
v_accvgpr_write_b32 a24, v246
v_accvgpr_write_b32 a25, v247
v_accvgpr_write_b32 a26, v248
v_accvgpr_write_b32 a27, v249
v_accvgpr_read_b32 v242, a40
v_accvgpr_read_b32 v243, a41
v_accvgpr_read_b32 v244, a42
v_accvgpr_read_b32 v245, a43
v_mul_f32 v242, v242, v114
v_mul_f32 v243, v243, v114
v_mul_f32 v244, v244, v114
v_mul_f32 v245, v245, v114
v_accvgpr_write_b32 a40, v242
v_accvgpr_write_b32 a41, v243
v_accvgpr_write_b32 a42, v244
v_accvgpr_write_b32 a43, v245
v_accvgpr_read_b32 v246, a56
v_accvgpr_read_b32 v247, a57
v_accvgpr_read_b32 v248, a58
v_accvgpr_read_b32 v249, a59
v_mul_f32 v246, v246, v114
v_mul_f32 v247, v247, v114
v_mul_f32 v248, v248, v114
v_mul_f32 v249, v249, v114
v_accvgpr_write_b32 a56, v246
v_accvgpr_write_b32 a57, v247
v_accvgpr_write_b32 a58, v248
v_accvgpr_write_b32 a59, v249
v_accvgpr_read_b32 v242, a72
v_accvgpr_read_b32 v243, a73
v_accvgpr_read_b32 v244, a74
v_accvgpr_read_b32 v245, a75
v_mul_f32 v242, v242, v114
v_mul_f32 v243, v243, v114
v_mul_f32 v244, v244, v114
v_mul_f32 v245, v245, v114
v_accvgpr_write_b32 a72, v242
v_accvgpr_write_b32 a73, v243
v_accvgpr_write_b32 a74, v244
v_accvgpr_write_b32 a75, v245
v_accvgpr_read_b32 v246, a88
v_accvgpr_read_b32 v247, a89
v_accvgpr_read_b32 v248, a90
v_accvgpr_read_b32 v249, a91
v_mul_f32 v246, v246, v114
v_mul_f32 v247, v247, v114
v_mul_f32 v248, v248, v114
v_mul_f32 v249, v249, v114
v_accvgpr_write_b32 a88, v246
v_accvgpr_write_b32 a89, v247
v_accvgpr_write_b32 a90, v248
v_accvgpr_write_b32 a91, v249
v_accvgpr_read_b32 v242, a104
v_accvgpr_read_b32 v243, a105
v_accvgpr_read_b32 v244, a106
v_accvgpr_read_b32 v245, a107
v_mul_f32 v242, v242, v114
v_mul_f32 v243, v243, v114
v_mul_f32 v244, v244, v114
v_mul_f32 v245, v245, v114
v_accvgpr_write_b32 a104, v242
v_accvgpr_write_b32 a105, v243
v_accvgpr_write_b32 a106, v244
v_accvgpr_write_b32 a107, v245
v_accvgpr_read_b32 v246, a120
v_accvgpr_read_b32 v247, a121
v_accvgpr_read_b32 v248, a122
v_accvgpr_read_b32 v249, a123
v_mul_f32 v246, v246, v114
v_mul_f32 v247, v247, v114
v_mul_f32 v248, v248, v114
v_mul_f32 v249, v249, v114
v_accvgpr_write_b32 a120, v246
v_accvgpr_write_b32 a121, v247
v_accvgpr_write_b32 a122, v248
v_accvgpr_write_b32 a123, v249
v_accvgpr_read_b32 v242, a136
v_accvgpr_read_b32 v243, a137
v_accvgpr_read_b32 v244, a138
v_accvgpr_read_b32 v245, a139
v_mul_f32 v242, v242, v114
v_mul_f32 v243, v243, v114
v_mul_f32 v244, v244, v114
v_mul_f32 v245, v245, v114
v_accvgpr_write_b32 a136, v242
v_accvgpr_write_b32 a137, v243
v_accvgpr_write_b32 a138, v244
v_accvgpr_write_b32 a139, v245
v_accvgpr_read_b32 v246, a152
v_accvgpr_read_b32 v247, a153
v_accvgpr_read_b32 v248, a154
v_accvgpr_read_b32 v249, a155
v_mul_f32 v246, v246, v114
v_mul_f32 v247, v247, v114
v_mul_f32 v248, v248, v114
v_mul_f32 v249, v249, v114
v_accvgpr_write_b32 a152, v246
v_accvgpr_write_b32 a153, v247
v_accvgpr_write_b32 a154, v248
v_accvgpr_write_b32 a155, v249
v_accvgpr_read_b32 v242, a168
v_accvgpr_read_b32 v243, a169
v_accvgpr_read_b32 v244, a170
v_accvgpr_read_b32 v245, a171
v_mul_f32 v242, v242, v114
v_mul_f32 v243, v243, v114
v_mul_f32 v244, v244, v114
v_mul_f32 v245, v245, v114
v_accvgpr_write_b32 a168, v242
v_accvgpr_write_b32 a169, v243
v_accvgpr_write_b32 a170, v244
v_accvgpr_write_b32 a171, v245
v_accvgpr_read_b32 v246, a184
v_accvgpr_read_b32 v247, a185
v_accvgpr_read_b32 v248, a186
v_accvgpr_read_b32 v249, a187
v_mul_f32 v246, v246, v114
v_mul_f32 v247, v247, v114
v_mul_f32 v248, v248, v114
v_mul_f32 v249, v249, v114
v_accvgpr_write_b32 a184, v246
v_accvgpr_write_b32 a185, v247
v_accvgpr_write_b32 a186, v248
v_accvgpr_write_b32 a187, v249
v_max3_f32 v232, v88, v89, v90
v_max3_f32 v232, v232, v91, v92
v_max3_f32 v232, v232, v93, v94
v_max_f32 v232, v232, v95
v_mov_b32 v233, v232
s_nop 1
v_permlane32_swap_b32 v232, v233
v_max_f32 v232, v232, v233
v_mov_b32 v233, v232
s_nop 1
v_permlane16_swap_b32 v232, v233
v_max_f32 v232, v232, v233
v_max_f32 v232, s66, v232
v_min_f32_e64 v233, -v232, 0
v_exp_f32 v115, v233
v_sub_f32 v88, v88, v232
v_sub_f32 v89, v89, v232
v_sub_f32 v90, v90, v232
v_sub_f32 v91, v91, v232
v_sub_f32 v92, v92, v232
v_sub_f32 v93, v93, v232
v_sub_f32 v94, v94, v232
v_sub_f32 v95, v95, v232
v_sub_f32 v56, v56, v232
v_sub_f32 v57, v57, v232
v_sub_f32 v58, v58, v232
v_sub_f32 v59, v59, v232
v_sub_f32 v60, v60, v232
v_sub_f32 v61, v61, v232
v_sub_f32 v62, v62, v232
v_sub_f32 v63, v63, v232
v_sub_f32 v108, v108, v232
v_sub_f32 v109, v109, v232
v_sub_f32 v110, v110, v232
v_sub_f32 v111, v111, v232
v_exp_f32 v234, v88
v_exp_f32 v235, v89
v_exp_f32 v236, v90
v_exp_f32 v237, v91
v_exp_f32 v238, v92
v_exp_f32 v239, v93
v_exp_f32 v240, v94
v_exp_f32 v241, v95
v_mul_f32 v30, v30, v115
v_add_f32 v119, v234, v235
v_add_f32 v119, v119, v236
v_add_f32 v119, v119, v237
v_add_f32 v119, v119, v238
v_add_f32 v119, v119, v239
v_add_f32 v119, v119, v240
v_add_f32 v119, v119, v241
v_cvt_pk_bf16_f32 v228, v234, v235
v_cvt_pk_bf16_f32 v229, v236, v237
v_cvt_pk_bf16_f32 v230, v238, v239
v_cvt_pk_bf16_f32 v231, v240, v241
v_accvgpr_read_b32 v242, a12
v_accvgpr_read_b32 v243, a13
v_accvgpr_read_b32 v244, a14
v_accvgpr_read_b32 v245, a15
v_mul_f32 v242, v242, v115
v_mul_f32 v243, v243, v115
v_mul_f32 v244, v244, v115
v_mul_f32 v245, v245, v115
v_accvgpr_write_b32 a12, v242
v_accvgpr_write_b32 a13, v243
v_accvgpr_write_b32 a14, v244
v_accvgpr_write_b32 a15, v245
v_accvgpr_read_b32 v246, a28
v_accvgpr_read_b32 v247, a29
v_accvgpr_read_b32 v248, a30
v_accvgpr_read_b32 v249, a31
v_mul_f32 v246, v246, v115
v_mul_f32 v247, v247, v115
v_mul_f32 v248, v248, v115
v_mul_f32 v249, v249, v115
v_accvgpr_write_b32 a28, v246
v_accvgpr_write_b32 a29, v247
v_accvgpr_write_b32 a30, v248
v_accvgpr_write_b32 a31, v249
v_accvgpr_read_b32 v242, a44
v_accvgpr_read_b32 v243, a45
v_accvgpr_read_b32 v244, a46
v_accvgpr_read_b32 v245, a47
v_mul_f32 v242, v242, v115
v_mul_f32 v243, v243, v115
v_mul_f32 v244, v244, v115
v_mul_f32 v245, v245, v115
v_accvgpr_write_b32 a44, v242
v_accvgpr_write_b32 a45, v243
v_accvgpr_write_b32 a46, v244
v_accvgpr_write_b32 a47, v245
v_accvgpr_read_b32 v246, a60
v_accvgpr_read_b32 v247, a61
v_accvgpr_read_b32 v248, a62
v_accvgpr_read_b32 v249, a63
v_mul_f32 v246, v246, v115
v_mul_f32 v247, v247, v115
v_mul_f32 v248, v248, v115
v_mul_f32 v249, v249, v115
v_accvgpr_write_b32 a60, v246
v_accvgpr_write_b32 a61, v247
v_accvgpr_write_b32 a62, v248
v_accvgpr_write_b32 a63, v249
v_accvgpr_read_b32 v242, a76
v_accvgpr_read_b32 v243, a77
v_accvgpr_read_b32 v244, a78
v_accvgpr_read_b32 v245, a79
v_mul_f32 v242, v242, v115
v_mul_f32 v243, v243, v115
v_mul_f32 v244, v244, v115
v_mul_f32 v245, v245, v115
v_accvgpr_write_b32 a76, v242
v_accvgpr_write_b32 a77, v243
v_accvgpr_write_b32 a78, v244
v_accvgpr_write_b32 a79, v245
v_accvgpr_read_b32 v246, a92
v_accvgpr_read_b32 v247, a93
v_accvgpr_read_b32 v248, a94
v_accvgpr_read_b32 v249, a95
v_mul_f32 v246, v246, v115
v_mul_f32 v247, v247, v115
v_mul_f32 v248, v248, v115
v_mul_f32 v249, v249, v115
v_accvgpr_write_b32 a92, v246
v_accvgpr_write_b32 a93, v247
v_accvgpr_write_b32 a94, v248
v_accvgpr_write_b32 a95, v249
v_accvgpr_read_b32 v242, a108
v_accvgpr_read_b32 v243, a109
v_accvgpr_read_b32 v244, a110
v_accvgpr_read_b32 v245, a111
v_mul_f32 v242, v242, v115
v_mul_f32 v243, v243, v115
v_mul_f32 v244, v244, v115
v_mul_f32 v245, v245, v115
v_accvgpr_write_b32 a108, v242
v_accvgpr_write_b32 a109, v243
v_accvgpr_write_b32 a110, v244
v_accvgpr_write_b32 a111, v245
v_accvgpr_read_b32 v246, a124
v_accvgpr_read_b32 v247, a125
v_accvgpr_read_b32 v248, a126
v_accvgpr_read_b32 v249, a127
v_mul_f32 v246, v246, v115
v_mul_f32 v247, v247, v115
v_mul_f32 v248, v248, v115
v_mul_f32 v249, v249, v115
v_accvgpr_write_b32 a124, v246
v_accvgpr_write_b32 a125, v247
v_accvgpr_write_b32 a126, v248
v_accvgpr_write_b32 a127, v249
v_accvgpr_read_b32 v242, a140
v_accvgpr_read_b32 v243, a141
v_accvgpr_read_b32 v244, a142
v_accvgpr_read_b32 v245, a143
v_mul_f32 v242, v242, v115
v_mul_f32 v243, v243, v115
v_mul_f32 v244, v244, v115
v_mul_f32 v245, v245, v115
v_accvgpr_write_b32 a140, v242
v_accvgpr_write_b32 a141, v243
v_accvgpr_write_b32 a142, v244
v_accvgpr_write_b32 a143, v245
v_accvgpr_read_b32 v246, a156
v_accvgpr_read_b32 v247, a157
v_accvgpr_read_b32 v248, a158
v_accvgpr_read_b32 v249, a159
v_mul_f32 v246, v246, v115
v_mul_f32 v247, v247, v115
v_mul_f32 v248, v248, v115
v_mul_f32 v249, v249, v115
v_accvgpr_write_b32 a156, v246
v_accvgpr_write_b32 a157, v247
v_accvgpr_write_b32 a158, v248
v_accvgpr_write_b32 a159, v249
v_accvgpr_read_b32 v242, a172
v_accvgpr_read_b32 v243, a173
v_accvgpr_read_b32 v244, a174
v_accvgpr_read_b32 v245, a175
v_mul_f32 v242, v242, v115
v_mul_f32 v243, v243, v115
v_mul_f32 v244, v244, v115
v_mul_f32 v245, v245, v115
v_accvgpr_write_b32 a172, v242
v_accvgpr_write_b32 a173, v243
v_accvgpr_write_b32 a174, v244
v_accvgpr_write_b32 a175, v245
v_accvgpr_read_b32 v246, a188
v_accvgpr_read_b32 v247, a189
v_accvgpr_read_b32 v248, a190
v_accvgpr_read_b32 v249, a191
v_mul_f32 v246, v246, v115
v_mul_f32 v247, v247, v115
v_mul_f32 v248, v248, v115
v_mul_f32 v249, v249, v115
v_accvgpr_write_b32 a188, v246
v_accvgpr_write_b32 a189, v247
v_accvgpr_write_b32 a190, v248
v_accvgpr_write_b32 a191, v249
s_mov_b32 s64, 0x43800000
s_mov_b32 s66, 0
s_nop 1
s_cmp_eq_u32 s50, 1
s_cbranch_scc1 RBACK1
s_cmp_eq_u32 s50, 3
s_cbranch_scc1 RBACK3
s_cmp_eq_u32 s50, 5
s_cbranch_scc1 RBACK5
s_cmp_eq_u32 s50, 7
s_cbranch_scc1 RBACK7
s_cmp_eq_u32 s50, 9
s_cbranch_scc1 RBACK9
s_endpgm
K1_DONE:
s_endpgm
.section .rodata,"a"
.p2align 6
.amdhsa_kernel attn_kernel
  .amdhsa_next_free_vgpr 512
  .amdhsa_next_free_sgpr 100
  .amdhsa_accum_offset 256
  .amdhsa_group_segment_fixed_size 0
  .amdhsa_kernarg_size 104
  .amdhsa_user_sgpr_count 2
  .amdhsa_user_sgpr_kernarg_segment_ptr 1
  .amdhsa_system_sgpr_workgroup_id_x 1
.end_amdhsa_kernel
.text
.globl oproj_kernel
.p2align 8
.type oproj_kernel,@function
oproj_kernel:
s_cmp_ge_u32 s2, 256
s_cbranch_scc1 K2_DONE
s_load_dwordx2 s[52:53], s[0:1], 32
s_load_dwordx2 s[54:55], s[0:1], 64
s_load_dwordx2 s[58:59], s[0:1], 96
s_and_b32 s6, s2, 7
s_lshr_b32 s4, s2, 3
s_lshr_b32 s3, s4, 2
s_and_b32 s4, s4, 3
v_lshrrev_b32 v2, 6, v0
v_and_b32 v1, 63, v0
s_nop 0
v_readfirstlane_b32 s5, v2
s_waitcnt lgkmcnt(0)
s_cmp_ge_u32 s6, 6
s_mov_b32 s24, 4194304
s_mov_b32 s62, 25165824
s_mov_b32 s66, 7864320
s_cselect_b32 s24, 33554432, s24
s_cselect_b32 s62, 6291456, s62
s_cselect_b32 s64, s54, s52
s_cselect_b32 s65, s55, s53
s_cselect_b32 s66, 1966080, s66
s_cselect_b32 s48, 3, 4
s_cselect_b32 s25, 48, 192
s_cselect_b32 s26, 6, 0
s_movk_i32 s27, 1024
s_cselect_b32 s27, 768, s27
s_sub_u32 s26, s6, s26
s_mul_i32 s26, s26, s27
s_add_u32 s60, s58, s24
s_addc_u32 s61, s59, 0
s_mov_b32 s63, 0x00020000
s_mov_b32 s67, 0x00020000
s_add_u32 s28, s58, 50331648
s_addc_u32 s29, s59, 0
s_mov_b32 s30, 20971520
s_mov_b32 s31, 0x00020000
s_lshl_b32 s7, s3, 4
s_lshl_b32 s27, s5, 2
s_add_u32 s7, s7, s27
s_mul_i32 s27, s7, s25
s_lshl_b32 s27, s27, 10
s_lshl_b32 s25, s25, 10
v_lshlrev_b32 v35, 4, v1
v_add_u32 v2, s27, v35
v_add_u32 v3, s25, v2
v_add_u32 v16, s25, v3
v_add_u32 v17, s25, v16
s_lshl_b32 s41, s26, 5
s_mul_i32 s40, s26, 1280
s_mul_i32 s27, s4, 320
s_add_u32 s40, s40, s27
s_sub_u32 s45, s66, 81920
s_add_u32 s45, s45, s27
s_mul_i32 s50, s6, 2621440
s_mul_i32 s27, s7, 20480
s_add_u32 s50, s50, s27
s_mul_i32 s27, s4, 5120
s_add_u32 s50, s50, s27
v_mov_b32 v4, v35
s_mul_i32 s24, s5, 320
v_add_u32 v36, s24, v1
v_mul_u32_u24 v37, 3277, v36
v_lshrrev_b32 v37, 16, v37
v_mul_u32_u24 v38, 20, v37
v_sub_u32 v38, v36, v38
v_bfe_u32 v39, v37, 2, 1
v_lshlrev_b32 v39, 1, v39
v_xor_b32 v38, v38, v39
v_lshlrev_b32 v38, 4, v38
v_mul_u32_u24 v40, 1280, v37
v_add_u32 v40, v40, v38
v_subrev_u32 v5, 0, v40
v_add_u32 v36, s24, v1
v_add_u32 v36, 64, v36
v_mul_u32_u24 v37, 3277, v36
v_lshrrev_b32 v37, 16, v37
v_mul_u32_u24 v38, 20, v37
v_sub_u32 v38, v36, v38
v_bfe_u32 v39, v37, 2, 1
v_lshlrev_b32 v39, 1, v39
v_xor_b32 v38, v38, v39
v_lshlrev_b32 v38, 4, v38
v_mul_u32_u24 v40, 1280, v37
v_add_u32 v40, v40, v38
v_subrev_u32 v6, 1024, v40
v_add_u32 v36, s24, v1
v_add_u32 v36, 128, v36
v_mul_u32_u24 v37, 3277, v36
v_lshrrev_b32 v37, 16, v37
v_mul_u32_u24 v38, 20, v37
v_sub_u32 v38, v36, v38
v_bfe_u32 v39, v37, 2, 1
v_lshlrev_b32 v39, 1, v39
v_xor_b32 v38, v38, v39
v_lshlrev_b32 v38, 4, v38
v_mul_u32_u24 v40, 1280, v37
v_add_u32 v40, v40, v38
v_subrev_u32 v7, 2048, v40
v_add_u32 v36, s24, v1
v_add_u32 v36, 192, v36
v_mul_u32_u24 v37, 3277, v36
v_lshrrev_b32 v37, 16, v37
v_mul_u32_u24 v38, 20, v37
v_sub_u32 v38, v36, v38
v_bfe_u32 v39, v37, 2, 1
v_lshlrev_b32 v39, 1, v39
v_xor_b32 v38, v38, v39
v_lshlrev_b32 v38, 4, v38
v_mul_u32_u24 v40, 1280, v37
v_add_u32 v40, v40, v38
v_subrev_u32 v8, 3072, v40
v_add_u32 v36, s24, v1
v_add_u32 v36, 256, v36
v_mul_u32_u24 v37, 3277, v36
v_lshrrev_b32 v37, 16, v37
v_mul_u32_u24 v38, 20, v37
v_sub_u32 v38, v36, v38
v_bfe_u32 v39, v37, 2, 1
v_lshlrev_b32 v39, 1, v39
v_xor_b32 v38, v38, v39
v_lshlrev_b32 v38, 4, v38
v_mul_u32_u24 v40, 1280, v37
v_add_u32 v40, v40, v38
v_mov_b32 v9, v40
v_lshrrev_b32 v36, 4, v1
v_bfe_u32 v37, v1, 2, 2
v_bfe_u32 v38, v1, 1, 1
v_and_b32 v39, 1, v1
v_lshlrev_b32 v41, 4, v38
v_lshl_add_u32 v41, v39, 3, v41
v_lshl_add_u32 v42, v36, 2, v37
v_mul_u32_u24 v43, 320, v42
v_add_u32 v43, v43, v41
v_and_b32 v40, 1, v36
v_lshlrev_b32 v40, 5, v40
v_add_u32 v10, v43, v40
v_sub_u32 v11, v43, v40
v_add_u32 v12, 61440, v10
v_add_u32 v13, 61440, v11
v_add_u32 v14, 122880, v10
v_add_u32 v15, 122880, v11
s_mul_i32 s44, s5, 5120
s_add_u32 m0, s44, 0
s_nop 0
buffer_load_dwordx4 v5, s[64:67], s40 offen offset:0 lds
buffer_load_dwordx4 v6, s[64:67], s40 offen offset:1024 lds
buffer_load_dwordx4 v7, s[64:67], s40 offen offset:2048 lds
buffer_load_dwordx4 v8, s[64:67], s40 offen offset:3072 lds
s_add_u32 m0, s44, 4096
s_nop 0
buffer_load_dwordx4 v9, s[64:67], s40 offen lds
s_add_u32 s40, s40, 81920
s_min_u32 s40, s40, s45
buffer_load_dwordx4 v[64:67], v2, s[60:63], s41 offen offset:0
buffer_load_dwordx4 v[68:71], v2, s[60:63], s41 offen offset:1024
buffer_load_dwordx4 v[72:75], v3, s[60:63], s41 offen offset:0
buffer_load_dwordx4 v[76:79], v3, s[60:63], s41 offen offset:1024
buffer_load_dwordx4 v[80:83], v16, s[60:63], s41 offen offset:0
buffer_load_dwordx4 v[84:87], v16, s[60:63], s41 offen offset:1024
buffer_load_dwordx4 v[88:91], v17, s[60:63], s41 offen offset:0
buffer_load_dwordx4 v[92:95], v17, s[60:63], s41 offen offset:1024
s_add_u32 s41, s41, 2048
s_add_u32 m0, s44, 20480
s_nop 0
buffer_load_dwordx4 v5, s[64:67], s40 offen offset:0 lds
buffer_load_dwordx4 v6, s[64:67], s40 offen offset:1024 lds
buffer_load_dwordx4 v7, s[64:67], s40 offen offset:2048 lds
buffer_load_dwordx4 v8, s[64:67], s40 offen offset:3072 lds
s_add_u32 m0, s44, 24576
s_nop 0
buffer_load_dwordx4 v9, s[64:67], s40 offen lds
s_add_u32 s40, s40, 81920
s_min_u32 s40, s40, s45
buffer_load_dwordx4 v[96:99], v2, s[60:63], s41 offen offset:0
buffer_load_dwordx4 v[100:103], v2, s[60:63], s41 offen offset:1024
buffer_load_dwordx4 v[104:107], v3, s[60:63], s41 offen offset:0
buffer_load_dwordx4 v[108:111], v3, s[60:63], s41 offen offset:1024
buffer_load_dwordx4 v[112:115], v16, s[60:63], s41 offen offset:0
buffer_load_dwordx4 v[116:119], v16, s[60:63], s41 offen offset:1024
buffer_load_dwordx4 v[120:123], v17, s[60:63], s41 offen offset:0
buffer_load_dwordx4 v[124:127], v17, s[60:63], s41 offen offset:1024
s_add_u32 s41, s41, 2048
s_add_u32 m0, s44, 40960
s_nop 0
buffer_load_dwordx4 v5, s[64:67], s40 offen offset:0 lds
buffer_load_dwordx4 v6, s[64:67], s40 offen offset:1024 lds
buffer_load_dwordx4 v7, s[64:67], s40 offen offset:2048 lds
buffer_load_dwordx4 v8, s[64:67], s40 offen offset:3072 lds
s_add_u32 m0, s44, 45056
s_nop 0
buffer_load_dwordx4 v9, s[64:67], s40 offen lds
s_add_u32 s40, s40, 81920
s_min_u32 s40, s40, s45
buffer_load_dwordx4 v[128:131], v2, s[60:63], s41 offen offset:0
buffer_load_dwordx4 v[132:135], v2, s[60:63], s41 offen offset:1024
buffer_load_dwordx4 v[136:139], v3, s[60:63], s41 offen offset:0
buffer_load_dwordx4 v[140:143], v3, s[60:63], s41 offen offset:1024
buffer_load_dwordx4 v[144:147], v16, s[60:63], s41 offen offset:0
buffer_load_dwordx4 v[148:151], v16, s[60:63], s41 offen offset:1024
buffer_load_dwordx4 v[152:155], v17, s[60:63], s41 offen offset:0
buffer_load_dwordx4 v[156:159], v17, s[60:63], s41 offen offset:1024
s_add_u32 s41, s41, 2048
s_add_u32 m0, s44, 61440
s_nop 0
buffer_load_dwordx4 v5, s[64:67], s40 offen offset:0 lds
buffer_load_dwordx4 v6, s[64:67], s40 offen offset:1024 lds
buffer_load_dwordx4 v7, s[64:67], s40 offen offset:2048 lds
buffer_load_dwordx4 v8, s[64:67], s40 offen offset:3072 lds
s_add_u32 m0, s44, 65536
s_nop 0
buffer_load_dwordx4 v9, s[64:67], s40 offen lds
s_add_u32 s40, s40, 81920
s_min_u32 s40, s40, s45
s_add_u32 m0, s44, 81920
s_nop 0
buffer_load_dwordx4 v5, s[64:67], s40 offen offset:0 lds
buffer_load_dwordx4 v6, s[64:67], s40 offen offset:1024 lds
buffer_load_dwordx4 v7, s[64:67], s40 offen offset:2048 lds
buffer_load_dwordx4 v8, s[64:67], s40 offen offset:3072 lds
s_add_u32 m0, s44, 86016
s_nop 0
buffer_load_dwordx4 v9, s[64:67], s40 offen lds
s_add_u32 s40, s40, 81920
s_min_u32 s40, s40, s45
s_add_u32 m0, s44, 102400
s_nop 0
buffer_load_dwordx4 v5, s[64:67], s40 offen offset:0 lds
buffer_load_dwordx4 v6, s[64:67], s40 offen offset:1024 lds
buffer_load_dwordx4 v7, s[64:67], s40 offen offset:2048 lds
buffer_load_dwordx4 v8, s[64:67], s40 offen offset:3072 lds
s_add_u32 m0, s44, 106496
s_nop 0
buffer_load_dwordx4 v9, s[64:67], s40 offen lds
s_add_u32 s40, s40, 81920
s_min_u32 s40, s40, s45
s_add_u32 m0, s44, 122880
s_nop 0
buffer_load_dwordx4 v5, s[64:67], s40 offen offset:0 lds
buffer_load_dwordx4 v6, s[64:67], s40 offen offset:1024 lds
buffer_load_dwordx4 v7, s[64:67], s40 offen offset:2048 lds
buffer_load_dwordx4 v8, s[64:67], s40 offen offset:3072 lds
s_add_u32 m0, s44, 126976
s_nop 0
buffer_load_dwordx4 v9, s[64:67], s40 offen lds
s_add_u32 s40, s40, 81920
s_min_u32 s40, s40, s45
v_accvgpr_write_b32 a0, 0
v_accvgpr_write_b32 a1, 0
v_accvgpr_write_b32 a2, 0
v_accvgpr_write_b32 a3, 0
v_accvgpr_write_b32 a4, 0
v_accvgpr_write_b32 a5, 0
v_accvgpr_write_b32 a6, 0
v_accvgpr_write_b32 a7, 0
v_accvgpr_write_b32 a8, 0
v_accvgpr_write_b32 a9, 0
v_accvgpr_write_b32 a10, 0
v_accvgpr_write_b32 a11, 0
v_accvgpr_write_b32 a12, 0
v_accvgpr_write_b32 a13, 0
v_accvgpr_write_b32 a14, 0
v_accvgpr_write_b32 a15, 0
v_accvgpr_write_b32 a16, 0
v_accvgpr_write_b32 a17, 0
v_accvgpr_write_b32 a18, 0
v_accvgpr_write_b32 a19, 0
v_accvgpr_write_b32 a20, 0
v_accvgpr_write_b32 a21, 0
v_accvgpr_write_b32 a22, 0
v_accvgpr_write_b32 a23, 0
v_accvgpr_write_b32 a24, 0
v_accvgpr_write_b32 a25, 0
v_accvgpr_write_b32 a26, 0
v_accvgpr_write_b32 a27, 0
v_accvgpr_write_b32 a28, 0
v_accvgpr_write_b32 a29, 0
v_accvgpr_write_b32 a30, 0
v_accvgpr_write_b32 a31, 0
v_accvgpr_write_b32 a32, 0
v_accvgpr_write_b32 a33, 0
v_accvgpr_write_b32 a34, 0
v_accvgpr_write_b32 a35, 0
v_accvgpr_write_b32 a36, 0
v_accvgpr_write_b32 a37, 0
v_accvgpr_write_b32 a38, 0
v_accvgpr_write_b32 a39, 0
v_accvgpr_write_b32 a40, 0
v_accvgpr_write_b32 a41, 0
v_accvgpr_write_b32 a42, 0
v_accvgpr_write_b32 a43, 0
v_accvgpr_write_b32 a44, 0
v_accvgpr_write_b32 a45, 0
v_accvgpr_write_b32 a46, 0
v_accvgpr_write_b32 a47, 0
v_accvgpr_write_b32 a48, 0
v_accvgpr_write_b32 a49, 0
v_accvgpr_write_b32 a50, 0
v_accvgpr_write_b32 a51, 0
v_accvgpr_write_b32 a52, 0
v_accvgpr_write_b32 a53, 0
v_accvgpr_write_b32 a54, 0
v_accvgpr_write_b32 a55, 0
v_accvgpr_write_b32 a56, 0
v_accvgpr_write_b32 a57, 0
v_accvgpr_write_b32 a58, 0
v_accvgpr_write_b32 a59, 0
v_accvgpr_write_b32 a60, 0
v_accvgpr_write_b32 a61, 0
v_accvgpr_write_b32 a62, 0
v_accvgpr_write_b32 a63, 0
v_accvgpr_write_b32 a64, 0
v_accvgpr_write_b32 a65, 0
v_accvgpr_write_b32 a66, 0
v_accvgpr_write_b32 a67, 0
v_accvgpr_write_b32 a68, 0
v_accvgpr_write_b32 a69, 0
v_accvgpr_write_b32 a70, 0
v_accvgpr_write_b32 a71, 0
v_accvgpr_write_b32 a72, 0
v_accvgpr_write_b32 a73, 0
v_accvgpr_write_b32 a74, 0
v_accvgpr_write_b32 a75, 0
v_accvgpr_write_b32 a76, 0
v_accvgpr_write_b32 a77, 0
v_accvgpr_write_b32 a78, 0
v_accvgpr_write_b32 a79, 0
v_accvgpr_write_b32 a80, 0
v_accvgpr_write_b32 a81, 0
v_accvgpr_write_b32 a82, 0
v_accvgpr_write_b32 a83, 0
v_accvgpr_write_b32 a84, 0
v_accvgpr_write_b32 a85, 0
v_accvgpr_write_b32 a86, 0
v_accvgpr_write_b32 a87, 0
v_accvgpr_write_b32 a88, 0
v_accvgpr_write_b32 a89, 0
v_accvgpr_write_b32 a90, 0
v_accvgpr_write_b32 a91, 0
v_accvgpr_write_b32 a92, 0
v_accvgpr_write_b32 a93, 0
v_accvgpr_write_b32 a94, 0
v_accvgpr_write_b32 a95, 0
v_accvgpr_write_b32 a96, 0
v_accvgpr_write_b32 a97, 0
v_accvgpr_write_b32 a98, 0
v_accvgpr_write_b32 a99, 0
v_accvgpr_write_b32 a100, 0
v_accvgpr_write_b32 a101, 0
v_accvgpr_write_b32 a102, 0
v_accvgpr_write_b32 a103, 0
v_accvgpr_write_b32 a104, 0
v_accvgpr_write_b32 a105, 0
v_accvgpr_write_b32 a106, 0
v_accvgpr_write_b32 a107, 0
v_accvgpr_write_b32 a108, 0
v_accvgpr_write_b32 a109, 0
v_accvgpr_write_b32 a110, 0
v_accvgpr_write_b32 a111, 0
v_accvgpr_write_b32 a112, 0
v_accvgpr_write_b32 a113, 0
v_accvgpr_write_b32 a114, 0
v_accvgpr_write_b32 a115, 0
v_accvgpr_write_b32 a116, 0
v_accvgpr_write_b32 a117, 0
v_accvgpr_write_b32 a118, 0
v_accvgpr_write_b32 a119, 0
v_accvgpr_write_b32 a120, 0
v_accvgpr_write_b32 a121, 0
v_accvgpr_write_b32 a122, 0
v_accvgpr_write_b32 a123, 0
v_accvgpr_write_b32 a124, 0
v_accvgpr_write_b32 a125, 0
v_accvgpr_write_b32 a126, 0
v_accvgpr_write_b32 a127, 0
v_accvgpr_write_b32 a128, 0
v_accvgpr_write_b32 a129, 0
v_accvgpr_write_b32 a130, 0
v_accvgpr_write_b32 a131, 0
v_accvgpr_write_b32 a132, 0
v_accvgpr_write_b32 a133, 0
v_accvgpr_write_b32 a134, 0
v_accvgpr_write_b32 a135, 0
v_accvgpr_write_b32 a136, 0
v_accvgpr_write_b32 a137, 0
v_accvgpr_write_b32 a138, 0
v_accvgpr_write_b32 a139, 0
v_accvgpr_write_b32 a140, 0
v_accvgpr_write_b32 a141, 0
v_accvgpr_write_b32 a142, 0
v_accvgpr_write_b32 a143, 0
v_accvgpr_write_b32 a144, 0
v_accvgpr_write_b32 a145, 0
v_accvgpr_write_b32 a146, 0
v_accvgpr_write_b32 a147, 0
v_accvgpr_write_b32 a148, 0
v_accvgpr_write_b32 a149, 0
v_accvgpr_write_b32 a150, 0
v_accvgpr_write_b32 a151, 0
v_accvgpr_write_b32 a152, 0
v_accvgpr_write_b32 a153, 0
v_accvgpr_write_b32 a154, 0
v_accvgpr_write_b32 a155, 0
v_accvgpr_write_b32 a156, 0
v_accvgpr_write_b32 a157, 0
v_accvgpr_write_b32 a158, 0
v_accvgpr_write_b32 a159, 0
s_waitcnt vmcnt(54)
s_barrier
ds_read_b64_tr_b16 v[192:193], v10 offset:0
ds_read_b64_tr_b16 v[194:195], v10 offset:5120
ds_read_b64_tr_b16 v[196:197], v11 offset:32
ds_read_b64_tr_b16 v[198:199], v11 offset:5152
ds_read_b64_tr_b16 v[200:201], v10 offset:64
ds_read_b64_tr_b16 v[202:203], v10 offset:5184
ds_read_b64_tr_b16 v[204:205], v11 offset:96
ds_read_b64_tr_b16 v[206:207], v11 offset:5216
ds_read_b64_tr_b16 v[208:209], v10 offset:128
ds_read_b64_tr_b16 v[210:211], v10 offset:5248
ds_read_b64_tr_b16 v[212:213], v11 offset:160
ds_read_b64_tr_b16 v[214:215], v11 offset:5280
ds_read_b64_tr_b16 v[216:217], v10 offset:192
ds_read_b64_tr_b16 v[218:219], v10 offset:5312
.p2align 6
K2_LOOP:
s_waitcnt vmcnt(26) lgkmcnt(6)
v_mfma_f32_16x16x32_bf16 a[0:3], v[192:195], v[64:67], a[0:3]
s_waitcnt vmcnt(41)
s_barrier
v_mfma_f32_16x16x32_bf16 a[4:7], v[192:195], v[72:75], a[4:7]
ds_read_b64_tr_b16 v[220:221], v11 offset:224
v_mfma_f32_16x16x32_bf16 a[8:11], v[192:195], v[80:83], a[8:11]
s_add_u32 m0, s44, 143360
ds_read_b64_tr_b16 v[222:223], v11 offset:5344
v_mfma_f32_16x16x32_bf16 a[12:15], v[192:195], v[88:91], a[12:15]
buffer_load_dwordx4 v5, s[64:67], s40 offen offset:0 lds
v_mfma_f32_16x16x32_bf16 a[16:19], v[196:199], v[64:67], a[16:19]
v_mfma_f32_16x16x32_bf16 a[20:23], v[196:199], v[72:75], a[20:23]
ds_read_b64_tr_b16 v[224:225], v10 offset:256
v_mfma_f32_16x16x32_bf16 a[24:27], v[196:199], v[80:83], a[24:27]
ds_read_b64_tr_b16 v[226:227], v10 offset:5376
v_mfma_f32_16x16x32_bf16 a[28:31], v[196:199], v[88:91], a[28:31]
buffer_load_dwordx4 v6, s[64:67], s40 offen offset:1024 lds
v_mfma_f32_16x16x32_bf16 a[32:35], v[200:203], v[64:67], a[32:35]
v_mfma_f32_16x16x32_bf16 a[36:39], v[200:203], v[72:75], a[36:39]
ds_read_b64_tr_b16 v[228:229], v11 offset:288
v_mfma_f32_16x16x32_bf16 a[40:43], v[200:203], v[80:83], a[40:43]
ds_read_b64_tr_b16 v[230:231], v11 offset:5408
v_mfma_f32_16x16x32_bf16 a[44:47], v[200:203], v[88:91], a[44:47]
buffer_load_dwordx4 v7, s[64:67], s40 offen offset:2048 lds
v_mfma_f32_16x16x32_bf16 a[48:51], v[204:207], v[64:67], a[48:51]
v_mfma_f32_16x16x32_bf16 a[52:55], v[204:207], v[72:75], a[52:55]
ds_read_b64_tr_b16 v[192:193], v10 offset:10240
v_mfma_f32_16x16x32_bf16 a[56:59], v[204:207], v[80:83], a[56:59]
ds_read_b64_tr_b16 v[194:195], v10 offset:15360
v_mfma_f32_16x16x32_bf16 a[60:63], v[204:207], v[88:91], a[60:63]
s_waitcnt lgkmcnt(6)
buffer_load_dwordx4 v8, s[64:67], s40 offen offset:3072 lds
v_mfma_f32_16x16x32_bf16 a[64:67], v[208:211], v[64:67], a[64:67]
v_mfma_f32_16x16x32_bf16 a[68:71], v[208:211], v[72:75], a[68:71]
s_add_u32 m0, s44, 147456
ds_read_b64_tr_b16 v[196:197], v11 offset:10272
v_mfma_f32_16x16x32_bf16 a[72:75], v[208:211], v[80:83], a[72:75]
ds_read_b64_tr_b16 v[198:199], v11 offset:15392
v_mfma_f32_16x16x32_bf16 a[76:79], v[208:211], v[88:91], a[76:79]
buffer_load_dwordx4 v9, s[64:67], s40 offen lds
v_mfma_f32_16x16x32_bf16 a[80:83], v[212:215], v[64:67], a[80:83]
v_mfma_f32_16x16x32_bf16 a[84:87], v[212:215], v[72:75], a[84:87]
ds_read_b64_tr_b16 v[200:201], v10 offset:10304
v_mfma_f32_16x16x32_bf16 a[88:91], v[212:215], v[80:83], a[88:91]
s_add_u32 s40, s40, 81920
s_min_u32 s40, s40, s45
ds_read_b64_tr_b16 v[202:203], v10 offset:15424
v_mfma_f32_16x16x32_bf16 a[92:95], v[212:215], v[88:91], a[92:95]
v_mfma_f32_16x16x32_bf16 a[96:99], v[216:219], v[64:67], a[96:99]
v_mfma_f32_16x16x32_bf16 a[100:103], v[216:219], v[72:75], a[100:103]
ds_read_b64_tr_b16 v[204:205], v11 offset:10336
v_mfma_f32_16x16x32_bf16 a[104:107], v[216:219], v[80:83], a[104:107]
ds_read_b64_tr_b16 v[206:207], v11 offset:15456
v_mfma_f32_16x16x32_bf16 a[108:111], v[216:219], v[88:91], a[108:111]
buffer_load_dwordx4 v[160:163], v2, s[60:63], s41 offen offset:0
v_mfma_f32_16x16x32_bf16 a[112:115], v[220:223], v[64:67], a[112:115]
v_mfma_f32_16x16x32_bf16 a[116:119], v[220:223], v[72:75], a[116:119]
ds_read_b64_tr_b16 v[208:209], v10 offset:10368
v_mfma_f32_16x16x32_bf16 a[120:123], v[220:223], v[80:83], a[120:123]
ds_read_b64_tr_b16 v[210:211], v10 offset:15488
v_mfma_f32_16x16x32_bf16 a[124:127], v[220:223], v[88:91], a[124:127]
s_waitcnt lgkmcnt(6)
v_mfma_f32_16x16x32_bf16 a[128:131], v[224:227], v[64:67], a[128:131]
v_mfma_f32_16x16x32_bf16 a[132:135], v[224:227], v[72:75], a[132:135]
buffer_load_dwordx4 v[164:167], v2, s[60:63], s41 offen offset:1024
ds_read_b64_tr_b16 v[212:213], v11 offset:10400
v_mfma_f32_16x16x32_bf16 a[136:139], v[224:227], v[80:83], a[136:139]
ds_read_b64_tr_b16 v[214:215], v11 offset:15520
v_mfma_f32_16x16x32_bf16 a[140:143], v[224:227], v[88:91], a[140:143]
v_mfma_f32_16x16x32_bf16 a[144:147], v[228:231], v[64:67], a[144:147]
v_mfma_f32_16x16x32_bf16 a[148:151], v[228:231], v[72:75], a[148:151]
ds_read_b64_tr_b16 v[216:217], v10 offset:10432
v_mfma_f32_16x16x32_bf16 a[152:155], v[228:231], v[80:83], a[152:155]
ds_read_b64_tr_b16 v[218:219], v10 offset:15552
v_mfma_f32_16x16x32_bf16 a[156:159], v[228:231], v[88:91], a[156:159]
buffer_load_dwordx4 v[168:171], v3, s[60:63], s41 offen offset:0
v_mfma_f32_16x16x32_bf16 a[0:3], v[192:195], v[68:71], a[0:3]
v_mfma_f32_16x16x32_bf16 a[4:7], v[192:195], v[76:79], a[4:7]
ds_read_b64_tr_b16 v[220:221], v11 offset:10464
v_mfma_f32_16x16x32_bf16 a[8:11], v[192:195], v[84:87], a[8:11]
ds_read_b64_tr_b16 v[222:223], v11 offset:15584
v_mfma_f32_16x16x32_bf16 a[12:15], v[192:195], v[92:95], a[12:15]
v_mfma_f32_16x16x32_bf16 a[16:19], v[196:199], v[68:71], a[16:19]
v_mfma_f32_16x16x32_bf16 a[20:23], v[196:199], v[76:79], a[20:23]
buffer_load_dwordx4 v[172:175], v3, s[60:63], s41 offen offset:1024
ds_read_b64_tr_b16 v[224:225], v10 offset:10496
v_mfma_f32_16x16x32_bf16 a[24:27], v[196:199], v[84:87], a[24:27]
ds_read_b64_tr_b16 v[226:227], v10 offset:15616
v_mfma_f32_16x16x32_bf16 a[28:31], v[196:199], v[92:95], a[28:31]
s_waitcnt lgkmcnt(6)
v_mfma_f32_16x16x32_bf16 a[32:35], v[200:203], v[68:71], a[32:35]
v_mfma_f32_16x16x32_bf16 a[36:39], v[200:203], v[76:79], a[36:39]
ds_read_b64_tr_b16 v[228:229], v11 offset:10528
v_mfma_f32_16x16x32_bf16 a[40:43], v[200:203], v[84:87], a[40:43]
ds_read_b64_tr_b16 v[230:231], v11 offset:15648
v_mfma_f32_16x16x32_bf16 a[44:47], v[200:203], v[92:95], a[44:47]
buffer_load_dwordx4 v[176:179], v16, s[60:63], s41 offen offset:0
v_mfma_f32_16x16x32_bf16 a[48:51], v[204:207], v[68:71], a[48:51]
v_mfma_f32_16x16x32_bf16 a[52:55], v[204:207], v[76:79], a[52:55]
ds_read_b64_tr_b16 v[192:193], v10 offset:20480
v_mfma_f32_16x16x32_bf16 a[56:59], v[204:207], v[84:87], a[56:59]
ds_read_b64_tr_b16 v[194:195], v10 offset:25600
v_mfma_f32_16x16x32_bf16 a[60:63], v[204:207], v[92:95], a[60:63]
v_mfma_f32_16x16x32_bf16 a[64:67], v[208:211], v[68:71], a[64:67]
v_mfma_f32_16x16x32_bf16 a[68:71], v[208:211], v[76:79], a[68:71]
buffer_load_dwordx4 v[180:183], v16, s[60:63], s41 offen offset:1024
ds_read_b64_tr_b16 v[196:197], v11 offset:20512
v_mfma_f32_16x16x32_bf16 a[72:75], v[208:211], v[84:87], a[72:75]
ds_read_b64_tr_b16 v[198:199], v11 offset:25632
v_mfma_f32_16x16x32_bf16 a[76:79], v[208:211], v[92:95], a[76:79]
v_mfma_f32_16x16x32_bf16 a[80:83], v[212:215], v[68:71], a[80:83]
v_mfma_f32_16x16x32_bf16 a[84:87], v[212:215], v[76:79], a[84:87]
ds_read_b64_tr_b16 v[200:201], v10 offset:20544
v_mfma_f32_16x16x32_bf16 a[88:91], v[212:215], v[84:87], a[88:91]
ds_read_b64_tr_b16 v[202:203], v10 offset:25664
v_mfma_f32_16x16x32_bf16 a[92:95], v[212:215], v[92:95], a[92:95]
s_waitcnt lgkmcnt(6)
buffer_load_dwordx4 v[184:187], v17, s[60:63], s41 offen offset:0
v_mfma_f32_16x16x32_bf16 a[96:99], v[216:219], v[68:71], a[96:99]
v_mfma_f32_16x16x32_bf16 a[100:103], v[216:219], v[76:79], a[100:103]
ds_read_b64_tr_b16 v[204:205], v11 offset:20576
v_mfma_f32_16x16x32_bf16 a[104:107], v[216:219], v[84:87], a[104:107]
ds_read_b64_tr_b16 v[206:207], v11 offset:25696
v_mfma_f32_16x16x32_bf16 a[108:111], v[216:219], v[92:95], a[108:111]
v_mfma_f32_16x16x32_bf16 a[112:115], v[220:223], v[68:71], a[112:115]
v_mfma_f32_16x16x32_bf16 a[116:119], v[220:223], v[76:79], a[116:119]
buffer_load_dwordx4 v[188:191], v17, s[60:63], s41 offen offset:1024
ds_read_b64_tr_b16 v[208:209], v10 offset:20608
v_mfma_f32_16x16x32_bf16 a[120:123], v[220:223], v[84:87], a[120:123]
ds_read_b64_tr_b16 v[210:211], v10 offset:25728
v_mfma_f32_16x16x32_bf16 a[124:127], v[220:223], v[92:95], a[124:127]
v_mfma_f32_16x16x32_bf16 a[128:131], v[224:227], v[68:71], a[128:131]
v_mfma_f32_16x16x32_bf16 a[132:135], v[224:227], v[76:79], a[132:135]
ds_read_b64_tr_b16 v[212:213], v11 offset:20640
v_mfma_f32_16x16x32_bf16 a[136:139], v[224:227], v[84:87], a[136:139]
s_add_u32 s41, s41, 2048
ds_read_b64_tr_b16 v[214:215], v11 offset:25760
v_mfma_f32_16x16x32_bf16 a[140:143], v[224:227], v[92:95], a[140:143]
v_mfma_f32_16x16x32_bf16 a[144:147], v[228:231], v[68:71], a[144:147]
v_mfma_f32_16x16x32_bf16 a[148:151], v[228:231], v[76:79], a[148:151]
ds_read_b64_tr_b16 v[216:217], v10 offset:20672
v_mfma_f32_16x16x32_bf16 a[152:155], v[228:231], v[84:87], a[152:155]
ds_read_b64_tr_b16 v[218:219], v10 offset:25792
v_mfma_f32_16x16x32_bf16 a[156:159], v[228:231], v[92:95], a[156:159]
s_waitcnt vmcnt(26) lgkmcnt(6)
v_mfma_f32_16x16x32_bf16 a[0:3], v[192:195], v[96:99], a[0:3]
s_waitcnt vmcnt(41)
s_barrier
v_mfma_f32_16x16x32_bf16 a[4:7], v[192:195], v[104:107], a[4:7]
ds_read_b64_tr_b16 v[220:221], v11 offset:20704
v_mfma_f32_16x16x32_bf16 a[8:11], v[192:195], v[112:115], a[8:11]
s_add_u32 m0, s44, 0
ds_read_b64_tr_b16 v[222:223], v11 offset:25824
v_mfma_f32_16x16x32_bf16 a[12:15], v[192:195], v[120:123], a[12:15]
buffer_load_dwordx4 v5, s[64:67], s40 offen offset:0 lds
v_mfma_f32_16x16x32_bf16 a[16:19], v[196:199], v[96:99], a[16:19]
v_mfma_f32_16x16x32_bf16 a[20:23], v[196:199], v[104:107], a[20:23]
ds_read_b64_tr_b16 v[224:225], v10 offset:20736
v_mfma_f32_16x16x32_bf16 a[24:27], v[196:199], v[112:115], a[24:27]
ds_read_b64_tr_b16 v[226:227], v10 offset:25856
v_mfma_f32_16x16x32_bf16 a[28:31], v[196:199], v[120:123], a[28:31]
buffer_load_dwordx4 v6, s[64:67], s40 offen offset:1024 lds
v_mfma_f32_16x16x32_bf16 a[32:35], v[200:203], v[96:99], a[32:35]
v_mfma_f32_16x16x32_bf16 a[36:39], v[200:203], v[104:107], a[36:39]
ds_read_b64_tr_b16 v[228:229], v11 offset:20768
v_mfma_f32_16x16x32_bf16 a[40:43], v[200:203], v[112:115], a[40:43]
ds_read_b64_tr_b16 v[230:231], v11 offset:25888
v_mfma_f32_16x16x32_bf16 a[44:47], v[200:203], v[120:123], a[44:47]
buffer_load_dwordx4 v7, s[64:67], s40 offen offset:2048 lds
v_mfma_f32_16x16x32_bf16 a[48:51], v[204:207], v[96:99], a[48:51]
v_mfma_f32_16x16x32_bf16 a[52:55], v[204:207], v[104:107], a[52:55]
ds_read_b64_tr_b16 v[192:193], v10 offset:30720
v_mfma_f32_16x16x32_bf16 a[56:59], v[204:207], v[112:115], a[56:59]
ds_read_b64_tr_b16 v[194:195], v10 offset:35840
v_mfma_f32_16x16x32_bf16 a[60:63], v[204:207], v[120:123], a[60:63]
s_waitcnt lgkmcnt(6)
buffer_load_dwordx4 v8, s[64:67], s40 offen offset:3072 lds
v_mfma_f32_16x16x32_bf16 a[64:67], v[208:211], v[96:99], a[64:67]
v_mfma_f32_16x16x32_bf16 a[68:71], v[208:211], v[104:107], a[68:71]
s_add_u32 m0, s44, 4096
ds_read_b64_tr_b16 v[196:197], v11 offset:30752
v_mfma_f32_16x16x32_bf16 a[72:75], v[208:211], v[112:115], a[72:75]
ds_read_b64_tr_b16 v[198:199], v11 offset:35872
v_mfma_f32_16x16x32_bf16 a[76:79], v[208:211], v[120:123], a[76:79]
buffer_load_dwordx4 v9, s[64:67], s40 offen lds
v_mfma_f32_16x16x32_bf16 a[80:83], v[212:215], v[96:99], a[80:83]
v_mfma_f32_16x16x32_bf16 a[84:87], v[212:215], v[104:107], a[84:87]
ds_read_b64_tr_b16 v[200:201], v10 offset:30784
v_mfma_f32_16x16x32_bf16 a[88:91], v[212:215], v[112:115], a[88:91]
s_add_u32 s40, s40, 81920
s_min_u32 s40, s40, s45
ds_read_b64_tr_b16 v[202:203], v10 offset:35904
v_mfma_f32_16x16x32_bf16 a[92:95], v[212:215], v[120:123], a[92:95]
v_mfma_f32_16x16x32_bf16 a[96:99], v[216:219], v[96:99], a[96:99]
v_mfma_f32_16x16x32_bf16 a[100:103], v[216:219], v[104:107], a[100:103]
ds_read_b64_tr_b16 v[204:205], v11 offset:30816
v_mfma_f32_16x16x32_bf16 a[104:107], v[216:219], v[112:115], a[104:107]
ds_read_b64_tr_b16 v[206:207], v11 offset:35936
v_mfma_f32_16x16x32_bf16 a[108:111], v[216:219], v[120:123], a[108:111]
buffer_load_dwordx4 v[64:67], v2, s[60:63], s41 offen offset:0
v_mfma_f32_16x16x32_bf16 a[112:115], v[220:223], v[96:99], a[112:115]
v_mfma_f32_16x16x32_bf16 a[116:119], v[220:223], v[104:107], a[116:119]
ds_read_b64_tr_b16 v[208:209], v10 offset:30848
v_mfma_f32_16x16x32_bf16 a[120:123], v[220:223], v[112:115], a[120:123]
ds_read_b64_tr_b16 v[210:211], v10 offset:35968
v_mfma_f32_16x16x32_bf16 a[124:127], v[220:223], v[120:123], a[124:127]
s_waitcnt lgkmcnt(6)
v_mfma_f32_16x16x32_bf16 a[128:131], v[224:227], v[96:99], a[128:131]
v_mfma_f32_16x16x32_bf16 a[132:135], v[224:227], v[104:107], a[132:135]
buffer_load_dwordx4 v[68:71], v2, s[60:63], s41 offen offset:1024
ds_read_b64_tr_b16 v[212:213], v11 offset:30880
v_mfma_f32_16x16x32_bf16 a[136:139], v[224:227], v[112:115], a[136:139]
ds_read_b64_tr_b16 v[214:215], v11 offset:36000
v_mfma_f32_16x16x32_bf16 a[140:143], v[224:227], v[120:123], a[140:143]
v_mfma_f32_16x16x32_bf16 a[144:147], v[228:231], v[96:99], a[144:147]
v_mfma_f32_16x16x32_bf16 a[148:151], v[228:231], v[104:107], a[148:151]
ds_read_b64_tr_b16 v[216:217], v10 offset:30912
v_mfma_f32_16x16x32_bf16 a[152:155], v[228:231], v[112:115], a[152:155]
ds_read_b64_tr_b16 v[218:219], v10 offset:36032
v_mfma_f32_16x16x32_bf16 a[156:159], v[228:231], v[120:123], a[156:159]
buffer_load_dwordx4 v[72:75], v3, s[60:63], s41 offen offset:0
v_mfma_f32_16x16x32_bf16 a[0:3], v[192:195], v[100:103], a[0:3]
v_mfma_f32_16x16x32_bf16 a[4:7], v[192:195], v[108:111], a[4:7]
ds_read_b64_tr_b16 v[220:221], v11 offset:30944
v_mfma_f32_16x16x32_bf16 a[8:11], v[192:195], v[116:119], a[8:11]
ds_read_b64_tr_b16 v[222:223], v11 offset:36064
v_mfma_f32_16x16x32_bf16 a[12:15], v[192:195], v[124:127], a[12:15]
v_mfma_f32_16x16x32_bf16 a[16:19], v[196:199], v[100:103], a[16:19]
v_mfma_f32_16x16x32_bf16 a[20:23], v[196:199], v[108:111], a[20:23]
buffer_load_dwordx4 v[76:79], v3, s[60:63], s41 offen offset:1024
ds_read_b64_tr_b16 v[224:225], v10 offset:30976
v_mfma_f32_16x16x32_bf16 a[24:27], v[196:199], v[116:119], a[24:27]
ds_read_b64_tr_b16 v[226:227], v10 offset:36096
v_mfma_f32_16x16x32_bf16 a[28:31], v[196:199], v[124:127], a[28:31]
s_waitcnt lgkmcnt(6)
v_mfma_f32_16x16x32_bf16 a[32:35], v[200:203], v[100:103], a[32:35]
v_mfma_f32_16x16x32_bf16 a[36:39], v[200:203], v[108:111], a[36:39]
ds_read_b64_tr_b16 v[228:229], v11 offset:31008
v_mfma_f32_16x16x32_bf16 a[40:43], v[200:203], v[116:119], a[40:43]
ds_read_b64_tr_b16 v[230:231], v11 offset:36128
v_mfma_f32_16x16x32_bf16 a[44:47], v[200:203], v[124:127], a[44:47]
buffer_load_dwordx4 v[80:83], v16, s[60:63], s41 offen offset:0
v_mfma_f32_16x16x32_bf16 a[48:51], v[204:207], v[100:103], a[48:51]
v_mfma_f32_16x16x32_bf16 a[52:55], v[204:207], v[108:111], a[52:55]
ds_read_b64_tr_b16 v[192:193], v10 offset:40960
v_mfma_f32_16x16x32_bf16 a[56:59], v[204:207], v[116:119], a[56:59]
ds_read_b64_tr_b16 v[194:195], v10 offset:46080
v_mfma_f32_16x16x32_bf16 a[60:63], v[204:207], v[124:127], a[60:63]
v_mfma_f32_16x16x32_bf16 a[64:67], v[208:211], v[100:103], a[64:67]
v_mfma_f32_16x16x32_bf16 a[68:71], v[208:211], v[108:111], a[68:71]
buffer_load_dwordx4 v[84:87], v16, s[60:63], s41 offen offset:1024
ds_read_b64_tr_b16 v[196:197], v11 offset:40992
v_mfma_f32_16x16x32_bf16 a[72:75], v[208:211], v[116:119], a[72:75]
ds_read_b64_tr_b16 v[198:199], v11 offset:46112
v_mfma_f32_16x16x32_bf16 a[76:79], v[208:211], v[124:127], a[76:79]
v_mfma_f32_16x16x32_bf16 a[80:83], v[212:215], v[100:103], a[80:83]
v_mfma_f32_16x16x32_bf16 a[84:87], v[212:215], v[108:111], a[84:87]
ds_read_b64_tr_b16 v[200:201], v10 offset:41024
v_mfma_f32_16x16x32_bf16 a[88:91], v[212:215], v[116:119], a[88:91]
ds_read_b64_tr_b16 v[202:203], v10 offset:46144
v_mfma_f32_16x16x32_bf16 a[92:95], v[212:215], v[124:127], a[92:95]
s_waitcnt lgkmcnt(6)
buffer_load_dwordx4 v[88:91], v17, s[60:63], s41 offen offset:0
v_mfma_f32_16x16x32_bf16 a[96:99], v[216:219], v[100:103], a[96:99]
v_mfma_f32_16x16x32_bf16 a[100:103], v[216:219], v[108:111], a[100:103]
ds_read_b64_tr_b16 v[204:205], v11 offset:41056
v_mfma_f32_16x16x32_bf16 a[104:107], v[216:219], v[116:119], a[104:107]
ds_read_b64_tr_b16 v[206:207], v11 offset:46176
v_mfma_f32_16x16x32_bf16 a[108:111], v[216:219], v[124:127], a[108:111]
v_mfma_f32_16x16x32_bf16 a[112:115], v[220:223], v[100:103], a[112:115]
v_mfma_f32_16x16x32_bf16 a[116:119], v[220:223], v[108:111], a[116:119]
buffer_load_dwordx4 v[92:95], v17, s[60:63], s41 offen offset:1024
ds_read_b64_tr_b16 v[208:209], v10 offset:41088
v_mfma_f32_16x16x32_bf16 a[120:123], v[220:223], v[116:119], a[120:123]
ds_read_b64_tr_b16 v[210:211], v10 offset:46208
v_mfma_f32_16x16x32_bf16 a[124:127], v[220:223], v[124:127], a[124:127]
v_mfma_f32_16x16x32_bf16 a[128:131], v[224:227], v[100:103], a[128:131]
v_mfma_f32_16x16x32_bf16 a[132:135], v[224:227], v[108:111], a[132:135]
ds_read_b64_tr_b16 v[212:213], v11 offset:41120
v_mfma_f32_16x16x32_bf16 a[136:139], v[224:227], v[116:119], a[136:139]
s_add_u32 s41, s41, 2048
ds_read_b64_tr_b16 v[214:215], v11 offset:46240
v_mfma_f32_16x16x32_bf16 a[140:143], v[224:227], v[124:127], a[140:143]
v_mfma_f32_16x16x32_bf16 a[144:147], v[228:231], v[100:103], a[144:147]
v_mfma_f32_16x16x32_bf16 a[148:151], v[228:231], v[108:111], a[148:151]
ds_read_b64_tr_b16 v[216:217], v10 offset:41152
v_mfma_f32_16x16x32_bf16 a[152:155], v[228:231], v[116:119], a[152:155]
ds_read_b64_tr_b16 v[218:219], v10 offset:46272
v_mfma_f32_16x16x32_bf16 a[156:159], v[228:231], v[124:127], a[156:159]
s_waitcnt vmcnt(26) lgkmcnt(6)
v_mfma_f32_16x16x32_bf16 a[0:3], v[192:195], v[128:131], a[0:3]
s_waitcnt vmcnt(41)
s_barrier
v_mfma_f32_16x16x32_bf16 a[4:7], v[192:195], v[136:139], a[4:7]
ds_read_b64_tr_b16 v[220:221], v11 offset:41184
v_mfma_f32_16x16x32_bf16 a[8:11], v[192:195], v[144:147], a[8:11]
s_add_u32 m0, s44, 20480
ds_read_b64_tr_b16 v[222:223], v11 offset:46304
v_mfma_f32_16x16x32_bf16 a[12:15], v[192:195], v[152:155], a[12:15]
buffer_load_dwordx4 v5, s[64:67], s40 offen offset:0 lds
v_mfma_f32_16x16x32_bf16 a[16:19], v[196:199], v[128:131], a[16:19]
v_mfma_f32_16x16x32_bf16 a[20:23], v[196:199], v[136:139], a[20:23]
ds_read_b64_tr_b16 v[224:225], v10 offset:41216
v_mfma_f32_16x16x32_bf16 a[24:27], v[196:199], v[144:147], a[24:27]
ds_read_b64_tr_b16 v[226:227], v10 offset:46336
v_mfma_f32_16x16x32_bf16 a[28:31], v[196:199], v[152:155], a[28:31]
buffer_load_dwordx4 v6, s[64:67], s40 offen offset:1024 lds
v_mfma_f32_16x16x32_bf16 a[32:35], v[200:203], v[128:131], a[32:35]
v_mfma_f32_16x16x32_bf16 a[36:39], v[200:203], v[136:139], a[36:39]
ds_read_b64_tr_b16 v[228:229], v11 offset:41248
v_mfma_f32_16x16x32_bf16 a[40:43], v[200:203], v[144:147], a[40:43]
ds_read_b64_tr_b16 v[230:231], v11 offset:46368
v_mfma_f32_16x16x32_bf16 a[44:47], v[200:203], v[152:155], a[44:47]
buffer_load_dwordx4 v7, s[64:67], s40 offen offset:2048 lds
v_mfma_f32_16x16x32_bf16 a[48:51], v[204:207], v[128:131], a[48:51]
v_mfma_f32_16x16x32_bf16 a[52:55], v[204:207], v[136:139], a[52:55]
ds_read_b64_tr_b16 v[192:193], v10 offset:51200
v_mfma_f32_16x16x32_bf16 a[56:59], v[204:207], v[144:147], a[56:59]
ds_read_b64_tr_b16 v[194:195], v10 offset:56320
v_mfma_f32_16x16x32_bf16 a[60:63], v[204:207], v[152:155], a[60:63]
s_waitcnt lgkmcnt(6)
buffer_load_dwordx4 v8, s[64:67], s40 offen offset:3072 lds
v_mfma_f32_16x16x32_bf16 a[64:67], v[208:211], v[128:131], a[64:67]
v_mfma_f32_16x16x32_bf16 a[68:71], v[208:211], v[136:139], a[68:71]
s_add_u32 m0, s44, 24576
ds_read_b64_tr_b16 v[196:197], v11 offset:51232
v_mfma_f32_16x16x32_bf16 a[72:75], v[208:211], v[144:147], a[72:75]
ds_read_b64_tr_b16 v[198:199], v11 offset:56352
v_mfma_f32_16x16x32_bf16 a[76:79], v[208:211], v[152:155], a[76:79]
buffer_load_dwordx4 v9, s[64:67], s40 offen lds
v_mfma_f32_16x16x32_bf16 a[80:83], v[212:215], v[128:131], a[80:83]
v_mfma_f32_16x16x32_bf16 a[84:87], v[212:215], v[136:139], a[84:87]
ds_read_b64_tr_b16 v[200:201], v10 offset:51264
v_mfma_f32_16x16x32_bf16 a[88:91], v[212:215], v[144:147], a[88:91]
s_add_u32 s40, s40, 81920
s_min_u32 s40, s40, s45
ds_read_b64_tr_b16 v[202:203], v10 offset:56384
v_mfma_f32_16x16x32_bf16 a[92:95], v[212:215], v[152:155], a[92:95]
v_mfma_f32_16x16x32_bf16 a[96:99], v[216:219], v[128:131], a[96:99]
v_mfma_f32_16x16x32_bf16 a[100:103], v[216:219], v[136:139], a[100:103]
ds_read_b64_tr_b16 v[204:205], v11 offset:51296
v_mfma_f32_16x16x32_bf16 a[104:107], v[216:219], v[144:147], a[104:107]
ds_read_b64_tr_b16 v[206:207], v11 offset:56416
v_mfma_f32_16x16x32_bf16 a[108:111], v[216:219], v[152:155], a[108:111]
buffer_load_dwordx4 v[96:99], v2, s[60:63], s41 offen offset:0
v_mfma_f32_16x16x32_bf16 a[112:115], v[220:223], v[128:131], a[112:115]
v_mfma_f32_16x16x32_bf16 a[116:119], v[220:223], v[136:139], a[116:119]
ds_read_b64_tr_b16 v[208:209], v10 offset:51328
v_mfma_f32_16x16x32_bf16 a[120:123], v[220:223], v[144:147], a[120:123]
ds_read_b64_tr_b16 v[210:211], v10 offset:56448
v_mfma_f32_16x16x32_bf16 a[124:127], v[220:223], v[152:155], a[124:127]
s_waitcnt lgkmcnt(6)
v_mfma_f32_16x16x32_bf16 a[128:131], v[224:227], v[128:131], a[128:131]
v_mfma_f32_16x16x32_bf16 a[132:135], v[224:227], v[136:139], a[132:135]
buffer_load_dwordx4 v[100:103], v2, s[60:63], s41 offen offset:1024
ds_read_b64_tr_b16 v[212:213], v11 offset:51360
v_mfma_f32_16x16x32_bf16 a[136:139], v[224:227], v[144:147], a[136:139]
ds_read_b64_tr_b16 v[214:215], v11 offset:56480
v_mfma_f32_16x16x32_bf16 a[140:143], v[224:227], v[152:155], a[140:143]
v_mfma_f32_16x16x32_bf16 a[144:147], v[228:231], v[128:131], a[144:147]
v_mfma_f32_16x16x32_bf16 a[148:151], v[228:231], v[136:139], a[148:151]
ds_read_b64_tr_b16 v[216:217], v10 offset:51392
v_mfma_f32_16x16x32_bf16 a[152:155], v[228:231], v[144:147], a[152:155]
ds_read_b64_tr_b16 v[218:219], v10 offset:56512
v_mfma_f32_16x16x32_bf16 a[156:159], v[228:231], v[152:155], a[156:159]
buffer_load_dwordx4 v[104:107], v3, s[60:63], s41 offen offset:0
v_mfma_f32_16x16x32_bf16 a[0:3], v[192:195], v[132:135], a[0:3]
v_mfma_f32_16x16x32_bf16 a[4:7], v[192:195], v[140:143], a[4:7]
ds_read_b64_tr_b16 v[220:221], v11 offset:51424
v_mfma_f32_16x16x32_bf16 a[8:11], v[192:195], v[148:151], a[8:11]
ds_read_b64_tr_b16 v[222:223], v11 offset:56544
v_mfma_f32_16x16x32_bf16 a[12:15], v[192:195], v[156:159], a[12:15]
v_mfma_f32_16x16x32_bf16 a[16:19], v[196:199], v[132:135], a[16:19]
v_mfma_f32_16x16x32_bf16 a[20:23], v[196:199], v[140:143], a[20:23]
buffer_load_dwordx4 v[108:111], v3, s[60:63], s41 offen offset:1024
ds_read_b64_tr_b16 v[224:225], v10 offset:51456
v_mfma_f32_16x16x32_bf16 a[24:27], v[196:199], v[148:151], a[24:27]
ds_read_b64_tr_b16 v[226:227], v10 offset:56576
v_mfma_f32_16x16x32_bf16 a[28:31], v[196:199], v[156:159], a[28:31]
s_waitcnt lgkmcnt(6)
v_mfma_f32_16x16x32_bf16 a[32:35], v[200:203], v[132:135], a[32:35]
v_mfma_f32_16x16x32_bf16 a[36:39], v[200:203], v[140:143], a[36:39]
ds_read_b64_tr_b16 v[228:229], v11 offset:51488
v_mfma_f32_16x16x32_bf16 a[40:43], v[200:203], v[148:151], a[40:43]
ds_read_b64_tr_b16 v[230:231], v11 offset:56608
v_mfma_f32_16x16x32_bf16 a[44:47], v[200:203], v[156:159], a[44:47]
buffer_load_dwordx4 v[112:115], v16, s[60:63], s41 offen offset:0
v_mfma_f32_16x16x32_bf16 a[48:51], v[204:207], v[132:135], a[48:51]
v_mfma_f32_16x16x32_bf16 a[52:55], v[204:207], v[140:143], a[52:55]
ds_read_b64_tr_b16 v[192:193], v12 offset:0
v_mfma_f32_16x16x32_bf16 a[56:59], v[204:207], v[148:151], a[56:59]
ds_read_b64_tr_b16 v[194:195], v12 offset:5120
v_mfma_f32_16x16x32_bf16 a[60:63], v[204:207], v[156:159], a[60:63]
v_mfma_f32_16x16x32_bf16 a[64:67], v[208:211], v[132:135], a[64:67]
v_mfma_f32_16x16x32_bf16 a[68:71], v[208:211], v[140:143], a[68:71]
buffer_load_dwordx4 v[116:119], v16, s[60:63], s41 offen offset:1024
ds_read_b64_tr_b16 v[196:197], v13 offset:32
v_mfma_f32_16x16x32_bf16 a[72:75], v[208:211], v[148:151], a[72:75]
ds_read_b64_tr_b16 v[198:199], v13 offset:5152
v_mfma_f32_16x16x32_bf16 a[76:79], v[208:211], v[156:159], a[76:79]
v_mfma_f32_16x16x32_bf16 a[80:83], v[212:215], v[132:135], a[80:83]
v_mfma_f32_16x16x32_bf16 a[84:87], v[212:215], v[140:143], a[84:87]
ds_read_b64_tr_b16 v[200:201], v12 offset:64
v_mfma_f32_16x16x32_bf16 a[88:91], v[212:215], v[148:151], a[88:91]
ds_read_b64_tr_b16 v[202:203], v12 offset:5184
v_mfma_f32_16x16x32_bf16 a[92:95], v[212:215], v[156:159], a[92:95]
s_waitcnt lgkmcnt(6)
buffer_load_dwordx4 v[120:123], v17, s[60:63], s41 offen offset:0
v_mfma_f32_16x16x32_bf16 a[96:99], v[216:219], v[132:135], a[96:99]
v_mfma_f32_16x16x32_bf16 a[100:103], v[216:219], v[140:143], a[100:103]
ds_read_b64_tr_b16 v[204:205], v13 offset:96
v_mfma_f32_16x16x32_bf16 a[104:107], v[216:219], v[148:151], a[104:107]
ds_read_b64_tr_b16 v[206:207], v13 offset:5216
v_mfma_f32_16x16x32_bf16 a[108:111], v[216:219], v[156:159], a[108:111]
v_mfma_f32_16x16x32_bf16 a[112:115], v[220:223], v[132:135], a[112:115]
v_mfma_f32_16x16x32_bf16 a[116:119], v[220:223], v[140:143], a[116:119]
buffer_load_dwordx4 v[124:127], v17, s[60:63], s41 offen offset:1024
ds_read_b64_tr_b16 v[208:209], v12 offset:128
v_mfma_f32_16x16x32_bf16 a[120:123], v[220:223], v[148:151], a[120:123]
ds_read_b64_tr_b16 v[210:211], v12 offset:5248
v_mfma_f32_16x16x32_bf16 a[124:127], v[220:223], v[156:159], a[124:127]
v_mfma_f32_16x16x32_bf16 a[128:131], v[224:227], v[132:135], a[128:131]
v_mfma_f32_16x16x32_bf16 a[132:135], v[224:227], v[140:143], a[132:135]
ds_read_b64_tr_b16 v[212:213], v13 offset:160
v_mfma_f32_16x16x32_bf16 a[136:139], v[224:227], v[148:151], a[136:139]
s_add_u32 s41, s41, 2048
ds_read_b64_tr_b16 v[214:215], v13 offset:5280
v_mfma_f32_16x16x32_bf16 a[140:143], v[224:227], v[156:159], a[140:143]
v_mfma_f32_16x16x32_bf16 a[144:147], v[228:231], v[132:135], a[144:147]
v_mfma_f32_16x16x32_bf16 a[148:151], v[228:231], v[140:143], a[148:151]
ds_read_b64_tr_b16 v[216:217], v12 offset:192
v_mfma_f32_16x16x32_bf16 a[152:155], v[228:231], v[148:151], a[152:155]
ds_read_b64_tr_b16 v[218:219], v12 offset:5312
v_mfma_f32_16x16x32_bf16 a[156:159], v[228:231], v[156:159], a[156:159]
s_waitcnt vmcnt(26) lgkmcnt(6)
v_mfma_f32_16x16x32_bf16 a[0:3], v[192:195], v[160:163], a[0:3]
s_barrier
v_mfma_f32_16x16x32_bf16 a[4:7], v[192:195], v[168:171], a[4:7]
ds_read_b64_tr_b16 v[220:221], v13 offset:224
v_mfma_f32_16x16x32_bf16 a[8:11], v[192:195], v[176:179], a[8:11]
s_add_u32 m0, s44, 40960
ds_read_b64_tr_b16 v[222:223], v13 offset:5344
v_mfma_f32_16x16x32_bf16 a[12:15], v[192:195], v[184:187], a[12:15]
buffer_load_dwordx4 v5, s[64:67], s40 offen offset:0 lds
v_mfma_f32_16x16x32_bf16 a[16:19], v[196:199], v[160:163], a[16:19]
v_mfma_f32_16x16x32_bf16 a[20:23], v[196:199], v[168:171], a[20:23]
ds_read_b64_tr_b16 v[224:225], v12 offset:256
v_mfma_f32_16x16x32_bf16 a[24:27], v[196:199], v[176:179], a[24:27]
ds_read_b64_tr_b16 v[226:227], v12 offset:5376
v_mfma_f32_16x16x32_bf16 a[28:31], v[196:199], v[184:187], a[28:31]
buffer_load_dwordx4 v6, s[64:67], s40 offen offset:1024 lds
v_mfma_f32_16x16x32_bf16 a[32:35], v[200:203], v[160:163], a[32:35]
v_mfma_f32_16x16x32_bf16 a[36:39], v[200:203], v[168:171], a[36:39]
ds_read_b64_tr_b16 v[228:229], v13 offset:288
v_mfma_f32_16x16x32_bf16 a[40:43], v[200:203], v[176:179], a[40:43]
ds_read_b64_tr_b16 v[230:231], v13 offset:5408
v_mfma_f32_16x16x32_bf16 a[44:47], v[200:203], v[184:187], a[44:47]
buffer_load_dwordx4 v7, s[64:67], s40 offen offset:2048 lds
v_mfma_f32_16x16x32_bf16 a[48:51], v[204:207], v[160:163], a[48:51]
v_mfma_f32_16x16x32_bf16 a[52:55], v[204:207], v[168:171], a[52:55]
ds_read_b64_tr_b16 v[192:193], v12 offset:10240
v_mfma_f32_16x16x32_bf16 a[56:59], v[204:207], v[176:179], a[56:59]
ds_read_b64_tr_b16 v[194:195], v12 offset:15360
v_mfma_f32_16x16x32_bf16 a[60:63], v[204:207], v[184:187], a[60:63]
s_waitcnt lgkmcnt(6)
buffer_load_dwordx4 v8, s[64:67], s40 offen offset:3072 lds
v_mfma_f32_16x16x32_bf16 a[64:67], v[208:211], v[160:163], a[64:67]
v_mfma_f32_16x16x32_bf16 a[68:71], v[208:211], v[168:171], a[68:71]
s_add_u32 m0, s44, 45056
ds_read_b64_tr_b16 v[196:197], v13 offset:10272
v_mfma_f32_16x16x32_bf16 a[72:75], v[208:211], v[176:179], a[72:75]
ds_read_b64_tr_b16 v[198:199], v13 offset:15392
v_mfma_f32_16x16x32_bf16 a[76:79], v[208:211], v[184:187], a[76:79]
buffer_load_dwordx4 v9, s[64:67], s40 offen lds
v_mfma_f32_16x16x32_bf16 a[80:83], v[212:215], v[160:163], a[80:83]
v_mfma_f32_16x16x32_bf16 a[84:87], v[212:215], v[168:171], a[84:87]
ds_read_b64_tr_b16 v[200:201], v12 offset:10304
v_mfma_f32_16x16x32_bf16 a[88:91], v[212:215], v[176:179], a[88:91]
s_add_u32 s40, s40, 81920
s_min_u32 s40, s40, s45
ds_read_b64_tr_b16 v[202:203], v12 offset:15424
v_mfma_f32_16x16x32_bf16 a[92:95], v[212:215], v[184:187], a[92:95]
v_mfma_f32_16x16x32_bf16 a[96:99], v[216:219], v[160:163], a[96:99]
v_mfma_f32_16x16x32_bf16 a[100:103], v[216:219], v[168:171], a[100:103]
ds_read_b64_tr_b16 v[204:205], v13 offset:10336
v_mfma_f32_16x16x32_bf16 a[104:107], v[216:219], v[176:179], a[104:107]
ds_read_b64_tr_b16 v[206:207], v13 offset:15456
v_mfma_f32_16x16x32_bf16 a[108:111], v[216:219], v[184:187], a[108:111]
buffer_load_dwordx4 v[128:131], v2, s[60:63], s41 offen offset:0
v_mfma_f32_16x16x32_bf16 a[112:115], v[220:223], v[160:163], a[112:115]
v_mfma_f32_16x16x32_bf16 a[116:119], v[220:223], v[168:171], a[116:119]
ds_read_b64_tr_b16 v[208:209], v12 offset:10368
v_mfma_f32_16x16x32_bf16 a[120:123], v[220:223], v[176:179], a[120:123]
ds_read_b64_tr_b16 v[210:211], v12 offset:15488
v_mfma_f32_16x16x32_bf16 a[124:127], v[220:223], v[184:187], a[124:127]
s_waitcnt lgkmcnt(6)
v_mfma_f32_16x16x32_bf16 a[128:131], v[224:227], v[160:163], a[128:131]
v_mfma_f32_16x16x32_bf16 a[132:135], v[224:227], v[168:171], a[132:135]
buffer_load_dwordx4 v[132:135], v2, s[60:63], s41 offen offset:1024
ds_read_b64_tr_b16 v[212:213], v13 offset:10400
v_mfma_f32_16x16x32_bf16 a[136:139], v[224:227], v[176:179], a[136:139]
ds_read_b64_tr_b16 v[214:215], v13 offset:15520
v_mfma_f32_16x16x32_bf16 a[140:143], v[224:227], v[184:187], a[140:143]
v_mfma_f32_16x16x32_bf16 a[144:147], v[228:231], v[160:163], a[144:147]
v_mfma_f32_16x16x32_bf16 a[148:151], v[228:231], v[168:171], a[148:151]
ds_read_b64_tr_b16 v[216:217], v12 offset:10432
v_mfma_f32_16x16x32_bf16 a[152:155], v[228:231], v[176:179], a[152:155]
ds_read_b64_tr_b16 v[218:219], v12 offset:15552
v_mfma_f32_16x16x32_bf16 a[156:159], v[228:231], v[184:187], a[156:159]
buffer_load_dwordx4 v[136:139], v3, s[60:63], s41 offen offset:0
v_mfma_f32_16x16x32_bf16 a[0:3], v[192:195], v[164:167], a[0:3]
v_mfma_f32_16x16x32_bf16 a[4:7], v[192:195], v[172:175], a[4:7]
ds_read_b64_tr_b16 v[220:221], v13 offset:10464
v_mfma_f32_16x16x32_bf16 a[8:11], v[192:195], v[180:183], a[8:11]
ds_read_b64_tr_b16 v[222:223], v13 offset:15584
v_mfma_f32_16x16x32_bf16 a[12:15], v[192:195], v[188:191], a[12:15]
v_mfma_f32_16x16x32_bf16 a[16:19], v[196:199], v[164:167], a[16:19]
v_mfma_f32_16x16x32_bf16 a[20:23], v[196:199], v[172:175], a[20:23]
buffer_load_dwordx4 v[140:143], v3, s[60:63], s41 offen offset:1024
ds_read_b64_tr_b16 v[224:225], v12 offset:10496
v_mfma_f32_16x16x32_bf16 a[24:27], v[196:199], v[180:183], a[24:27]
ds_read_b64_tr_b16 v[226:227], v12 offset:15616
v_mfma_f32_16x16x32_bf16 a[28:31], v[196:199], v[188:191], a[28:31]
s_waitcnt lgkmcnt(6)
v_mfma_f32_16x16x32_bf16 a[32:35], v[200:203], v[164:167], a[32:35]
v_mfma_f32_16x16x32_bf16 a[36:39], v[200:203], v[172:175], a[36:39]
ds_read_b64_tr_b16 v[228:229], v13 offset:10528
v_mfma_f32_16x16x32_bf16 a[40:43], v[200:203], v[180:183], a[40:43]
ds_read_b64_tr_b16 v[230:231], v13 offset:15648
v_mfma_f32_16x16x32_bf16 a[44:47], v[200:203], v[188:191], a[44:47]
buffer_load_dwordx4 v[144:147], v16, s[60:63], s41 offen offset:0
v_mfma_f32_16x16x32_bf16 a[48:51], v[204:207], v[164:167], a[48:51]
v_mfma_f32_16x16x32_bf16 a[52:55], v[204:207], v[172:175], a[52:55]
ds_read_b64_tr_b16 v[192:193], v12 offset:20480
v_mfma_f32_16x16x32_bf16 a[56:59], v[204:207], v[180:183], a[56:59]
ds_read_b64_tr_b16 v[194:195], v12 offset:25600
v_mfma_f32_16x16x32_bf16 a[60:63], v[204:207], v[188:191], a[60:63]
v_mfma_f32_16x16x32_bf16 a[64:67], v[208:211], v[164:167], a[64:67]
v_mfma_f32_16x16x32_bf16 a[68:71], v[208:211], v[172:175], a[68:71]
buffer_load_dwordx4 v[148:151], v16, s[60:63], s41 offen offset:1024
ds_read_b64_tr_b16 v[196:197], v13 offset:20512
v_mfma_f32_16x16x32_bf16 a[72:75], v[208:211], v[180:183], a[72:75]
ds_read_b64_tr_b16 v[198:199], v13 offset:25632
v_mfma_f32_16x16x32_bf16 a[76:79], v[208:211], v[188:191], a[76:79]
v_mfma_f32_16x16x32_bf16 a[80:83], v[212:215], v[164:167], a[80:83]
v_mfma_f32_16x16x32_bf16 a[84:87], v[212:215], v[172:175], a[84:87]
ds_read_b64_tr_b16 v[200:201], v12 offset:20544
v_mfma_f32_16x16x32_bf16 a[88:91], v[212:215], v[180:183], a[88:91]
ds_read_b64_tr_b16 v[202:203], v12 offset:25664
v_mfma_f32_16x16x32_bf16 a[92:95], v[212:215], v[188:191], a[92:95]
s_waitcnt lgkmcnt(6)
buffer_load_dwordx4 v[152:155], v17, s[60:63], s41 offen offset:0
v_mfma_f32_16x16x32_bf16 a[96:99], v[216:219], v[164:167], a[96:99]
v_mfma_f32_16x16x32_bf16 a[100:103], v[216:219], v[172:175], a[100:103]
ds_read_b64_tr_b16 v[204:205], v13 offset:20576
v_mfma_f32_16x16x32_bf16 a[104:107], v[216:219], v[180:183], a[104:107]
ds_read_b64_tr_b16 v[206:207], v13 offset:25696
v_mfma_f32_16x16x32_bf16 a[108:111], v[216:219], v[188:191], a[108:111]
v_mfma_f32_16x16x32_bf16 a[112:115], v[220:223], v[164:167], a[112:115]
v_mfma_f32_16x16x32_bf16 a[116:119], v[220:223], v[172:175], a[116:119]
buffer_load_dwordx4 v[156:159], v17, s[60:63], s41 offen offset:1024
ds_read_b64_tr_b16 v[208:209], v12 offset:20608
v_mfma_f32_16x16x32_bf16 a[120:123], v[220:223], v[180:183], a[120:123]
ds_read_b64_tr_b16 v[210:211], v12 offset:25728
v_mfma_f32_16x16x32_bf16 a[124:127], v[220:223], v[188:191], a[124:127]
v_mfma_f32_16x16x32_bf16 a[128:131], v[224:227], v[164:167], a[128:131]
v_mfma_f32_16x16x32_bf16 a[132:135], v[224:227], v[172:175], a[132:135]
ds_read_b64_tr_b16 v[212:213], v13 offset:20640
v_mfma_f32_16x16x32_bf16 a[136:139], v[224:227], v[180:183], a[136:139]
s_add_u32 s41, s41, 2048
ds_read_b64_tr_b16 v[214:215], v13 offset:25760
v_mfma_f32_16x16x32_bf16 a[140:143], v[224:227], v[188:191], a[140:143]
v_mfma_f32_16x16x32_bf16 a[144:147], v[228:231], v[164:167], a[144:147]
v_mfma_f32_16x16x32_bf16 a[148:151], v[228:231], v[172:175], a[148:151]
ds_read_b64_tr_b16 v[216:217], v12 offset:20672
v_mfma_f32_16x16x32_bf16 a[152:155], v[228:231], v[180:183], a[152:155]
ds_read_b64_tr_b16 v[218:219], v12 offset:25792
v_mfma_f32_16x16x32_bf16 a[156:159], v[228:231], v[188:191], a[156:159]
s_waitcnt vmcnt(26) lgkmcnt(6)
s_sub_u32 s48, s48, 1
s_cmp_eq_u32 s48, 0
s_cbranch_scc1 K2_EXIT
v_mfma_f32_16x16x32_bf16 a[0:3], v[192:195], v[64:67], a[0:3]
s_barrier
v_mfma_f32_16x16x32_bf16 a[4:7], v[192:195], v[72:75], a[4:7]
ds_read_b64_tr_b16 v[220:221], v13 offset:20704
v_mfma_f32_16x16x32_bf16 a[8:11], v[192:195], v[80:83], a[8:11]
s_add_u32 m0, s44, 61440
ds_read_b64_tr_b16 v[222:223], v13 offset:25824
v_mfma_f32_16x16x32_bf16 a[12:15], v[192:195], v[88:91], a[12:15]
buffer_load_dwordx4 v5, s[64:67], s40 offen offset:0 lds
v_mfma_f32_16x16x32_bf16 a[16:19], v[196:199], v[64:67], a[16:19]
v_mfma_f32_16x16x32_bf16 a[20:23], v[196:199], v[72:75], a[20:23]
ds_read_b64_tr_b16 v[224:225], v12 offset:20736
v_mfma_f32_16x16x32_bf16 a[24:27], v[196:199], v[80:83], a[24:27]
ds_read_b64_tr_b16 v[226:227], v12 offset:25856
v_mfma_f32_16x16x32_bf16 a[28:31], v[196:199], v[88:91], a[28:31]
buffer_load_dwordx4 v6, s[64:67], s40 offen offset:1024 lds
v_mfma_f32_16x16x32_bf16 a[32:35], v[200:203], v[64:67], a[32:35]
v_mfma_f32_16x16x32_bf16 a[36:39], v[200:203], v[72:75], a[36:39]
ds_read_b64_tr_b16 v[228:229], v13 offset:20768
v_mfma_f32_16x16x32_bf16 a[40:43], v[200:203], v[80:83], a[40:43]
ds_read_b64_tr_b16 v[230:231], v13 offset:25888
v_mfma_f32_16x16x32_bf16 a[44:47], v[200:203], v[88:91], a[44:47]
buffer_load_dwordx4 v7, s[64:67], s40 offen offset:2048 lds
v_mfma_f32_16x16x32_bf16 a[48:51], v[204:207], v[64:67], a[48:51]
v_mfma_f32_16x16x32_bf16 a[52:55], v[204:207], v[72:75], a[52:55]
ds_read_b64_tr_b16 v[192:193], v12 offset:30720
v_mfma_f32_16x16x32_bf16 a[56:59], v[204:207], v[80:83], a[56:59]
ds_read_b64_tr_b16 v[194:195], v12 offset:35840
v_mfma_f32_16x16x32_bf16 a[60:63], v[204:207], v[88:91], a[60:63]
s_waitcnt lgkmcnt(6)
buffer_load_dwordx4 v8, s[64:67], s40 offen offset:3072 lds
v_mfma_f32_16x16x32_bf16 a[64:67], v[208:211], v[64:67], a[64:67]
v_mfma_f32_16x16x32_bf16 a[68:71], v[208:211], v[72:75], a[68:71]
s_add_u32 m0, s44, 65536
ds_read_b64_tr_b16 v[196:197], v13 offset:30752
v_mfma_f32_16x16x32_bf16 a[72:75], v[208:211], v[80:83], a[72:75]
ds_read_b64_tr_b16 v[198:199], v13 offset:35872
v_mfma_f32_16x16x32_bf16 a[76:79], v[208:211], v[88:91], a[76:79]
buffer_load_dwordx4 v9, s[64:67], s40 offen lds
v_mfma_f32_16x16x32_bf16 a[80:83], v[212:215], v[64:67], a[80:83]
v_mfma_f32_16x16x32_bf16 a[84:87], v[212:215], v[72:75], a[84:87]
ds_read_b64_tr_b16 v[200:201], v12 offset:30784
v_mfma_f32_16x16x32_bf16 a[88:91], v[212:215], v[80:83], a[88:91]
s_add_u32 s40, s40, 81920
s_min_u32 s40, s40, s45
ds_read_b64_tr_b16 v[202:203], v12 offset:35904
v_mfma_f32_16x16x32_bf16 a[92:95], v[212:215], v[88:91], a[92:95]
v_mfma_f32_16x16x32_bf16 a[96:99], v[216:219], v[64:67], a[96:99]
v_mfma_f32_16x16x32_bf16 a[100:103], v[216:219], v[72:75], a[100:103]
ds_read_b64_tr_b16 v[204:205], v13 offset:30816
v_mfma_f32_16x16x32_bf16 a[104:107], v[216:219], v[80:83], a[104:107]
ds_read_b64_tr_b16 v[206:207], v13 offset:35936
v_mfma_f32_16x16x32_bf16 a[108:111], v[216:219], v[88:91], a[108:111]
buffer_load_dwordx4 v[160:163], v2, s[60:63], s41 offen offset:0
v_mfma_f32_16x16x32_bf16 a[112:115], v[220:223], v[64:67], a[112:115]
v_mfma_f32_16x16x32_bf16 a[116:119], v[220:223], v[72:75], a[116:119]
ds_read_b64_tr_b16 v[208:209], v12 offset:30848
v_mfma_f32_16x16x32_bf16 a[120:123], v[220:223], v[80:83], a[120:123]
ds_read_b64_tr_b16 v[210:211], v12 offset:35968
v_mfma_f32_16x16x32_bf16 a[124:127], v[220:223], v[88:91], a[124:127]
s_waitcnt lgkmcnt(6)
v_mfma_f32_16x16x32_bf16 a[128:131], v[224:227], v[64:67], a[128:131]
v_mfma_f32_16x16x32_bf16 a[132:135], v[224:227], v[72:75], a[132:135]
buffer_load_dwordx4 v[164:167], v2, s[60:63], s41 offen offset:1024
ds_read_b64_tr_b16 v[212:213], v13 offset:30880
v_mfma_f32_16x16x32_bf16 a[136:139], v[224:227], v[80:83], a[136:139]
ds_read_b64_tr_b16 v[214:215], v13 offset:36000
v_mfma_f32_16x16x32_bf16 a[140:143], v[224:227], v[88:91], a[140:143]
v_mfma_f32_16x16x32_bf16 a[144:147], v[228:231], v[64:67], a[144:147]
v_mfma_f32_16x16x32_bf16 a[148:151], v[228:231], v[72:75], a[148:151]
ds_read_b64_tr_b16 v[216:217], v12 offset:30912
v_mfma_f32_16x16x32_bf16 a[152:155], v[228:231], v[80:83], a[152:155]
ds_read_b64_tr_b16 v[218:219], v12 offset:36032
v_mfma_f32_16x16x32_bf16 a[156:159], v[228:231], v[88:91], a[156:159]
buffer_load_dwordx4 v[168:171], v3, s[60:63], s41 offen offset:0
v_mfma_f32_16x16x32_bf16 a[0:3], v[192:195], v[68:71], a[0:3]
v_mfma_f32_16x16x32_bf16 a[4:7], v[192:195], v[76:79], a[4:7]
ds_read_b64_tr_b16 v[220:221], v13 offset:30944
v_mfma_f32_16x16x32_bf16 a[8:11], v[192:195], v[84:87], a[8:11]
ds_read_b64_tr_b16 v[222:223], v13 offset:36064
v_mfma_f32_16x16x32_bf16 a[12:15], v[192:195], v[92:95], a[12:15]
v_mfma_f32_16x16x32_bf16 a[16:19], v[196:199], v[68:71], a[16:19]
v_mfma_f32_16x16x32_bf16 a[20:23], v[196:199], v[76:79], a[20:23]
buffer_load_dwordx4 v[172:175], v3, s[60:63], s41 offen offset:1024
ds_read_b64_tr_b16 v[224:225], v12 offset:30976
v_mfma_f32_16x16x32_bf16 a[24:27], v[196:199], v[84:87], a[24:27]
ds_read_b64_tr_b16 v[226:227], v12 offset:36096
v_mfma_f32_16x16x32_bf16 a[28:31], v[196:199], v[92:95], a[28:31]
s_waitcnt lgkmcnt(6)
v_mfma_f32_16x16x32_bf16 a[32:35], v[200:203], v[68:71], a[32:35]
v_mfma_f32_16x16x32_bf16 a[36:39], v[200:203], v[76:79], a[36:39]
ds_read_b64_tr_b16 v[228:229], v13 offset:31008
v_mfma_f32_16x16x32_bf16 a[40:43], v[200:203], v[84:87], a[40:43]
ds_read_b64_tr_b16 v[230:231], v13 offset:36128
v_mfma_f32_16x16x32_bf16 a[44:47], v[200:203], v[92:95], a[44:47]
buffer_load_dwordx4 v[176:179], v16, s[60:63], s41 offen offset:0
v_mfma_f32_16x16x32_bf16 a[48:51], v[204:207], v[68:71], a[48:51]
v_mfma_f32_16x16x32_bf16 a[52:55], v[204:207], v[76:79], a[52:55]
ds_read_b64_tr_b16 v[192:193], v12 offset:40960
v_mfma_f32_16x16x32_bf16 a[56:59], v[204:207], v[84:87], a[56:59]
ds_read_b64_tr_b16 v[194:195], v12 offset:46080
v_mfma_f32_16x16x32_bf16 a[60:63], v[204:207], v[92:95], a[60:63]
v_mfma_f32_16x16x32_bf16 a[64:67], v[208:211], v[68:71], a[64:67]
v_mfma_f32_16x16x32_bf16 a[68:71], v[208:211], v[76:79], a[68:71]
buffer_load_dwordx4 v[180:183], v16, s[60:63], s41 offen offset:1024
ds_read_b64_tr_b16 v[196:197], v13 offset:40992
v_mfma_f32_16x16x32_bf16 a[72:75], v[208:211], v[84:87], a[72:75]
ds_read_b64_tr_b16 v[198:199], v13 offset:46112
v_mfma_f32_16x16x32_bf16 a[76:79], v[208:211], v[92:95], a[76:79]
v_mfma_f32_16x16x32_bf16 a[80:83], v[212:215], v[68:71], a[80:83]
v_mfma_f32_16x16x32_bf16 a[84:87], v[212:215], v[76:79], a[84:87]
ds_read_b64_tr_b16 v[200:201], v12 offset:41024
v_mfma_f32_16x16x32_bf16 a[88:91], v[212:215], v[84:87], a[88:91]
ds_read_b64_tr_b16 v[202:203], v12 offset:46144
v_mfma_f32_16x16x32_bf16 a[92:95], v[212:215], v[92:95], a[92:95]
s_waitcnt lgkmcnt(6)
buffer_load_dwordx4 v[184:187], v17, s[60:63], s41 offen offset:0
v_mfma_f32_16x16x32_bf16 a[96:99], v[216:219], v[68:71], a[96:99]
v_mfma_f32_16x16x32_bf16 a[100:103], v[216:219], v[76:79], a[100:103]
ds_read_b64_tr_b16 v[204:205], v13 offset:41056
v_mfma_f32_16x16x32_bf16 a[104:107], v[216:219], v[84:87], a[104:107]
ds_read_b64_tr_b16 v[206:207], v13 offset:46176
v_mfma_f32_16x16x32_bf16 a[108:111], v[216:219], v[92:95], a[108:111]
v_mfma_f32_16x16x32_bf16 a[112:115], v[220:223], v[68:71], a[112:115]
v_mfma_f32_16x16x32_bf16 a[116:119], v[220:223], v[76:79], a[116:119]
buffer_load_dwordx4 v[188:191], v17, s[60:63], s41 offen offset:1024
ds_read_b64_tr_b16 v[208:209], v12 offset:41088
v_mfma_f32_16x16x32_bf16 a[120:123], v[220:223], v[84:87], a[120:123]
ds_read_b64_tr_b16 v[210:211], v12 offset:46208
v_mfma_f32_16x16x32_bf16 a[124:127], v[220:223], v[92:95], a[124:127]
v_mfma_f32_16x16x32_bf16 a[128:131], v[224:227], v[68:71], a[128:131]
v_mfma_f32_16x16x32_bf16 a[132:135], v[224:227], v[76:79], a[132:135]
ds_read_b64_tr_b16 v[212:213], v13 offset:41120
v_mfma_f32_16x16x32_bf16 a[136:139], v[224:227], v[84:87], a[136:139]
s_add_u32 s41, s41, 2048
ds_read_b64_tr_b16 v[214:215], v13 offset:46240
v_mfma_f32_16x16x32_bf16 a[140:143], v[224:227], v[92:95], a[140:143]
v_mfma_f32_16x16x32_bf16 a[144:147], v[228:231], v[68:71], a[144:147]
v_mfma_f32_16x16x32_bf16 a[148:151], v[228:231], v[76:79], a[148:151]
ds_read_b64_tr_b16 v[216:217], v12 offset:41152
v_mfma_f32_16x16x32_bf16 a[152:155], v[228:231], v[84:87], a[152:155]
ds_read_b64_tr_b16 v[218:219], v12 offset:46272
v_mfma_f32_16x16x32_bf16 a[156:159], v[228:231], v[92:95], a[156:159]
s_waitcnt vmcnt(26) lgkmcnt(6)
v_mfma_f32_16x16x32_bf16 a[0:3], v[192:195], v[96:99], a[0:3]
s_barrier
v_mfma_f32_16x16x32_bf16 a[4:7], v[192:195], v[104:107], a[4:7]
ds_read_b64_tr_b16 v[220:221], v13 offset:41184
v_mfma_f32_16x16x32_bf16 a[8:11], v[192:195], v[112:115], a[8:11]
s_add_u32 m0, s44, 81920
ds_read_b64_tr_b16 v[222:223], v13 offset:46304
v_mfma_f32_16x16x32_bf16 a[12:15], v[192:195], v[120:123], a[12:15]
buffer_load_dwordx4 v5, s[64:67], s40 offen offset:0 lds
v_mfma_f32_16x16x32_bf16 a[16:19], v[196:199], v[96:99], a[16:19]
v_mfma_f32_16x16x32_bf16 a[20:23], v[196:199], v[104:107], a[20:23]
ds_read_b64_tr_b16 v[224:225], v12 offset:41216
v_mfma_f32_16x16x32_bf16 a[24:27], v[196:199], v[112:115], a[24:27]
ds_read_b64_tr_b16 v[226:227], v12 offset:46336
v_mfma_f32_16x16x32_bf16 a[28:31], v[196:199], v[120:123], a[28:31]
buffer_load_dwordx4 v6, s[64:67], s40 offen offset:1024 lds
v_mfma_f32_16x16x32_bf16 a[32:35], v[200:203], v[96:99], a[32:35]
v_mfma_f32_16x16x32_bf16 a[36:39], v[200:203], v[104:107], a[36:39]
ds_read_b64_tr_b16 v[228:229], v13 offset:41248
v_mfma_f32_16x16x32_bf16 a[40:43], v[200:203], v[112:115], a[40:43]
ds_read_b64_tr_b16 v[230:231], v13 offset:46368
v_mfma_f32_16x16x32_bf16 a[44:47], v[200:203], v[120:123], a[44:47]
buffer_load_dwordx4 v7, s[64:67], s40 offen offset:2048 lds
v_mfma_f32_16x16x32_bf16 a[48:51], v[204:207], v[96:99], a[48:51]
v_mfma_f32_16x16x32_bf16 a[52:55], v[204:207], v[104:107], a[52:55]
ds_read_b64_tr_b16 v[192:193], v12 offset:51200
v_mfma_f32_16x16x32_bf16 a[56:59], v[204:207], v[112:115], a[56:59]
ds_read_b64_tr_b16 v[194:195], v12 offset:56320
v_mfma_f32_16x16x32_bf16 a[60:63], v[204:207], v[120:123], a[60:63]
s_waitcnt lgkmcnt(6)
buffer_load_dwordx4 v8, s[64:67], s40 offen offset:3072 lds
v_mfma_f32_16x16x32_bf16 a[64:67], v[208:211], v[96:99], a[64:67]
v_mfma_f32_16x16x32_bf16 a[68:71], v[208:211], v[104:107], a[68:71]
s_add_u32 m0, s44, 86016
ds_read_b64_tr_b16 v[196:197], v13 offset:51232
v_mfma_f32_16x16x32_bf16 a[72:75], v[208:211], v[112:115], a[72:75]
ds_read_b64_tr_b16 v[198:199], v13 offset:56352
v_mfma_f32_16x16x32_bf16 a[76:79], v[208:211], v[120:123], a[76:79]
buffer_load_dwordx4 v9, s[64:67], s40 offen lds
v_mfma_f32_16x16x32_bf16 a[80:83], v[212:215], v[96:99], a[80:83]
v_mfma_f32_16x16x32_bf16 a[84:87], v[212:215], v[104:107], a[84:87]
ds_read_b64_tr_b16 v[200:201], v12 offset:51264
v_mfma_f32_16x16x32_bf16 a[88:91], v[212:215], v[112:115], a[88:91]
s_add_u32 s40, s40, 81920
s_min_u32 s40, s40, s45
ds_read_b64_tr_b16 v[202:203], v12 offset:56384
v_mfma_f32_16x16x32_bf16 a[92:95], v[212:215], v[120:123], a[92:95]
v_mfma_f32_16x16x32_bf16 a[96:99], v[216:219], v[96:99], a[96:99]
v_mfma_f32_16x16x32_bf16 a[100:103], v[216:219], v[104:107], a[100:103]
ds_read_b64_tr_b16 v[204:205], v13 offset:51296
v_mfma_f32_16x16x32_bf16 a[104:107], v[216:219], v[112:115], a[104:107]
ds_read_b64_tr_b16 v[206:207], v13 offset:56416
v_mfma_f32_16x16x32_bf16 a[108:111], v[216:219], v[120:123], a[108:111]
buffer_load_dwordx4 v[64:67], v2, s[60:63], s41 offen offset:0
v_mfma_f32_16x16x32_bf16 a[112:115], v[220:223], v[96:99], a[112:115]
v_mfma_f32_16x16x32_bf16 a[116:119], v[220:223], v[104:107], a[116:119]
ds_read_b64_tr_b16 v[208:209], v12 offset:51328
v_mfma_f32_16x16x32_bf16 a[120:123], v[220:223], v[112:115], a[120:123]
ds_read_b64_tr_b16 v[210:211], v12 offset:56448
v_mfma_f32_16x16x32_bf16 a[124:127], v[220:223], v[120:123], a[124:127]
s_waitcnt lgkmcnt(6)
v_mfma_f32_16x16x32_bf16 a[128:131], v[224:227], v[96:99], a[128:131]
v_mfma_f32_16x16x32_bf16 a[132:135], v[224:227], v[104:107], a[132:135]
buffer_load_dwordx4 v[68:71], v2, s[60:63], s41 offen offset:1024
ds_read_b64_tr_b16 v[212:213], v13 offset:51360
v_mfma_f32_16x16x32_bf16 a[136:139], v[224:227], v[112:115], a[136:139]
ds_read_b64_tr_b16 v[214:215], v13 offset:56480
v_mfma_f32_16x16x32_bf16 a[140:143], v[224:227], v[120:123], a[140:143]
v_mfma_f32_16x16x32_bf16 a[144:147], v[228:231], v[96:99], a[144:147]
v_mfma_f32_16x16x32_bf16 a[148:151], v[228:231], v[104:107], a[148:151]
ds_read_b64_tr_b16 v[216:217], v12 offset:51392
v_mfma_f32_16x16x32_bf16 a[152:155], v[228:231], v[112:115], a[152:155]
ds_read_b64_tr_b16 v[218:219], v12 offset:56512
v_mfma_f32_16x16x32_bf16 a[156:159], v[228:231], v[120:123], a[156:159]
buffer_load_dwordx4 v[72:75], v3, s[60:63], s41 offen offset:0
v_mfma_f32_16x16x32_bf16 a[0:3], v[192:195], v[100:103], a[0:3]
v_mfma_f32_16x16x32_bf16 a[4:7], v[192:195], v[108:111], a[4:7]
ds_read_b64_tr_b16 v[220:221], v13 offset:51424
v_mfma_f32_16x16x32_bf16 a[8:11], v[192:195], v[116:119], a[8:11]
ds_read_b64_tr_b16 v[222:223], v13 offset:56544
v_mfma_f32_16x16x32_bf16 a[12:15], v[192:195], v[124:127], a[12:15]
v_mfma_f32_16x16x32_bf16 a[16:19], v[196:199], v[100:103], a[16:19]
v_mfma_f32_16x16x32_bf16 a[20:23], v[196:199], v[108:111], a[20:23]
buffer_load_dwordx4 v[76:79], v3, s[60:63], s41 offen offset:1024
ds_read_b64_tr_b16 v[224:225], v12 offset:51456
v_mfma_f32_16x16x32_bf16 a[24:27], v[196:199], v[116:119], a[24:27]
ds_read_b64_tr_b16 v[226:227], v12 offset:56576
v_mfma_f32_16x16x32_bf16 a[28:31], v[196:199], v[124:127], a[28:31]
s_waitcnt lgkmcnt(6)
v_mfma_f32_16x16x32_bf16 a[32:35], v[200:203], v[100:103], a[32:35]
v_mfma_f32_16x16x32_bf16 a[36:39], v[200:203], v[108:111], a[36:39]
ds_read_b64_tr_b16 v[228:229], v13 offset:51488
v_mfma_f32_16x16x32_bf16 a[40:43], v[200:203], v[116:119], a[40:43]
ds_read_b64_tr_b16 v[230:231], v13 offset:56608
v_mfma_f32_16x16x32_bf16 a[44:47], v[200:203], v[124:127], a[44:47]
buffer_load_dwordx4 v[80:83], v16, s[60:63], s41 offen offset:0
v_mfma_f32_16x16x32_bf16 a[48:51], v[204:207], v[100:103], a[48:51]
v_mfma_f32_16x16x32_bf16 a[52:55], v[204:207], v[108:111], a[52:55]
ds_read_b64_tr_b16 v[192:193], v14 offset:0
v_mfma_f32_16x16x32_bf16 a[56:59], v[204:207], v[116:119], a[56:59]
ds_read_b64_tr_b16 v[194:195], v14 offset:5120
v_mfma_f32_16x16x32_bf16 a[60:63], v[204:207], v[124:127], a[60:63]
v_mfma_f32_16x16x32_bf16 a[64:67], v[208:211], v[100:103], a[64:67]
v_mfma_f32_16x16x32_bf16 a[68:71], v[208:211], v[108:111], a[68:71]
buffer_load_dwordx4 v[84:87], v16, s[60:63], s41 offen offset:1024
ds_read_b64_tr_b16 v[196:197], v15 offset:32
v_mfma_f32_16x16x32_bf16 a[72:75], v[208:211], v[116:119], a[72:75]
ds_read_b64_tr_b16 v[198:199], v15 offset:5152
v_mfma_f32_16x16x32_bf16 a[76:79], v[208:211], v[124:127], a[76:79]
v_mfma_f32_16x16x32_bf16 a[80:83], v[212:215], v[100:103], a[80:83]
v_mfma_f32_16x16x32_bf16 a[84:87], v[212:215], v[108:111], a[84:87]
ds_read_b64_tr_b16 v[200:201], v14 offset:64
v_mfma_f32_16x16x32_bf16 a[88:91], v[212:215], v[116:119], a[88:91]
ds_read_b64_tr_b16 v[202:203], v14 offset:5184
v_mfma_f32_16x16x32_bf16 a[92:95], v[212:215], v[124:127], a[92:95]
s_waitcnt lgkmcnt(6)
buffer_load_dwordx4 v[88:91], v17, s[60:63], s41 offen offset:0
v_mfma_f32_16x16x32_bf16 a[96:99], v[216:219], v[100:103], a[96:99]
v_mfma_f32_16x16x32_bf16 a[100:103], v[216:219], v[108:111], a[100:103]
ds_read_b64_tr_b16 v[204:205], v15 offset:96
v_mfma_f32_16x16x32_bf16 a[104:107], v[216:219], v[116:119], a[104:107]
ds_read_b64_tr_b16 v[206:207], v15 offset:5216
v_mfma_f32_16x16x32_bf16 a[108:111], v[216:219], v[124:127], a[108:111]
v_mfma_f32_16x16x32_bf16 a[112:115], v[220:223], v[100:103], a[112:115]
v_mfma_f32_16x16x32_bf16 a[116:119], v[220:223], v[108:111], a[116:119]
buffer_load_dwordx4 v[92:95], v17, s[60:63], s41 offen offset:1024
ds_read_b64_tr_b16 v[208:209], v14 offset:128
v_mfma_f32_16x16x32_bf16 a[120:123], v[220:223], v[116:119], a[120:123]
ds_read_b64_tr_b16 v[210:211], v14 offset:5248
v_mfma_f32_16x16x32_bf16 a[124:127], v[220:223], v[124:127], a[124:127]
v_mfma_f32_16x16x32_bf16 a[128:131], v[224:227], v[100:103], a[128:131]
v_mfma_f32_16x16x32_bf16 a[132:135], v[224:227], v[108:111], a[132:135]
ds_read_b64_tr_b16 v[212:213], v15 offset:160
v_mfma_f32_16x16x32_bf16 a[136:139], v[224:227], v[116:119], a[136:139]
s_add_u32 s41, s41, 2048
ds_read_b64_tr_b16 v[214:215], v15 offset:5280
v_mfma_f32_16x16x32_bf16 a[140:143], v[224:227], v[124:127], a[140:143]
v_mfma_f32_16x16x32_bf16 a[144:147], v[228:231], v[100:103], a[144:147]
v_mfma_f32_16x16x32_bf16 a[148:151], v[228:231], v[108:111], a[148:151]
ds_read_b64_tr_b16 v[216:217], v14 offset:192
v_mfma_f32_16x16x32_bf16 a[152:155], v[228:231], v[116:119], a[152:155]
ds_read_b64_tr_b16 v[218:219], v14 offset:5312
v_mfma_f32_16x16x32_bf16 a[156:159], v[228:231], v[124:127], a[156:159]
s_waitcnt vmcnt(26) lgkmcnt(6)
v_mfma_f32_16x16x32_bf16 a[0:3], v[192:195], v[128:131], a[0:3]
s_barrier
v_mfma_f32_16x16x32_bf16 a[4:7], v[192:195], v[136:139], a[4:7]
ds_read_b64_tr_b16 v[220:221], v15 offset:224
v_mfma_f32_16x16x32_bf16 a[8:11], v[192:195], v[144:147], a[8:11]
s_add_u32 m0, s44, 102400
ds_read_b64_tr_b16 v[222:223], v15 offset:5344
v_mfma_f32_16x16x32_bf16 a[12:15], v[192:195], v[152:155], a[12:15]
buffer_load_dwordx4 v5, s[64:67], s40 offen offset:0 lds
v_mfma_f32_16x16x32_bf16 a[16:19], v[196:199], v[128:131], a[16:19]
v_mfma_f32_16x16x32_bf16 a[20:23], v[196:199], v[136:139], a[20:23]
ds_read_b64_tr_b16 v[224:225], v14 offset:256
v_mfma_f32_16x16x32_bf16 a[24:27], v[196:199], v[144:147], a[24:27]
ds_read_b64_tr_b16 v[226:227], v14 offset:5376
v_mfma_f32_16x16x32_bf16 a[28:31], v[196:199], v[152:155], a[28:31]
buffer_load_dwordx4 v6, s[64:67], s40 offen offset:1024 lds
v_mfma_f32_16x16x32_bf16 a[32:35], v[200:203], v[128:131], a[32:35]
v_mfma_f32_16x16x32_bf16 a[36:39], v[200:203], v[136:139], a[36:39]
ds_read_b64_tr_b16 v[228:229], v15 offset:288
v_mfma_f32_16x16x32_bf16 a[40:43], v[200:203], v[144:147], a[40:43]
ds_read_b64_tr_b16 v[230:231], v15 offset:5408
v_mfma_f32_16x16x32_bf16 a[44:47], v[200:203], v[152:155], a[44:47]
buffer_load_dwordx4 v7, s[64:67], s40 offen offset:2048 lds
v_mfma_f32_16x16x32_bf16 a[48:51], v[204:207], v[128:131], a[48:51]
v_mfma_f32_16x16x32_bf16 a[52:55], v[204:207], v[136:139], a[52:55]
ds_read_b64_tr_b16 v[192:193], v14 offset:10240
v_mfma_f32_16x16x32_bf16 a[56:59], v[204:207], v[144:147], a[56:59]
ds_read_b64_tr_b16 v[194:195], v14 offset:15360
v_mfma_f32_16x16x32_bf16 a[60:63], v[204:207], v[152:155], a[60:63]
s_waitcnt lgkmcnt(6)
buffer_load_dwordx4 v8, s[64:67], s40 offen offset:3072 lds
v_mfma_f32_16x16x32_bf16 a[64:67], v[208:211], v[128:131], a[64:67]
v_mfma_f32_16x16x32_bf16 a[68:71], v[208:211], v[136:139], a[68:71]
s_add_u32 m0, s44, 106496
ds_read_b64_tr_b16 v[196:197], v15 offset:10272
v_mfma_f32_16x16x32_bf16 a[72:75], v[208:211], v[144:147], a[72:75]
ds_read_b64_tr_b16 v[198:199], v15 offset:15392
v_mfma_f32_16x16x32_bf16 a[76:79], v[208:211], v[152:155], a[76:79]
buffer_load_dwordx4 v9, s[64:67], s40 offen lds
v_mfma_f32_16x16x32_bf16 a[80:83], v[212:215], v[128:131], a[80:83]
v_mfma_f32_16x16x32_bf16 a[84:87], v[212:215], v[136:139], a[84:87]
ds_read_b64_tr_b16 v[200:201], v14 offset:10304
v_mfma_f32_16x16x32_bf16 a[88:91], v[212:215], v[144:147], a[88:91]
s_add_u32 s40, s40, 81920
s_min_u32 s40, s40, s45
ds_read_b64_tr_b16 v[202:203], v14 offset:15424
v_mfma_f32_16x16x32_bf16 a[92:95], v[212:215], v[152:155], a[92:95]
v_mfma_f32_16x16x32_bf16 a[96:99], v[216:219], v[128:131], a[96:99]
v_mfma_f32_16x16x32_bf16 a[100:103], v[216:219], v[136:139], a[100:103]
ds_read_b64_tr_b16 v[204:205], v15 offset:10336
v_mfma_f32_16x16x32_bf16 a[104:107], v[216:219], v[144:147], a[104:107]
ds_read_b64_tr_b16 v[206:207], v15 offset:15456
v_mfma_f32_16x16x32_bf16 a[108:111], v[216:219], v[152:155], a[108:111]
buffer_load_dwordx4 v[96:99], v2, s[60:63], s41 offen offset:0
v_mfma_f32_16x16x32_bf16 a[112:115], v[220:223], v[128:131], a[112:115]
v_mfma_f32_16x16x32_bf16 a[116:119], v[220:223], v[136:139], a[116:119]
ds_read_b64_tr_b16 v[208:209], v14 offset:10368
v_mfma_f32_16x16x32_bf16 a[120:123], v[220:223], v[144:147], a[120:123]
ds_read_b64_tr_b16 v[210:211], v14 offset:15488
v_mfma_f32_16x16x32_bf16 a[124:127], v[220:223], v[152:155], a[124:127]
s_waitcnt lgkmcnt(6)
v_mfma_f32_16x16x32_bf16 a[128:131], v[224:227], v[128:131], a[128:131]
v_mfma_f32_16x16x32_bf16 a[132:135], v[224:227], v[136:139], a[132:135]
buffer_load_dwordx4 v[100:103], v2, s[60:63], s41 offen offset:1024
ds_read_b64_tr_b16 v[212:213], v15 offset:10400
v_mfma_f32_16x16x32_bf16 a[136:139], v[224:227], v[144:147], a[136:139]
ds_read_b64_tr_b16 v[214:215], v15 offset:15520
v_mfma_f32_16x16x32_bf16 a[140:143], v[224:227], v[152:155], a[140:143]
v_mfma_f32_16x16x32_bf16 a[144:147], v[228:231], v[128:131], a[144:147]
v_mfma_f32_16x16x32_bf16 a[148:151], v[228:231], v[136:139], a[148:151]
ds_read_b64_tr_b16 v[216:217], v14 offset:10432
v_mfma_f32_16x16x32_bf16 a[152:155], v[228:231], v[144:147], a[152:155]
ds_read_b64_tr_b16 v[218:219], v14 offset:15552
v_mfma_f32_16x16x32_bf16 a[156:159], v[228:231], v[152:155], a[156:159]
buffer_load_dwordx4 v[104:107], v3, s[60:63], s41 offen offset:0
v_mfma_f32_16x16x32_bf16 a[0:3], v[192:195], v[132:135], a[0:3]
v_mfma_f32_16x16x32_bf16 a[4:7], v[192:195], v[140:143], a[4:7]
ds_read_b64_tr_b16 v[220:221], v15 offset:10464
v_mfma_f32_16x16x32_bf16 a[8:11], v[192:195], v[148:151], a[8:11]
ds_read_b64_tr_b16 v[222:223], v15 offset:15584
v_mfma_f32_16x16x32_bf16 a[12:15], v[192:195], v[156:159], a[12:15]
v_mfma_f32_16x16x32_bf16 a[16:19], v[196:199], v[132:135], a[16:19]
v_mfma_f32_16x16x32_bf16 a[20:23], v[196:199], v[140:143], a[20:23]
buffer_load_dwordx4 v[108:111], v3, s[60:63], s41 offen offset:1024
ds_read_b64_tr_b16 v[224:225], v14 offset:10496
v_mfma_f32_16x16x32_bf16 a[24:27], v[196:199], v[148:151], a[24:27]
ds_read_b64_tr_b16 v[226:227], v14 offset:15616
v_mfma_f32_16x16x32_bf16 a[28:31], v[196:199], v[156:159], a[28:31]
s_waitcnt lgkmcnt(6)
v_mfma_f32_16x16x32_bf16 a[32:35], v[200:203], v[132:135], a[32:35]
v_mfma_f32_16x16x32_bf16 a[36:39], v[200:203], v[140:143], a[36:39]
ds_read_b64_tr_b16 v[228:229], v15 offset:10528
v_mfma_f32_16x16x32_bf16 a[40:43], v[200:203], v[148:151], a[40:43]
ds_read_b64_tr_b16 v[230:231], v15 offset:15648
v_mfma_f32_16x16x32_bf16 a[44:47], v[200:203], v[156:159], a[44:47]
buffer_load_dwordx4 v[112:115], v16, s[60:63], s41 offen offset:0
v_mfma_f32_16x16x32_bf16 a[48:51], v[204:207], v[132:135], a[48:51]
v_mfma_f32_16x16x32_bf16 a[52:55], v[204:207], v[140:143], a[52:55]
ds_read_b64_tr_b16 v[192:193], v14 offset:20480
v_mfma_f32_16x16x32_bf16 a[56:59], v[204:207], v[148:151], a[56:59]
ds_read_b64_tr_b16 v[194:195], v14 offset:25600
v_mfma_f32_16x16x32_bf16 a[60:63], v[204:207], v[156:159], a[60:63]
v_mfma_f32_16x16x32_bf16 a[64:67], v[208:211], v[132:135], a[64:67]
v_mfma_f32_16x16x32_bf16 a[68:71], v[208:211], v[140:143], a[68:71]
buffer_load_dwordx4 v[116:119], v16, s[60:63], s41 offen offset:1024
ds_read_b64_tr_b16 v[196:197], v15 offset:20512
v_mfma_f32_16x16x32_bf16 a[72:75], v[208:211], v[148:151], a[72:75]
ds_read_b64_tr_b16 v[198:199], v15 offset:25632
v_mfma_f32_16x16x32_bf16 a[76:79], v[208:211], v[156:159], a[76:79]
v_mfma_f32_16x16x32_bf16 a[80:83], v[212:215], v[132:135], a[80:83]
v_mfma_f32_16x16x32_bf16 a[84:87], v[212:215], v[140:143], a[84:87]
ds_read_b64_tr_b16 v[200:201], v14 offset:20544
v_mfma_f32_16x16x32_bf16 a[88:91], v[212:215], v[148:151], a[88:91]
ds_read_b64_tr_b16 v[202:203], v14 offset:25664
v_mfma_f32_16x16x32_bf16 a[92:95], v[212:215], v[156:159], a[92:95]
s_waitcnt lgkmcnt(6)
buffer_load_dwordx4 v[120:123], v17, s[60:63], s41 offen offset:0
v_mfma_f32_16x16x32_bf16 a[96:99], v[216:219], v[132:135], a[96:99]
v_mfma_f32_16x16x32_bf16 a[100:103], v[216:219], v[140:143], a[100:103]
ds_read_b64_tr_b16 v[204:205], v15 offset:20576
v_mfma_f32_16x16x32_bf16 a[104:107], v[216:219], v[148:151], a[104:107]
ds_read_b64_tr_b16 v[206:207], v15 offset:25696
v_mfma_f32_16x16x32_bf16 a[108:111], v[216:219], v[156:159], a[108:111]
v_mfma_f32_16x16x32_bf16 a[112:115], v[220:223], v[132:135], a[112:115]
v_mfma_f32_16x16x32_bf16 a[116:119], v[220:223], v[140:143], a[116:119]
buffer_load_dwordx4 v[124:127], v17, s[60:63], s41 offen offset:1024
ds_read_b64_tr_b16 v[208:209], v14 offset:20608
v_mfma_f32_16x16x32_bf16 a[120:123], v[220:223], v[148:151], a[120:123]
ds_read_b64_tr_b16 v[210:211], v14 offset:25728
v_mfma_f32_16x16x32_bf16 a[124:127], v[220:223], v[156:159], a[124:127]
v_mfma_f32_16x16x32_bf16 a[128:131], v[224:227], v[132:135], a[128:131]
v_mfma_f32_16x16x32_bf16 a[132:135], v[224:227], v[140:143], a[132:135]
ds_read_b64_tr_b16 v[212:213], v15 offset:20640
v_mfma_f32_16x16x32_bf16 a[136:139], v[224:227], v[148:151], a[136:139]
s_add_u32 s41, s41, 2048
ds_read_b64_tr_b16 v[214:215], v15 offset:25760
v_mfma_f32_16x16x32_bf16 a[140:143], v[224:227], v[156:159], a[140:143]
v_mfma_f32_16x16x32_bf16 a[144:147], v[228:231], v[132:135], a[144:147]
v_mfma_f32_16x16x32_bf16 a[148:151], v[228:231], v[140:143], a[148:151]
ds_read_b64_tr_b16 v[216:217], v14 offset:20672
v_mfma_f32_16x16x32_bf16 a[152:155], v[228:231], v[148:151], a[152:155]
ds_read_b64_tr_b16 v[218:219], v14 offset:25792
v_mfma_f32_16x16x32_bf16 a[156:159], v[228:231], v[156:159], a[156:159]
s_waitcnt vmcnt(26) lgkmcnt(6)
v_mfma_f32_16x16x32_bf16 a[0:3], v[192:195], v[160:163], a[0:3]
s_barrier
v_mfma_f32_16x16x32_bf16 a[4:7], v[192:195], v[168:171], a[4:7]
ds_read_b64_tr_b16 v[220:221], v15 offset:20704
v_mfma_f32_16x16x32_bf16 a[8:11], v[192:195], v[176:179], a[8:11]
s_add_u32 m0, s44, 122880
ds_read_b64_tr_b16 v[222:223], v15 offset:25824
v_mfma_f32_16x16x32_bf16 a[12:15], v[192:195], v[184:187], a[12:15]
buffer_load_dwordx4 v5, s[64:67], s40 offen offset:0 lds
v_mfma_f32_16x16x32_bf16 a[16:19], v[196:199], v[160:163], a[16:19]
v_mfma_f32_16x16x32_bf16 a[20:23], v[196:199], v[168:171], a[20:23]
ds_read_b64_tr_b16 v[224:225], v14 offset:20736
v_mfma_f32_16x16x32_bf16 a[24:27], v[196:199], v[176:179], a[24:27]
ds_read_b64_tr_b16 v[226:227], v14 offset:25856
v_mfma_f32_16x16x32_bf16 a[28:31], v[196:199], v[184:187], a[28:31]
buffer_load_dwordx4 v6, s[64:67], s40 offen offset:1024 lds
v_mfma_f32_16x16x32_bf16 a[32:35], v[200:203], v[160:163], a[32:35]
v_mfma_f32_16x16x32_bf16 a[36:39], v[200:203], v[168:171], a[36:39]
ds_read_b64_tr_b16 v[228:229], v15 offset:20768
v_mfma_f32_16x16x32_bf16 a[40:43], v[200:203], v[176:179], a[40:43]
ds_read_b64_tr_b16 v[230:231], v15 offset:25888
v_mfma_f32_16x16x32_bf16 a[44:47], v[200:203], v[184:187], a[44:47]
buffer_load_dwordx4 v7, s[64:67], s40 offen offset:2048 lds
v_mfma_f32_16x16x32_bf16 a[48:51], v[204:207], v[160:163], a[48:51]
v_mfma_f32_16x16x32_bf16 a[52:55], v[204:207], v[168:171], a[52:55]
ds_read_b64_tr_b16 v[192:193], v14 offset:30720
v_mfma_f32_16x16x32_bf16 a[56:59], v[204:207], v[176:179], a[56:59]
ds_read_b64_tr_b16 v[194:195], v14 offset:35840
v_mfma_f32_16x16x32_bf16 a[60:63], v[204:207], v[184:187], a[60:63]
s_waitcnt lgkmcnt(6)
buffer_load_dwordx4 v8, s[64:67], s40 offen offset:3072 lds
v_mfma_f32_16x16x32_bf16 a[64:67], v[208:211], v[160:163], a[64:67]
v_mfma_f32_16x16x32_bf16 a[68:71], v[208:211], v[168:171], a[68:71]
s_add_u32 m0, s44, 126976
ds_read_b64_tr_b16 v[196:197], v15 offset:30752
v_mfma_f32_16x16x32_bf16 a[72:75], v[208:211], v[176:179], a[72:75]
ds_read_b64_tr_b16 v[198:199], v15 offset:35872
v_mfma_f32_16x16x32_bf16 a[76:79], v[208:211], v[184:187], a[76:79]
buffer_load_dwordx4 v9, s[64:67], s40 offen lds
v_mfma_f32_16x16x32_bf16 a[80:83], v[212:215], v[160:163], a[80:83]
v_mfma_f32_16x16x32_bf16 a[84:87], v[212:215], v[168:171], a[84:87]
ds_read_b64_tr_b16 v[200:201], v14 offset:30784
v_mfma_f32_16x16x32_bf16 a[88:91], v[212:215], v[176:179], a[88:91]
s_add_u32 s40, s40, 81920
s_min_u32 s40, s40, s45
ds_read_b64_tr_b16 v[202:203], v14 offset:35904
v_mfma_f32_16x16x32_bf16 a[92:95], v[212:215], v[184:187], a[92:95]
v_mfma_f32_16x16x32_bf16 a[96:99], v[216:219], v[160:163], a[96:99]
v_mfma_f32_16x16x32_bf16 a[100:103], v[216:219], v[168:171], a[100:103]
ds_read_b64_tr_b16 v[204:205], v15 offset:30816
v_mfma_f32_16x16x32_bf16 a[104:107], v[216:219], v[176:179], a[104:107]
ds_read_b64_tr_b16 v[206:207], v15 offset:35936
v_mfma_f32_16x16x32_bf16 a[108:111], v[216:219], v[184:187], a[108:111]
buffer_load_dwordx4 v[128:131], v2, s[60:63], s41 offen offset:0
v_mfma_f32_16x16x32_bf16 a[112:115], v[220:223], v[160:163], a[112:115]
v_mfma_f32_16x16x32_bf16 a[116:119], v[220:223], v[168:171], a[116:119]
ds_read_b64_tr_b16 v[208:209], v14 offset:30848
v_mfma_f32_16x16x32_bf16 a[120:123], v[220:223], v[176:179], a[120:123]
ds_read_b64_tr_b16 v[210:211], v14 offset:35968
v_mfma_f32_16x16x32_bf16 a[124:127], v[220:223], v[184:187], a[124:127]
s_waitcnt lgkmcnt(6)
v_mfma_f32_16x16x32_bf16 a[128:131], v[224:227], v[160:163], a[128:131]
v_mfma_f32_16x16x32_bf16 a[132:135], v[224:227], v[168:171], a[132:135]
buffer_load_dwordx4 v[132:135], v2, s[60:63], s41 offen offset:1024
ds_read_b64_tr_b16 v[212:213], v15 offset:30880
v_mfma_f32_16x16x32_bf16 a[136:139], v[224:227], v[176:179], a[136:139]
ds_read_b64_tr_b16 v[214:215], v15 offset:36000
v_mfma_f32_16x16x32_bf16 a[140:143], v[224:227], v[184:187], a[140:143]
v_mfma_f32_16x16x32_bf16 a[144:147], v[228:231], v[160:163], a[144:147]
v_mfma_f32_16x16x32_bf16 a[148:151], v[228:231], v[168:171], a[148:151]
ds_read_b64_tr_b16 v[216:217], v14 offset:30912
v_mfma_f32_16x16x32_bf16 a[152:155], v[228:231], v[176:179], a[152:155]
ds_read_b64_tr_b16 v[218:219], v14 offset:36032
v_mfma_f32_16x16x32_bf16 a[156:159], v[228:231], v[184:187], a[156:159]
buffer_load_dwordx4 v[136:139], v3, s[60:63], s41 offen offset:0
v_mfma_f32_16x16x32_bf16 a[0:3], v[192:195], v[164:167], a[0:3]
v_mfma_f32_16x16x32_bf16 a[4:7], v[192:195], v[172:175], a[4:7]
ds_read_b64_tr_b16 v[220:221], v15 offset:30944
v_mfma_f32_16x16x32_bf16 a[8:11], v[192:195], v[180:183], a[8:11]
ds_read_b64_tr_b16 v[222:223], v15 offset:36064
v_mfma_f32_16x16x32_bf16 a[12:15], v[192:195], v[188:191], a[12:15]
v_mfma_f32_16x16x32_bf16 a[16:19], v[196:199], v[164:167], a[16:19]
v_mfma_f32_16x16x32_bf16 a[20:23], v[196:199], v[172:175], a[20:23]
buffer_load_dwordx4 v[140:143], v3, s[60:63], s41 offen offset:1024
ds_read_b64_tr_b16 v[224:225], v14 offset:30976
v_mfma_f32_16x16x32_bf16 a[24:27], v[196:199], v[180:183], a[24:27]
ds_read_b64_tr_b16 v[226:227], v14 offset:36096
v_mfma_f32_16x16x32_bf16 a[28:31], v[196:199], v[188:191], a[28:31]
s_waitcnt lgkmcnt(6)
v_mfma_f32_16x16x32_bf16 a[32:35], v[200:203], v[164:167], a[32:35]
v_mfma_f32_16x16x32_bf16 a[36:39], v[200:203], v[172:175], a[36:39]
ds_read_b64_tr_b16 v[228:229], v15 offset:31008
v_mfma_f32_16x16x32_bf16 a[40:43], v[200:203], v[180:183], a[40:43]
ds_read_b64_tr_b16 v[230:231], v15 offset:36128
v_mfma_f32_16x16x32_bf16 a[44:47], v[200:203], v[188:191], a[44:47]
buffer_load_dwordx4 v[144:147], v16, s[60:63], s41 offen offset:0
v_mfma_f32_16x16x32_bf16 a[48:51], v[204:207], v[164:167], a[48:51]
v_mfma_f32_16x16x32_bf16 a[52:55], v[204:207], v[172:175], a[52:55]
ds_read_b64_tr_b16 v[192:193], v10 offset:0
v_mfma_f32_16x16x32_bf16 a[56:59], v[204:207], v[180:183], a[56:59]
ds_read_b64_tr_b16 v[194:195], v10 offset:5120
v_mfma_f32_16x16x32_bf16 a[60:63], v[204:207], v[188:191], a[60:63]
v_mfma_f32_16x16x32_bf16 a[64:67], v[208:211], v[164:167], a[64:67]
v_mfma_f32_16x16x32_bf16 a[68:71], v[208:211], v[172:175], a[68:71]
buffer_load_dwordx4 v[148:151], v16, s[60:63], s41 offen offset:1024
ds_read_b64_tr_b16 v[196:197], v11 offset:32
v_mfma_f32_16x16x32_bf16 a[72:75], v[208:211], v[180:183], a[72:75]
ds_read_b64_tr_b16 v[198:199], v11 offset:5152
v_mfma_f32_16x16x32_bf16 a[76:79], v[208:211], v[188:191], a[76:79]
v_mfma_f32_16x16x32_bf16 a[80:83], v[212:215], v[164:167], a[80:83]
v_mfma_f32_16x16x32_bf16 a[84:87], v[212:215], v[172:175], a[84:87]
ds_read_b64_tr_b16 v[200:201], v10 offset:64
v_mfma_f32_16x16x32_bf16 a[88:91], v[212:215], v[180:183], a[88:91]
ds_read_b64_tr_b16 v[202:203], v10 offset:5184
v_mfma_f32_16x16x32_bf16 a[92:95], v[212:215], v[188:191], a[92:95]
s_waitcnt lgkmcnt(6)
buffer_load_dwordx4 v[152:155], v17, s[60:63], s41 offen offset:0
v_mfma_f32_16x16x32_bf16 a[96:99], v[216:219], v[164:167], a[96:99]
v_mfma_f32_16x16x32_bf16 a[100:103], v[216:219], v[172:175], a[100:103]
ds_read_b64_tr_b16 v[204:205], v11 offset:96
v_mfma_f32_16x16x32_bf16 a[104:107], v[216:219], v[180:183], a[104:107]
ds_read_b64_tr_b16 v[206:207], v11 offset:5216
v_mfma_f32_16x16x32_bf16 a[108:111], v[216:219], v[188:191], a[108:111]
v_mfma_f32_16x16x32_bf16 a[112:115], v[220:223], v[164:167], a[112:115]
v_mfma_f32_16x16x32_bf16 a[116:119], v[220:223], v[172:175], a[116:119]
buffer_load_dwordx4 v[156:159], v17, s[60:63], s41 offen offset:1024
ds_read_b64_tr_b16 v[208:209], v10 offset:128
v_mfma_f32_16x16x32_bf16 a[120:123], v[220:223], v[180:183], a[120:123]
ds_read_b64_tr_b16 v[210:211], v10 offset:5248
v_mfma_f32_16x16x32_bf16 a[124:127], v[220:223], v[188:191], a[124:127]
v_mfma_f32_16x16x32_bf16 a[128:131], v[224:227], v[164:167], a[128:131]
v_mfma_f32_16x16x32_bf16 a[132:135], v[224:227], v[172:175], a[132:135]
ds_read_b64_tr_b16 v[212:213], v11 offset:160
v_mfma_f32_16x16x32_bf16 a[136:139], v[224:227], v[180:183], a[136:139]
s_add_u32 s41, s41, 2048
ds_read_b64_tr_b16 v[214:215], v11 offset:5280
v_mfma_f32_16x16x32_bf16 a[140:143], v[224:227], v[188:191], a[140:143]
v_mfma_f32_16x16x32_bf16 a[144:147], v[228:231], v[164:167], a[144:147]
v_mfma_f32_16x16x32_bf16 a[148:151], v[228:231], v[172:175], a[148:151]
ds_read_b64_tr_b16 v[216:217], v10 offset:192
v_mfma_f32_16x16x32_bf16 a[152:155], v[228:231], v[180:183], a[152:155]
ds_read_b64_tr_b16 v[218:219], v10 offset:5312
v_mfma_f32_16x16x32_bf16 a[156:159], v[228:231], v[188:191], a[156:159]
s_sub_u32 s48, s48, 1
s_cmp_lg_u32 s48, 0
s_cbranch_scc1 K2_LOOP
K2_EXIT:
s_nop 7
v_accvgpr_read_b32 v20, a0
v_accvgpr_read_b32 v21, a1
v_accvgpr_read_b32 v22, a2
v_accvgpr_read_b32 v23, a3
v_accvgpr_read_b32 v24, a16
v_accvgpr_read_b32 v25, a17
v_accvgpr_read_b32 v26, a18
v_accvgpr_read_b32 v27, a19
v_cvt_pk_bf16_f32 v40, v20, v21
v_cvt_pk_bf16_f32 v41, v22, v23
v_cvt_pk_bf16_f32 v42, v24, v25
v_cvt_pk_bf16_f32 v43, v26, v27
s_add_u32 s51, s50, 0
buffer_store_dwordx4 v[40:43], v4, s[28:31], s51 offen
v_accvgpr_read_b32 v28, a32
v_accvgpr_read_b32 v29, a33
v_accvgpr_read_b32 v30, a34
v_accvgpr_read_b32 v31, a35
v_accvgpr_read_b32 v32, a48
v_accvgpr_read_b32 v33, a49
v_accvgpr_read_b32 v34, a50
v_accvgpr_read_b32 v35, a51
v_cvt_pk_bf16_f32 v44, v28, v29
v_cvt_pk_bf16_f32 v45, v30, v31
v_cvt_pk_bf16_f32 v46, v32, v33
v_cvt_pk_bf16_f32 v47, v34, v35
s_add_u32 s51, s50, 1024
buffer_store_dwordx4 v[44:47], v4, s[28:31], s51 offen
v_accvgpr_read_b32 v20, a64
v_accvgpr_read_b32 v21, a65
v_accvgpr_read_b32 v22, a66
v_accvgpr_read_b32 v23, a67
v_accvgpr_read_b32 v24, a80
v_accvgpr_read_b32 v25, a81
v_accvgpr_read_b32 v26, a82
v_accvgpr_read_b32 v27, a83
v_cvt_pk_bf16_f32 v48, v20, v21
v_cvt_pk_bf16_f32 v49, v22, v23
v_cvt_pk_bf16_f32 v50, v24, v25
v_cvt_pk_bf16_f32 v51, v26, v27
s_add_u32 s51, s50, 2048
buffer_store_dwordx4 v[48:51], v4, s[28:31], s51 offen
v_accvgpr_read_b32 v28, a96
v_accvgpr_read_b32 v29, a97
v_accvgpr_read_b32 v30, a98
v_accvgpr_read_b32 v31, a99
v_accvgpr_read_b32 v32, a112
v_accvgpr_read_b32 v33, a113
v_accvgpr_read_b32 v34, a114
v_accvgpr_read_b32 v35, a115
v_cvt_pk_bf16_f32 v52, v28, v29
v_cvt_pk_bf16_f32 v53, v30, v31
v_cvt_pk_bf16_f32 v54, v32, v33
v_cvt_pk_bf16_f32 v55, v34, v35
s_add_u32 s51, s50, 3072
buffer_store_dwordx4 v[52:55], v4, s[28:31], s51 offen
v_accvgpr_read_b32 v20, a128
v_accvgpr_read_b32 v21, a129
v_accvgpr_read_b32 v22, a130
v_accvgpr_read_b32 v23, a131
v_accvgpr_read_b32 v24, a144
v_accvgpr_read_b32 v25, a145
v_accvgpr_read_b32 v26, a146
v_accvgpr_read_b32 v27, a147
v_cvt_pk_bf16_f32 v40, v20, v21
v_cvt_pk_bf16_f32 v41, v22, v23
v_cvt_pk_bf16_f32 v42, v24, v25
v_cvt_pk_bf16_f32 v43, v26, v27
s_add_u32 s51, s50, 4096
buffer_store_dwordx4 v[40:43], v4, s[28:31], s51 offen
v_accvgpr_read_b32 v28, a4
v_accvgpr_read_b32 v29, a5
v_accvgpr_read_b32 v30, a6
v_accvgpr_read_b32 v31, a7
v_accvgpr_read_b32 v32, a20
v_accvgpr_read_b32 v33, a21
v_accvgpr_read_b32 v34, a22
v_accvgpr_read_b32 v35, a23
v_cvt_pk_bf16_f32 v44, v28, v29
v_cvt_pk_bf16_f32 v45, v30, v31
v_cvt_pk_bf16_f32 v46, v32, v33
v_cvt_pk_bf16_f32 v47, v34, v35
s_add_u32 s51, s50, 20480
buffer_store_dwordx4 v[44:47], v4, s[28:31], s51 offen
v_accvgpr_read_b32 v20, a36
v_accvgpr_read_b32 v21, a37
v_accvgpr_read_b32 v22, a38
v_accvgpr_read_b32 v23, a39
v_accvgpr_read_b32 v24, a52
v_accvgpr_read_b32 v25, a53
v_accvgpr_read_b32 v26, a54
v_accvgpr_read_b32 v27, a55
v_cvt_pk_bf16_f32 v48, v20, v21
v_cvt_pk_bf16_f32 v49, v22, v23
v_cvt_pk_bf16_f32 v50, v24, v25
v_cvt_pk_bf16_f32 v51, v26, v27
s_add_u32 s51, s50, 21504
buffer_store_dwordx4 v[48:51], v4, s[28:31], s51 offen
v_accvgpr_read_b32 v28, a68
v_accvgpr_read_b32 v29, a69
v_accvgpr_read_b32 v30, a70
v_accvgpr_read_b32 v31, a71
v_accvgpr_read_b32 v32, a84
v_accvgpr_read_b32 v33, a85
v_accvgpr_read_b32 v34, a86
v_accvgpr_read_b32 v35, a87
v_cvt_pk_bf16_f32 v52, v28, v29
v_cvt_pk_bf16_f32 v53, v30, v31
v_cvt_pk_bf16_f32 v54, v32, v33
v_cvt_pk_bf16_f32 v55, v34, v35
s_add_u32 s51, s50, 22528
buffer_store_dwordx4 v[52:55], v4, s[28:31], s51 offen
v_accvgpr_read_b32 v20, a100
v_accvgpr_read_b32 v21, a101
v_accvgpr_read_b32 v22, a102
v_accvgpr_read_b32 v23, a103
v_accvgpr_read_b32 v24, a116
v_accvgpr_read_b32 v25, a117
v_accvgpr_read_b32 v26, a118
v_accvgpr_read_b32 v27, a119
v_cvt_pk_bf16_f32 v40, v20, v21
v_cvt_pk_bf16_f32 v41, v22, v23
v_cvt_pk_bf16_f32 v42, v24, v25
v_cvt_pk_bf16_f32 v43, v26, v27
s_add_u32 s51, s50, 23552
buffer_store_dwordx4 v[40:43], v4, s[28:31], s51 offen
v_accvgpr_read_b32 v28, a132
v_accvgpr_read_b32 v29, a133
v_accvgpr_read_b32 v30, a134
v_accvgpr_read_b32 v31, a135
v_accvgpr_read_b32 v32, a148
v_accvgpr_read_b32 v33, a149
v_accvgpr_read_b32 v34, a150
v_accvgpr_read_b32 v35, a151
v_cvt_pk_bf16_f32 v44, v28, v29
v_cvt_pk_bf16_f32 v45, v30, v31
v_cvt_pk_bf16_f32 v46, v32, v33
v_cvt_pk_bf16_f32 v47, v34, v35
s_add_u32 s51, s50, 24576
buffer_store_dwordx4 v[44:47], v4, s[28:31], s51 offen
v_accvgpr_read_b32 v20, a8
v_accvgpr_read_b32 v21, a9
v_accvgpr_read_b32 v22, a10
v_accvgpr_read_b32 v23, a11
v_accvgpr_read_b32 v24, a24
v_accvgpr_read_b32 v25, a25
v_accvgpr_read_b32 v26, a26
v_accvgpr_read_b32 v27, a27
v_cvt_pk_bf16_f32 v48, v20, v21
v_cvt_pk_bf16_f32 v49, v22, v23
v_cvt_pk_bf16_f32 v50, v24, v25
v_cvt_pk_bf16_f32 v51, v26, v27
s_add_u32 s51, s50, 40960
buffer_store_dwordx4 v[48:51], v4, s[28:31], s51 offen
v_accvgpr_read_b32 v28, a40
v_accvgpr_read_b32 v29, a41
v_accvgpr_read_b32 v30, a42
v_accvgpr_read_b32 v31, a43
v_accvgpr_read_b32 v32, a56
v_accvgpr_read_b32 v33, a57
v_accvgpr_read_b32 v34, a58
v_accvgpr_read_b32 v35, a59
v_cvt_pk_bf16_f32 v52, v28, v29
v_cvt_pk_bf16_f32 v53, v30, v31
v_cvt_pk_bf16_f32 v54, v32, v33
v_cvt_pk_bf16_f32 v55, v34, v35
s_add_u32 s51, s50, 41984
buffer_store_dwordx4 v[52:55], v4, s[28:31], s51 offen
v_accvgpr_read_b32 v20, a72
v_accvgpr_read_b32 v21, a73
v_accvgpr_read_b32 v22, a74
v_accvgpr_read_b32 v23, a75
v_accvgpr_read_b32 v24, a88
v_accvgpr_read_b32 v25, a89
v_accvgpr_read_b32 v26, a90
v_accvgpr_read_b32 v27, a91
v_cvt_pk_bf16_f32 v40, v20, v21
v_cvt_pk_bf16_f32 v41, v22, v23
v_cvt_pk_bf16_f32 v42, v24, v25
v_cvt_pk_bf16_f32 v43, v26, v27
s_add_u32 s51, s50, 43008
buffer_store_dwordx4 v[40:43], v4, s[28:31], s51 offen
v_accvgpr_read_b32 v28, a104
v_accvgpr_read_b32 v29, a105
v_accvgpr_read_b32 v30, a106
v_accvgpr_read_b32 v31, a107
v_accvgpr_read_b32 v32, a120
v_accvgpr_read_b32 v33, a121
v_accvgpr_read_b32 v34, a122
v_accvgpr_read_b32 v35, a123
v_cvt_pk_bf16_f32 v44, v28, v29
v_cvt_pk_bf16_f32 v45, v30, v31
v_cvt_pk_bf16_f32 v46, v32, v33
v_cvt_pk_bf16_f32 v47, v34, v35
s_add_u32 s51, s50, 44032
buffer_store_dwordx4 v[44:47], v4, s[28:31], s51 offen
v_accvgpr_read_b32 v20, a136
v_accvgpr_read_b32 v21, a137
v_accvgpr_read_b32 v22, a138
v_accvgpr_read_b32 v23, a139
v_accvgpr_read_b32 v24, a152
v_accvgpr_read_b32 v25, a153
v_accvgpr_read_b32 v26, a154
v_accvgpr_read_b32 v27, a155
v_cvt_pk_bf16_f32 v48, v20, v21
v_cvt_pk_bf16_f32 v49, v22, v23
v_cvt_pk_bf16_f32 v50, v24, v25
v_cvt_pk_bf16_f32 v51, v26, v27
s_add_u32 s51, s50, 45056
buffer_store_dwordx4 v[48:51], v4, s[28:31], s51 offen
v_accvgpr_read_b32 v28, a12
v_accvgpr_read_b32 v29, a13
v_accvgpr_read_b32 v30, a14
v_accvgpr_read_b32 v31, a15
v_accvgpr_read_b32 v32, a28
v_accvgpr_read_b32 v33, a29
v_accvgpr_read_b32 v34, a30
v_accvgpr_read_b32 v35, a31
v_cvt_pk_bf16_f32 v52, v28, v29
v_cvt_pk_bf16_f32 v53, v30, v31
v_cvt_pk_bf16_f32 v54, v32, v33
v_cvt_pk_bf16_f32 v55, v34, v35
s_add_u32 s51, s50, 61440
buffer_store_dwordx4 v[52:55], v4, s[28:31], s51 offen
v_accvgpr_read_b32 v20, a44
v_accvgpr_read_b32 v21, a45
v_accvgpr_read_b32 v22, a46
v_accvgpr_read_b32 v23, a47
v_accvgpr_read_b32 v24, a60
v_accvgpr_read_b32 v25, a61
v_accvgpr_read_b32 v26, a62
v_accvgpr_read_b32 v27, a63
v_cvt_pk_bf16_f32 v40, v20, v21
v_cvt_pk_bf16_f32 v41, v22, v23
v_cvt_pk_bf16_f32 v42, v24, v25
v_cvt_pk_bf16_f32 v43, v26, v27
s_add_u32 s51, s50, 62464
buffer_store_dwordx4 v[40:43], v4, s[28:31], s51 offen
v_accvgpr_read_b32 v28, a76
v_accvgpr_read_b32 v29, a77
v_accvgpr_read_b32 v30, a78
v_accvgpr_read_b32 v31, a79
v_accvgpr_read_b32 v32, a92
v_accvgpr_read_b32 v33, a93
v_accvgpr_read_b32 v34, a94
v_accvgpr_read_b32 v35, a95
v_cvt_pk_bf16_f32 v44, v28, v29
v_cvt_pk_bf16_f32 v45, v30, v31
v_cvt_pk_bf16_f32 v46, v32, v33
v_cvt_pk_bf16_f32 v47, v34, v35
s_add_u32 s51, s50, 63488
buffer_store_dwordx4 v[44:47], v4, s[28:31], s51 offen
v_accvgpr_read_b32 v20, a108
v_accvgpr_read_b32 v21, a109
v_accvgpr_read_b32 v22, a110
v_accvgpr_read_b32 v23, a111
v_accvgpr_read_b32 v24, a124
v_accvgpr_read_b32 v25, a125
v_accvgpr_read_b32 v26, a126
v_accvgpr_read_b32 v27, a127
v_cvt_pk_bf16_f32 v48, v20, v21
v_cvt_pk_bf16_f32 v49, v22, v23
v_cvt_pk_bf16_f32 v50, v24, v25
v_cvt_pk_bf16_f32 v51, v26, v27
s_add_u32 s51, s50, 64512
buffer_store_dwordx4 v[48:51], v4, s[28:31], s51 offen
v_accvgpr_read_b32 v28, a140
v_accvgpr_read_b32 v29, a141
v_accvgpr_read_b32 v30, a142
v_accvgpr_read_b32 v31, a143
v_accvgpr_read_b32 v32, a156
v_accvgpr_read_b32 v33, a157
v_accvgpr_read_b32 v34, a158
v_accvgpr_read_b32 v35, a159
v_cvt_pk_bf16_f32 v52, v28, v29
v_cvt_pk_bf16_f32 v53, v30, v31
v_cvt_pk_bf16_f32 v54, v32, v33
v_cvt_pk_bf16_f32 v55, v34, v35
s_add_u32 s51, s50, 65536
buffer_store_dwordx4 v[52:55], v4, s[28:31], s51 offen
s_waitcnt vmcnt(0)
K2_DONE:
s_endpgm
.section .rodata,"a"
.p2align 6
.amdhsa_kernel oproj_kernel
  .amdhsa_next_free_vgpr 416
  .amdhsa_next_free_sgpr 100
  .amdhsa_accum_offset 256
  .amdhsa_group_segment_fixed_size 0
  .amdhsa_kernarg_size 104
  .amdhsa_user_sgpr_count 2
  .amdhsa_user_sgpr_kernarg_segment_ptr 1
  .amdhsa_system_sgpr_workgroup_id_x 1
.end_amdhsa_kernel
.text
.globl recurrent_scan__mha_block_cached__dense_activation_squared_relu__prompt_kernel
.p2align 8
.type recurrent_scan__mha_block_cached__dense_activation_squared_relu__prompt_kernel,@function
recurrent_scan__mha_block_cached__dense_activation_squared_relu__prompt_kernel:
    s_cmp_ge_u32 s2, 640
    s_cbranch_scc1 K3_DONE
    s_load_dwordx2 s[4:5], s[0:1], 0
    s_load_dwordx2 s[6:7], s[0:1], 72
    s_load_dwordx2 s[24:25], s[0:1], 80
    s_load_dwordx2 s[28:29], s[0:1], 96
    v_lshrrev_b32 v2, 6, v0
    v_and_b32 v1, 63, v0
    s_nop 0
    v_readfirstlane_b32 s30, v2
    s_lshl_b32 s3, s2, 2
    s_add_u32 s3, s3, s30
    s_mov_b32 s16, 0xccccccd
    s_mul_hi_u32 s17, s3, s16
    s_mul_i32 s18, s17, 20
    s_sub_u32 s18, s3, s18
    v_lshlrev_b32 v3, 4, v1
    s_lshl_b32 s19, s3, 10
    v_add_u32 v3, s19, v3
    v_and_b32 v4, 15, v1
    v_lshrrev_b32 v5, 4, v1
    s_lshl_b32 s17, s17, 4
    v_add_u32 v4, s17, v4
    v_mul_u32_u24 v4, 1280, v4
    s_lshl_b32 s18, s18, 6
    v_lshl_add_u32 v5, v5, 3, s18
    v_add_u32 v4, v4, v5
    s_waitcnt lgkmcnt(0)
    s_mov_b32 s8, s4
    s_mov_b32 s9, s5
    s_mov_b32 s10, 2621440
    s_mov_b32 s11, 0x00020000
    s_mov_b32 s12, s6
    s_mov_b32 s13, s7
    s_mov_b32 s14, 1280
    s_mov_b32 s15, 0x00020000
    s_mov_b32 s16, s24
    s_mov_b32 s17, s25
    s_mov_b32 s18, 2621440
    s_mov_b32 s19, 0x00020000
    s_add_u32 s20, s28, 50331648
    s_addc_u32 s21, s29, 0
    s_mov_b32 s22, 20971520
    s_mov_b32 s23, 0x00020000
    s_mov_b32 s3, 0
    buffer_load_dwordx4 v[16:19], v3, s[20:23], s3 offen
    s_mov_b32 s3, 2621440
    buffer_load_dwordx4 v[20:23], v3, s[20:23], s3 offen
    s_mov_b32 s3, 5242880
    buffer_load_dwordx4 v[24:27], v3, s[20:23], s3 offen
    s_mov_b32 s3, 7864320
    buffer_load_dwordx4 v[28:31], v3, s[20:23], s3 offen
    s_mov_b32 s3, 10485760
    buffer_load_dwordx4 v[32:35], v3, s[20:23], s3 offen
    s_mov_b32 s3, 13107200
    buffer_load_dwordx4 v[36:39], v3, s[20:23], s3 offen
    s_mov_b32 s3, 15728640
    buffer_load_dwordx4 v[40:43], v3, s[20:23], s3 offen
    s_mov_b32 s3, 18350080
    buffer_load_dwordx4 v[44:47], v3, s[20:23], s3 offen
    buffer_load_dwordx2 v[8:9], v4, s[8:11], 0 offen
    buffer_load_dwordx2 v[10:11], v4, s[8:11], 0 offen offset:32
    buffer_load_dwordx2 v[12:13], v5, s[12:15], 0 offen
    buffer_load_dwordx2 v[14:15], v5, s[12:15], 0 offen offset:32
    s_waitcnt vmcnt(0)
    v_lshlrev_b32 v48, 16, v16
    v_and_b32 v49, 0xffff0000, v16
    v_lshlrev_b32 v50, 16, v17
    v_and_b32 v51, 0xffff0000, v17
    v_lshlrev_b32 v52, 16, v18
    v_and_b32 v53, 0xffff0000, v18
    v_lshlrev_b32 v54, 16, v19
    v_and_b32 v55, 0xffff0000, v19
    v_lshlrev_b32 v64, 16, v20
    v_and_b32 v65, 0xffff0000, v20
    v_add_f32 v48, v48, v64
    v_add_f32 v49, v49, v65
    v_lshlrev_b32 v64, 16, v21
    v_and_b32 v65, 0xffff0000, v21
    v_add_f32 v50, v50, v64
    v_add_f32 v51, v51, v65
    v_lshlrev_b32 v64, 16, v22
    v_and_b32 v65, 0xffff0000, v22
    v_add_f32 v52, v52, v64
    v_add_f32 v53, v53, v65
    v_lshlrev_b32 v64, 16, v23
    v_and_b32 v65, 0xffff0000, v23
    v_add_f32 v54, v54, v64
    v_add_f32 v55, v55, v65
    v_lshlrev_b32 v64, 16, v24
    v_and_b32 v65, 0xffff0000, v24
    v_add_f32 v48, v48, v64
    v_add_f32 v49, v49, v65
    v_lshlrev_b32 v64, 16, v25
    v_and_b32 v65, 0xffff0000, v25
    v_add_f32 v50, v50, v64
    v_add_f32 v51, v51, v65
    v_lshlrev_b32 v64, 16, v26
    v_and_b32 v65, 0xffff0000, v26
    v_add_f32 v52, v52, v64
    v_add_f32 v53, v53, v65
    v_lshlrev_b32 v64, 16, v27
    v_and_b32 v65, 0xffff0000, v27
    v_add_f32 v54, v54, v64
    v_add_f32 v55, v55, v65
    v_lshlrev_b32 v64, 16, v28
    v_and_b32 v65, 0xffff0000, v28
    v_add_f32 v48, v48, v64
    v_add_f32 v49, v49, v65
    v_lshlrev_b32 v64, 16, v29
    v_and_b32 v65, 0xffff0000, v29
    v_add_f32 v50, v50, v64
    v_add_f32 v51, v51, v65
    v_lshlrev_b32 v64, 16, v30
    v_and_b32 v65, 0xffff0000, v30
    v_add_f32 v52, v52, v64
    v_add_f32 v53, v53, v65
    v_lshlrev_b32 v64, 16, v31
    v_and_b32 v65, 0xffff0000, v31
    v_add_f32 v54, v54, v64
    v_add_f32 v55, v55, v65
    v_lshlrev_b32 v64, 16, v32
    v_and_b32 v65, 0xffff0000, v32
    v_add_f32 v48, v48, v64
    v_add_f32 v49, v49, v65
    v_lshlrev_b32 v64, 16, v33
    v_and_b32 v65, 0xffff0000, v33
    v_add_f32 v50, v50, v64
    v_add_f32 v51, v51, v65
    v_lshlrev_b32 v64, 16, v34
    v_and_b32 v65, 0xffff0000, v34
    v_add_f32 v52, v52, v64
    v_add_f32 v53, v53, v65
    v_lshlrev_b32 v64, 16, v35
    v_and_b32 v65, 0xffff0000, v35
    v_add_f32 v54, v54, v64
    v_add_f32 v55, v55, v65
    v_lshlrev_b32 v64, 16, v36
    v_and_b32 v65, 0xffff0000, v36
    v_add_f32 v48, v48, v64
    v_add_f32 v49, v49, v65
    v_lshlrev_b32 v64, 16, v37
    v_and_b32 v65, 0xffff0000, v37
    v_add_f32 v50, v50, v64
    v_add_f32 v51, v51, v65
    v_lshlrev_b32 v64, 16, v38
    v_and_b32 v65, 0xffff0000, v38
    v_add_f32 v52, v52, v64
    v_add_f32 v53, v53, v65
    v_lshlrev_b32 v64, 16, v39
    v_and_b32 v65, 0xffff0000, v39
    v_add_f32 v54, v54, v64
    v_add_f32 v55, v55, v65
    v_lshlrev_b32 v56, 16, v40
    v_and_b32 v57, 0xffff0000, v40
    v_lshlrev_b32 v58, 16, v41
    v_and_b32 v59, 0xffff0000, v41
    v_lshlrev_b32 v60, 16, v42
    v_and_b32 v61, 0xffff0000, v42
    v_lshlrev_b32 v62, 16, v43
    v_and_b32 v63, 0xffff0000, v43
    v_lshlrev_b32 v64, 16, v44
    v_and_b32 v65, 0xffff0000, v44
    v_add_f32 v56, v56, v64
    v_add_f32 v57, v57, v65
    v_lshlrev_b32 v64, 16, v45
    v_and_b32 v65, 0xffff0000, v45
    v_add_f32 v58, v58, v64
    v_add_f32 v59, v59, v65
    v_lshlrev_b32 v64, 16, v46
    v_and_b32 v65, 0xffff0000, v46
    v_add_f32 v60, v60, v64
    v_add_f32 v61, v61, v65
    v_lshlrev_b32 v64, 16, v47
    v_and_b32 v65, 0xffff0000, v47
    v_add_f32 v62, v62, v64
    v_add_f32 v63, v63, v65
    v_lshlrev_b32 v64, 16, v12
    v_and_b32 v65, 0xffff0000, v12
    v_add_f32 v56, v56, v64
    v_add_f32 v57, v57, v65
    v_lshlrev_b32 v64, 16, v13
    v_and_b32 v65, 0xffff0000, v13
    v_add_f32 v58, v58, v64
    v_add_f32 v59, v59, v65
    v_lshlrev_b32 v64, 16, v14
    v_and_b32 v65, 0xffff0000, v14
    v_add_f32 v60, v60, v64
    v_add_f32 v61, v61, v65
    v_lshlrev_b32 v64, 16, v15
    v_and_b32 v65, 0xffff0000, v15
    v_add_f32 v62, v62, v64
    v_add_f32 v63, v63, v65
    v_lshlrev_b32 v72, 16, v8
    v_and_b32 v73, 0xffff0000, v8
    v_lshlrev_b32 v74, 16, v9
    v_and_b32 v75, 0xffff0000, v9
    v_lshlrev_b32 v76, 16, v10
    v_and_b32 v77, 0xffff0000, v10
    v_lshlrev_b32 v78, 16, v11
    v_and_b32 v79, 0xffff0000, v11
    s_mov_b32 s3, 0xbfb8aa3b
    v_mul_f32 v64, s3, v56
    v_mul_f32 v65, s3, v57
    v_mul_f32 v66, s3, v58
    v_mul_f32 v67, s3, v59
    v_mul_f32 v68, s3, v60
    v_mul_f32 v69, s3, v61
    v_mul_f32 v70, s3, v62
    v_mul_f32 v71, s3, v63
    v_exp_f32 v64, v64
    v_exp_f32 v65, v65
    v_exp_f32 v66, v66
    v_exp_f32 v67, v67
    v_exp_f32 v68, v68
    v_exp_f32 v69, v69
    v_exp_f32 v70, v70
    v_exp_f32 v71, v71
    s_nop 0
    v_add_f32 v64, 1.0, v64
    v_add_f32 v65, 1.0, v65
    v_add_f32 v66, 1.0, v66
    v_add_f32 v67, 1.0, v67
    v_add_f32 v68, 1.0, v68
    v_add_f32 v69, 1.0, v69
    v_add_f32 v70, 1.0, v70
    v_add_f32 v71, 1.0, v71
    v_rcp_f32 v64, v64
    v_rcp_f32 v65, v65
    v_rcp_f32 v66, v66
    v_rcp_f32 v67, v67
    v_rcp_f32 v68, v68
    v_rcp_f32 v69, v69
    v_rcp_f32 v70, v70
    v_rcp_f32 v71, v71
    s_nop 0
    v_mul_f32 v56, v56, v64
    v_mul_f32 v57, v57, v65
    v_mul_f32 v58, v58, v66
    v_mul_f32 v59, v59, v67
    v_mul_f32 v60, v60, v68
    v_mul_f32 v61, v61, v69
    v_mul_f32 v62, v62, v70
    v_mul_f32 v63, v63, v71
    v_fmac_f32 v72, v48, v56
    v_fmac_f32 v73, v49, v57
    v_fmac_f32 v74, v50, v58
    v_fmac_f32 v75, v51, v59
    v_fmac_f32 v76, v52, v60
    v_fmac_f32 v77, v53, v61
    v_fmac_f32 v78, v54, v62
    v_fmac_f32 v79, v55, v63
    v_cvt_pk_bf16_f32 v8, v72, v73
    v_cvt_pk_bf16_f32 v9, v74, v75
    v_cvt_pk_bf16_f32 v10, v76, v77
    v_cvt_pk_bf16_f32 v11, v78, v79
    buffer_store_dwordx2 v[8:9], v4, s[16:19], 0 offen
    buffer_store_dwordx2 v[10:11], v4, s[16:19], 0 offen offset:32
K3_DONE:
    s_endpgm
.section .rodata,"a"
.p2align 6
.amdhsa_kernel recurrent_scan__mha_block_cached__dense_activation_squared_relu__prompt_kernel
  .amdhsa_next_free_vgpr 80
  .amdhsa_next_free_sgpr 100
  .amdhsa_accum_offset 80
  .amdhsa_group_segment_fixed_size 0
  .amdhsa_kernarg_size 104
  .amdhsa_user_sgpr_count 2
  .amdhsa_user_sgpr_kernarg_segment_ptr 1
  .amdhsa_system_sgpr_workgroup_id_x 1
.end_amdhsa_kernel
.text
```
